```python
import torch

def _softmax(x, axis=-1):
    return torch.softmax(x, dim=axis)
def _gelu(x):
    return torch.nn.functional.gelu(x, approximate="tanh")
def _silu(x):
    return torch.nn.functional.silu(x)
def _sigmoid(x):
    return torch.sigmoid(x)
def _layernorm(x, axis=-1, eps=1e-5):
    m = x.mean(dim=axis, keepdim=True)
    v = x.var(dim=axis, keepdim=True, unbiased=False)
    return (x - m) / torch.sqrt(v + eps)
def _scatter_add(tgt, idx, src, axis=0):
    return tgt.clone().index_add_(axis, idx, src)
def _segment_sum(src, seg, n):
    out = torch.zeros((n,) + src.shape[1:], dtype=src.dtype)
    return out.index_add_(0, seg, src)
def _pad(x, pw):
    flat = tuple(v for pair in reversed(pw) for v in pair)
    return torch.nn.functional.pad(x, flat)

kernel_name = 'standalone__modern_conv_block_slak__vision'

def setup_inputs():

    _w = (lambda a: (lambda t: t.to(torch.bfloat16) if t.is_floating_point() else t)(torch.as_tensor(a)))
    H = W = 512
    C = 96
    K = 3
    return {
        "x": _w((lambda *s: torch.randn(*s, dtype=torch.bfloat16) * 0.05)(1, H, W, C)),
        "dw": _w((lambda *s: torch.randn(*s, dtype=torch.bfloat16) * 0.05)(K, K, C)),
        "w1": _w((lambda *s: torch.randn(*s, dtype=torch.bfloat16) * 0.05)(C, 4 * C)),
        "w2": _w((lambda *s: torch.randn(*s, dtype=torch.bfloat16) * 0.05)(4 * C, C)),
        "grn_g": _w((lambda *s: torch.randn(*s, dtype=torch.bfloat16) * 0.05)(4 * C)),
        "grn_b": _w((lambda *s: torch.randn(*s, dtype=torch.bfloat16) * 0.05)(4 * C)),
    }

def reference(x, dw, w1, w2, grn_g, grn_b):
    B, H, W, C = x.shape
    K = dw.shape[0]
    pad = K // 2
    xp = _pad(x, ((0,0),(pad,pad),(pad,pad),(0,0)))
    out = torch.zeros_like(x)
    for i in range(K):
        for j in range(K):
            out = out + xp[:, i:i+H, j:j+W, :] * dw[i, j][None, None, None, :]
    h = _layernorm(out, axis=-1)
    h = _gelu(h @ w1)
    gx = torch.sqrt((h * h).sum(axis=(1, 2), keepdims=True) + 1e-6)
    nx = gx / (gx.mean(axis=-1, keepdims=True) + 1e-6)
    h = grn_g[None, None, None, :] * (h * nx) + grn_b[None, None, None, :] + h
    return x + h @ w2
```

```asm
; @launch grid=(256,1,1) block=(512,1,1) lds=163840
.amdgcn_target "amdgcn-amd-amdhsa--gfx950"
.text
.globl standalone__modern_conv_block_slak__vision_kernel
.p2align 8
.type standalone__modern_conv_block_slak__vision_kernel,@function
standalone__modern_conv_block_slak__vision_kernel:
s_cmp_ge_u32 s2, 256
s_cbranch_scc1 L_end
s_load_dwordx16 s[48:63], s[0:1], 0
s_load_dwordx2 s[64:65], s[0:1], 64
v_and_b32 v1, 63, v0
v_lshrrev_b32 v15, 6, v0
v_lshlrev_b32 v2, 4, v1
v_readfirstlane_b32 s32, v15
s_getpc_b64 s[66:67]
L_pc:
s_nop 2
s_cmp_lg_u32 s32, 0
s_cbranch_scc1 L_nocpf
s_bfe_u32 s44, s2, 0x30003
s_mul_i32 s44, s44, 5248
s_add_u32 s44, s44, 256
v_lshlrev_b32 v226, 7, v1
v_min_u32 v226, 5120, v226
v_add_u32 v226, s44, v226
v_min_u32 v226, 41228, v226
v_mov_b32 v227, s67
v_add_co_u32 v226, vcc, s66, v226
s_nop 1
v_addc_co_u32 v227, vcc, 0, v227, vcc
global_load_dword v255, v[226:227], off
L_nocpf:
v_add_u32 v3, 0x10000, v2
v_mov_b32 v6, 1
v_lshrrev_b32 v14, 5, v1
s_mov_b32 s3, s2
s_and_b32 s33, s3, 15
s_lshl_b32 s33, s33, 5
s_lshr_b32 s34, s3, 4
s_lshl_b32 s34, s34, 5
s_and_b32 s41, s2, 7
s_mov_b32 s35, 104
s_mov_b32 s43, 0
s_lshl_b32 s40, s32, 10
s_add_u32 s39, s40, 8192
s_cmp_lt_u32 s32, 5
s_cselect_b32 s39, s39, 73728
s_lshl_b32 s44, s34, 9
s_add_u32 s44, s44, s33
s_sub_u32 s44, s44, 513
s_mul_i32 s37, s44, 192
v_and_b32 v250, 15, v1
v_mul_u32_u24 v250, 12, v250
v_bfe_u32 v251, v1, 4, 1
v_lshlrev_b32 v251, 1, v251
v_add_u32 v251, v251, v14
v_mul_u32_u24 v251, 3072, v251
v_add_u32 v250, v250, v251
s_mul_i32 s44, s32, 3
s_add_u32 s44, s44, 0
s_lshr_b32 s45, s44, 3
s_mul_i32 s45, s45, 24576
s_and_b32 s46, s44, 1
s_mul_i32 s46, s46, 12288
s_add_u32 s45, s45, s46
s_bfe_u32 s46, s44, 0x20001
s_mul_i32 s46, s46, 192
s_add_u32 s24, s45, s46
s_mul_i32 s44, s32, 3
s_add_u32 s44, s44, 1
s_lshr_b32 s45, s44, 3
s_mul_i32 s45, s45, 24576
s_and_b32 s46, s44, 1
s_mul_i32 s46, s46, 12288
s_add_u32 s45, s45, s46
s_bfe_u32 s46, s44, 0x20001
s_mul_i32 s46, s46, 192
s_add_u32 s25, s45, s46
s_mul_i32 s44, s32, 3
s_add_u32 s44, s44, 2
s_lshr_b32 s45, s44, 3
s_mul_i32 s45, s45, 24576
s_and_b32 s46, s44, 1
s_mul_i32 s46, s46, 12288
s_add_u32 s45, s45, s46
s_bfe_u32 s46, s44, 0x20001
s_mul_i32 s46, s46, 192
s_add_u32 s26, s45, s46
s_waitcnt lgkmcnt(0)
s_mov_b32 s16, s50
s_and_b32 s17, s51, 0xffff
s_mov_b32 s18, 1728
s_mov_b32 s19, 0x20000
s_mov_b32 s4, s48
s_and_b32 s5, s49, 0xffff
s_mov_b32 s6, 50331648
s_mov_b32 s7, 0x20000
s_mov_b32 s12, s52
s_and_b32 s13, s53, 0xffff
s_mov_b32 s14, 73728
s_mov_b32 s15, 0x20000
s_mov_b32 m0, 156672
s_nop 0
buffer_load_dwordx4 v2, s[16:19], 0 offen offset:0 lds
s_mov_b32 m0, 156672
s_nop 0
buffer_load_dwordx4 v2, s[16:19], 0 offen offset:1024 lds
buffer_load_dwordx3 v[16:18], v250, s[12:15], s24 offen offset:0
buffer_load_dwordx3 v[20:22], v250, s[12:15], s24 offen offset:768
buffer_load_dwordx3 v[24:26], v250, s[12:15], s24 offen offset:1536
buffer_load_dwordx3 v[28:30], v250, s[12:15], s24 offen offset:2304
buffer_load_dwordx3 v[32:34], v250, s[12:15], s25 offen offset:0
buffer_load_dwordx3 v[36:38], v250, s[12:15], s25 offen offset:768
buffer_load_dwordx3 v[136:138], v250, s[12:15], s25 offen offset:1536
buffer_load_dwordx3 v[140:142], v250, s[12:15], s25 offen offset:2304
buffer_load_dwordx3 v[144:146], v250, s[12:15], s26 offen offset:0
buffer_load_dwordx3 v[148:150], v250, s[12:15], s26 offen offset:768
buffer_load_dwordx3 v[152:154], v250, s[12:15], s26 offen offset:1536
buffer_load_dwordx3 v[156:158], v250, s[12:15], s26 offen offset:2304
s_lshl_b32 s44, s32, 6
s_add_u32 s44, s44, 0
v_add_u32 v217, s44, v1
v_cmp_le_u32 vcc, 416, v217
s_nop 1
v_cndmask_b32 v218, 0, 1, vcc
v_mul_u32_u24 v219, 416, v218
v_sub_u32 v219, v217, v219
v_mul_u32_u24 v220, 5462, v219
v_lshrrev_b32 v220, 16, v220
v_mul_u32_u24 v221, 12, v220
v_sub_u32 v221, v219, v221
v_bfe_u32 v222, v220, 2, 2
v_xor_b32 v221, v221, v222
v_lshl_add_u32 v222, v218, 9, v220
v_mul_u32_u24 v222, 192, v222
v_lshl_add_u32 v222, v221, 4, v222
v_add_u32 v223, s33, v220
v_subrev_u32 v223, 1, v223
v_mov_b32 v221, 0x80000000
v_cmp_gt_u32 vcc, 512, v223
v_cmp_gt_u32 s[44:45], 34, v220
s_and_b64 vcc, vcc, s[44:45]
v_cmp_gt_u32 s[44:45], v217, v6
v_mov_b32 v226, 832
v_cmp_gt_u32 s[44:45], v226, v217
s_and_b64 vcc, vcc, s[44:45]
s_nop 1
v_cndmask_b32 v4, v221, v222, vcc
v_add_u32 v222, s37, v222
v_add_u32 v223, s34, v218
v_cmp_lt_u32 s[44:45], 0, v223
s_and_b64 vcc, vcc, s[44:45]
s_nop 1
v_cndmask_b32 v228, v221, v222, vcc
s_lshl_b32 s44, s32, 6
s_add_u32 s44, s44, 512
v_add_u32 v217, s44, v1
v_cmp_le_u32 vcc, 416, v217
s_nop 1
v_cndmask_b32 v218, 0, 1, vcc
v_mul_u32_u24 v219, 416, v218
v_sub_u32 v219, v217, v219
v_mul_u32_u24 v220, 5462, v219
v_lshrrev_b32 v220, 16, v220
v_mul_u32_u24 v221, 12, v220
v_sub_u32 v221, v219, v221
v_bfe_u32 v222, v220, 2, 2
v_xor_b32 v221, v221, v222
v_lshl_add_u32 v222, v218, 9, v220
v_mul_u32_u24 v222, 192, v222
v_lshl_add_u32 v222, v221, 4, v222
v_add_u32 v223, s33, v220
v_subrev_u32 v223, 1, v223
v_mov_b32 v221, 0x80000000
v_cmp_gt_u32 vcc, 512, v223
v_cmp_gt_u32 s[44:45], 34, v220
s_and_b64 vcc, vcc, s[44:45]
v_cmp_gt_u32 s[44:45], v217, v6
v_mov_b32 v226, 832
v_cmp_gt_u32 s[44:45], v226, v217
s_and_b64 vcc, vcc, s[44:45]
s_nop 1
v_cndmask_b32 v5, v221, v222, vcc
v_add_u32 v222, s37, v222
v_add_u32 v223, s34, v218
v_cmp_lt_u32 s[44:45], 0, v223
s_and_b64 vcc, vcc, s[44:45]
s_nop 1
v_cndmask_b32 v229, v221, v222, vcc
s_add_u32 m0, s40, 90112
s_nop 0
buffer_load_dwordx4 v228, s[4:7], 0 offen lds
s_add_u32 m0, s39, 90112
s_nop 0
buffer_load_dwordx4 v229, s[4:7], 0 offen lds
s_mov_b32 s20, s54
s_and_b32 s21, s55, 0xffff
s_mov_b32 s22, 73728
s_mov_b32 s23, 0x20000
s_mov_b32 s28, s62
s_and_b32 s29, s63, 0xffff
s_mov_b32 s30, 256
s_mov_b32 s31, 0x20000
s_mov_b32 s8, s64
s_and_b32 s9, s65, 0xffff
s_mov_b32 s10, 268435456
s_mov_b32 s11, 0x20000
v_lshlrev_b32 v209, 19, v0
v_or_b32 v209, 0x8000, v209
v_lshlrev_b32 v208, 4, v0
v_add_u32 v210, 0x10000, v208
v_add_u32 v212, 0x0, v209
v_add_u32 v213, 0x10000, v209
v_add_u32 v214, 0x20000, v209
v_add_u32 v215, 0x30000, v209
v_ldexp_f32 v212, v212, s35
v_ldexp_f32 v213, v213, s35
v_ldexp_f32 v214, v214, s35
v_ldexp_f32 v215, v215, s35
v_fmaak_f32 v216, v212, v212, 0x409d30fc
v_fmaak_f32 v217, v213, v213, 0x409d30fc
v_fmaak_f32 v218, v214, v214, 0x409d30fc
v_fmaak_f32 v219, v215, v215, 0x409d30fc
v_mul_f32 v216, v212, v216
v_mul_f32 v217, v213, v217
s_add_u32 m0, s40, 103424
s_add_u32 s3, s37, 196608
buffer_load_dwordx4 v4, s[4:7], s3 offen lds
v_mul_f32 v218, v214, v218
v_mul_f32 v219, v215, v219
v_exp_f32 v216, v216
v_exp_f32 v217, v217
v_exp_f32 v218, v218
v_exp_f32 v219, v219
v_add_f32 v216, 1.0, v216
v_add_f32 v217, 1.0, v217
v_add_f32 v218, 1.0, v218
v_add_f32 v219, 1.0, v219
v_rcp_f32 v216, v216
v_rcp_f32 v217, v217
v_rcp_f32 v218, v218
v_rcp_f32 v219, v219
v_mul_f32 v216, v212, v216
v_mul_f32 v217, v213, v217
v_mul_f32 v218, v214, v218
v_mul_f32 v219, v215, v219
v_sub_f32 v212, v216, v212
v_sub_f32 v213, v217, v213
v_sub_f32 v214, v218, v214
v_sub_f32 v215, v219, v215
v_cvt_pk_bf16_f32 v200, v216, v217
v_cvt_pk_bf16_f32 v201, v218, v219
v_cvt_pk_bf16_f32 v204, v212, v213
v_cvt_pk_bf16_f32 v205, v214, v215
v_mul_f32 v212, v212, v212
v_mul_f32 v213, v213, v213
v_mul_f32 v214, v214, v214
v_mul_f32 v215, v215, v215
s_add_u32 m0, s39, 103424
s_nop 0
buffer_load_dwordx4 v5, s[4:7], s3 offen lds
v_mul_f32 v216, v216, v216
v_mul_f32 v217, v217, v217
v_mul_f32 v218, v218, v218
v_mul_f32 v219, v219, v219
v_cvt_pk_bf16_f32 v220, v216, v217
v_cvt_pk_bf16_f32 v221, v218, v219
v_cvt_pk_bf16_f32 v224, v212, v213
v_cvt_pk_bf16_f32 v225, v214, v215
v_add_u32 v212, 0x40000, v209
v_add_u32 v213, 0x50000, v209
v_add_u32 v214, 0x60000, v209
v_add_u32 v215, 0x70000, v209
v_ldexp_f32 v212, v212, s35
v_ldexp_f32 v213, v213, s35
v_ldexp_f32 v214, v214, s35
v_ldexp_f32 v215, v215, s35
v_fmaak_f32 v216, v212, v212, 0x409d30fc
v_fmaak_f32 v217, v213, v213, 0x409d30fc
v_fmaak_f32 v218, v214, v214, 0x409d30fc
v_fmaak_f32 v219, v215, v215, 0x409d30fc
v_mul_f32 v216, v212, v216
v_mul_f32 v217, v213, v217
v_mul_f32 v218, v214, v218
v_mul_f32 v219, v215, v219
v_exp_f32 v216, v216
v_exp_f32 v217, v217
v_exp_f32 v218, v218
v_exp_f32 v219, v219
v_add_f32 v216, 1.0, v216
v_add_f32 v217, 1.0, v217
s_add_u32 m0, s40, 116736
s_add_u32 s3, s37, 393216
buffer_load_dwordx4 v4, s[4:7], s3 offen lds
v_add_f32 v218, 1.0, v218
v_add_f32 v219, 1.0, v219
v_rcp_f32 v216, v216
v_rcp_f32 v217, v217
v_rcp_f32 v218, v218
v_rcp_f32 v219, v219
v_mul_f32 v216, v212, v216
v_mul_f32 v217, v213, v217
v_mul_f32 v218, v214, v218
v_mul_f32 v219, v215, v219
v_sub_f32 v212, v216, v212
v_sub_f32 v213, v217, v213
v_sub_f32 v214, v218, v214
v_sub_f32 v215, v219, v215
v_cvt_pk_bf16_f32 v202, v216, v217
v_cvt_pk_bf16_f32 v203, v218, v219
v_cvt_pk_bf16_f32 v206, v212, v213
v_cvt_pk_bf16_f32 v207, v214, v215
v_mul_f32 v212, v212, v212
v_mul_f32 v213, v213, v213
v_mul_f32 v214, v214, v214
v_mul_f32 v215, v215, v215
v_mul_f32 v216, v216, v216
v_mul_f32 v217, v217, v217
v_mul_f32 v218, v218, v218
v_mul_f32 v219, v219, v219
v_cvt_pk_bf16_f32 v222, v216, v217
v_cvt_pk_bf16_f32 v223, v218, v219
v_cvt_pk_bf16_f32 v226, v212, v213
v_cvt_pk_bf16_f32 v227, v214, v215
s_add_u32 m0, s39, 116736
s_nop 0
buffer_load_dwordx4 v5, s[4:7], s3 offen lds
ds_write_b128 v208, v[220:223]
ds_write_b128 v210, v[224:227]
v_and_b32 v217, 3, v1
v_bfe_u32 v218, v1, 2, 2
v_lshl_add_u32 v217, v217, 2, v218
v_bfe_u32 v218, v1, 4, 1
s_and_b32 s44, s32, 1
s_lshl_b32 s44, s44, 4
v_add_u32 v219, s44, v217
v_add_u32 v219, 0, v219
v_bfe_u32 v220, v219, 2, 2
v_lshlrev_b32 v220, 4, v220
v_mul_u32_u24 v219, 192, v219
v_add_u32 v219, v219, v220
v_mul_u32_u24 v220, 6656, v218
v_add_u32 v8, v219, v220
v_add_u32 v219, s44, v217
v_add_u32 v219, 1, v219
v_bfe_u32 v220, v219, 2, 2
v_lshlrev_b32 v220, 4, v220
v_mul_u32_u24 v219, 192, v219
v_add_u32 v219, v219, v220
v_mul_u32_u24 v220, 6656, v218
v_add_u32 v9, v219, v220
v_add_u32 v219, s44, v217
v_add_u32 v219, 2, v219
v_bfe_u32 v220, v219, 2, 2
v_lshlrev_b32 v220, 4, v220
v_mul_u32_u24 v219, 192, v219
v_add_u32 v219, v219, v220
s_add_u32 m0, s40, 130048
s_add_u32 s3, s37, 589824
buffer_load_dwordx4 v4, s[4:7], s3 offen lds
v_mul_u32_u24 v220, 6656, v218
v_add_u32 v10, v219, v220
v_bfe_u32 v232, v1, 2, 1
v_bfe_u32 v233, v1, 3, 1
v_and_b32 v234, 3, v1
v_lshl_add_u32 v235, v233, 2, v234
v_lshrrev_b32 v236, 4, v1
v_and_b32 v239, 1, v236
v_lshlrev_b32 v239, 1, v239
v_sub_u32 v239, v239, v232
v_mul_u32_u24 v237, 3, v239
v_add_u32 v237, v14, v237
v_mul_u32_u24 v237, 96, v237
v_add_u32 v237, v237, v235
v_lshlrev_b32 v237, 1, v237
v_add_u32 v237, 156672, v237
v_mov_b32 v238, 158464
v_cmp_gt_u32 vcc, 3, v239
s_nop 1
v_cndmask_b32 v240, v238, v237, vcc
v_add_u32 v239, 1, v239
v_mul_u32_u24 v237, 3, v239
v_add_u32 v237, v14, v237
v_mul_u32_u24 v237, 96, v237
v_add_u32 v237, v237, v235
v_lshlrev_b32 v237, 1, v237
v_add_u32 v237, 156672, v237
v_mov_b32 v238, 158464
v_cmp_gt_u32 vcc, 3, v239
s_nop 1
v_cndmask_b32 v241, v238, v237, vcc
s_add_u32 m0, s39, 130048
s_nop 0
buffer_load_dwordx4 v5, s[4:7], s3 offen lds
v_sub_u32 v239, v236, v232
v_mul_u32_u24 v237, 3, v239
v_add_u32 v237, 2, v237
v_mul_u32_u24 v237, 96, v237
v_add_u32 v237, v237, v235
v_lshlrev_b32 v237, 1, v237
v_add_u32 v237, 156672, v237
v_mov_b32 v238, 158464
v_cmp_gt_u32 vcc, 3, v239
s_nop 1
v_cndmask_b32 v242, v238, v237, vcc
v_xor_b32 v237, 1, v234
v_lshl_or_b32 v237, v237, 2, v234
v_mul_u32_u24 v7, 0x1111, v237
v_subrev_u32 v243, 1, v233
v_not_b32 v244, v243
v_and_b32 v245, 1, v235
v_lshlrev_b32 v245, 4, v245
v_lshrrev_b32 v237, 1, v235
v_cmp_eq_u32 vcc, 0, v237
s_nop 1
v_cndmask_b32 v246, 0, -1, vcc
v_cmp_eq_u32 vcc, 1, v237
s_nop 1
v_cndmask_b32 v247, 0, -1, vcc
v_cmp_eq_u32 vcc, 2, v237
s_nop 1
v_cndmask_b32 v248, 0, -1, vcc
v_cmp_eq_u32 vcc, 3, v237
s_nop 1
v_cndmask_b32 v249, 0, -1, vcc
s_add_u32 m0, s40, 143360
s_add_u32 s3, s37, 786432
buffer_load_dwordx4 v4, s[4:7], s3 offen lds
s_waitcnt vmcnt(21)
ds_read_u16 v40, v240 offset:0
ds_read_u16 v42, v241 offset:0
ds_read_u16 v88, v242 offset:0
ds_read_u16 v44, v240 offset:16
ds_read_u16 v46, v241 offset:16
ds_read_u16 v92, v242 offset:16
ds_read_u16 v48, v240 offset:32
ds_read_u16 v50, v241 offset:32
ds_read_u16 v96, v242 offset:32
ds_read_u16 v52, v240 offset:48
ds_read_u16 v54, v241 offset:48
ds_read_u16 v100, v242 offset:48
ds_read_u16 v56, v240 offset:64
ds_read_u16 v58, v241 offset:64
ds_read_u16 v104, v242 offset:64
ds_read_u16 v60, v240 offset:80
ds_read_u16 v62, v241 offset:80
ds_read_u16 v108, v242 offset:80
ds_read_u16 v64, v240 offset:96
ds_read_u16 v66, v241 offset:96
ds_read_u16 v112, v242 offset:96
ds_read_u16 v68, v240 offset:112
ds_read_u16 v70, v241 offset:112
ds_read_u16 v116, v242 offset:112
ds_read_u16 v72, v240 offset:128
ds_read_u16 v74, v241 offset:128
ds_read_u16 v120, v242 offset:128
ds_read_u16 v76, v240 offset:144
ds_read_u16 v78, v241 offset:144
ds_read_u16 v124, v242 offset:144
s_add_u32 m0, s39, 143360
s_nop 0
buffer_load_dwordx4 v5, s[4:7], s3 offen lds
ds_read_u16 v80, v240 offset:160
ds_read_u16 v82, v241 offset:160
ds_read_u16 v128, v242 offset:160
ds_read_u16 v84, v240 offset:176
ds_read_u16 v86, v241 offset:176
ds_read_u16 v132, v242 offset:176
s_waitcnt lgkmcnt(15)
v_and_b32 v41, v244, v40
v_and_b32 v40, v243, v40
v_and_b32 v43, v244, v42
v_and_b32 v42, v243, v42
v_lshlrev_b32 v88, v245, v88
v_and_b32 v89, v247, v88
v_and_b32 v90, v248, v88
v_and_b32 v91, v249, v88
v_and_b32 v88, v246, v88
v_and_b32 v45, v244, v44
v_and_b32 v44, v243, v44
v_and_b32 v47, v244, v46
v_and_b32 v46, v243, v46
v_lshlrev_b32 v92, v245, v92
v_and_b32 v93, v247, v92
v_and_b32 v94, v248, v92
v_and_b32 v95, v249, v92
v_and_b32 v92, v246, v92
v_and_b32 v49, v244, v48
v_and_b32 v48, v243, v48
v_and_b32 v51, v244, v50
v_and_b32 v50, v243, v50
v_lshlrev_b32 v96, v245, v96
v_and_b32 v97, v247, v96
v_and_b32 v98, v248, v96
v_and_b32 v99, v249, v96
v_and_b32 v96, v246, v96
v_and_b32 v53, v244, v52
v_and_b32 v52, v243, v52
v_and_b32 v55, v244, v54
v_and_b32 v54, v243, v54
v_lshlrev_b32 v100, v245, v100
v_and_b32 v101, v247, v100
v_and_b32 v102, v248, v100
v_and_b32 v103, v249, v100
v_and_b32 v100, v246, v100
v_and_b32 v57, v244, v56
v_and_b32 v56, v243, v56
v_and_b32 v59, v244, v58
v_and_b32 v58, v243, v58
v_lshlrev_b32 v104, v245, v104
v_and_b32 v105, v247, v104
v_and_b32 v106, v248, v104
v_and_b32 v107, v249, v104
v_and_b32 v104, v246, v104
v_and_b32 v61, v244, v60
v_and_b32 v60, v243, v60
v_and_b32 v63, v244, v62
v_and_b32 v62, v243, v62
v_lshlrev_b32 v108, v245, v108
v_and_b32 v109, v247, v108
v_and_b32 v110, v248, v108
v_and_b32 v111, v249, v108
v_and_b32 v108, v246, v108
v_and_b32 v65, v244, v64
v_and_b32 v64, v243, v64
v_and_b32 v67, v244, v66
v_and_b32 v66, v243, v66
v_lshlrev_b32 v112, v245, v112
v_and_b32 v113, v247, v112
v_and_b32 v114, v248, v112
v_and_b32 v115, v249, v112
v_and_b32 v112, v246, v112
s_waitcnt lgkmcnt(14)
v_and_b32 v69, v244, v68
v_and_b32 v68, v243, v68
s_waitcnt lgkmcnt(13)
v_and_b32 v71, v244, v70
v_and_b32 v70, v243, v70
s_waitcnt lgkmcnt(12)
v_lshlrev_b32 v116, v245, v116
v_and_b32 v117, v247, v116
v_and_b32 v118, v248, v116
v_and_b32 v119, v249, v116
v_and_b32 v116, v246, v116
s_waitcnt lgkmcnt(11)
v_and_b32 v73, v244, v72
v_and_b32 v72, v243, v72
s_waitcnt lgkmcnt(10)
v_and_b32 v75, v244, v74
v_and_b32 v74, v243, v74
s_waitcnt lgkmcnt(9)
v_lshlrev_b32 v120, v245, v120
v_and_b32 v121, v247, v120
v_and_b32 v122, v248, v120
v_and_b32 v123, v249, v120
v_and_b32 v120, v246, v120
s_waitcnt lgkmcnt(8)
v_and_b32 v77, v244, v76
v_and_b32 v76, v243, v76
s_waitcnt lgkmcnt(7)
v_and_b32 v79, v244, v78
v_and_b32 v78, v243, v78
s_waitcnt lgkmcnt(6)
v_lshlrev_b32 v124, v245, v124
v_and_b32 v125, v247, v124
v_and_b32 v126, v248, v124
v_and_b32 v127, v249, v124
v_and_b32 v124, v246, v124
s_waitcnt lgkmcnt(5)
v_and_b32 v81, v244, v80
v_and_b32 v80, v243, v80
s_waitcnt lgkmcnt(4)
v_and_b32 v83, v244, v82
v_and_b32 v82, v243, v82
s_waitcnt lgkmcnt(3)
v_lshlrev_b32 v128, v245, v128
v_and_b32 v129, v247, v128
v_and_b32 v130, v248, v128
v_and_b32 v131, v249, v128
v_and_b32 v128, v246, v128
s_waitcnt lgkmcnt(2)
v_and_b32 v85, v244, v84
v_and_b32 v84, v243, v84
s_waitcnt lgkmcnt(1)
v_and_b32 v87, v244, v86
v_and_b32 v86, v243, v86
s_waitcnt lgkmcnt(0)
v_lshlrev_b32 v132, v245, v132
v_and_b32 v133, v247, v132
v_and_b32 v134, v248, v132
v_and_b32 v135, v249, v132
v_and_b32 v132, v246, v132
s_lshl_b32 s38, s2, 4
s_add_u32 s38, s38, s32
s_mul_i32 s38, s38, 6144
s_lshr_b32 s45, s32, 1
s_lshl_b32 s45, s45, 1
s_add_u32 s44, s34, s45
s_lshl_b32 s44, s44, 9
s_add_u32 s44, s44, s33
s_and_b32 s45, s32, 1
s_lshl_b32 s45, s45, 4
s_add_u32 s44, s44, s45
s_mul_i32 s52, s44, 192
s_add_u32 s53, s52, 786432
s_add_u32 s54, s52, 1572864
s_add_u32 s55, s52, 2359296
s_mov_b32 s24, s58
s_and_b32 s25, s59, 0xffff
s_mov_b32 s26, 768
s_mov_b32 s27, 0x20000
s_waitcnt vmcnt(21)
v_or_b32 v232, v16, v17
s_waitcnt vmcnt(20)
v_or3_b32 v232, v232, v18, v20
v_or3_b32 v232, v232, v21, v22
s_waitcnt vmcnt(19)
v_or3_b32 v232, v232, v24, v25
s_waitcnt vmcnt(18)
v_or3_b32 v232, v232, v26, v28
v_or3_b32 v232, v232, v29, v30
s_waitcnt vmcnt(17)
v_or3_b32 v232, v232, v32, v33
s_waitcnt vmcnt(16)
v_or3_b32 v232, v232, v34, v36
v_or3_b32 v232, v232, v37, v38
s_waitcnt vmcnt(15)
v_or3_b32 v232, v232, v136, v137
s_waitcnt vmcnt(14)
v_or3_b32 v232, v232, v138, v140
v_or3_b32 v232, v232, v141, v142
s_waitcnt vmcnt(13)
v_or3_b32 v232, v232, v144, v145
s_waitcnt vmcnt(12)
v_or3_b32 v232, v232, v146, v148
v_or3_b32 v232, v232, v149, v150
s_waitcnt vmcnt(11)
v_or3_b32 v232, v232, v152, v153
s_waitcnt vmcnt(10)
v_or3_b32 v232, v232, v154, v156
v_or3_b32 v232, v232, v157, v158
v_and_b32 v232, 0x40004000, v232
v_and_b32 v233, 0x7fff, v16
v_cmp_ne_u32 vcc, 0, v232
v_mov_b32 v234, 15104
v_cmp_le_u32 s[44:45], v234, v233
s_cmp_lg_u64 vcc, 0
s_cselect_b32 s46, 1, 0
s_cmp_lg_u64 s[44:45], 0
s_cselect_b32 s47, 2, 0
s_or_b32 s44, s46, s47
s_lshl_b32 s45, s32, 2
s_add_u32 s45, s45, 158720
v_mov_b32 v232, s44
v_mov_b32 v233, s45
ds_write_b32 v233, v232
s_mul_i32 s36, s35, 0x800080
s_mov_b32 s50, 0x07060302
s_mov_b32 s51, 0x05040100
v_mov_b32 v236, 0x7fff7fff
s_mul_i32 s44, s32, 3
s_add_u32 s44, s44, 0
s_lshr_b32 s45, s44, 3
s_bfe_u32 s46, s44, 0x20001
s_mul_i32 s49, s46, 6
s_lshr_b32 s49, 0xa6db6d, s49
s_mul_i32 s47, s46, 18
s_add_u32 s45, s45, s47
s_cmp_ge_u32 s45, 56
s_cselect_b32 s47, 16, 8
s_cmp_ge_u32 s45, 53
s_cselect_b32 s48, 16, 8
s_and_b32 s44, s44, 1
s_lshl_b32 s44, s44, 3
s_add_u32 s47, s47, s45
s_lshl_b32 s47, s47, 10
s_add_u32 s47, s47, s44
v_add_u32 v238, s47, v2
s_add_u32 s48, s48, s45
s_lshl_b32 s48, s48, 10
s_add_u32 s48, s48, s44
v_add_u32 v239, s48, v2
v_perm_b32 v232, v20, v16, s51
v_perm_b32 v233, v28, v24, s51
v_and_b32 v234, v236, v232
v_and_b32 v235, v236, v233
v_pk_sub_u16 v234, v234, s36 clamp
v_pk_sub_u16 v235, v235, s36 clamp
v_bitop3_b32 v232, v234, v232, v236 bitop3:0xf4
v_bitop3_b32 v233, v235, v233, v236 bitop3:0xf4
ds_write_b64 v238, v[232:233] offset:0
v_perm_b32 v232, v20, v16, s50
v_perm_b32 v233, v28, v24, s50
ds_write_b64 v239, v[232:233] offset:3072
s_bitcmp1_b32 s49, 2
s_cselect_b32 s48, s36, 0
v_perm_b32 v232, v21, v17, s51
v_perm_b32 v233, v29, v25, s51
v_and_b32 v234, v236, v232
v_and_b32 v235, v236, v233
v_pk_sub_u16 v234, v234, s48 clamp
v_pk_sub_u16 v235, v235, s48 clamp
v_bitop3_b32 v232, v234, v232, v236 bitop3:0xf4
v_bitop3_b32 v233, v235, v233, v236 bitop3:0xf4
ds_write_b64 v239, v[232:233] offset:6144
v_perm_b32 v232, v21, v17, s50
v_perm_b32 v233, v29, v25, s50
v_and_b32 v234, v236, v232
v_and_b32 v235, v236, v233
v_pk_sub_u16 v234, v234, s36 clamp
v_pk_sub_u16 v235, v235, s36 clamp
v_bitop3_b32 v232, v234, v232, v236 bitop3:0xf4
v_bitop3_b32 v233, v235, v233, v236 bitop3:0xf4
ds_write_b64 v239, v[232:233] offset:9216
v_perm_b32 v232, v22, v18, s51
v_perm_b32 v233, v30, v26, s51
ds_write_b64 v239, v[232:233] offset:12288
v_perm_b32 v232, v22, v18, s50
v_perm_b32 v233, v30, v26, s50
v_and_b32 v234, v236, v232
v_and_b32 v235, v236, v233
v_pk_sub_u16 v234, v234, s36 clamp
v_pk_sub_u16 v235, v235, s36 clamp
v_bitop3_b32 v232, v234, v232, v236 bitop3:0xf4
v_bitop3_b32 v233, v235, v233, v236 bitop3:0xf4
ds_write_b64 v239, v[232:233] offset:15360
s_mul_i32 s44, s32, 3
s_add_u32 s44, s44, 1
s_lshr_b32 s45, s44, 3
s_bfe_u32 s46, s44, 0x20001
s_mul_i32 s49, s46, 6
s_lshr_b32 s49, 0xa6db6d, s49
s_mul_i32 s47, s46, 18
s_add_u32 s45, s45, s47
s_cmp_ge_u32 s45, 56
s_cselect_b32 s47, 16, 8
s_cmp_ge_u32 s45, 53
s_cselect_b32 s48, 16, 8
s_and_b32 s44, s44, 1
s_lshl_b32 s44, s44, 3
s_add_u32 s47, s47, s45
s_lshl_b32 s47, s47, 10
s_add_u32 s47, s47, s44
v_add_u32 v238, s47, v2
s_add_u32 s48, s48, s45
s_lshl_b32 s48, s48, 10
s_add_u32 s48, s48, s44
v_add_u32 v239, s48, v2
v_perm_b32 v232, v36, v32, s51
v_perm_b32 v233, v140, v136, s51
v_and_b32 v234, v236, v232
v_and_b32 v235, v236, v233
v_pk_sub_u16 v234, v234, s36 clamp
v_pk_sub_u16 v235, v235, s36 clamp
v_bitop3_b32 v232, v234, v232, v236 bitop3:0xf4
v_bitop3_b32 v233, v235, v233, v236 bitop3:0xf4
ds_write_b64 v238, v[232:233] offset:0
v_perm_b32 v232, v36, v32, s50
v_perm_b32 v233, v140, v136, s50
ds_write_b64 v239, v[232:233] offset:3072
s_bitcmp1_b32 s49, 2
s_cselect_b32 s48, s36, 0
v_perm_b32 v232, v37, v33, s51
v_perm_b32 v233, v141, v137, s51
v_and_b32 v234, v236, v232
v_and_b32 v235, v236, v233
v_pk_sub_u16 v234, v234, s48 clamp
v_pk_sub_u16 v235, v235, s48 clamp
v_bitop3_b32 v232, v234, v232, v236 bitop3:0xf4
v_bitop3_b32 v233, v235, v233, v236 bitop3:0xf4
ds_write_b64 v239, v[232:233] offset:6144
v_perm_b32 v232, v37, v33, s50
v_perm_b32 v233, v141, v137, s50
v_and_b32 v234, v236, v232
v_and_b32 v235, v236, v233
v_pk_sub_u16 v234, v234, s36 clamp
v_pk_sub_u16 v235, v235, s36 clamp
v_bitop3_b32 v232, v234, v232, v236 bitop3:0xf4
v_bitop3_b32 v233, v235, v233, v236 bitop3:0xf4
ds_write_b64 v239, v[232:233] offset:9216
v_perm_b32 v232, v38, v34, s51
v_perm_b32 v233, v142, v138, s51
ds_write_b64 v239, v[232:233] offset:12288
v_perm_b32 v232, v38, v34, s50
v_perm_b32 v233, v142, v138, s50
v_and_b32 v234, v236, v232
v_and_b32 v235, v236, v233
v_pk_sub_u16 v234, v234, s36 clamp
v_pk_sub_u16 v235, v235, s36 clamp
v_bitop3_b32 v232, v234, v232, v236 bitop3:0xf4
v_bitop3_b32 v233, v235, v233, v236 bitop3:0xf4
ds_write_b64 v239, v[232:233] offset:15360
s_waitcnt vmcnt(0) lgkmcnt(0)
s_barrier
s_lshr_b32 s44, s32, 1
s_add_u32 s44, s44, 0
s_add_u32 s45, s44, 1
s_cmp_ge_u32 s44, 5
s_cselect_b32 s46, 5, 0
s_sub_u32 s44, s44, s46
s_mul_i32 s44, s44, 13312
s_cmp_ge_u32 s45, 5
s_cselect_b32 s46, 5, 0
s_sub_u32 s45, s45, s46
s_mul_i32 s45, s45, 13312
s_sub_u32 s45, s45, s44
s_add_u32 s44, s44, 90112
v_mul_lo_u32 v15, v14, s45
v_add_u32 v15, s44, v15
v_add_u32 v11, v15, v8
v_add_u32 v12, v15, v9
v_add_u32 v13, v15, v10
ds_read_b128 v[216:219], v13 offset:0
ds_read_b128 v[208:211], v11 offset:0
ds_read_b128 v[212:215], v12 offset:0
v_and_b32 v255, 7, v1
v_lshlrev_b32 v255, 2, v255
v_add_u32 v255, 158720, v255
ds_read_b32 v255, v255
v_lshlrev_b32 v254, 4, v0
s_add_u32 s3, s43, 50360320
buffer_store_dwordx4 v[200:203], v254, s[8:11], s3 offen
s_add_u32 s3, s43, 50368512
buffer_store_dwordx4 v[204:207], v254, s[8:11], s3 offen
s_mul_i32 s44, s32, 3
s_add_u32 s44, s44, 2
s_lshr_b32 s45, s44, 3
s_bfe_u32 s46, s44, 0x20001
s_mul_i32 s49, s46, 6
s_lshr_b32 s49, 0xa6db6d, s49
s_mul_i32 s47, s46, 18
s_add_u32 s45, s45, s47
s_cmp_ge_u32 s45, 56
s_cselect_b32 s47, 16, 8
s_cmp_ge_u32 s45, 53
s_cselect_b32 s48, 16, 8
s_and_b32 s44, s44, 1
s_lshl_b32 s44, s44, 3
s_add_u32 s47, s47, s45
s_lshl_b32 s47, s47, 10
s_add_u32 s47, s47, s44
v_add_u32 v238, s47, v2
s_add_u32 s48, s48, s45
s_lshl_b32 s48, s48, 10
s_add_u32 s48, s48, s44
v_add_u32 v239, s48, v2
ds_read_b128 v[228:231], v13 offset:64
ds_read_b128 v[220:223], v11 offset:64
ds_read_b128 v[224:227], v12 offset:64
s_waitcnt lgkmcnt(6)
v_mfma_f32_16x16x32_bf16 v[160:163], v[88:91], v[216:219], 0
s_waitcnt lgkmcnt(4)
v_smfmac_f32_16x16x64_bf16 v[160:163], v[40:43], v[208:215], v7
ds_read_b128 v[248:251], v13 offset:128
ds_read_b128 v[240:243], v11 offset:128
ds_read_b128 v[244:247], v12 offset:128
v_perm_b32 v232, v148, v144, s51
v_perm_b32 v233, v156, v152, s51
v_and_b32 v234, v236, v232
v_and_b32 v235, v236, v233
v_pk_sub_u16 v234, v234, s36 clamp
v_pk_sub_u16 v235, v235, s36 clamp
v_bitop3_b32 v232, v234, v232, v236 bitop3:0xf4
v_bitop3_b32 v233, v235, v233, v236 bitop3:0xf4
ds_write_b64 v238, v[232:233] offset:0
s_waitcnt lgkmcnt(6)
v_mfma_f32_16x16x32_bf16 v[164:167], v[104:107], v[228:231], 0
s_waitcnt lgkmcnt(4)
v_smfmac_f32_16x16x64_bf16 v[164:167], v[56:59], v[220:227], v7
v_xor_b32 v11, 16, v11
v_xor_b32 v12, 16, v12
v_xor_b32 v13, 16, v13
ds_read_b128 v[216:219], v13 offset:0
ds_read_b128 v[208:211], v11 offset:0
ds_read_b128 v[212:215], v12 offset:0
v_mov_b32 v252, v160
v_mul_f32 v253, v160, v160
v_add_f32 v252, v161, v252
v_fmac_f32 v253, v161, v161
v_add_f32 v252, v162, v252
v_fmac_f32 v253, v162, v162
v_add_f32 v252, v163, v252
v_fmac_f32 v253, v163, v163
s_waitcnt lgkmcnt(6)
v_mfma_f32_16x16x32_bf16 v[168:171], v[120:123], v[248:251], 0
s_waitcnt lgkmcnt(4)
v_smfmac_f32_16x16x64_bf16 v[168:171], v[72:75], v[240:247], v7
ds_read_b128 v[228:231], v13 offset:64
ds_read_b128 v[220:223], v11 offset:64
ds_read_b128 v[224:227], v12 offset:64
v_perm_b32 v232, v148, v144, s50
v_perm_b32 v233, v156, v152, s50
ds_write_b64 v239, v[232:233] offset:3072
v_add_f32 v252, v164, v252
v_fmac_f32 v253, v164, v164
v_add_f32 v252, v165, v252
v_fmac_f32 v253, v165, v165
v_add_f32 v252, v166, v252
v_fmac_f32 v253, v166, v166
v_add_f32 v252, v167, v252
v_fmac_f32 v253, v167, v167
s_waitcnt lgkmcnt(6)
v_mfma_f32_16x16x32_bf16 v[172:175], v[92:95], v[216:219], 0
s_waitcnt lgkmcnt(4)
v_smfmac_f32_16x16x64_bf16 v[172:175], v[44:47], v[208:215], v7
ds_read_b128 v[248:251], v13 offset:128
ds_read_b128 v[240:243], v11 offset:128
ds_read_b128 v[244:247], v12 offset:128
v_add_f32 v252, v168, v252
v_fmac_f32 v253, v168, v168
v_add_f32 v252, v169, v252
v_fmac_f32 v253, v169, v169
v_add_f32 v252, v170, v252
v_fmac_f32 v253, v170, v170
v_add_f32 v252, v171, v252
v_fmac_f32 v253, v171, v171
s_waitcnt lgkmcnt(6)
v_mfma_f32_16x16x32_bf16 v[176:179], v[108:111], v[228:231], 0
s_waitcnt lgkmcnt(4)
v_smfmac_f32_16x16x64_bf16 v[176:179], v[60:63], v[220:227], v7
v_xor_b32 v11, 48, v11
v_xor_b32 v12, 48, v12
v_xor_b32 v13, 48, v13
ds_read_b128 v[216:219], v13 offset:0
ds_read_b128 v[208:211], v11 offset:0
ds_read_b128 v[212:215], v12 offset:0
s_bitcmp1_b32 s49, 2
s_cselect_b32 s48, s36, 0
v_perm_b32 v232, v149, v145, s51
v_perm_b32 v233, v157, v153, s51
v_and_b32 v234, v236, v232
v_and_b32 v235, v236, v233
v_pk_sub_u16 v234, v234, s48 clamp
v_pk_sub_u16 v235, v235, s48 clamp
v_bitop3_b32 v232, v234, v232, v236 bitop3:0xf4
v_bitop3_b32 v233, v235, v233, v236 bitop3:0xf4
ds_write_b64 v239, v[232:233] offset:6144
v_add_f32 v252, v172, v252
v_fmac_f32 v253, v172, v172
v_add_f32 v252, v173, v252
v_fmac_f32 v253, v173, v173
v_add_f32 v252, v174, v252
v_fmac_f32 v253, v174, v174
v_add_f32 v252, v175, v252
v_fmac_f32 v253, v175, v175
s_waitcnt lgkmcnt(6)
v_mfma_f32_16x16x32_bf16 v[180:183], v[124:127], v[248:251], 0
s_waitcnt lgkmcnt(4)
v_smfmac_f32_16x16x64_bf16 v[180:183], v[76:79], v[240:247], v7
ds_read_b128 v[228:231], v13 offset:64
ds_read_b128 v[220:223], v11 offset:64
ds_read_b128 v[224:227], v12 offset:64
v_add_f32 v252, v176, v252
v_fmac_f32 v253, v176, v176
v_add_f32 v252, v177, v252
v_fmac_f32 v253, v177, v177
v_add_f32 v252, v178, v252
v_fmac_f32 v253, v178, v178
v_add_f32 v252, v179, v252
v_fmac_f32 v253, v179, v179
s_waitcnt lgkmcnt(6)
v_mfma_f32_16x16x32_bf16 v[184:187], v[96:99], v[216:219], 0
s_waitcnt lgkmcnt(4)
v_smfmac_f32_16x16x64_bf16 v[184:187], v[48:51], v[208:215], v7
ds_read_b128 v[248:251], v13 offset:128
ds_read_b128 v[240:243], v11 offset:128
ds_read_b128 v[244:247], v12 offset:128
v_perm_b32 v232, v149, v145, s50
v_perm_b32 v233, v157, v153, s50
v_and_b32 v234, v236, v232
v_and_b32 v235, v236, v233
v_pk_sub_u16 v234, v234, s36 clamp
v_pk_sub_u16 v235, v235, s36 clamp
v_bitop3_b32 v232, v234, v232, v236 bitop3:0xf4
v_bitop3_b32 v233, v235, v233, v236 bitop3:0xf4
ds_write_b64 v239, v[232:233] offset:9216
v_add_f32 v252, v180, v252
v_fmac_f32 v253, v180, v180
v_and_b32 v254, 1, v255
v_cmp_ne_u32 vcc, 0, v254
v_cmp_lt_u32 s[44:45], 1, v255
s_cmp_lg_u64 vcc, 0
s_cselect_b32 s42, 1, 0
s_cmp_eq_u64 s[44:45], 0
s_cselect_b32 s42, 1, s42
v_add_f32 v252, v181, v252
v_fmac_f32 v253, v181, v181
v_add_f32 v252, v182, v252
v_fmac_f32 v253, v182, v182
v_add_f32 v252, v183, v252
v_fmac_f32 v253, v183, v183
s_waitcnt lgkmcnt(6)
v_mfma_f32_16x16x32_bf16 v[188:191], v[112:115], v[228:231], 0
s_waitcnt lgkmcnt(4)
v_smfmac_f32_16x16x64_bf16 v[188:191], v[64:67], v[220:227], v7
v_xor_b32 v11, 16, v11
v_xor_b32 v12, 16, v12
v_xor_b32 v13, 16, v13
ds_read_b128 v[216:219], v13 offset:0
ds_read_b128 v[208:211], v11 offset:0
ds_read_b128 v[212:215], v12 offset:0
v_add_f32 v252, v184, v252
v_fmac_f32 v253, v184, v184
v_add_f32 v252, v185, v252
v_fmac_f32 v253, v185, v185
v_add_f32 v252, v186, v252
v_fmac_f32 v253, v186, v186
v_add_f32 v252, v187, v252
v_fmac_f32 v253, v187, v187
s_waitcnt lgkmcnt(6)
v_mfma_f32_16x16x32_bf16 v[192:195], v[128:131], v[248:251], 0
s_waitcnt lgkmcnt(4)
v_smfmac_f32_16x16x64_bf16 v[192:195], v[80:83], v[240:247], v7
ds_read_b128 v[228:231], v13 offset:64
ds_read_b128 v[220:223], v11 offset:64
ds_read_b128 v[224:227], v12 offset:64
v_perm_b32 v232, v150, v146, s51
v_perm_b32 v233, v158, v154, s51
ds_write_b64 v239, v[232:233] offset:12288
v_add_f32 v252, v188, v252
v_fmac_f32 v253, v188, v188
v_add_f32 v252, v189, v252
v_fmac_f32 v253, v189, v189
v_add_f32 v252, v190, v252
v_fmac_f32 v253, v190, v190
v_add_f32 v252, v191, v252
v_fmac_f32 v253, v191, v191
s_waitcnt lgkmcnt(6)
v_mfma_f32_16x16x32_bf16 v[196:199], v[100:103], v[216:219], 0
s_waitcnt lgkmcnt(4)
v_smfmac_f32_16x16x64_bf16 v[196:199], v[52:55], v[208:215], v7
ds_read_b128 v[248:251], v13 offset:128
ds_read_b128 v[240:243], v11 offset:128
ds_read_b128 v[244:247], v12 offset:128
v_add_f32 v252, v192, v252
v_fmac_f32 v253, v192, v192
v_add_f32 v252, v193, v252
v_fmac_f32 v253, v193, v193
v_add_f32 v252, v194, v252
v_fmac_f32 v253, v194, v194
v_add_f32 v252, v195, v252
v_fmac_f32 v253, v195, v195
s_waitcnt lgkmcnt(6)
v_mfma_f32_16x16x32_bf16 v[200:203], v[116:119], v[228:231], 0
s_waitcnt lgkmcnt(4)
v_smfmac_f32_16x16x64_bf16 v[200:203], v[68:71], v[220:227], v7
v_add_f32 v252, v196, v252
v_fmac_f32 v253, v196, v196
v_add_f32 v252, v197, v252
v_fmac_f32 v253, v197, v197
v_add_f32 v252, v198, v252
v_fmac_f32 v253, v198, v198
v_perm_b32 v232, v150, v146, s50
v_perm_b32 v233, v158, v154, s50
v_and_b32 v234, v236, v232
v_and_b32 v235, v236, v233
v_pk_sub_u16 v234, v234, s36 clamp
v_pk_sub_u16 v235, v235, s36 clamp
v_bitop3_b32 v232, v234, v232, v236 bitop3:0xf4
v_bitop3_b32 v233, v235, v233, v236 bitop3:0xf4
ds_write_b64 v239, v[232:233] offset:15360
v_add_f32 v252, v199, v252
v_fmac_f32 v253, v199, v199
s_waitcnt lgkmcnt(3)
v_mfma_f32_16x16x32_bf16 v[204:207], v[132:135], v[248:251], 0
s_waitcnt lgkmcnt(1)
v_smfmac_f32_16x16x64_bf16 v[204:207], v[84:87], v[240:247], v7
v_add_f32 v252, v200, v252
v_fmac_f32 v253, v200, v200
v_add_f32 v252, v201, v252
v_fmac_f32 v253, v201, v201
v_add_f32 v252, v202, v252
v_fmac_f32 v253, v202, v202
v_add_f32 v252, v203, v252
v_fmac_f32 v253, v203, v203
v_add_f32 v252, v204, v252
v_fmac_f32 v253, v204, v204
v_add_f32 v252, v205, v252
v_fmac_f32 v253, v205, v205
v_add_f32 v252, v206, v252
v_fmac_f32 v253, v206, v206
v_add_f32 v252, v207, v252
v_fmac_f32 v253, v207, v207
s_waitcnt lgkmcnt(0)
s_barrier
s_cmp_lg_u32 s42, 0
s_cbranch_scc1 L_exact
L_go:
v_mov_b32 v16, 0
v_mov_b32 v17, 0
v_mov_b32 v18, 0
v_mov_b32 v19, 0
v_mov_b32 v20, 0
v_mov_b32 v21, 0
v_mov_b32 v22, 0
v_mov_b32 v23, 0
v_mov_b32 v24, 0
v_mov_b32 v25, 0
v_mov_b32 v26, 0
v_mov_b32 v27, 0
v_mov_b32 v28, 0
v_mov_b32 v29, 0
v_mov_b32 v30, 0
v_mov_b32 v31, 0
v_mov_b32 v32, 0
v_mov_b32 v33, 0
v_mov_b32 v34, 0
v_mov_b32 v35, 0
v_mov_b32 v36, 0
v_mov_b32 v37, 0
v_mov_b32 v38, 0
v_mov_b32 v39, 0
s_setprio 1
v_permlane32_swap_b32 v252, v253
v_add_f32 v252, v252, v253
v_mov_b32 v253, v252
s_nop 1
v_permlane32_swap_b32 v252, v253
v_mul_f32 v252, 0x3c2aaaab, v252
v_mul_f32 v253, 0x3c2aaaab, v253
v_mul_f32 v15, v252, v252
v_sub_f32 v253, v253, v15
v_mul_f32 v15, 0x36800000, v15
v_max_f32 v253, v15, v253
v_add_f32 v253, 0x3727c5ac, v253
v_rsq_f32 v253, v253
s_nop 0
v_mul_f32 v253, 0xbeeff558, v253
v_mul_f32 v252, v252, v253
ds_read_b128 v[240:243], v2 offset:8192
ds_read_b128 v[244:247], v2 offset:11264
s_setprio 0
v_fma_f32 v160, v160, v253, -v252
v_fma_f32 v161, v161, v253, -v252
v_fma_f32 v162, v162, v253, -v252
v_fma_f32 v163, v163, v253, -v252
v_fma_f32 v172, v172, v253, -v252
v_fma_f32 v173, v173, v253, -v252
v_fma_f32 v174, v174, v253, -v252
v_fma_f32 v175, v175, v253, -v252
v_fma_f32 v184, v184, v253, -v252
v_fma_f32 v185, v185, v253, -v252
v_fma_f32 v186, v186, v253, -v252
v_fma_f32 v187, v187, v253, -v252
v_fma_f32 v196, v196, v253, -v252
v_fma_f32 v197, v197, v253, -v252
v_fma_f32 v198, v198, v253, -v252
v_fma_f32 v199, v199, v253, -v252
s_setprio 1
v_cvt_pk_bf16_f32 v136, v160, v161
v_cvt_pk_bf16_f32 v137, v162, v163
v_cvt_pk_bf16_f32 v148, v172, v173
v_cvt_pk_bf16_f32 v149, v174, v175
v_cvt_pk_bf16_f32 v138, v184, v185
v_cvt_pk_bf16_f32 v139, v186, v187
v_cvt_pk_bf16_f32 v150, v196, v197
v_cvt_pk_bf16_f32 v151, v198, v199
v_permlane16_swap_b32 v136, v148
v_permlane16_swap_b32 v137, v149
v_permlane16_swap_b32 v138, v150
v_permlane16_swap_b32 v139, v151
s_waitcnt lgkmcnt(0)
s_nop 0
v_mfma_f32_16x16x32_bf16 v[208:211], v[136:139], v[240:243], 0
v_mfma_f32_16x16x32_bf16 v[212:215], v[148:151], v[240:243], 0
s_setprio 0
v_fma_f32 v164, v164, v253, -v252
v_fma_f32 v165, v165, v253, -v252
v_fma_f32 v166, v166, v253, -v252
v_fma_f32 v167, v167, v253, -v252
v_fma_f32 v176, v176, v253, -v252
v_fma_f32 v177, v177, v253, -v252
v_fma_f32 v178, v178, v253, -v252
v_fma_f32 v179, v179, v253, -v252
v_fma_f32 v188, v188, v253, -v252
v_fma_f32 v189, v189, v253, -v252
v_fma_f32 v190, v190, v253, -v252
v_fma_f32 v191, v191, v253, -v252
v_fma_f32 v200, v200, v253, -v252
v_fma_f32 v201, v201, v253, -v252
v_fma_f32 v202, v202, v253, -v252
v_fma_f32 v203, v203, v253, -v252
ds_read_b128 v[248:251], v2 offset:9216
v_mfma_f32_16x16x32_bf16 v[216:219], v[136:139], v[244:247], 0
s_barrier
v_mfma_f32_16x16x32_bf16 v[220:223], v[148:151], v[244:247], 0
s_add_u32 m0, s40, 90112
s_add_u32 s3, s37, 983040
buffer_load_dwordx4 v4, s[4:7], s3 offen lds
s_setprio 1
ds_read_b128 v[240:243], v2 offset:12288
v_cvt_pk_bf16_f32 v140, v164, v165
v_cvt_pk_bf16_f32 v141, v166, v167
v_cvt_pk_bf16_f32 v152, v176, v177
v_cvt_pk_bf16_f32 v153, v178, v179
v_cvt_pk_bf16_f32 v142, v188, v189
v_cvt_pk_bf16_f32 v143, v190, v191
v_cvt_pk_bf16_f32 v154, v200, v201
v_cvt_pk_bf16_f32 v155, v202, v203
v_permlane16_swap_b32 v140, v152
v_permlane16_swap_b32 v141, v153
v_permlane16_swap_b32 v142, v154
v_permlane16_swap_b32 v143, v155
s_waitcnt lgkmcnt(0)
s_nop 0
v_mfma_f32_16x16x32_bf16 v[208:211], v[140:143], v[248:251], v[208:211]
s_setprio 0
v_fma_f32 v168, v168, v253, -v252
v_fma_f32 v169, v169, v253, -v252
v_fma_f32 v170, v170, v253, -v252
v_fma_f32 v171, v171, v253, -v252
v_fma_f32 v180, v180, v253, -v252
v_fma_f32 v181, v181, v253, -v252
v_fma_f32 v182, v182, v253, -v252
v_fma_f32 v183, v183, v253, -v252
v_fma_f32 v192, v192, v253, -v252
v_fma_f32 v193, v193, v253, -v252
v_fma_f32 v194, v194, v253, -v252
v_fma_f32 v195, v195, v253, -v252
v_fma_f32 v204, v204, v253, -v252
v_fma_f32 v205, v205, v253, -v252
v_fma_f32 v206, v206, v253, -v252
v_fma_f32 v207, v207, v253, -v252
v_mfma_f32_16x16x32_bf16 v[212:215], v[152:155], v[248:251], v[212:215]
ds_read_b128 v[244:247], v2 offset:10240
v_mfma_f32_16x16x32_bf16 v[216:219], v[140:143], v[240:243], v[216:219]
v_mfma_f32_16x16x32_bf16 v[220:223], v[152:155], v[240:243], v[220:223]
s_setprio 1
ds_read_b128 v[248:251], v2 offset:13312
v_cvt_pk_bf16_f32 v144, v168, v169
v_cvt_pk_bf16_f32 v145, v170, v171
v_cvt_pk_bf16_f32 v156, v180, v181
v_cvt_pk_bf16_f32 v157, v182, v183
v_cvt_pk_bf16_f32 v146, v192, v193
v_cvt_pk_bf16_f32 v147, v194, v195
v_cvt_pk_bf16_f32 v158, v204, v205
v_cvt_pk_bf16_f32 v159, v206, v207
v_permlane16_swap_b32 v144, v156
v_permlane16_swap_b32 v145, v157
v_permlane16_swap_b32 v146, v158
v_permlane16_swap_b32 v147, v159
s_waitcnt lgkmcnt(0)
s_nop 0
v_mfma_f32_16x16x32_bf16 v[208:211], v[144:147], v[244:247], v[208:211]
s_setprio 1
v_mfma_f32_16x16x32_bf16 v[212:215], v[156:159], v[244:247], v[212:215]
ds_read_b128 v[240:243], v2 offset:14336
v_mfma_f32_16x16x32_bf16 v[216:219], v[144:147], v[248:251], v[216:219]
v_mfma_f32_16x16x32_bf16 v[220:223], v[156:159], v[248:251], v[220:223]
ds_read_b128 v[244:247], v2 offset:15360
s_waitcnt lgkmcnt(1)
v_mfma_f32_16x16x32_bf16 v[160:163], v[136:139], v[240:243], 0
v_mfma_f32_16x16x32_bf16 v[164:167], v[148:151], v[240:243], 0
ds_read_b128 v[248:251], v2 offset:16384
s_waitcnt lgkmcnt(1)
v_mfma_f32_16x16x32_bf16 v[160:163], v[140:143], v[244:247], v[160:163]
v_mfma_f32_16x16x32_bf16 v[164:167], v[152:155], v[244:247], v[164:167]
s_add_u32 m0, s39, 90112
s_nop 0
buffer_load_dwordx4 v5, s[4:7], s3 offen lds
ds_read_b128 v[240:243], v2 offset:17408
s_waitcnt lgkmcnt(1)
v_mfma_f32_16x16x32_bf16 v[160:163], v[144:147], v[248:251], v[160:163]
v_mfma_f32_16x16x32_bf16 v[164:167], v[156:159], v[248:251], v[164:167]
ds_read_b128 v[244:247], v2 offset:18432
s_setprio 0
v_fmaak_f32 v224, v216, v216, 0x409d30fc
v_fmaak_f32 v225, v217, v217, 0x409d30fc
v_fmaak_f32 v226, v218, v218, 0x409d30fc
v_fmaak_f32 v227, v219, v219, 0x409d30fc
v_mul_f32 v224, v216, v224
v_mul_f32 v225, v217, v225
v_mul_f32 v226, v218, v226
v_mul_f32 v227, v219, v227
s_setprio 1
v_lshlrev_b32_sdwa v208, v6, v208 dst_sel:DWORD dst_unused:UNUSED_PAD src0_sel:DWORD src1_sel:WORD_1
s_waitcnt lgkmcnt(1)
v_mfma_f32_16x16x32_bf16 v[168:171], v[136:139], v[240:243], 0
ds_read_u16_d16_hi v208, v208
s_cmp_eq_u32 s32, 7
s_cbranch_scc0 L_tk0
s_lshl_b32 s44, s41, 2
v_mov_b32 v254, 1
v_mov_b32 v255, 0
s_mov_b64 exec, 1
buffer_atomic_add v254, v255, s[28:31], s44 offen sc0
s_mov_b64 exec, -1
s_nop 1
L_tk0:
v_exp_f32 v224, v224
v_lshlrev_b32_sdwa v209, v6, v209 dst_sel:DWORD dst_unused:UNUSED_PAD src0_sel:DWORD src1_sel:WORD_1
v_mfma_f32_16x16x32_bf16 v[172:175], v[148:151], v[240:243], 0
ds_read_u16_d16_hi v209, v209
ds_read_b128 v[248:251], v2 offset:19456
v_lshlrev_b32_sdwa v210, v6, v210 dst_sel:DWORD dst_unused:UNUSED_PAD src0_sel:DWORD src1_sel:WORD_1
s_waitcnt lgkmcnt(3)
v_mfma_f32_16x16x32_bf16 v[168:171], v[140:143], v[244:247], v[168:171]
ds_read_u16_d16_hi v210, v210
v_exp_f32 v225, v225
v_lshlrev_b32_sdwa v211, v6, v211 dst_sel:DWORD dst_unused:UNUSED_PAD src0_sel:DWORD src1_sel:WORD_1
v_mfma_f32_16x16x32_bf16 v[172:175], v[152:155], v[244:247], v[172:175]
ds_read_u16_d16_hi v211, v211
ds_read_b128 v[240:243], v2 offset:20480
v_exp_f32 v226, v226
v_lshlrev_b32_sdwa v212, v6, v212 dst_sel:DWORD dst_unused:UNUSED_PAD src0_sel:DWORD src1_sel:WORD_1
s_waitcnt lgkmcnt(3)
v_mfma_f32_16x16x32_bf16 v[168:171], v[144:147], v[248:251], v[168:171]
ds_read_u16_d16_hi v212, v212
v_lshlrev_b32_sdwa v213, v6, v213 dst_sel:DWORD dst_unused:UNUSED_PAD src0_sel:DWORD src1_sel:WORD_1
v_mfma_f32_16x16x32_bf16 v[172:175], v[156:159], v[248:251], v[172:175]
ds_read_u16_d16_hi v213, v213
ds_read_b128 v[244:247], v2 offset:21504
v_exp_f32 v227, v227
s_setprio 0
v_add_f32 v224, 1.0, v224
v_add_f32 v225, 1.0, v225
v_add_f32 v226, 1.0, v226
v_add_f32 v227, 1.0, v227
v_fmaak_f32 v228, v220, v220, 0x409d30fc
v_fmaak_f32 v229, v221, v221, 0x409d30fc
v_fmaak_f32 v230, v222, v222, 0x409d30fc
v_mul_f32 v228, v220, v228
v_mul_f32 v229, v221, v229
v_mul_f32 v230, v222, v230
s_setprio 1
v_lshlrev_b32_sdwa v214, v6, v214 dst_sel:DWORD dst_unused:UNUSED_PAD src0_sel:DWORD src1_sel:WORD_1
s_waitcnt lgkmcnt(0)
v_mfma_f32_16x16x32_bf16 v[176:179], v[136:139], v[240:243], 0
ds_read_u16_d16_hi v214, v214
v_rcp_f32 v224, v224
v_lshlrev_b32_sdwa v215, v6, v215 dst_sel:DWORD dst_unused:UNUSED_PAD src0_sel:DWORD src1_sel:WORD_1
v_mfma_f32_16x16x32_bf16 v[180:183], v[148:151], v[240:243], 0
ds_read_u16_d16_hi v215, v215
ds_read_b128 v[248:251], v2 offset:22528
v_rcp_f32 v225, v225
s_add_u32 m0, s40, 103424
s_add_u32 s3, s37, 1179648
buffer_load_dwordx4 v4, s[4:7], s3 offen lds
v_lshlrev_b32_sdwa v160, v6, v160 dst_sel:DWORD dst_unused:UNUSED_PAD src0_sel:DWORD src1_sel:WORD_1
v_mfma_f32_16x16x32_bf16 v[176:179], v[140:143], v[244:247], v[176:179]
ds_read_u16_d16_hi v160, v160
v_rcp_f32 v226, v226
v_lshlrev_b32_sdwa v161, v6, v161 dst_sel:DWORD dst_unused:UNUSED_PAD src0_sel:DWORD src1_sel:WORD_1
v_rcp_f32 v227, v227
v_mfma_f32_16x16x32_bf16 v[180:183], v[152:155], v[244:247], v[180:183]
ds_read_u16_d16_hi v161, v161
ds_read_b128 v[240:243], v2 offset:23552
v_exp_f32 v228, v228
v_lshlrev_b32_sdwa v162, v6, v162 dst_sel:DWORD dst_unused:UNUSED_PAD src0_sel:DWORD src1_sel:WORD_1
s_waitcnt lgkmcnt(3)
v_mfma_f32_16x16x32_bf16 v[176:179], v[144:147], v[248:251], v[176:179]
ds_read_u16_d16_hi v162, v162
v_exp_f32 v229, v229
v_mfma_f32_16x16x32_bf16 v[180:183], v[156:159], v[248:251], v[180:183]
ds_read_b128 v[244:247], v2 offset:24576
v_exp_f32 v230, v230
s_setprio 0
v_mul_f32 v224, v216, v224
v_mul_f32 v225, v217, v225
v_mul_f32 v226, v218, v226
v_mul_f32 v227, v219, v227
v_add_f32 v228, 1.0, v228
v_add_f32 v229, 1.0, v229
v_add_f32 v230, 1.0, v230
v_add_f32 v16, v208, v16
v_add_f32 v16, v209, v16
v_add_f32 v16, v210, v16
v_add_f32 v16, v211, v16
v_add_f32 v16, v212, v16
v_add_f32 v16, v213, v16
v_fmac_f32 v17, v224, v224
v_fmac_f32 v17, v225, v225
v_fmac_f32 v17, v226, v226
v_fmac_f32 v17, v227, v227
v_fmaak_f32 v231, v223, v223, 0x409d30fc
v_fmaak_f32 v232, v176, v176, 0x409d30fc
v_fmaak_f32 v233, v177, v177, 0x409d30fc
v_mul_f32 v231, v223, v231
v_mul_f32 v232, v176, v232
v_mul_f32 v233, v177, v233
s_setprio 1
v_lshlrev_b32_sdwa v163, v6, v163 dst_sel:DWORD dst_unused:UNUSED_PAD src0_sel:DWORD src1_sel:WORD_1
s_waitcnt lgkmcnt(0)
v_mfma_f32_16x16x32_bf16 v[184:187], v[136:139], v[240:243], 0
ds_read_u16_d16_hi v163, v163
v_rcp_f32 v228, v228
v_lshlrev_b32_sdwa v164, v6, v164 dst_sel:DWORD dst_unused:UNUSED_PAD src0_sel:DWORD src1_sel:WORD_1
v_mfma_f32_16x16x32_bf16 v[188:191], v[148:151], v[240:243], 0
ds_read_u16_d16_hi v164, v164
ds_read_b128 v[248:251], v2 offset:25600
v_rcp_f32 v229, v229
v_lshlrev_b32_sdwa v165, v6, v165 dst_sel:DWORD dst_unused:UNUSED_PAD src0_sel:DWORD src1_sel:WORD_1
v_mfma_f32_16x16x32_bf16 v[184:187], v[140:143], v[244:247], v[184:187]
ds_read_u16_d16_hi v165, v165
v_rcp_f32 v230, v230
v_lshlrev_b32_sdwa v166, v6, v166 dst_sel:DWORD dst_unused:UNUSED_PAD src0_sel:DWORD src1_sel:WORD_1
v_mfma_f32_16x16x32_bf16 v[188:191], v[152:155], v[244:247], v[188:191]
ds_read_u16_d16_hi v166, v166
ds_read_b128 v[240:243], v2 offset:29696
v_exp_f32 v231, v231
v_lshlrev_b32_sdwa v167, v6, v167 dst_sel:DWORD dst_unused:UNUSED_PAD src0_sel:DWORD src1_sel:WORD_1
s_waitcnt lgkmcnt(3)
v_mfma_f32_16x16x32_bf16 v[184:187], v[144:147], v[248:251], v[184:187]
ds_read_u16_d16_hi v167, v167
v_exp_f32 v232, v232
v_lshlrev_b32_sdwa v168, v6, v168 dst_sel:DWORD dst_unused:UNUSED_PAD src0_sel:DWORD src1_sel:WORD_1
v_mfma_f32_16x16x32_bf16 v[188:191], v[156:159], v[248:251], v[188:191]
ds_read_u16_d16_hi v168, v168
ds_read_b128 v[244:247], v2 offset:30720
s_add_u32 m0, s39, 103424
s_nop 0
buffer_load_dwordx4 v5, s[4:7], s3 offen lds
v_exp_f32 v233, v233
s_setprio 0
v_mul_f32 v228, v220, v228
v_mul_f32 v229, v221, v229
v_mul_f32 v230, v222, v230
v_add_f32 v231, 1.0, v231
v_add_f32 v232, 1.0, v232
v_add_f32 v233, 1.0, v233
v_add_f32 v16, v214, v16
v_add_f32 v16, v215, v16
v_add_f32 v18, v160, v18
v_add_f32 v18, v161, v18
v_add_f32 v18, v162, v18
v_fmac_f32 v17, v228, v228
v_fmac_f32 v17, v229, v229
v_fmac_f32 v17, v230, v230
v_fmaak_f32 v234, v178, v178, 0x409d30fc
v_fmaak_f32 v235, v179, v179, 0x409d30fc
v_fmaak_f32 v236, v180, v180, 0x409d30fc
v_fmaak_f32 v237, v181, v181, 0x409d30fc
v_mul_f32 v234, v178, v234
v_mul_f32 v235, v179, v235
v_mul_f32 v236, v180, v236
v_mul_f32 v237, v181, v237
s_setprio 1
v_lshlrev_b32_sdwa v169, v6, v169 dst_sel:DWORD dst_unused:UNUSED_PAD src0_sel:DWORD src1_sel:WORD_1
s_waitcnt lgkmcnt(0)
v_mfma_f32_16x16x32_bf16 v[192:195], v[136:139], v[240:243], 0
ds_read_u16_d16_hi v169, v169
v_rcp_f32 v231, v231
v_lshlrev_b32_sdwa v170, v6, v170 dst_sel:DWORD dst_unused:UNUSED_PAD src0_sel:DWORD src1_sel:WORD_1
v_mfma_f32_16x16x32_bf16 v[196:199], v[148:151], v[240:243], 0
ds_read_u16_d16_hi v170, v170
ds_read_b128 v[248:251], v2 offset:31744
v_rcp_f32 v232, v232
v_lshlrev_b32_sdwa v171, v6, v171 dst_sel:DWORD dst_unused:UNUSED_PAD src0_sel:DWORD src1_sel:WORD_1
v_mfma_f32_16x16x32_bf16 v[192:195], v[140:143], v[244:247], v[192:195]
ds_read_u16_d16_hi v171, v171
v_rcp_f32 v233, v233
v_lshlrev_b32_sdwa v172, v6, v172 dst_sel:DWORD dst_unused:UNUSED_PAD src0_sel:DWORD src1_sel:WORD_1
v_exp_f32 v234, v234
v_mfma_f32_16x16x32_bf16 v[196:199], v[152:155], v[244:247], v[196:199]
ds_read_u16_d16_hi v172, v172
ds_read_b128 v[240:243], v2 offset:26624
v_exp_f32 v235, v235
v_lshlrev_b32_sdwa v173, v6, v173 dst_sel:DWORD dst_unused:UNUSED_PAD src0_sel:DWORD src1_sel:WORD_1
s_waitcnt lgkmcnt(3)
v_mfma_f32_16x16x32_bf16 v[192:195], v[144:147], v[248:251], v[192:195]
ds_read_u16_d16_hi v173, v173
v_exp_f32 v236, v236
v_mfma_f32_16x16x32_bf16 v[196:199], v[156:159], v[248:251], v[196:199]
ds_read_b128 v[244:247], v2 offset:27648
v_exp_f32 v237, v237
s_setprio 0
v_mul_f32 v231, v223, v231
v_mul_f32 v232, v176, v232
v_mul_f32 v233, v177, v233
v_add_f32 v234, 1.0, v234
v_add_f32 v235, 1.0, v235
v_add_f32 v236, 1.0, v236
v_add_f32 v237, 1.0, v237
v_add_f32 v18, v163, v18
v_add_f32 v18, v164, v18
v_add_f32 v18, v165, v18
v_add_f32 v18, v166, v18
v_add_f32 v18, v167, v18
v_add_f32 v19, v168, v19
v_fmac_f32 v17, v231, v231
v_fmac_f32 v20, v232, v232
v_fmac_f32 v20, v233, v233
v_fmaak_f32 v238, v182, v182, 0x409d30fc
v_fmaak_f32 v239, v183, v183, 0x409d30fc
v_fmaak_f32 v224, v192, v192, 0x409d30fc
v_mul_f32 v238, v182, v238
v_mul_f32 v239, v183, v239
v_mul_f32 v224, v192, v224
s_setprio 1
v_lshlrev_b32_sdwa v174, v6, v174 dst_sel:DWORD dst_unused:UNUSED_PAD src0_sel:DWORD src1_sel:WORD_1
s_waitcnt lgkmcnt(0)
v_mfma_f32_16x16x32_bf16 v[200:203], v[136:139], v[240:243], 0
ds_read_u16_d16_hi v174, v174
v_rcp_f32 v234, v234
v_lshlrev_b32_sdwa v175, v6, v175 dst_sel:DWORD dst_unused:UNUSED_PAD src0_sel:DWORD src1_sel:WORD_1
v_mfma_f32_16x16x32_bf16 v[204:207], v[148:151], v[240:243], 0
ds_read_u16_d16_hi v175, v175
ds_read_b128 v[248:251], v2 offset:28672
v_rcp_f32 v235, v235
v_lshlrev_b32_sdwa v184, v6, v184 dst_sel:DWORD dst_unused:UNUSED_PAD src0_sel:DWORD src1_sel:WORD_1
v_mfma_f32_16x16x32_bf16 v[200:203], v[140:143], v[244:247], v[200:203]
ds_read_u16_d16_hi v184, v184
v_rcp_f32 v236, v236
s_add_u32 m0, s40, 116736
s_add_u32 s3, s37, 1376256
buffer_load_dwordx4 v4, s[4:7], s3 offen lds
v_lshlrev_b32_sdwa v185, v6, v185 dst_sel:DWORD dst_unused:UNUSED_PAD src0_sel:DWORD src1_sel:WORD_1
v_rcp_f32 v237, v237
v_mfma_f32_16x16x32_bf16 v[204:207], v[152:155], v[244:247], v[204:207]
ds_read_u16_d16_hi v185, v185
ds_read_b128 v[240:243], v2 offset:32768
v_exp_f32 v238, v238
v_lshlrev_b32_sdwa v186, v6, v186 dst_sel:DWORD dst_unused:UNUSED_PAD src0_sel:DWORD src1_sel:WORD_1
s_waitcnt lgkmcnt(3)
v_mfma_f32_16x16x32_bf16 v[200:203], v[144:147], v[248:251], v[200:203]
ds_read_u16_d16_hi v186, v186
v_exp_f32 v239, v239
v_lshlrev_b32_sdwa v187, v6, v187 dst_sel:DWORD dst_unused:UNUSED_PAD src0_sel:DWORD src1_sel:WORD_1
v_mfma_f32_16x16x32_bf16 v[204:207], v[156:159], v[248:251], v[204:207]
ds_read_u16_d16_hi v187, v187
ds_read_b128 v[244:247], v2 offset:33792
v_exp_f32 v224, v224
s_setprio 0
v_mul_f32 v234, v178, v234
v_mul_f32 v235, v179, v235
v_mul_f32 v236, v180, v236
v_mul_f32 v237, v181, v237
v_add_f32 v238, 1.0, v238
v_add_f32 v239, 1.0, v239
v_add_f32 v224, 1.0, v224
v_add_f32 v19, v169, v19
v_add_f32 v19, v170, v19
v_add_f32 v19, v171, v19
v_add_f32 v19, v172, v19
v_add_f32 v19, v173, v19
v_fmac_f32 v20, v234, v234
v_fmac_f32 v20, v235, v235
v_fmac_f32 v20, v236, v236
v_fmac_f32 v20, v237, v237
v_fmaak_f32 v225, v193, v193, 0x409d30fc
v_fmaak_f32 v226, v194, v194, 0x409d30fc
v_fmaak_f32 v227, v195, v195, 0x409d30fc
v_mul_f32 v225, v193, v225
v_mul_f32 v226, v194, v226
v_mul_f32 v227, v195, v227
s_setprio 1
v_lshlrev_b32_sdwa v188, v6, v188 dst_sel:DWORD dst_unused:UNUSED_PAD src0_sel:DWORD src1_sel:WORD_1
s_waitcnt lgkmcnt(0)
v_mfma_f32_16x16x32_bf16 v[208:211], v[136:139], v[240:243], 0
ds_read_u16_d16_hi v188, v188
v_rcp_f32 v238, v238
v_lshlrev_b32_sdwa v189, v6, v189 dst_sel:DWORD dst_unused:UNUSED_PAD src0_sel:DWORD src1_sel:WORD_1
v_mfma_f32_16x16x32_bf16 v[212:215], v[148:151], v[240:243], 0
ds_read_u16_d16_hi v189, v189
ds_read_b128 v[248:251], v2 offset:34816
v_rcp_f32 v239, v239
v_lshlrev_b32_sdwa v190, v6, v190 dst_sel:DWORD dst_unused:UNUSED_PAD src0_sel:DWORD src1_sel:WORD_1
v_mfma_f32_16x16x32_bf16 v[208:211], v[140:143], v[244:247], v[208:211]
ds_read_u16_d16_hi v190, v190
v_rcp_f32 v224, v224
v_lshlrev_b32_sdwa v191, v6, v191 dst_sel:DWORD dst_unused:UNUSED_PAD src0_sel:DWORD src1_sel:WORD_1
v_mfma_f32_16x16x32_bf16 v[212:215], v[152:155], v[244:247], v[212:215]
ds_read_u16_d16_hi v191, v191
ds_read_b128 v[240:243], v2 offset:38912
v_exp_f32 v225, v225
v_lshlrev_b32_sdwa v200, v6, v200 dst_sel:DWORD dst_unused:UNUSED_PAD src0_sel:DWORD src1_sel:WORD_1
s_waitcnt lgkmcnt(3)
v_mfma_f32_16x16x32_bf16 v[208:211], v[144:147], v[248:251], v[208:211]
ds_read_u16_d16_hi v200, v200
v_exp_f32 v226, v226
v_mfma_f32_16x16x32_bf16 v[212:215], v[156:159], v[248:251], v[212:215]
ds_read_b128 v[244:247], v2 offset:39936
v_exp_f32 v227, v227
s_setprio 0
v_mul_f32 v238, v182, v238
v_mul_f32 v239, v183, v239
v_mul_f32 v224, v192, v224
v_add_f32 v225, 1.0, v225
v_add_f32 v226, 1.0, v226
v_add_f32 v227, 1.0, v227
v_add_f32 v19, v174, v19
v_add_f32 v19, v175, v19
v_add_f32 v21, v184, v21
v_add_f32 v21, v185, v21
v_add_f32 v21, v186, v21
v_add_f32 v21, v187, v21
v_fmac_f32 v20, v238, v238
v_fmac_f32 v20, v239, v239
v_fmac_f32 v23, v224, v224
v_fmaak_f32 v228, v196, v196, 0x409d30fc
v_fmaak_f32 v229, v197, v197, 0x409d30fc
v_fmaak_f32 v230, v198, v198, 0x409d30fc
v_mul_f32 v228, v196, v228
v_mul_f32 v229, v197, v229
v_mul_f32 v230, v198, v230
s_setprio 1
v_lshlrev_b32_sdwa v201, v6, v201 dst_sel:DWORD dst_unused:UNUSED_PAD src0_sel:DWORD src1_sel:WORD_1
s_waitcnt lgkmcnt(0)
v_mfma_f32_16x16x32_bf16 v[216:219], v[136:139], v[240:243], 0
ds_read_u16_d16_hi v201, v201
s_add_u32 m0, s39, 116736
s_nop 0
buffer_load_dwordx4 v5, s[4:7], s3 offen lds
v_rcp_f32 v225, v225
v_lshlrev_b32_sdwa v202, v6, v202 dst_sel:DWORD dst_unused:UNUSED_PAD src0_sel:DWORD src1_sel:WORD_1
v_mfma_f32_16x16x32_bf16 v[220:223], v[148:151], v[240:243], 0
ds_read_u16_d16_hi v202, v202
ds_read_b128 v[248:251], v2 offset:40960
v_rcp_f32 v226, v226
v_lshlrev_b32_sdwa v203, v6, v203 dst_sel:DWORD dst_unused:UNUSED_PAD src0_sel:DWORD src1_sel:WORD_1
v_mfma_f32_16x16x32_bf16 v[216:219], v[140:143], v[244:247], v[216:219]
ds_read_u16_d16_hi v203, v203
v_rcp_f32 v227, v227
v_lshlrev_b32_sdwa v204, v6, v204 dst_sel:DWORD dst_unused:UNUSED_PAD src0_sel:DWORD src1_sel:WORD_1
v_mfma_f32_16x16x32_bf16 v[220:223], v[152:155], v[244:247], v[220:223]
ds_read_u16_d16_hi v204, v204
ds_read_b128 v[240:243], v2 offset:35840
v_exp_f32 v228, v228
v_lshlrev_b32_sdwa v205, v6, v205 dst_sel:DWORD dst_unused:UNUSED_PAD src0_sel:DWORD src1_sel:WORD_1
s_waitcnt lgkmcnt(3)
v_mfma_f32_16x16x32_bf16 v[216:219], v[144:147], v[248:251], v[216:219]
ds_read_u16_d16_hi v205, v205
v_exp_f32 v229, v229
v_lshlrev_b32_sdwa v206, v6, v206 dst_sel:DWORD dst_unused:UNUSED_PAD src0_sel:DWORD src1_sel:WORD_1
v_mfma_f32_16x16x32_bf16 v[220:223], v[156:159], v[248:251], v[220:223]
ds_read_u16_d16_hi v206, v206
ds_read_b128 v[244:247], v2 offset:36864
v_exp_f32 v230, v230
s_setprio 0
v_mul_f32 v225, v193, v225
v_mul_f32 v226, v194, v226
v_mul_f32 v227, v195, v227
v_add_f32 v228, 1.0, v228
v_add_f32 v229, 1.0, v229
v_add_f32 v230, 1.0, v230
v_add_f32 v21, v188, v21
v_add_f32 v21, v189, v21
v_add_f32 v21, v190, v21
v_add_f32 v21, v191, v21
v_add_f32 v22, v200, v22
v_fmac_f32 v23, v225, v225
v_fmac_f32 v23, v226, v226
v_fmac_f32 v23, v227, v227
v_fmaak_f32 v232, v216, v216, 0x409d30fc
v_fmaak_f32 v233, v217, v217, 0x409d30fc
v_fmaak_f32 v234, v218, v218, 0x409d30fc
v_fmaak_f32 v231, v199, v199, 0x409d30fc
v_mul_f32 v232, v216, v232
v_mul_f32 v233, v217, v233
v_mul_f32 v234, v218, v234
v_mul_f32 v231, v199, v231
s_setprio 1
v_lshlrev_b32_sdwa v207, v6, v207 dst_sel:DWORD dst_unused:UNUSED_PAD src0_sel:DWORD src1_sel:WORD_1
s_waitcnt lgkmcnt(0)
v_mfma_f32_16x16x32_bf16 v[160:163], v[136:139], v[240:243], 0
ds_read_u16_d16_hi v207, v207
v_rcp_f32 v228, v228
v_lshlrev_b32_sdwa v208, v6, v208 dst_sel:DWORD dst_unused:UNUSED_PAD src0_sel:DWORD src1_sel:WORD_1
v_mfma_f32_16x16x32_bf16 v[164:167], v[148:151], v[240:243], 0
ds_read_u16_d16_hi v208, v208
ds_read_b128 v[248:251], v2 offset:37888
v_rcp_f32 v229, v229
v_lshlrev_b32_sdwa v209, v6, v209 dst_sel:DWORD dst_unused:UNUSED_PAD src0_sel:DWORD src1_sel:WORD_1
v_mfma_f32_16x16x32_bf16 v[160:163], v[140:143], v[244:247], v[160:163]
ds_read_u16_d16_hi v209, v209
v_rcp_f32 v230, v230
v_lshlrev_b32_sdwa v210, v6, v210 dst_sel:DWORD dst_unused:UNUSED_PAD src0_sel:DWORD src1_sel:WORD_1
v_exp_f32 v231, v231
v_mfma_f32_16x16x32_bf16 v[164:167], v[152:155], v[244:247], v[164:167]
ds_read_u16_d16_hi v210, v210
ds_read_b128 v[240:243], v2 offset:41984
v_exp_f32 v232, v232
v_lshlrev_b32_sdwa v211, v6, v211 dst_sel:DWORD dst_unused:UNUSED_PAD src0_sel:DWORD src1_sel:WORD_1
s_waitcnt lgkmcnt(3)
v_mfma_f32_16x16x32_bf16 v[160:163], v[144:147], v[248:251], v[160:163]
ds_read_u16_d16_hi v211, v211
s_add_u32 m0, s40, 130048
s_add_u32 s3, s37, 1572864
buffer_load_dwordx4 v4, s[4:7], s3 offen lds
v_exp_f32 v233, v233
v_mfma_f32_16x16x32_bf16 v[164:167], v[156:159], v[248:251], v[164:167]
ds_read_b128 v[244:247], v2 offset:43008
v_exp_f32 v234, v234
s_setprio 0
v_mul_f32 v228, v196, v228
v_mul_f32 v229, v197, v229
v_mul_f32 v230, v198, v230
v_add_f32 v232, 1.0, v232
v_add_f32 v233, 1.0, v233
v_add_f32 v234, 1.0, v234
v_add_f32 v231, 1.0, v231
v_add_f32 v22, v201, v22
v_add_f32 v22, v202, v22
v_add_f32 v22, v203, v22
v_add_f32 v22, v204, v22
v_add_f32 v22, v205, v22
v_add_f32 v22, v206, v22
v_fmac_f32 v23, v228, v228
v_fmac_f32 v23, v229, v229
v_fmac_f32 v23, v230, v230
v_fmaak_f32 v235, v219, v219, 0x409d30fc
v_fmaak_f32 v236, v220, v220, 0x409d30fc
v_fmaak_f32 v237, v221, v221, 0x409d30fc
v_mul_f32 v235, v219, v235
v_mul_f32 v236, v220, v236
v_mul_f32 v237, v221, v237
s_setprio 1
v_lshlrev_b32_sdwa v212, v6, v212 dst_sel:DWORD dst_unused:UNUSED_PAD src0_sel:DWORD src1_sel:WORD_1
s_waitcnt lgkmcnt(0)
v_mfma_f32_16x16x32_bf16 v[168:171], v[136:139], v[240:243], 0
ds_read_u16_d16_hi v212, v212
v_rcp_f32 v231, v231
v_lshlrev_b32_sdwa v213, v6, v213 dst_sel:DWORD dst_unused:UNUSED_PAD src0_sel:DWORD src1_sel:WORD_1
v_mfma_f32_16x16x32_bf16 v[172:175], v[148:151], v[240:243], 0
ds_read_u16_d16_hi v213, v213
ds_read_b128 v[248:251], v2 offset:44032
v_rcp_f32 v232, v232
v_lshlrev_b32_sdwa v214, v6, v214 dst_sel:DWORD dst_unused:UNUSED_PAD src0_sel:DWORD src1_sel:WORD_1
v_mfma_f32_16x16x32_bf16 v[168:171], v[140:143], v[244:247], v[168:171]
ds_read_u16_d16_hi v214, v214
v_rcp_f32 v233, v233
v_lshlrev_b32_sdwa v215, v6, v215 dst_sel:DWORD dst_unused:UNUSED_PAD src0_sel:DWORD src1_sel:WORD_1
v_rcp_f32 v234, v234
v_mfma_f32_16x16x32_bf16 v[172:175], v[152:155], v[244:247], v[172:175]
ds_read_u16_d16_hi v215, v215
ds_read_b128 v[240:243], v2 offset:48128
v_exp_f32 v235, v235
v_lshlrev_b32_sdwa v160, v6, v160 dst_sel:DWORD dst_unused:UNUSED_PAD src0_sel:DWORD src1_sel:WORD_1
s_waitcnt lgkmcnt(3)
v_mfma_f32_16x16x32_bf16 v[168:171], v[144:147], v[248:251], v[168:171]
ds_read_u16_d16_hi v160, v160
v_exp_f32 v236, v236
v_lshlrev_b32_sdwa v161, v6, v161 dst_sel:DWORD dst_unused:UNUSED_PAD src0_sel:DWORD src1_sel:WORD_1
v_mfma_f32_16x16x32_bf16 v[172:175], v[156:159], v[248:251], v[172:175]
ds_read_u16_d16_hi v161, v161
ds_read_b128 v[244:247], v2 offset:49152
v_exp_f32 v237, v237
s_setprio 0
v_mul_f32 v232, v216, v232
v_mul_f32 v233, v217, v233
v_mul_f32 v234, v218, v234
v_mul_f32 v231, v199, v231
v_add_f32 v235, 1.0, v235
v_add_f32 v236, 1.0, v236
v_add_f32 v237, 1.0, v237
v_add_f32 v24, v208, v24
v_add_f32 v24, v209, v24
v_add_f32 v24, v210, v24
v_add_f32 v24, v211, v24
v_add_f32 v22, v207, v22
v_fmac_f32 v26, v232, v232
v_fmac_f32 v26, v233, v233
v_fmac_f32 v26, v234, v234
v_fmac_f32 v23, v231, v231
v_fmaak_f32 v224, v222, v222, 0x409d30fc
v_fmaak_f32 v238, v223, v223, 0x409d30fc
v_mul_f32 v224, v222, v224
v_mul_f32 v238, v223, v238
s_setprio 1
v_lshlrev_b32_sdwa v162, v6, v162 dst_sel:DWORD dst_unused:UNUSED_PAD src0_sel:DWORD src1_sel:WORD_1
s_waitcnt lgkmcnt(0)
v_mfma_f32_16x16x32_bf16 v[176:179], v[136:139], v[240:243], 0
ds_read_u16_d16_hi v162, v162
v_rcp_f32 v235, v235
v_lshlrev_b32_sdwa v163, v6, v163 dst_sel:DWORD dst_unused:UNUSED_PAD src0_sel:DWORD src1_sel:WORD_1
v_mfma_f32_16x16x32_bf16 v[180:183], v[148:151], v[240:243], 0
ds_read_u16_d16_hi v163, v163
ds_read_b128 v[248:251], v2 offset:50176
s_add_u32 m0, s39, 130048
s_nop 0
buffer_load_dwordx4 v5, s[4:7], s3 offen lds
v_rcp_f32 v236, v236
v_lshlrev_b32_sdwa v164, v6, v164 dst_sel:DWORD dst_unused:UNUSED_PAD src0_sel:DWORD src1_sel:WORD_1
v_mfma_f32_16x16x32_bf16 v[176:179], v[140:143], v[244:247], v[176:179]
ds_read_u16_d16_hi v164, v164
v_lshlrev_b32_sdwa v165, v6, v165 dst_sel:DWORD dst_unused:UNUSED_PAD src0_sel:DWORD src1_sel:WORD_1
v_rcp_f32 v237, v237
v_mfma_f32_16x16x32_bf16 v[180:183], v[152:155], v[244:247], v[180:183]
ds_read_u16_d16_hi v165, v165
ds_read_b128 v[240:243], v2 offset:45056
v_lshlrev_b32_sdwa v166, v6, v166 dst_sel:DWORD dst_unused:UNUSED_PAD src0_sel:DWORD src1_sel:WORD_1
s_waitcnt lgkmcnt(3)
v_mfma_f32_16x16x32_bf16 v[176:179], v[144:147], v[248:251], v[176:179]
ds_read_u16_d16_hi v166, v166
v_exp_f32 v224, v224
v_mfma_f32_16x16x32_bf16 v[180:183], v[156:159], v[248:251], v[180:183]
ds_read_b128 v[244:247], v2 offset:46080
v_exp_f32 v238, v238
s_setprio 0
v_mul_f32 v235, v219, v235
v_mul_f32 v236, v220, v236
v_mul_f32 v237, v221, v237
v_add_f32 v224, 1.0, v224
v_add_f32 v238, 1.0, v238
v_add_f32 v24, v212, v24
v_add_f32 v24, v213, v24
v_add_f32 v24, v214, v24
v_add_f32 v24, v215, v24
v_add_f32 v25, v160, v25
v_add_f32 v25, v161, v25
v_fmac_f32 v26, v235, v235
v_fmac_f32 v26, v236, v236
v_fmac_f32 v26, v237, v237
v_fmaak_f32 v239, v176, v176, 0x409d30fc
v_fmaak_f32 v225, v177, v177, 0x409d30fc
v_fmaak_f32 v226, v178, v178, 0x409d30fc
v_fmaak_f32 v227, v179, v179, 0x409d30fc
v_mul_f32 v239, v176, v239
v_mul_f32 v225, v177, v225
v_mul_f32 v226, v178, v226
v_mul_f32 v227, v179, v227
s_setprio 1
v_lshlrev_b32_sdwa v167, v6, v167 dst_sel:DWORD dst_unused:UNUSED_PAD src0_sel:DWORD src1_sel:WORD_1
s_waitcnt lgkmcnt(0)
v_mfma_f32_16x16x32_bf16 v[184:187], v[136:139], v[240:243], 0
ds_read_u16_d16_hi v167, v167
v_rcp_f32 v224, v224
v_lshlrev_b32_sdwa v168, v6, v168 dst_sel:DWORD dst_unused:UNUSED_PAD src0_sel:DWORD src1_sel:WORD_1
v_mfma_f32_16x16x32_bf16 v[188:191], v[148:151], v[240:243], 0
ds_read_u16_d16_hi v168, v168
ds_read_b128 v[248:251], v2 offset:47104
v_rcp_f32 v238, v238
v_lshlrev_b32_sdwa v169, v6, v169 dst_sel:DWORD dst_unused:UNUSED_PAD src0_sel:DWORD src1_sel:WORD_1
v_mfma_f32_16x16x32_bf16 v[184:187], v[140:143], v[244:247], v[184:187]
ds_read_u16_d16_hi v169, v169
v_exp_f32 v239, v239
v_lshlrev_b32_sdwa v170, v6, v170 dst_sel:DWORD dst_unused:UNUSED_PAD src0_sel:DWORD src1_sel:WORD_1
v_mfma_f32_16x16x32_bf16 v[188:191], v[152:155], v[244:247], v[188:191]
ds_read_u16_d16_hi v170, v170
ds_read_b128 v[240:243], v2 offset:57344
v_exp_f32 v225, v225
v_lshlrev_b32_sdwa v171, v6, v171 dst_sel:DWORD dst_unused:UNUSED_PAD src0_sel:DWORD src1_sel:WORD_1
s_waitcnt lgkmcnt(3)
v_mfma_f32_16x16x32_bf16 v[184:187], v[144:147], v[248:251], v[184:187]
ds_read_u16_d16_hi v171, v171
v_exp_f32 v226, v226
v_mfma_f32_16x16x32_bf16 v[188:191], v[156:159], v[248:251], v[188:191]
ds_read_b128 v[244:247], v2 offset:58368
v_exp_f32 v227, v227
s_setprio 0
v_mul_f32 v224, v222, v224
v_mul_f32 v238, v223, v238
v_add_f32 v239, 1.0, v239
v_add_f32 v225, 1.0, v225
v_add_f32 v226, 1.0, v226
v_add_f32 v227, 1.0, v227
v_add_f32 v25, v162, v25
v_add_f32 v25, v163, v25
v_add_f32 v25, v164, v25
v_add_f32 v25, v165, v25
v_add_f32 v25, v166, v25
v_fmac_f32 v26, v224, v224
v_fmac_f32 v26, v238, v238
v_fmaak_f32 v228, v180, v180, 0x409d30fc
v_fmaak_f32 v229, v181, v181, 0x409d30fc
v_fmaak_f32 v230, v182, v182, 0x409d30fc
v_fmaak_f32 v231, v183, v183, 0x409d30fc
v_mul_f32 v228, v180, v228
v_mul_f32 v229, v181, v229
v_mul_f32 v230, v182, v230
v_mul_f32 v231, v183, v231
s_setprio 1
v_lshlrev_b32_sdwa v172, v6, v172 dst_sel:DWORD dst_unused:UNUSED_PAD src0_sel:DWORD src1_sel:WORD_1
s_waitcnt lgkmcnt(0)
v_mfma_f32_16x16x32_bf16 v[192:195], v[136:139], v[240:243], 0
ds_read_u16_d16_hi v172, v172
v_rcp_f32 v239, v239
v_lshlrev_b32_sdwa v173, v6, v173 dst_sel:DWORD dst_unused:UNUSED_PAD src0_sel:DWORD src1_sel:WORD_1
v_mfma_f32_16x16x32_bf16 v[196:199], v[148:151], v[240:243], 0
ds_read_u16_d16_hi v173, v173
ds_read_b128 v[248:251], v2 offset:59392
v_rcp_f32 v225, v225
v_rcp_f32 v226, v226
v_lshlrev_b32_sdwa v174, v6, v174 dst_sel:DWORD dst_unused:UNUSED_PAD src0_sel:DWORD src1_sel:WORD_1
v_mfma_f32_16x16x32_bf16 v[192:195], v[140:143], v[244:247], v[192:195]
ds_read_u16_d16_hi v174, v174
v_rcp_f32 v227, v227
v_lshlrev_b32_sdwa v175, v6, v175 dst_sel:DWORD dst_unused:UNUSED_PAD src0_sel:DWORD src1_sel:WORD_1
v_mfma_f32_16x16x32_bf16 v[196:199], v[152:155], v[244:247], v[196:199]
ds_read_u16_d16_hi v175, v175
ds_read_b128 v[240:243], v2 offset:51200
s_add_u32 s62, s38, 0
buffer_store_dwordx4 v[136:139], v2, s[8:11], s62 offen offset:0
v_exp_f32 v228, v228
v_lshlrev_b32_sdwa v184, v6, v184 dst_sel:DWORD dst_unused:UNUSED_PAD src0_sel:DWORD src1_sel:WORD_1
s_waitcnt lgkmcnt(3)
v_mfma_f32_16x16x32_bf16 v[192:195], v[144:147], v[248:251], v[192:195]
ds_read_u16_d16_hi v184, v184
v_exp_f32 v229, v229
v_exp_f32 v230, v230
v_lshlrev_b32_sdwa v185, v6, v185 dst_sel:DWORD dst_unused:UNUSED_PAD src0_sel:DWORD src1_sel:WORD_1
v_mfma_f32_16x16x32_bf16 v[196:199], v[156:159], v[248:251], v[196:199]
ds_read_u16_d16_hi v185, v185
ds_read_b128 v[244:247], v2 offset:52224
v_exp_f32 v231, v231
s_setprio 0
v_mul_f32 v239, v176, v239
v_mul_f32 v225, v177, v225
v_mul_f32 v226, v178, v226
v_mul_f32 v227, v179, v227
v_add_f32 v228, 1.0, v228
v_add_f32 v229, 1.0, v229
v_add_f32 v230, 1.0, v230
v_add_f32 v231, 1.0, v231
v_add_f32 v25, v167, v25
v_add_f32 v27, v168, v27
v_add_f32 v27, v169, v27
v_add_f32 v27, v170, v27
v_add_f32 v27, v171, v27
v_fmac_f32 v29, v239, v239
v_fmac_f32 v29, v225, v225
v_fmac_f32 v29, v226, v226
v_fmac_f32 v29, v227, v227
v_fmaak_f32 v232, v192, v192, 0x409d30fc
v_fmaak_f32 v233, v193, v193, 0x409d30fc
v_fmaak_f32 v234, v194, v194, 0x409d30fc
v_mul_f32 v232, v192, v232
v_mul_f32 v233, v193, v233
v_mul_f32 v234, v194, v234
s_setprio 1
v_lshlrev_b32_sdwa v186, v6, v186 dst_sel:DWORD dst_unused:UNUSED_PAD src0_sel:DWORD src1_sel:WORD_1
s_waitcnt lgkmcnt(0)
v_mfma_f32_16x16x32_bf16 v[200:203], v[136:139], v[240:243], 0
ds_read_u16_d16_hi v186, v186
v_rcp_f32 v228, v228
v_lshlrev_b32_sdwa v187, v6, v187 dst_sel:DWORD dst_unused:UNUSED_PAD src0_sel:DWORD src1_sel:WORD_1
v_mfma_f32_16x16x32_bf16 v[204:207], v[148:151], v[240:243], 0
ds_read_u16_d16_hi v187, v187
ds_read_b128 v[248:251], v2 offset:53248
v_rcp_f32 v229, v229
v_lshlrev_b32_sdwa v188, v6, v188 dst_sel:DWORD dst_unused:UNUSED_PAD src0_sel:DWORD src1_sel:WORD_1
v_mfma_f32_16x16x32_bf16 v[200:203], v[140:143], v[244:247], v[200:203]
ds_read_u16_d16_hi v188, v188
v_rcp_f32 v230, v230
v_lshlrev_b32_sdwa v189, v6, v189 dst_sel:DWORD dst_unused:UNUSED_PAD src0_sel:DWORD src1_sel:WORD_1
v_rcp_f32 v231, v231
v_mfma_f32_16x16x32_bf16 v[204:207], v[152:155], v[244:247], v[204:207]
ds_read_u16_d16_hi v189, v189
ds_read_b128 v[240:243], v2 offset:54272
v_exp_f32 v232, v232
v_lshlrev_b32_sdwa v190, v6, v190 dst_sel:DWORD dst_unused:UNUSED_PAD src0_sel:DWORD src1_sel:WORD_1
s_waitcnt lgkmcnt(3)
v_mfma_f32_16x16x32_bf16 v[200:203], v[144:147], v[248:251], v[200:203]
ds_read_u16_d16_hi v190, v190
v_exp_f32 v233, v233
v_mfma_f32_16x16x32_bf16 v[204:207], v[156:159], v[248:251], v[204:207]
ds_read_b128 v[244:247], v2 offset:55296
v_exp_f32 v234, v234
s_setprio 0
v_mul_f32 v228, v180, v228
v_mul_f32 v229, v181, v229
v_mul_f32 v230, v182, v230
v_mul_f32 v231, v183, v231
v_add_f32 v232, 1.0, v232
v_add_f32 v233, 1.0, v233
v_add_f32 v234, 1.0, v234
v_add_f32 v27, v172, v27
v_add_f32 v27, v173, v27
v_add_f32 v27, v174, v27
v_add_f32 v27, v175, v27
v_add_f32 v28, v184, v28
v_add_f32 v28, v185, v28
v_fmac_f32 v29, v228, v228
v_fmac_f32 v29, v229, v229
v_fmac_f32 v29, v230, v230
v_fmac_f32 v29, v231, v231
v_fmaak_f32 v235, v195, v195, 0x409d30fc
v_fmaak_f32 v236, v196, v196, 0x409d30fc
v_fmaak_f32 v237, v197, v197, 0x409d30fc
v_mul_f32 v235, v195, v235
v_mul_f32 v236, v196, v236
v_mul_f32 v237, v197, v237
s_setprio 1
v_lshlrev_b32_sdwa v191, v6, v191 dst_sel:DWORD dst_unused:UNUSED_PAD src0_sel:DWORD src1_sel:WORD_1
s_waitcnt lgkmcnt(0)
v_mfma_f32_16x16x32_bf16 v[208:211], v[136:139], v[240:243], 0
ds_read_u16_d16_hi v191, v191
buffer_store_dwordx4 v[140:143], v2, s[8:11], s62 offen offset:1024
v_rcp_f32 v232, v232
v_lshlrev_b32_sdwa v200, v6, v200 dst_sel:DWORD dst_unused:UNUSED_PAD src0_sel:DWORD src1_sel:WORD_1
v_mfma_f32_16x16x32_bf16 v[212:215], v[148:151], v[240:243], 0
ds_read_u16_d16_hi v200, v200
ds_read_b128 v[248:251], v2 offset:56320
v_rcp_f32 v233, v233
v_lshlrev_b32_sdwa v201, v6, v201 dst_sel:DWORD dst_unused:UNUSED_PAD src0_sel:DWORD src1_sel:WORD_1
v_mfma_f32_16x16x32_bf16 v[208:211], v[140:143], v[244:247], v[208:211]
ds_read_u16_d16_hi v201, v201
v_rcp_f32 v234, v234
v_lshlrev_b32_sdwa v202, v6, v202 dst_sel:DWORD dst_unused:UNUSED_PAD src0_sel:DWORD src1_sel:WORD_1
v_mfma_f32_16x16x32_bf16 v[212:215], v[152:155], v[244:247], v[212:215]
ds_read_u16_d16_hi v202, v202
ds_read_b128 v[240:243], v3 offset:9216
v_exp_f32 v235, v235
v_lshlrev_b32_sdwa v203, v6, v203 dst_sel:DWORD dst_unused:UNUSED_PAD src0_sel:DWORD src1_sel:WORD_1
s_waitcnt lgkmcnt(3)
v_mfma_f32_16x16x32_bf16 v[208:211], v[144:147], v[248:251], v[208:211]
ds_read_u16_d16_hi v203, v203
v_exp_f32 v236, v236
v_lshlrev_b32_sdwa v204, v6, v204 dst_sel:DWORD dst_unused:UNUSED_PAD src0_sel:DWORD src1_sel:WORD_1
v_mfma_f32_16x16x32_bf16 v[212:215], v[156:159], v[248:251], v[212:215]
ds_read_u16_d16_hi v204, v204
ds_read_b128 v[244:247], v3 offset:10240
v_exp_f32 v237, v237
s_setprio 0
v_mul_f32 v232, v192, v232
v_mul_f32 v233, v193, v233
v_mul_f32 v234, v194, v234
v_add_f32 v235, 1.0, v235
v_add_f32 v236, 1.0, v236
v_add_f32 v237, 1.0, v237
v_add_f32 v28, v186, v28
v_add_f32 v28, v187, v28
v_add_f32 v28, v188, v28
v_add_f32 v28, v189, v28
v_add_f32 v28, v190, v28
v_fmac_f32 v32, v232, v232
v_fmac_f32 v32, v233, v233
v_fmac_f32 v32, v234, v234
v_fmaak_f32 v224, v198, v198, 0x409d30fc
v_fmaak_f32 v238, v199, v199, 0x409d30fc
v_mul_f32 v224, v198, v224
v_mul_f32 v238, v199, v238
s_setprio 1
v_lshlrev_b32_sdwa v205, v6, v205 dst_sel:DWORD dst_unused:UNUSED_PAD src0_sel:DWORD src1_sel:WORD_1
s_waitcnt lgkmcnt(0)
v_mfma_f32_16x16x32_bf16 v[216:219], v[136:139], v[240:243], 0
ds_read_u16_d16_hi v205, v205
v_rcp_f32 v235, v235
v_lshlrev_b32_sdwa v206, v6, v206 dst_sel:DWORD dst_unused:UNUSED_PAD src0_sel:DWORD src1_sel:WORD_1
v_mfma_f32_16x16x32_bf16 v[220:223], v[148:151], v[240:243], 0
ds_read_u16_d16_hi v206, v206
ds_read_b128 v[248:251], v3 offset:11264
v_rcp_f32 v236, v236
v_lshlrev_b32_sdwa v207, v6, v207 dst_sel:DWORD dst_unused:UNUSED_PAD src0_sel:DWORD src1_sel:WORD_1
v_mfma_f32_16x16x32_bf16 v[216:219], v[140:143], v[244:247], v[216:219]
ds_read_u16_d16_hi v207, v207
v_lshlrev_b32_sdwa v208, v6, v208 dst_sel:DWORD dst_unused:UNUSED_PAD src0_sel:DWORD src1_sel:WORD_1
v_rcp_f32 v237, v237
v_mfma_f32_16x16x32_bf16 v[220:223], v[152:155], v[244:247], v[220:223]
ds_read_u16_d16_hi v208, v208
ds_read_b128 v[240:243], v2 offset:60416
buffer_store_dwordx4 v[144:147], v2, s[8:11], s62 offen offset:2048
v_lshlrev_b32_sdwa v209, v6, v209 dst_sel:DWORD dst_unused:UNUSED_PAD src0_sel:DWORD src1_sel:WORD_1
s_waitcnt lgkmcnt(3)
v_mfma_f32_16x16x32_bf16 v[216:219], v[144:147], v[248:251], v[216:219]
ds_read_u16_d16_hi v209, v209
v_exp_f32 v224, v224
v_mfma_f32_16x16x32_bf16 v[220:223], v[156:159], v[248:251], v[220:223]
ds_read_b128 v[244:247], v2 offset:61440
v_exp_f32 v238, v238
s_setprio 0
v_mul_f32 v235, v195, v235
v_mul_f32 v236, v196, v236
v_mul_f32 v237, v197, v237
v_add_f32 v224, 1.0, v224
v_add_f32 v238, 1.0, v238
v_add_f32 v28, v191, v28
v_add_f32 v30, v200, v30
v_add_f32 v30, v201, v30
v_add_f32 v30, v202, v30
v_add_f32 v30, v203, v30
v_add_f32 v30, v204, v30
v_fmac_f32 v32, v235, v235
v_fmac_f32 v32, v236, v236
v_fmac_f32 v32, v237, v237
v_fmaak_f32 v225, v216, v216, 0x409d30fc
v_fmaak_f32 v226, v217, v217, 0x409d30fc
v_fmaak_f32 v227, v218, v218, 0x409d30fc
v_fmaak_f32 v239, v219, v219, 0x409d30fc
v_fmaak_f32 v228, v220, v220, 0x409d30fc
v_mul_f32 v225, v216, v225
v_mul_f32 v226, v217, v226
v_mul_f32 v227, v218, v227
v_mul_f32 v239, v219, v239
v_mul_f32 v228, v220, v228
s_setprio 1
v_lshlrev_b32_sdwa v210, v6, v210 dst_sel:DWORD dst_unused:UNUSED_PAD src0_sel:DWORD src1_sel:WORD_1
s_waitcnt lgkmcnt(0)
v_mfma_f32_16x16x32_bf16 v[160:163], v[136:139], v[240:243], 0
ds_read_u16_d16_hi v210, v210
v_rcp_f32 v224, v224
v_lshlrev_b32_sdwa v211, v6, v211 dst_sel:DWORD dst_unused:UNUSED_PAD src0_sel:DWORD src1_sel:WORD_1
v_mfma_f32_16x16x32_bf16 v[164:167], v[148:151], v[240:243], 0
ds_read_u16_d16_hi v211, v211
ds_read_b128 v[248:251], v2 offset:62464
v_rcp_f32 v238, v238
v_lshlrev_b32_sdwa v212, v6, v212 dst_sel:DWORD dst_unused:UNUSED_PAD src0_sel:DWORD src1_sel:WORD_1
v_mfma_f32_16x16x32_bf16 v[160:163], v[140:143], v[244:247], v[160:163]
ds_read_u16_d16_hi v212, v212
v_exp_f32 v225, v225
v_lshlrev_b32_sdwa v213, v6, v213 dst_sel:DWORD dst_unused:UNUSED_PAD src0_sel:DWORD src1_sel:WORD_1
v_exp_f32 v226, v226
v_mfma_f32_16x16x32_bf16 v[164:167], v[152:155], v[244:247], v[164:167]
ds_read_u16_d16_hi v213, v213
ds_read_b128 v[240:243], v2 offset:63488
v_exp_f32 v227, v227
v_lshlrev_b32_sdwa v214, v6, v214 dst_sel:DWORD dst_unused:UNUSED_PAD src0_sel:DWORD src1_sel:WORD_1
s_waitcnt lgkmcnt(3)
v_mfma_f32_16x16x32_bf16 v[160:163], v[144:147], v[248:251], v[160:163]
ds_read_u16_d16_hi v214, v214
v_exp_f32 v239, v239
v_lshlrev_b32_sdwa v215, v6, v215 dst_sel:DWORD dst_unused:UNUSED_PAD src0_sel:DWORD src1_sel:WORD_1
v_mfma_f32_16x16x32_bf16 v[164:167], v[156:159], v[248:251], v[164:167]
ds_read_u16_d16_hi v215, v215
ds_read_b128 v[244:247], v2 offset:64512
v_exp_f32 v228, v228
s_setprio 0
v_mul_f32 v224, v198, v224
v_mul_f32 v238, v199, v238
v_add_f32 v225, 1.0, v225
v_add_f32 v226, 1.0, v226
v_add_f32 v227, 1.0, v227
v_add_f32 v239, 1.0, v239
v_add_f32 v228, 1.0, v228
v_add_f32 v31, v208, v31
v_add_f32 v31, v209, v31
v_add_f32 v30, v205, v30
v_add_f32 v30, v206, v30
v_add_f32 v30, v207, v30
v_fmac_f32 v32, v224, v224
v_fmac_f32 v32, v238, v238
v_fmaak_f32 v229, v221, v221, 0x409d30fc
v_fmaak_f32 v230, v222, v222, 0x409d30fc
v_fmaak_f32 v231, v223, v223, 0x409d30fc
v_mul_f32 v229, v221, v229
v_mul_f32 v230, v222, v230
v_mul_f32 v231, v223, v231
s_setprio 1
v_lshlrev_b32_sdwa v160, v6, v160 dst_sel:DWORD dst_unused:UNUSED_PAD src0_sel:DWORD src1_sel:WORD_1
s_waitcnt lgkmcnt(0)
v_mfma_f32_16x16x32_bf16 v[168:171], v[136:139], v[240:243], 0
ds_read_u16_d16_hi v160, v160
s_add_u32 s62, s38, 3072
buffer_store_dwordx4 v[148:151], v2, s[8:11], s62 offen offset:0
v_rcp_f32 v225, v225
v_lshlrev_b32_sdwa v161, v6, v161 dst_sel:DWORD dst_unused:UNUSED_PAD src0_sel:DWORD src1_sel:WORD_1
v_mfma_f32_16x16x32_bf16 v[172:175], v[148:151], v[240:243], 0
ds_read_u16_d16_hi v161, v161
ds_read_b128 v[248:251], v3 offset:8192
v_rcp_f32 v226, v226
v_rcp_f32 v227, v227
v_lshlrev_b32_sdwa v162, v6, v162 dst_sel:DWORD dst_unused:UNUSED_PAD src0_sel:DWORD src1_sel:WORD_1
v_mfma_f32_16x16x32_bf16 v[168:171], v[140:143], v[244:247], v[168:171]
ds_read_u16_d16_hi v162, v162
v_rcp_f32 v239, v239
v_lshlrev_b32_sdwa v163, v6, v163 dst_sel:DWORD dst_unused:UNUSED_PAD src0_sel:DWORD src1_sel:WORD_1
v_mfma_f32_16x16x32_bf16 v[172:175], v[152:155], v[244:247], v[172:175]
ds_read_u16_d16_hi v163, v163
ds_read_b128 v[240:243], v3 offset:12288
v_rcp_f32 v228, v228
v_lshlrev_b32_sdwa v164, v6, v164 dst_sel:DWORD dst_unused:UNUSED_PAD src0_sel:DWORD src1_sel:WORD_1
s_waitcnt lgkmcnt(3)
v_mfma_f32_16x16x32_bf16 v[168:171], v[144:147], v[248:251], v[168:171]
ds_read_u16_d16_hi v164, v164
v_exp_f32 v229, v229
v_exp_f32 v230, v230
v_mfma_f32_16x16x32_bf16 v[172:175], v[156:159], v[248:251], v[172:175]
ds_read_b128 v[244:247], v3 offset:13312
v_exp_f32 v231, v231
s_setprio 0
v_mul_f32 v225, v216, v225
v_mul_f32 v226, v217, v226
v_mul_f32 v227, v218, v227
v_mul_f32 v239, v219, v239
v_mul_f32 v228, v220, v228
v_add_f32 v229, 1.0, v229
v_add_f32 v230, 1.0, v230
v_add_f32 v231, 1.0, v231
v_add_f32 v31, v210, v31
v_add_f32 v31, v211, v31
v_add_f32 v31, v212, v31
v_add_f32 v31, v213, v31
v_add_f32 v31, v214, v31
v_add_f32 v31, v215, v31
v_fmac_f32 v35, v225, v225
v_fmac_f32 v35, v226, v226
v_fmac_f32 v35, v227, v227
v_fmac_f32 v35, v239, v239
v_fmac_f32 v35, v228, v228
s_setprio 1
v_lshlrev_b32_sdwa v165, v6, v165 dst_sel:DWORD dst_unused:UNUSED_PAD src0_sel:DWORD src1_sel:WORD_1
s_waitcnt lgkmcnt(0)
v_mfma_f32_16x16x32_bf16 v[176:179], v[136:139], v[240:243], 0
ds_read_u16_d16_hi v165, v165
v_lshlrev_b32_sdwa v166, v6, v166 dst_sel:DWORD dst_unused:UNUSED_PAD src0_sel:DWORD src1_sel:WORD_1
v_rcp_f32 v229, v229
v_mfma_f32_16x16x32_bf16 v[180:183], v[148:151], v[240:243], 0
ds_read_u16_d16_hi v166, v166
ds_read_b128 v[248:251], v3 offset:14336
v_lshlrev_b32_sdwa v167, v6, v167 dst_sel:DWORD dst_unused:UNUSED_PAD src0_sel:DWORD src1_sel:WORD_1
v_mfma_f32_16x16x32_bf16 v[176:179], v[140:143], v[244:247], v[176:179]
ds_read_u16_d16_hi v167, v167
v_lshlrev_b32_sdwa v168, v6, v168 dst_sel:DWORD dst_unused:UNUSED_PAD src0_sel:DWORD src1_sel:WORD_1
v_rcp_f32 v230, v230
v_mfma_f32_16x16x32_bf16 v[180:183], v[152:155], v[244:247], v[180:183]
ds_read_u16_d16_hi v168, v168
ds_read_b128 v[240:243], v3 offset:15360
buffer_store_dwordx4 v[152:155], v2, s[8:11], s62 offen offset:1024
v_lshlrev_b32_sdwa v169, v6, v169 dst_sel:DWORD dst_unused:UNUSED_PAD src0_sel:DWORD src1_sel:WORD_1
s_waitcnt lgkmcnt(3)
v_mfma_f32_16x16x32_bf16 v[176:179], v[144:147], v[248:251], v[176:179]
ds_read_u16_d16_hi v169, v169
v_lshlrev_b32_sdwa v170, v6, v170 dst_sel:DWORD dst_unused:UNUSED_PAD src0_sel:DWORD src1_sel:WORD_1
v_rcp_f32 v231, v231
v_mfma_f32_16x16x32_bf16 v[180:183], v[156:159], v[248:251], v[180:183]
ds_read_u16_d16_hi v170, v170
ds_read_b128 v[244:247], v3 offset:16384
s_setprio 0
v_mul_f32 v229, v221, v229
v_mul_f32 v230, v222, v230
v_mul_f32 v231, v223, v231
v_add_f32 v33, v160, v33
v_add_f32 v33, v161, v33
v_add_f32 v33, v162, v33
v_add_f32 v33, v163, v33
v_add_f32 v33, v164, v33
v_fmac_f32 v35, v229, v229
v_fmac_f32 v35, v230, v230
v_fmac_f32 v35, v231, v231
v_fmaak_f32 v232, v176, v176, 0x409d30fc
v_fmaak_f32 v233, v177, v177, 0x409d30fc
v_fmaak_f32 v234, v178, v178, 0x409d30fc
v_fmaak_f32 v235, v179, v179, 0x409d30fc
v_fmaak_f32 v236, v180, v180, 0x409d30fc
v_fmaak_f32 v237, v181, v181, 0x409d30fc
v_fmaak_f32 v224, v182, v182, 0x409d30fc
v_mul_f32 v232, v176, v232
v_mul_f32 v233, v177, v233
v_mul_f32 v234, v178, v234
v_mul_f32 v235, v179, v235
v_mul_f32 v236, v180, v236
v_mul_f32 v237, v181, v237
v_mul_f32 v224, v182, v224
s_setprio 1
v_lshlrev_b32_sdwa v171, v6, v171 dst_sel:DWORD dst_unused:UNUSED_PAD src0_sel:DWORD src1_sel:WORD_1
s_waitcnt lgkmcnt(0)
v_mfma_f32_16x16x32_bf16 v[184:187], v[136:139], v[240:243], 0
ds_read_u16_d16_hi v171, v171
v_exp_f32 v232, v232
v_lshlrev_b32_sdwa v172, v6, v172 dst_sel:DWORD dst_unused:UNUSED_PAD src0_sel:DWORD src1_sel:WORD_1
v_mfma_f32_16x16x32_bf16 v[188:191], v[148:151], v[240:243], 0
ds_read_u16_d16_hi v172, v172
ds_read_b128 v[248:251], v3 offset:17408
v_exp_f32 v233, v233
v_lshlrev_b32_sdwa v173, v6, v173 dst_sel:DWORD dst_unused:UNUSED_PAD src0_sel:DWORD src1_sel:WORD_1
v_mfma_f32_16x16x32_bf16 v[184:187], v[140:143], v[244:247], v[184:187]
ds_read_u16_d16_hi v173, v173
v_exp_f32 v234, v234
v_lshlrev_b32_sdwa v174, v6, v174 dst_sel:DWORD dst_unused:UNUSED_PAD src0_sel:DWORD src1_sel:WORD_1
v_exp_f32 v235, v235
v_mfma_f32_16x16x32_bf16 v[188:191], v[152:155], v[244:247], v[188:191]
ds_read_u16_d16_hi v174, v174
ds_read_b128 v[240:243], v3 offset:18432
v_exp_f32 v236, v236
v_lshlrev_b32_sdwa v175, v6, v175 dst_sel:DWORD dst_unused:UNUSED_PAD src0_sel:DWORD src1_sel:WORD_1
s_waitcnt lgkmcnt(3)
v_mfma_f32_16x16x32_bf16 v[184:187], v[144:147], v[248:251], v[184:187]
ds_read_u16_d16_hi v175, v175
v_exp_f32 v237, v237
v_mfma_f32_16x16x32_bf16 v[188:191], v[156:159], v[248:251], v[188:191]
ds_read_b128 v[244:247], v3 offset:19456
v_exp_f32 v224, v224
s_setprio 0
v_add_f32 v232, 1.0, v232
v_add_f32 v233, 1.0, v233
v_add_f32 v234, 1.0, v234
v_add_f32 v235, 1.0, v235
v_add_f32 v236, 1.0, v236
v_add_f32 v237, 1.0, v237
v_add_f32 v224, 1.0, v224
v_add_f32 v33, v165, v33
v_add_f32 v33, v166, v33
v_add_f32 v33, v167, v33
v_add_f32 v34, v168, v34
v_add_f32 v34, v169, v34
v_add_f32 v34, v170, v34
v_fmaak_f32 v238, v183, v183, 0x409d30fc
v_mul_f32 v238, v183, v238
s_setprio 1
v_lshlrev_b32_sdwa v184, v6, v184 dst_sel:DWORD dst_unused:UNUSED_PAD src0_sel:DWORD src1_sel:WORD_1
s_waitcnt lgkmcnt(0)
v_mfma_f32_16x16x32_bf16 v[192:195], v[136:139], v[240:243], 0
ds_read_u16_d16_hi v184, v184
buffer_store_dwordx4 v[156:159], v2, s[8:11], s62 offen offset:2048
v_rcp_f32 v232, v232
v_lshlrev_b32_sdwa v185, v6, v185 dst_sel:DWORD dst_unused:UNUSED_PAD src0_sel:DWORD src1_sel:WORD_1
v_mfma_f32_16x16x32_bf16 v[196:199], v[148:151], v[240:243], 0
ds_read_u16_d16_hi v185, v185
ds_read_b128 v[248:251], v3 offset:20480
v_rcp_f32 v233, v233
v_rcp_f32 v234, v234
v_lshlrev_b32_sdwa v186, v6, v186 dst_sel:DWORD dst_unused:UNUSED_PAD src0_sel:DWORD src1_sel:WORD_1
v_mfma_f32_16x16x32_bf16 v[192:195], v[140:143], v[244:247], v[192:195]
ds_read_u16_d16_hi v186, v186
v_rcp_f32 v235, v235
v_lshlrev_b32_sdwa v187, v6, v187 dst_sel:DWORD dst_unused:UNUSED_PAD src0_sel:DWORD src1_sel:WORD_1
v_mfma_f32_16x16x32_bf16 v[196:199], v[152:155], v[244:247], v[196:199]
ds_read_u16_d16_hi v187, v187
ds_read_b128 v[240:243], v3 offset:21504
v_rcp_f32 v236, v236
v_lshlrev_b32_sdwa v188, v6, v188 dst_sel:DWORD dst_unused:UNUSED_PAD src0_sel:DWORD src1_sel:WORD_1
s_waitcnt lgkmcnt(3)
v_mfma_f32_16x16x32_bf16 v[192:195], v[144:147], v[248:251], v[192:195]
ds_read_u16_d16_hi v188, v188
v_rcp_f32 v237, v237
v_rcp_f32 v224, v224
v_lshlrev_b32_sdwa v189, v6, v189 dst_sel:DWORD dst_unused:UNUSED_PAD src0_sel:DWORD src1_sel:WORD_1
v_mfma_f32_16x16x32_bf16 v[196:199], v[156:159], v[248:251], v[196:199]
ds_read_u16_d16_hi v189, v189
ds_read_b128 v[244:247], v3 offset:22528
v_exp_f32 v238, v238
s_setprio 0
v_mul_f32 v232, v176, v232
v_mul_f32 v233, v177, v233
v_mul_f32 v234, v178, v234
v_mul_f32 v235, v179, v235
v_mul_f32 v236, v180, v236
v_mul_f32 v237, v181, v237
v_mul_f32 v224, v182, v224
v_add_f32 v238, 1.0, v238
v_add_f32 v34, v171, v34
v_add_f32 v34, v172, v34
v_add_f32 v34, v173, v34
v_add_f32 v34, v174, v34
v_add_f32 v34, v175, v34
v_fmac_f32 v36, v232, v232
v_fmac_f32 v36, v233, v233
v_fmac_f32 v36, v234, v234
v_fmac_f32 v36, v235, v235
v_fmac_f32 v36, v236, v236
v_fmac_f32 v36, v237, v237
v_fmac_f32 v36, v224, v224
v_fmaak_f32 v239, v192, v192, 0x409d30fc
v_fmaak_f32 v232, v193, v193, 0x409d30fc
v_fmaak_f32 v233, v194, v194, 0x409d30fc
v_fmaak_f32 v234, v195, v195, 0x409d30fc
v_fmaak_f32 v235, v196, v196, 0x409d30fc
v_mul_f32 v239, v192, v239
v_mul_f32 v232, v193, v232
v_mul_f32 v233, v194, v233
v_mul_f32 v234, v195, v234
v_mul_f32 v235, v196, v235
s_setprio 1
v_lshlrev_b32_sdwa v190, v6, v190 dst_sel:DWORD dst_unused:UNUSED_PAD src0_sel:DWORD src1_sel:WORD_1
s_waitcnt lgkmcnt(0)
v_mfma_f32_16x16x32_bf16 v[200:203], v[136:139], v[240:243], 0
ds_read_u16_d16_hi v190, v190
v_rcp_f32 v238, v238
v_mfma_f32_16x16x32_bf16 v[204:207], v[148:151], v[240:243], 0
ds_read_b128 v[248:251], v3 offset:23552
v_exp_f32 v239, v239
v_mfma_f32_16x16x32_bf16 v[200:203], v[140:143], v[244:247], v[200:203]
v_exp_f32 v232, v232
v_lshlrev_b32_sdwa v191, v6, v191 dst_sel:DWORD dst_unused:UNUSED_PAD src0_sel:DWORD src1_sel:WORD_1
v_mfma_f32_16x16x32_bf16 v[204:207], v[152:155], v[244:247], v[204:207]
ds_read_u16_d16_hi v191, v191
v_exp_f32 v233, v233
s_waitcnt lgkmcnt(1)
v_mfma_f32_16x16x32_bf16 v[200:203], v[144:147], v[248:251], v[200:203]
s_lshr_b32 s44, s32, 1
s_add_u32 s44, s44, 4
s_add_u32 s45, s44, 1
s_cmp_ge_u32 s44, 5
s_cselect_b32 s46, 5, 0
s_sub_u32 s44, s44, s46
s_mul_i32 s44, s44, 13312
s_cmp_ge_u32 s45, 5
s_cselect_b32 s46, 5, 0
s_sub_u32 s45, s45, s46
s_mul_i32 s45, s45, 13312
s_sub_u32 s45, s45, s44
s_add_u32 s44, s44, 90112
v_mul_lo_u32 v15, v14, s45
v_add_u32 v15, s44, v15
v_add_u32 v11, v15, v8
v_add_u32 v12, v15, v9
v_add_u32 v13, v15, v10
v_exp_f32 v234, v234
v_mfma_f32_16x16x32_bf16 v[204:207], v[156:159], v[248:251], v[204:207]
v_exp_f32 v235, v235
s_setprio 0
v_mul_f32 v238, v183, v238
v_add_f32 v239, 1.0, v239
v_add_f32 v232, 1.0, v232
v_add_f32 v233, 1.0, v233
v_add_f32 v234, 1.0, v234
v_add_f32 v235, 1.0, v235
v_add_f32 v37, v184, v37
v_add_f32 v37, v185, v37
v_add_f32 v37, v186, v37
v_add_f32 v37, v187, v37
v_add_f32 v37, v188, v37
v_add_f32 v37, v189, v37
v_fmac_f32 v36, v238, v238
v_fmaak_f32 v236, v197, v197, 0x409d30fc
v_fmaak_f32 v237, v198, v198, 0x409d30fc
v_fmaak_f32 v238, v199, v199, 0x409d30fc
v_mul_f32 v236, v197, v236
v_mul_f32 v237, v198, v237
v_mul_f32 v238, v199, v238
s_setprio 1
v_lshlrev_b32_sdwa v200, v6, v200 dst_sel:DWORD dst_unused:UNUSED_PAD src0_sel:DWORD src1_sel:WORD_1
v_lshlrev_b32_sdwa v201, v6, v201 dst_sel:DWORD dst_unused:UNUSED_PAD src0_sel:DWORD src1_sel:WORD_1
ds_read_u16_d16_hi v200, v200
ds_read_u16_d16_hi v201, v201
s_waitcnt vmcnt(0)
s_barrier
v_rcp_f32 v239, v239
ds_read_b128 v[216:219], v13 offset:0
ds_read_b128 v[208:211], v11 offset:0
ds_read_b128 v[212:215], v12 offset:0
v_lshlrev_b32_sdwa v202, v6, v202 dst_sel:DWORD dst_unused:UNUSED_PAD src0_sel:DWORD src1_sel:WORD_1
ds_read_u16_d16_hi v202, v202
v_rcp_f32 v232, v232
v_rcp_f32 v233, v233
v_lshlrev_b32_sdwa v203, v6, v203 dst_sel:DWORD dst_unused:UNUSED_PAD src0_sel:DWORD src1_sel:WORD_1
ds_read_u16_d16_hi v203, v203
ds_read_b128 v[228:231], v13 offset:64
ds_read_b128 v[220:223], v11 offset:64
ds_read_b128 v[224:227], v12 offset:64
v_rcp_f32 v234, v234
v_lshlrev_b32_sdwa v204, v6, v204 dst_sel:DWORD dst_unused:UNUSED_PAD src0_sel:DWORD src1_sel:WORD_1
v_lshlrev_b32_sdwa v205, v6, v205 dst_sel:DWORD dst_unused:UNUSED_PAD src0_sel:DWORD src1_sel:WORD_1
ds_read_u16_d16_hi v204, v204
ds_read_u16_d16_hi v205, v205
v_rcp_f32 v235, v235
s_waitcnt lgkmcnt(6)
v_mfma_f32_16x16x32_bf16 v[160:163], v[88:91], v[216:219], 0
v_smfmac_f32_16x16x64_bf16 v[160:163], v[40:43], v[208:215], v7
v_lshlrev_b32_sdwa v206, v6, v206 dst_sel:DWORD dst_unused:UNUSED_PAD src0_sel:DWORD src1_sel:WORD_1
ds_read_b128 v[248:251], v13 offset:128
ds_read_b128 v[240:243], v11 offset:128
ds_read_b128 v[244:247], v12 offset:128
ds_read_u16_d16_hi v206, v206
v_exp_f32 v236, v236
v_exp_f32 v237, v237
v_lshlrev_b32_sdwa v207, v6, v207 dst_sel:DWORD dst_unused:UNUSED_PAD src0_sel:DWORD src1_sel:WORD_1
ds_read_u16_d16_hi v207, v207
s_waitcnt lgkmcnt(5)
v_mfma_f32_16x16x32_bf16 v[164:167], v[104:107], v[228:231], 0
v_smfmac_f32_16x16x64_bf16 v[164:167], v[56:59], v[220:227], v7
v_exp_f32 v238, v238
v_xor_b32 v11, 16, v11
v_xor_b32 v12, 16, v12
v_xor_b32 v13, 16, v13
ds_read_b128 v[216:219], v13 offset:0
ds_read_b128 v[208:211], v11 offset:0
ds_read_b128 v[212:215], v12 offset:0
s_setprio 0
v_mul_f32 v239, v192, v239
v_mul_f32 v232, v193, v232
v_mul_f32 v233, v194, v233
v_mul_f32 v234, v195, v234
v_mul_f32 v235, v196, v235
v_add_f32 v236, 1.0, v236
v_add_f32 v237, 1.0, v237
v_add_f32 v238, 1.0, v238
v_add_f32 v37, v190, v37
v_add_f32 v37, v191, v37
v_fmac_f32 v38, v239, v239
v_fmac_f32 v38, v232, v232
v_fmac_f32 v38, v233, v233
v_fmac_f32 v38, v234, v234
v_fmac_f32 v38, v235, v235
s_setprio 1
v_mov_b32 v252, v160
v_mul_f32 v253, v160, v160
v_add_f32 v252, v161, v252
v_fmac_f32 v253, v161, v161
v_add_f32 v252, v162, v252
v_fmac_f32 v253, v162, v162
v_add_f32 v252, v163, v252
v_fmac_f32 v253, v163, v163
s_waitcnt lgkmcnt(0)
v_mfma_f32_16x16x32_bf16 v[168:171], v[120:123], v[248:251], 0
v_smfmac_f32_16x16x64_bf16 v[168:171], v[72:75], v[240:247], v7
ds_read_b128 v[228:231], v13 offset:64
ds_read_b128 v[220:223], v11 offset:64
ds_read_b128 v[224:227], v12 offset:64
v_rcp_f32 v236, v236
v_add_f32 v252, v164, v252
v_fmac_f32 v253, v164, v164
v_add_f32 v252, v165, v252
v_fmac_f32 v253, v165, v165
v_add_f32 v252, v166, v252
v_fmac_f32 v253, v166, v166
v_add_f32 v252, v167, v252
v_fmac_f32 v253, v167, v167
v_mfma_f32_16x16x32_bf16 v[172:175], v[92:95], v[216:219], 0
v_smfmac_f32_16x16x64_bf16 v[172:175], v[44:47], v[208:215], v7
ds_read_b128 v[248:251], v13 offset:128
ds_read_b128 v[240:243], v11 offset:128
ds_read_b128 v[244:247], v12 offset:128
v_rcp_f32 v237, v237
v_add_f32 v252, v168, v252
v_fmac_f32 v253, v168, v168
v_add_f32 v252, v169, v252
v_fmac_f32 v253, v169, v169
v_add_f32 v252, v170, v252
v_fmac_f32 v253, v170, v170
v_add_f32 v252, v171, v252
v_fmac_f32 v253, v171, v171
s_waitcnt lgkmcnt(3)
v_mfma_f32_16x16x32_bf16 v[176:179], v[108:111], v[228:231], 0
v_smfmac_f32_16x16x64_bf16 v[176:179], v[60:63], v[220:227], v7
v_xor_b32 v11, 48, v11
v_xor_b32 v12, 48, v12
v_xor_b32 v13, 48, v13
ds_read_b128 v[216:219], v13 offset:0
ds_read_b128 v[208:211], v11 offset:0
ds_read_b128 v[212:215], v12 offset:0
v_rcp_f32 v238, v238
v_add_f32 v252, v172, v252
v_fmac_f32 v253, v172, v172
v_add_f32 v252, v173, v252
v_fmac_f32 v253, v173, v173
v_add_f32 v252, v174, v252
v_fmac_f32 v253, v174, v174
v_add_f32 v252, v175, v252
v_fmac_f32 v253, v175, v175
s_waitcnt lgkmcnt(3)
v_mfma_f32_16x16x32_bf16 v[180:183], v[124:127], v[248:251], 0
v_smfmac_f32_16x16x64_bf16 v[180:183], v[76:79], v[240:247], v7
s_setprio 0
ds_read_b128 v[228:231], v13 offset:64
ds_read_b128 v[220:223], v11 offset:64
ds_read_b128 v[224:227], v12 offset:64
v_mul_f32 v236, v197, v236
v_mul_f32 v237, v198, v237
v_mul_f32 v238, v199, v238
v_add_f32 v39, v200, v39
v_add_f32 v39, v201, v39
v_add_f32 v39, v202, v39
v_add_f32 v39, v203, v39
v_add_f32 v39, v204, v39
v_add_f32 v39, v205, v39
v_add_f32 v39, v206, v39
v_add_f32 v39, v207, v39
v_fmac_f32 v38, v236, v236
v_fmac_f32 v38, v237, v237
v_fmac_f32 v38, v238, v238
v_add_f32 v252, v176, v252
v_fmac_f32 v253, v176, v176
v_add_f32 v252, v177, v252
v_fmac_f32 v253, v177, v177
v_add_f32 v252, v178, v252
v_fmac_f32 v253, v178, v178
v_add_f32 v252, v179, v252
v_fmac_f32 v253, v179, v179
s_waitcnt lgkmcnt(0)
v_mfma_f32_16x16x32_bf16 v[184:187], v[96:99], v[216:219], 0
v_smfmac_f32_16x16x64_bf16 v[184:187], v[48:51], v[208:215], v7
ds_read_b128 v[248:251], v13 offset:128
ds_read_b128 v[240:243], v11 offset:128
ds_read_b128 v[244:247], v12 offset:128
v_add_f32 v252, v180, v252
v_fmac_f32 v253, v180, v180
v_add_f32 v252, v181, v252
v_fmac_f32 v253, v181, v181
v_add_f32 v252, v182, v252
v_fmac_f32 v253, v182, v182
v_add_f32 v252, v183, v252
v_fmac_f32 v253, v183, v183
v_mfma_f32_16x16x32_bf16 v[188:191], v[112:115], v[228:231], 0
v_smfmac_f32_16x16x64_bf16 v[188:191], v[64:67], v[220:227], v7
v_xor_b32 v11, 16, v11
v_xor_b32 v12, 16, v12
v_xor_b32 v13, 16, v13
ds_read_b128 v[216:219], v13 offset:0
ds_read_b128 v[208:211], v11 offset:0
ds_read_b128 v[212:215], v12 offset:0
v_add_f32 v252, v184, v252
v_fmac_f32 v253, v184, v184
v_add_f32 v252, v185, v252
v_fmac_f32 v253, v185, v185
v_add_f32 v252, v186, v252
v_fmac_f32 v253, v186, v186
v_add_f32 v252, v187, v252
v_fmac_f32 v253, v187, v187
s_waitcnt lgkmcnt(3)
v_mfma_f32_16x16x32_bf16 v[192:195], v[128:131], v[248:251], 0
v_smfmac_f32_16x16x64_bf16 v[192:195], v[80:83], v[240:247], v7
ds_read_b128 v[228:231], v13 offset:64
ds_read_b128 v[220:223], v11 offset:64
ds_read_b128 v[224:227], v12 offset:64
v_add_f32 v252, v188, v252
v_fmac_f32 v253, v188, v188
v_add_f32 v252, v189, v252
v_fmac_f32 v253, v189, v189
v_add_f32 v252, v190, v252
v_fmac_f32 v253, v190, v190
v_add_f32 v252, v191, v252
v_fmac_f32 v253, v191, v191
s_waitcnt lgkmcnt(3)
v_mfma_f32_16x16x32_bf16 v[196:199], v[100:103], v[216:219], 0
v_smfmac_f32_16x16x64_bf16 v[196:199], v[52:55], v[208:215], v7
ds_read_b128 v[248:251], v13 offset:128
ds_read_b128 v[240:243], v11 offset:128
ds_read_b128 v[244:247], v12 offset:128
v_add_f32 v252, v192, v252
v_fmac_f32 v253, v192, v192
v_add_f32 v252, v193, v252
v_fmac_f32 v253, v193, v193
v_add_f32 v252, v194, v252
v_fmac_f32 v253, v194, v194
v_add_f32 v252, v195, v252
v_fmac_f32 v253, v195, v195
s_waitcnt lgkmcnt(3)
v_mfma_f32_16x16x32_bf16 v[200:203], v[116:119], v[228:231], 0
v_smfmac_f32_16x16x64_bf16 v[200:203], v[68:71], v[220:227], v7
v_add_f32 v252, v196, v252
v_fmac_f32 v253, v196, v196
v_add_f32 v252, v197, v252
v_fmac_f32 v253, v197, v197
v_add_f32 v252, v198, v252
v_fmac_f32 v253, v198, v198
v_add_f32 v252, v199, v252
v_fmac_f32 v253, v199, v199
s_waitcnt lgkmcnt(0)
v_mfma_f32_16x16x32_bf16 v[204:207], v[132:135], v[248:251], 0
v_smfmac_f32_16x16x64_bf16 v[204:207], v[84:87], v[240:247], v7
v_add_f32 v252, v200, v252
v_fmac_f32 v253, v200, v200
v_add_f32 v252, v201, v252
v_fmac_f32 v253, v201, v201
v_add_f32 v252, v202, v252
v_fmac_f32 v253, v202, v202
v_add_f32 v252, v203, v252
v_fmac_f32 v253, v203, v203
v_add_f32 v252, v204, v252
v_fmac_f32 v253, v204, v204
v_add_f32 v252, v205, v252
v_fmac_f32 v253, v205, v205
v_add_f32 v252, v206, v252
v_fmac_f32 v253, v206, v206
v_add_f32 v252, v207, v252
v_fmac_f32 v253, v207, v207
s_setprio 1
s_nop 0
v_permlane32_swap_b32 v252, v253
v_add_f32 v252, v252, v253
v_mov_b32 v253, v252
s_nop 1
v_permlane32_swap_b32 v252, v253
v_mul_f32 v252, 0x3c2aaaab, v252
v_mul_f32 v253, 0x3c2aaaab, v253
v_mul_f32 v15, v252, v252
v_sub_f32 v253, v253, v15
v_mul_f32 v15, 0x36800000, v15
v_max_f32 v253, v15, v253
v_add_f32 v253, 0x3727c5ac, v253
v_rsq_f32 v253, v253
s_nop 0
v_mul_f32 v253, 0xbeeff558, v253
v_mul_f32 v252, v252, v253
ds_read_b128 v[240:243], v2 offset:8192
ds_read_b128 v[244:247], v2 offset:11264
s_setprio 0
v_fma_f32 v160, v160, v253, -v252
v_fma_f32 v161, v161, v253, -v252
v_fma_f32 v162, v162, v253, -v252
v_fma_f32 v163, v163, v253, -v252
v_fma_f32 v172, v172, v253, -v252
v_fma_f32 v173, v173, v253, -v252
v_fma_f32 v174, v174, v253, -v252
v_fma_f32 v175, v175, v253, -v252
v_fma_f32 v184, v184, v253, -v252
v_fma_f32 v185, v185, v253, -v252
v_fma_f32 v186, v186, v253, -v252
v_fma_f32 v187, v187, v253, -v252
v_fma_f32 v196, v196, v253, -v252
v_fma_f32 v197, v197, v253, -v252
v_fma_f32 v198, v198, v253, -v252
v_fma_f32 v199, v199, v253, -v252
s_setprio 1
v_cvt_pk_bf16_f32 v136, v160, v161
v_cvt_pk_bf16_f32 v137, v162, v163
v_cvt_pk_bf16_f32 v148, v172, v173
v_cvt_pk_bf16_f32 v149, v174, v175
v_cvt_pk_bf16_f32 v138, v184, v185
v_cvt_pk_bf16_f32 v139, v186, v187
v_cvt_pk_bf16_f32 v150, v196, v197
v_cvt_pk_bf16_f32 v151, v198, v199
v_permlane16_swap_b32 v136, v148
v_permlane16_swap_b32 v137, v149
v_permlane16_swap_b32 v138, v150
v_permlane16_swap_b32 v139, v151
s_waitcnt lgkmcnt(0)
s_nop 0
v_mfma_f32_16x16x32_bf16 v[208:211], v[136:139], v[240:243], 0
s_setprio 0
v_fma_f32 v164, v164, v253, -v252
v_fma_f32 v165, v165, v253, -v252
v_fma_f32 v166, v166, v253, -v252
v_fma_f32 v167, v167, v253, -v252
v_fma_f32 v176, v176, v253, -v252
v_fma_f32 v177, v177, v253, -v252
v_fma_f32 v178, v178, v253, -v252
v_fma_f32 v179, v179, v253, -v252
v_fma_f32 v188, v188, v253, -v252
v_fma_f32 v189, v189, v253, -v252
v_fma_f32 v190, v190, v253, -v252
v_fma_f32 v191, v191, v253, -v252
v_fma_f32 v200, v200, v253, -v252
v_fma_f32 v201, v201, v253, -v252
v_fma_f32 v202, v202, v253, -v252
v_fma_f32 v203, v203, v253, -v252
v_mfma_f32_16x16x32_bf16 v[212:215], v[148:151], v[240:243], 0
ds_read_b128 v[248:251], v2 offset:9216
v_mfma_f32_16x16x32_bf16 v[216:219], v[136:139], v[244:247], 0
s_barrier
v_mfma_f32_16x16x32_bf16 v[220:223], v[148:151], v[244:247], 0
s_add_u32 m0, s40, 143360
s_add_u32 s3, s37, 1769472
buffer_load_dwordx4 v4, s[4:7], s3 offen lds
s_setprio 1
ds_read_b128 v[240:243], v2 offset:12288
v_cvt_pk_bf16_f32 v140, v164, v165
v_cvt_pk_bf16_f32 v141, v166, v167
v_cvt_pk_bf16_f32 v152, v176, v177
v_cvt_pk_bf16_f32 v153, v178, v179
v_cvt_pk_bf16_f32 v142, v188, v189
v_cvt_pk_bf16_f32 v143, v190, v191
v_cvt_pk_bf16_f32 v154, v200, v201
v_cvt_pk_bf16_f32 v155, v202, v203
v_permlane16_swap_b32 v140, v152
v_permlane16_swap_b32 v141, v153
v_permlane16_swap_b32 v142, v154
v_permlane16_swap_b32 v143, v155
s_waitcnt lgkmcnt(0)
s_nop 0
v_mfma_f32_16x16x32_bf16 v[208:211], v[140:143], v[248:251], v[208:211]
s_setprio 0
v_fma_f32 v168, v168, v253, -v252
v_fma_f32 v169, v169, v253, -v252
v_fma_f32 v170, v170, v253, -v252
v_fma_f32 v171, v171, v253, -v252
v_fma_f32 v180, v180, v253, -v252
v_fma_f32 v181, v181, v253, -v252
v_fma_f32 v182, v182, v253, -v252
v_fma_f32 v183, v183, v253, -v252
v_fma_f32 v192, v192, v253, -v252
v_fma_f32 v193, v193, v253, -v252
v_fma_f32 v194, v194, v253, -v252
v_fma_f32 v195, v195, v253, -v252
v_fma_f32 v204, v204, v253, -v252
v_fma_f32 v205, v205, v253, -v252
v_fma_f32 v206, v206, v253, -v252
v_fma_f32 v207, v207, v253, -v252
v_mfma_f32_16x16x32_bf16 v[212:215], v[152:155], v[248:251], v[212:215]
ds_read_b128 v[244:247], v2 offset:10240
v_mfma_f32_16x16x32_bf16 v[216:219], v[140:143], v[240:243], v[216:219]
v_mfma_f32_16x16x32_bf16 v[220:223], v[152:155], v[240:243], v[220:223]
s_setprio 1
ds_read_b128 v[248:251], v2 offset:13312
v_cvt_pk_bf16_f32 v144, v168, v169
v_cvt_pk_bf16_f32 v145, v170, v171
v_cvt_pk_bf16_f32 v156, v180, v181
v_cvt_pk_bf16_f32 v157, v182, v183
v_cvt_pk_bf16_f32 v146, v192, v193
v_cvt_pk_bf16_f32 v147, v194, v195
v_cvt_pk_bf16_f32 v158, v204, v205
v_cvt_pk_bf16_f32 v159, v206, v207
v_permlane16_swap_b32 v144, v156
v_permlane16_swap_b32 v145, v157
v_permlane16_swap_b32 v146, v158
v_permlane16_swap_b32 v147, v159
s_waitcnt lgkmcnt(0)
s_nop 0
v_mfma_f32_16x16x32_bf16 v[208:211], v[144:147], v[244:247], v[208:211]
s_setprio 1
v_mfma_f32_16x16x32_bf16 v[212:215], v[156:159], v[244:247], v[212:215]
ds_read_b128 v[240:243], v2 offset:14336
v_mfma_f32_16x16x32_bf16 v[216:219], v[144:147], v[248:251], v[216:219]
v_mfma_f32_16x16x32_bf16 v[220:223], v[156:159], v[248:251], v[220:223]
ds_read_b128 v[244:247], v2 offset:15360
s_waitcnt lgkmcnt(1)
v_mfma_f32_16x16x32_bf16 v[160:163], v[136:139], v[240:243], 0
v_mfma_f32_16x16x32_bf16 v[164:167], v[148:151], v[240:243], 0
ds_read_b128 v[248:251], v2 offset:16384
s_waitcnt lgkmcnt(1)
v_mfma_f32_16x16x32_bf16 v[160:163], v[140:143], v[244:247], v[160:163]
v_mfma_f32_16x16x32_bf16 v[164:167], v[152:155], v[244:247], v[164:167]
s_add_u32 m0, s39, 143360
s_nop 0
buffer_load_dwordx4 v5, s[4:7], s3 offen lds
ds_read_b128 v[240:243], v2 offset:17408
s_waitcnt lgkmcnt(1)
v_mfma_f32_16x16x32_bf16 v[160:163], v[144:147], v[248:251], v[160:163]
v_mfma_f32_16x16x32_bf16 v[164:167], v[156:159], v[248:251], v[164:167]
ds_read_b128 v[244:247], v2 offset:18432
s_setprio 0
v_fmaak_f32 v224, v216, v216, 0x409d30fc
v_fmaak_f32 v225, v217, v217, 0x409d30fc
v_fmaak_f32 v226, v218, v218, 0x409d30fc
v_fmaak_f32 v227, v219, v219, 0x409d30fc
v_mul_f32 v224, v216, v224
v_mul_f32 v225, v217, v225
v_mul_f32 v226, v218, v226
v_mul_f32 v227, v219, v227
s_setprio 1
v_lshlrev_b32_sdwa v208, v6, v208 dst_sel:DWORD dst_unused:UNUSED_PAD src0_sel:DWORD src1_sel:WORD_1
s_waitcnt lgkmcnt(1)
v_mfma_f32_16x16x32_bf16 v[168:171], v[136:139], v[240:243], 0
ds_read_u16_d16_hi v208, v208
v_readfirstlane_b32 s42, v254
s_nop 3
s_cmp_eq_u32 s32, 7
s_cselect_b32 s42, s42, 1
s_cmp_eq_u32 s42, 0
s_cbranch_scc0 L_tk1
v_mov_b32 v254, 0
v_mov_b32 v255, 0
v_lshlrev_b32 v15, 3, v1
s_mul_i32 s44, s41, 3072
s_add_u32 s44, s44, 50331648
buffer_store_dwordx2 v[254:255], v15, s[8:11], s44 offen offset:0 sc0 sc1
buffer_store_dwordx2 v[254:255], v15, s[8:11], s44 offen offset:512 sc0 sc1
buffer_store_dwordx2 v[254:255], v15, s[8:11], s44 offen offset:1024 sc0 sc1
buffer_store_dwordx2 v[254:255], v15, s[8:11], s44 offen offset:1536 sc0 sc1
buffer_store_dwordx2 v[254:255], v15, s[8:11], s44 offen offset:2048 sc0 sc1
buffer_store_dwordx2 v[254:255], v15, s[8:11], s44 offen offset:2560 sc0 sc1
s_nop 1
L_tk1:
v_exp_f32 v224, v224
v_lshlrev_b32_sdwa v209, v6, v209 dst_sel:DWORD dst_unused:UNUSED_PAD src0_sel:DWORD src1_sel:WORD_1
v_mfma_f32_16x16x32_bf16 v[172:175], v[148:151], v[240:243], 0
ds_read_u16_d16_hi v209, v209
ds_read_b128 v[248:251], v2 offset:19456
v_lshlrev_b32_sdwa v210, v6, v210 dst_sel:DWORD dst_unused:UNUSED_PAD src0_sel:DWORD src1_sel:WORD_1
s_waitcnt lgkmcnt(2)
v_mfma_f32_16x16x32_bf16 v[168:171], v[140:143], v[244:247], v[168:171]
ds_read_u16_d16_hi v210, v210
v_exp_f32 v225, v225
v_lshlrev_b32_sdwa v211, v6, v211 dst_sel:DWORD dst_unused:UNUSED_PAD src0_sel:DWORD src1_sel:WORD_1
v_mfma_f32_16x16x32_bf16 v[172:175], v[152:155], v[244:247], v[172:175]
ds_read_u16_d16_hi v211, v211
ds_read_b128 v[240:243], v2 offset:20480
v_exp_f32 v226, v226
v_lshlrev_b32_sdwa v212, v6, v212 dst_sel:DWORD dst_unused:UNUSED_PAD src0_sel:DWORD src1_sel:WORD_1
s_waitcnt lgkmcnt(3)
v_mfma_f32_16x16x32_bf16 v[168:171], v[144:147], v[248:251], v[168:171]
ds_read_u16_d16_hi v212, v212
v_lshlrev_b32_sdwa v213, v6, v213 dst_sel:DWORD dst_unused:UNUSED_PAD src0_sel:DWORD src1_sel:WORD_1
v_mfma_f32_16x16x32_bf16 v[172:175], v[156:159], v[248:251], v[172:175]
ds_read_u16_d16_hi v213, v213
ds_read_b128 v[244:247], v2 offset:21504
v_exp_f32 v227, v227
s_setprio 0
v_add_f32 v224, 1.0, v224
v_add_f32 v225, 1.0, v225
v_add_f32 v226, 1.0, v226
v_add_f32 v227, 1.0, v227
v_fmaak_f32 v228, v220, v220, 0x409d30fc
v_fmaak_f32 v229, v221, v221, 0x409d30fc
v_fmaak_f32 v230, v222, v222, 0x409d30fc
v_mul_f32 v228, v220, v228
v_mul_f32 v229, v221, v229
v_mul_f32 v230, v222, v230
s_setprio 1
v_lshlrev_b32_sdwa v214, v6, v214 dst_sel:DWORD dst_unused:UNUSED_PAD src0_sel:DWORD src1_sel:WORD_1
s_waitcnt lgkmcnt(0)
v_mfma_f32_16x16x32_bf16 v[176:179], v[136:139], v[240:243], 0
ds_read_u16_d16_hi v214, v214
v_rcp_f32 v224, v224
v_lshlrev_b32_sdwa v215, v6, v215 dst_sel:DWORD dst_unused:UNUSED_PAD src0_sel:DWORD src1_sel:WORD_1
v_mfma_f32_16x16x32_bf16 v[180:183], v[148:151], v[240:243], 0
ds_read_u16_d16_hi v215, v215
ds_read_b128 v[248:251], v2 offset:22528
v_rcp_f32 v225, v225
s_add_u32 m0, s40, 90112
s_add_u32 s3, s37, 1966080
buffer_load_dwordx4 v4, s[4:7], s3 offen lds
v_lshlrev_b32_sdwa v160, v6, v160 dst_sel:DWORD dst_unused:UNUSED_PAD src0_sel:DWORD src1_sel:WORD_1
v_mfma_f32_16x16x32_bf16 v[176:179], v[140:143], v[244:247], v[176:179]
ds_read_u16_d16_hi v160, v160
v_rcp_f32 v226, v226
v_lshlrev_b32_sdwa v161, v6, v161 dst_sel:DWORD dst_unused:UNUSED_PAD src0_sel:DWORD src1_sel:WORD_1
v_mfma_f32_16x16x32_bf16 v[180:183], v[152:155], v[244:247], v[180:183]
v_rcp_f32 v227, v227
ds_read_u16_d16_hi v161, v161
ds_read_b128 v[240:243], v2 offset:23552
v_exp_f32 v228, v228
v_lshlrev_b32_sdwa v162, v6, v162 dst_sel:DWORD dst_unused:UNUSED_PAD src0_sel:DWORD src1_sel:WORD_1
s_waitcnt lgkmcnt(3)
v_mfma_f32_16x16x32_bf16 v[176:179], v[144:147], v[248:251], v[176:179]
ds_read_u16_d16_hi v162, v162
v_exp_f32 v229, v229
v_mfma_f32_16x16x32_bf16 v[180:183], v[156:159], v[248:251], v[180:183]
ds_read_b128 v[244:247], v2 offset:24576
v_exp_f32 v230, v230
s_setprio 0
v_mul_f32 v224, v216, v224
v_mul_f32 v225, v217, v225
v_mul_f32 v226, v218, v226
v_mul_f32 v227, v219, v227
v_add_f32 v228, 1.0, v228
v_add_f32 v229, 1.0, v229
v_add_f32 v230, 1.0, v230
v_add_f32 v16, v208, v16
v_add_f32 v16, v209, v16
v_add_f32 v16, v210, v16
v_add_f32 v16, v211, v16
v_add_f32 v16, v212, v16
v_add_f32 v16, v213, v16
v_fmac_f32 v17, v224, v224
v_fmac_f32 v17, v225, v225
v_fmac_f32 v17, v226, v226
v_fmac_f32 v17, v227, v227
v_fmaak_f32 v231, v223, v223, 0x409d30fc
v_fmaak_f32 v232, v176, v176, 0x409d30fc
v_fmaak_f32 v233, v177, v177, 0x409d30fc
v_mul_f32 v231, v223, v231
v_mul_f32 v232, v176, v232
v_mul_f32 v233, v177, v233
s_setprio 1
v_lshlrev_b32_sdwa v163, v6, v163 dst_sel:DWORD dst_unused:UNUSED_PAD src0_sel:DWORD src1_sel:WORD_1
s_waitcnt lgkmcnt(0)
v_mfma_f32_16x16x32_bf16 v[184:187], v[136:139], v[240:243], 0
ds_read_u16_d16_hi v163, v163
v_rcp_f32 v228, v228
v_lshlrev_b32_sdwa v164, v6, v164 dst_sel:DWORD dst_unused:UNUSED_PAD src0_sel:DWORD src1_sel:WORD_1
v_mfma_f32_16x16x32_bf16 v[188:191], v[148:151], v[240:243], 0
ds_read_u16_d16_hi v164, v164
ds_read_b128 v[248:251], v2 offset:25600
v_rcp_f32 v229, v229
v_lshlrev_b32_sdwa v165, v6, v165 dst_sel:DWORD dst_unused:UNUSED_PAD src0_sel:DWORD src1_sel:WORD_1
v_mfma_f32_16x16x32_bf16 v[184:187], v[140:143], v[244:247], v[184:187]
ds_read_u16_d16_hi v165, v165
v_rcp_f32 v230, v230
v_lshlrev_b32_sdwa v166, v6, v166 dst_sel:DWORD dst_unused:UNUSED_PAD src0_sel:DWORD src1_sel:WORD_1
v_mfma_f32_16x16x32_bf16 v[188:191], v[152:155], v[244:247], v[188:191]
ds_read_u16_d16_hi v166, v166
ds_read_b128 v[240:243], v2 offset:29696
v_exp_f32 v231, v231
v_lshlrev_b32_sdwa v167, v6, v167 dst_sel:DWORD dst_unused:UNUSED_PAD src0_sel:DWORD src1_sel:WORD_1
s_waitcnt lgkmcnt(3)
v_mfma_f32_16x16x32_bf16 v[184:187], v[144:147], v[248:251], v[184:187]
ds_read_u16_d16_hi v167, v167
v_exp_f32 v232, v232
v_lshlrev_b32_sdwa v168, v6, v168 dst_sel:DWORD dst_unused:UNUSED_PAD src0_sel:DWORD src1_sel:WORD_1
v_mfma_f32_16x16x32_bf16 v[188:191], v[156:159], v[248:251], v[188:191]
ds_read_u16_d16_hi v168, v168
ds_read_b128 v[244:247], v2 offset:30720
s_add_u32 m0, s39, 90112
s_nop 0
buffer_load_dwordx4 v5, s[4:7], s3 offen lds
v_exp_f32 v233, v233
s_setprio 0
v_mul_f32 v228, v220, v228
v_mul_f32 v229, v221, v229
v_mul_f32 v230, v222, v230
v_add_f32 v231, 1.0, v231
v_add_f32 v232, 1.0, v232
v_add_f32 v233, 1.0, v233
v_add_f32 v16, v214, v16
v_add_f32 v16, v215, v16
v_add_f32 v18, v160, v18
v_add_f32 v18, v161, v18
v_add_f32 v18, v162, v18
v_fmac_f32 v17, v228, v228
v_fmac_f32 v17, v229, v229
v_fmac_f32 v17, v230, v230
v_fmaak_f32 v234, v178, v178, 0x409d30fc
v_fmaak_f32 v235, v179, v179, 0x409d30fc
v_fmaak_f32 v236, v180, v180, 0x409d30fc
v_fmaak_f32 v237, v181, v181, 0x409d30fc
v_mul_f32 v234, v178, v234
v_mul_f32 v235, v179, v235
v_mul_f32 v236, v180, v236
v_mul_f32 v237, v181, v237
s_setprio 1
v_lshlrev_b32_sdwa v169, v6, v169 dst_sel:DWORD dst_unused:UNUSED_PAD src0_sel:DWORD src1_sel:WORD_1
s_waitcnt lgkmcnt(0)
v_mfma_f32_16x16x32_bf16 v[192:195], v[136:139], v[240:243], 0
ds_read_u16_d16_hi v169, v169
v_rcp_f32 v231, v231
v_lshlrev_b32_sdwa v170, v6, v170 dst_sel:DWORD dst_unused:UNUSED_PAD src0_sel:DWORD src1_sel:WORD_1
v_mfma_f32_16x16x32_bf16 v[196:199], v[148:151], v[240:243], 0
ds_read_u16_d16_hi v170, v170
ds_read_b128 v[248:251], v2 offset:31744
v_rcp_f32 v232, v232
v_lshlrev_b32_sdwa v171, v6, v171 dst_sel:DWORD dst_unused:UNUSED_PAD src0_sel:DWORD src1_sel:WORD_1
v_mfma_f32_16x16x32_bf16 v[192:195], v[140:143], v[244:247], v[192:195]
ds_read_u16_d16_hi v171, v171
v_rcp_f32 v233, v233
v_lshlrev_b32_sdwa v172, v6, v172 dst_sel:DWORD dst_unused:UNUSED_PAD src0_sel:DWORD src1_sel:WORD_1
v_mfma_f32_16x16x32_bf16 v[196:199], v[152:155], v[244:247], v[196:199]
v_exp_f32 v234, v234
ds_read_u16_d16_hi v172, v172
ds_read_b128 v[240:243], v2 offset:26624
v_exp_f32 v235, v235
v_lshlrev_b32_sdwa v173, v6, v173 dst_sel:DWORD dst_unused:UNUSED_PAD src0_sel:DWORD src1_sel:WORD_1
s_waitcnt lgkmcnt(3)
v_mfma_f32_16x16x32_bf16 v[192:195], v[144:147], v[248:251], v[192:195]
ds_read_u16_d16_hi v173, v173
v_exp_f32 v236, v236
v_mfma_f32_16x16x32_bf16 v[196:199], v[156:159], v[248:251], v[196:199]
ds_read_b128 v[244:247], v2 offset:27648
v_exp_f32 v237, v237
s_setprio 0
v_mul_f32 v231, v223, v231
v_mul_f32 v232, v176, v232
v_mul_f32 v233, v177, v233
v_add_f32 v234, 1.0, v234
v_add_f32 v235, 1.0, v235
v_add_f32 v236, 1.0, v236
v_add_f32 v237, 1.0, v237
v_add_f32 v18, v163, v18
v_add_f32 v18, v164, v18
v_add_f32 v18, v165, v18
v_add_f32 v18, v166, v18
v_add_f32 v18, v167, v18
v_add_f32 v19, v168, v19
v_fmac_f32 v17, v231, v231
v_fmac_f32 v20, v232, v232
v_fmac_f32 v20, v233, v233
v_fmaak_f32 v238, v182, v182, 0x409d30fc
v_fmaak_f32 v239, v183, v183, 0x409d30fc
v_fmaak_f32 v224, v192, v192, 0x409d30fc
v_mul_f32 v238, v182, v238
v_mul_f32 v239, v183, v239
v_mul_f32 v224, v192, v224
s_setprio 1
v_lshlrev_b32_sdwa v174, v6, v174 dst_sel:DWORD dst_unused:UNUSED_PAD src0_sel:DWORD src1_sel:WORD_1
s_waitcnt lgkmcnt(0)
v_mfma_f32_16x16x32_bf16 v[200:203], v[136:139], v[240:243], 0
ds_read_u16_d16_hi v174, v174
v_rcp_f32 v234, v234
v_lshlrev_b32_sdwa v175, v6, v175 dst_sel:DWORD dst_unused:UNUSED_PAD src0_sel:DWORD src1_sel:WORD_1
v_mfma_f32_16x16x32_bf16 v[204:207], v[148:151], v[240:243], 0
ds_read_u16_d16_hi v175, v175
ds_read_b128 v[248:251], v2 offset:28672
v_rcp_f32 v235, v235
v_lshlrev_b32_sdwa v184, v6, v184 dst_sel:DWORD dst_unused:UNUSED_PAD src0_sel:DWORD src1_sel:WORD_1
v_mfma_f32_16x16x32_bf16 v[200:203], v[140:143], v[244:247], v[200:203]
ds_read_u16_d16_hi v184, v184
v_rcp_f32 v236, v236
s_add_u32 m0, s40, 103424
s_add_u32 s3, s37, 2162688
buffer_load_dwordx4 v4, s[4:7], s3 offen lds
v_lshlrev_b32_sdwa v185, v6, v185 dst_sel:DWORD dst_unused:UNUSED_PAD src0_sel:DWORD src1_sel:WORD_1
v_mfma_f32_16x16x32_bf16 v[204:207], v[152:155], v[244:247], v[204:207]
v_rcp_f32 v237, v237
ds_read_u16_d16_hi v185, v185
ds_read_b128 v[240:243], v2 offset:32768
v_exp_f32 v238, v238
v_lshlrev_b32_sdwa v186, v6, v186 dst_sel:DWORD dst_unused:UNUSED_PAD src0_sel:DWORD src1_sel:WORD_1
s_waitcnt lgkmcnt(3)
v_mfma_f32_16x16x32_bf16 v[200:203], v[144:147], v[248:251], v[200:203]
ds_read_u16_d16_hi v186, v186
v_exp_f32 v239, v239
v_lshlrev_b32_sdwa v187, v6, v187 dst_sel:DWORD dst_unused:UNUSED_PAD src0_sel:DWORD src1_sel:WORD_1
v_mfma_f32_16x16x32_bf16 v[204:207], v[156:159], v[248:251], v[204:207]
ds_read_u16_d16_hi v187, v187
ds_read_b128 v[244:247], v2 offset:33792
v_exp_f32 v224, v224
s_setprio 0
v_mul_f32 v234, v178, v234
v_mul_f32 v235, v179, v235
v_mul_f32 v236, v180, v236
v_mul_f32 v237, v181, v237
v_add_f32 v238, 1.0, v238
v_add_f32 v239, 1.0, v239
v_add_f32 v224, 1.0, v224
v_add_f32 v19, v169, v19
v_add_f32 v19, v170, v19
v_add_f32 v19, v171, v19
v_add_f32 v19, v172, v19
v_add_f32 v19, v173, v19
v_fmac_f32 v20, v234, v234
v_fmac_f32 v20, v235, v235
v_fmac_f32 v20, v236, v236
v_fmac_f32 v20, v237, v237
v_fmaak_f32 v225, v193, v193, 0x409d30fc
v_fmaak_f32 v226, v194, v194, 0x409d30fc
v_fmaak_f32 v227, v195, v195, 0x409d30fc
v_mul_f32 v225, v193, v225
v_mul_f32 v226, v194, v226
v_mul_f32 v227, v195, v227
s_setprio 1
v_lshlrev_b32_sdwa v188, v6, v188 dst_sel:DWORD dst_unused:UNUSED_PAD src0_sel:DWORD src1_sel:WORD_1
s_waitcnt lgkmcnt(0)
v_mfma_f32_16x16x32_bf16 v[208:211], v[136:139], v[240:243], 0
ds_read_u16_d16_hi v188, v188
v_rcp_f32 v238, v238
v_lshlrev_b32_sdwa v189, v6, v189 dst_sel:DWORD dst_unused:UNUSED_PAD src0_sel:DWORD src1_sel:WORD_1
v_mfma_f32_16x16x32_bf16 v[212:215], v[148:151], v[240:243], 0
ds_read_u16_d16_hi v189, v189
ds_read_b128 v[248:251], v2 offset:34816
v_rcp_f32 v239, v239
v_lshlrev_b32_sdwa v190, v6, v190 dst_sel:DWORD dst_unused:UNUSED_PAD src0_sel:DWORD src1_sel:WORD_1
v_mfma_f32_16x16x32_bf16 v[208:211], v[140:143], v[244:247], v[208:211]
ds_read_u16_d16_hi v190, v190
v_rcp_f32 v224, v224
v_lshlrev_b32_sdwa v191, v6, v191 dst_sel:DWORD dst_unused:UNUSED_PAD src0_sel:DWORD src1_sel:WORD_1
v_mfma_f32_16x16x32_bf16 v[212:215], v[152:155], v[244:247], v[212:215]
ds_read_u16_d16_hi v191, v191
ds_read_b128 v[240:243], v2 offset:38912
v_exp_f32 v225, v225
v_lshlrev_b32_sdwa v200, v6, v200 dst_sel:DWORD dst_unused:UNUSED_PAD src0_sel:DWORD src1_sel:WORD_1
s_waitcnt lgkmcnt(3)
v_mfma_f32_16x16x32_bf16 v[208:211], v[144:147], v[248:251], v[208:211]
ds_read_u16_d16_hi v200, v200
v_exp_f32 v226, v226
v_mfma_f32_16x16x32_bf16 v[212:215], v[156:159], v[248:251], v[212:215]
ds_read_b128 v[244:247], v2 offset:39936
v_exp_f32 v227, v227
s_setprio 0
v_mul_f32 v238, v182, v238
v_mul_f32 v239, v183, v239
v_mul_f32 v224, v192, v224
v_add_f32 v225, 1.0, v225
v_add_f32 v226, 1.0, v226
v_add_f32 v227, 1.0, v227
v_add_f32 v19, v174, v19
v_add_f32 v19, v175, v19
v_add_f32 v21, v184, v21
v_add_f32 v21, v185, v21
v_add_f32 v21, v186, v21
v_add_f32 v21, v187, v21
v_fmac_f32 v20, v238, v238
v_fmac_f32 v20, v239, v239
v_fmac_f32 v23, v224, v224
v_fmaak_f32 v228, v196, v196, 0x409d30fc
v_fmaak_f32 v229, v197, v197, 0x409d30fc
v_fmaak_f32 v230, v198, v198, 0x409d30fc
v_mul_f32 v228, v196, v228
v_mul_f32 v229, v197, v229
v_mul_f32 v230, v198, v230
s_setprio 1
v_lshlrev_b32_sdwa v201, v6, v201 dst_sel:DWORD dst_unused:UNUSED_PAD src0_sel:DWORD src1_sel:WORD_1
s_waitcnt lgkmcnt(0)
v_mfma_f32_16x16x32_bf16 v[216:219], v[136:139], v[240:243], 0
ds_read_u16_d16_hi v201, v201
s_add_u32 m0, s39, 103424
s_nop 0
buffer_load_dwordx4 v5, s[4:7], s3 offen lds
v_rcp_f32 v225, v225
v_lshlrev_b32_sdwa v202, v6, v202 dst_sel:DWORD dst_unused:UNUSED_PAD src0_sel:DWORD src1_sel:WORD_1
v_mfma_f32_16x16x32_bf16 v[220:223], v[148:151], v[240:243], 0
ds_read_u16_d16_hi v202, v202
ds_read_b128 v[248:251], v2 offset:40960
v_rcp_f32 v226, v226
v_lshlrev_b32_sdwa v203, v6, v203 dst_sel:DWORD dst_unused:UNUSED_PAD src0_sel:DWORD src1_sel:WORD_1
v_mfma_f32_16x16x32_bf16 v[216:219], v[140:143], v[244:247], v[216:219]
ds_read_u16_d16_hi v203, v203
v_rcp_f32 v227, v227
v_lshlrev_b32_sdwa v204, v6, v204 dst_sel:DWORD dst_unused:UNUSED_PAD src0_sel:DWORD src1_sel:WORD_1
v_mfma_f32_16x16x32_bf16 v[220:223], v[152:155], v[244:247], v[220:223]
ds_read_u16_d16_hi v204, v204
ds_read_b128 v[240:243], v2 offset:35840
v_exp_f32 v228, v228
v_lshlrev_b32_sdwa v205, v6, v205 dst_sel:DWORD dst_unused:UNUSED_PAD src0_sel:DWORD src1_sel:WORD_1
s_waitcnt lgkmcnt(3)
v_mfma_f32_16x16x32_bf16 v[216:219], v[144:147], v[248:251], v[216:219]
ds_read_u16_d16_hi v205, v205
v_exp_f32 v229, v229
v_lshlrev_b32_sdwa v206, v6, v206 dst_sel:DWORD dst_unused:UNUSED_PAD src0_sel:DWORD src1_sel:WORD_1
v_mfma_f32_16x16x32_bf16 v[220:223], v[156:159], v[248:251], v[220:223]
ds_read_u16_d16_hi v206, v206
ds_read_b128 v[244:247], v2 offset:36864
v_exp_f32 v230, v230
s_setprio 0
v_mul_f32 v225, v193, v225
v_mul_f32 v226, v194, v226
v_mul_f32 v227, v195, v227
v_add_f32 v228, 1.0, v228
v_add_f32 v229, 1.0, v229
v_add_f32 v230, 1.0, v230
v_add_f32 v21, v188, v21
v_add_f32 v21, v189, v21
v_add_f32 v21, v190, v21
v_add_f32 v21, v191, v21
v_add_f32 v22, v200, v22
v_fmac_f32 v23, v225, v225
v_fmac_f32 v23, v226, v226
v_fmac_f32 v23, v227, v227
v_fmaak_f32 v232, v216, v216, 0x409d30fc
v_fmaak_f32 v233, v217, v217, 0x409d30fc
v_fmaak_f32 v234, v218, v218, 0x409d30fc
v_fmaak_f32 v231, v199, v199, 0x409d30fc
v_mul_f32 v232, v216, v232
v_mul_f32 v233, v217, v233
v_mul_f32 v234, v218, v234
v_mul_f32 v231, v199, v231
s_setprio 1
v_lshlrev_b32_sdwa v207, v6, v207 dst_sel:DWORD dst_unused:UNUSED_PAD src0_sel:DWORD src1_sel:WORD_1
s_waitcnt lgkmcnt(0)
v_mfma_f32_16x16x32_bf16 v[160:163], v[136:139], v[240:243], 0
ds_read_u16_d16_hi v207, v207
v_rcp_f32 v228, v228
v_lshlrev_b32_sdwa v208, v6, v208 dst_sel:DWORD dst_unused:UNUSED_PAD src0_sel:DWORD src1_sel:WORD_1
v_mfma_f32_16x16x32_bf16 v[164:167], v[148:151], v[240:243], 0
ds_read_u16_d16_hi v208, v208
ds_read_b128 v[248:251], v2 offset:37888
v_rcp_f32 v229, v229
v_lshlrev_b32_sdwa v209, v6, v209 dst_sel:DWORD dst_unused:UNUSED_PAD src0_sel:DWORD src1_sel:WORD_1
v_mfma_f32_16x16x32_bf16 v[160:163], v[140:143], v[244:247], v[160:163]
ds_read_u16_d16_hi v209, v209
v_rcp_f32 v230, v230
v_lshlrev_b32_sdwa v210, v6, v210 dst_sel:DWORD dst_unused:UNUSED_PAD src0_sel:DWORD src1_sel:WORD_1
v_mfma_f32_16x16x32_bf16 v[164:167], v[152:155], v[244:247], v[164:167]
v_exp_f32 v231, v231
ds_read_u16_d16_hi v210, v210
ds_read_b128 v[240:243], v2 offset:41984
v_exp_f32 v232, v232
v_lshlrev_b32_sdwa v211, v6, v211 dst_sel:DWORD dst_unused:UNUSED_PAD src0_sel:DWORD src1_sel:WORD_1
s_waitcnt lgkmcnt(3)
v_mfma_f32_16x16x32_bf16 v[160:163], v[144:147], v[248:251], v[160:163]
ds_read_u16_d16_hi v211, v211
s_add_u32 m0, s40, 116736
s_add_u32 s3, s37, 2359296
buffer_load_dwordx4 v4, s[4:7], s3 offen lds
v_exp_f32 v233, v233
v_mfma_f32_16x16x32_bf16 v[164:167], v[156:159], v[248:251], v[164:167]
ds_read_b128 v[244:247], v2 offset:43008
v_exp_f32 v234, v234
s_setprio 0
v_mul_f32 v228, v196, v228
v_mul_f32 v229, v197, v229
v_mul_f32 v230, v198, v230
v_add_f32 v232, 1.0, v232
v_add_f32 v233, 1.0, v233
v_add_f32 v234, 1.0, v234
v_add_f32 v231, 1.0, v231
v_add_f32 v22, v201, v22
v_add_f32 v22, v202, v22
v_add_f32 v22, v203, v22
v_add_f32 v22, v204, v22
v_add_f32 v22, v205, v22
v_add_f32 v22, v206, v22
v_fmac_f32 v23, v228, v228
v_fmac_f32 v23, v229, v229
v_fmac_f32 v23, v230, v230
v_fmaak_f32 v235, v219, v219, 0x409d30fc
v_fmaak_f32 v236, v220, v220, 0x409d30fc
v_fmaak_f32 v237, v221, v221, 0x409d30fc
v_mul_f32 v235, v219, v235
v_mul_f32 v236, v220, v236
v_mul_f32 v237, v221, v237
s_setprio 1
v_lshlrev_b32_sdwa v212, v6, v212 dst_sel:DWORD dst_unused:UNUSED_PAD src0_sel:DWORD src1_sel:WORD_1
s_waitcnt lgkmcnt(0)
v_mfma_f32_16x16x32_bf16 v[168:171], v[136:139], v[240:243], 0
ds_read_u16_d16_hi v212, v212
v_rcp_f32 v231, v231
v_lshlrev_b32_sdwa v213, v6, v213 dst_sel:DWORD dst_unused:UNUSED_PAD src0_sel:DWORD src1_sel:WORD_1
v_mfma_f32_16x16x32_bf16 v[172:175], v[148:151], v[240:243], 0
ds_read_u16_d16_hi v213, v213
ds_read_b128 v[248:251], v2 offset:44032
v_rcp_f32 v232, v232
v_lshlrev_b32_sdwa v214, v6, v214 dst_sel:DWORD dst_unused:UNUSED_PAD src0_sel:DWORD src1_sel:WORD_1
v_mfma_f32_16x16x32_bf16 v[168:171], v[140:143], v[244:247], v[168:171]
ds_read_u16_d16_hi v214, v214
v_rcp_f32 v233, v233
v_lshlrev_b32_sdwa v215, v6, v215 dst_sel:DWORD dst_unused:UNUSED_PAD src0_sel:DWORD src1_sel:WORD_1
v_mfma_f32_16x16x32_bf16 v[172:175], v[152:155], v[244:247], v[172:175]
v_rcp_f32 v234, v234
ds_read_u16_d16_hi v215, v215
ds_read_b128 v[240:243], v2 offset:48128
v_exp_f32 v235, v235
v_lshlrev_b32_sdwa v160, v6, v160 dst_sel:DWORD dst_unused:UNUSED_PAD src0_sel:DWORD src1_sel:WORD_1
s_waitcnt lgkmcnt(3)
v_mfma_f32_16x16x32_bf16 v[168:171], v[144:147], v[248:251], v[168:171]
ds_read_u16_d16_hi v160, v160
v_exp_f32 v236, v236
v_lshlrev_b32_sdwa v161, v6, v161 dst_sel:DWORD dst_unused:UNUSED_PAD src0_sel:DWORD src1_sel:WORD_1
v_mfma_f32_16x16x32_bf16 v[172:175], v[156:159], v[248:251], v[172:175]
ds_read_u16_d16_hi v161, v161
ds_read_b128 v[244:247], v2 offset:49152
v_exp_f32 v237, v237
s_setprio 0
v_mul_f32 v232, v216, v232
v_mul_f32 v233, v217, v233
v_mul_f32 v234, v218, v234
v_mul_f32 v231, v199, v231
v_add_f32 v235, 1.0, v235
v_add_f32 v236, 1.0, v236
v_add_f32 v237, 1.0, v237
v_add_f32 v24, v208, v24
v_add_f32 v24, v209, v24
v_add_f32 v24, v210, v24
v_add_f32 v24, v211, v24
v_add_f32 v22, v207, v22
v_fmac_f32 v26, v232, v232
v_fmac_f32 v26, v233, v233
v_fmac_f32 v26, v234, v234
v_fmac_f32 v23, v231, v231
v_fmaak_f32 v224, v222, v222, 0x409d30fc
v_fmaak_f32 v238, v223, v223, 0x409d30fc
v_mul_f32 v224, v222, v224
v_mul_f32 v238, v223, v238
s_setprio 1
v_lshlrev_b32_sdwa v162, v6, v162 dst_sel:DWORD dst_unused:UNUSED_PAD src0_sel:DWORD src1_sel:WORD_1
s_waitcnt lgkmcnt(0)
v_mfma_f32_16x16x32_bf16 v[176:179], v[136:139], v[240:243], 0
ds_read_u16_d16_hi v162, v162
v_rcp_f32 v235, v235
v_lshlrev_b32_sdwa v163, v6, v163 dst_sel:DWORD dst_unused:UNUSED_PAD src0_sel:DWORD src1_sel:WORD_1
v_mfma_f32_16x16x32_bf16 v[180:183], v[148:151], v[240:243], 0
ds_read_u16_d16_hi v163, v163
ds_read_b128 v[248:251], v2 offset:50176
s_add_u32 m0, s39, 116736
s_nop 0
buffer_load_dwordx4 v5, s[4:7], s3 offen lds
v_rcp_f32 v236, v236
v_lshlrev_b32_sdwa v164, v6, v164 dst_sel:DWORD dst_unused:UNUSED_PAD src0_sel:DWORD src1_sel:WORD_1
v_mfma_f32_16x16x32_bf16 v[176:179], v[140:143], v[244:247], v[176:179]
ds_read_u16_d16_hi v164, v164
v_lshlrev_b32_sdwa v165, v6, v165 dst_sel:DWORD dst_unused:UNUSED_PAD src0_sel:DWORD src1_sel:WORD_1
v_mfma_f32_16x16x32_bf16 v[180:183], v[152:155], v[244:247], v[180:183]
v_rcp_f32 v237, v237
ds_read_u16_d16_hi v165, v165
ds_read_b128 v[240:243], v2 offset:45056
v_lshlrev_b32_sdwa v166, v6, v166 dst_sel:DWORD dst_unused:UNUSED_PAD src0_sel:DWORD src1_sel:WORD_1
s_waitcnt lgkmcnt(3)
v_mfma_f32_16x16x32_bf16 v[176:179], v[144:147], v[248:251], v[176:179]
ds_read_u16_d16_hi v166, v166
v_exp_f32 v224, v224
v_mfma_f32_16x16x32_bf16 v[180:183], v[156:159], v[248:251], v[180:183]
ds_read_b128 v[244:247], v2 offset:46080
v_exp_f32 v238, v238
s_setprio 0
v_mul_f32 v235, v219, v235
v_mul_f32 v236, v220, v236
v_mul_f32 v237, v221, v237
v_add_f32 v224, 1.0, v224
v_add_f32 v238, 1.0, v238
v_add_f32 v24, v212, v24
v_add_f32 v24, v213, v24
v_add_f32 v24, v214, v24
v_add_f32 v24, v215, v24
v_add_f32 v25, v160, v25
v_add_f32 v25, v161, v25
v_fmac_f32 v26, v235, v235
v_fmac_f32 v26, v236, v236
v_fmac_f32 v26, v237, v237
v_fmaak_f32 v239, v176, v176, 0x409d30fc
v_fmaak_f32 v225, v177, v177, 0x409d30fc
v_fmaak_f32 v226, v178, v178, 0x409d30fc
v_fmaak_f32 v227, v179, v179, 0x409d30fc
v_mul_f32 v239, v176, v239
v_mul_f32 v225, v177, v225
v_mul_f32 v226, v178, v226
v_mul_f32 v227, v179, v227
s_setprio 1
v_lshlrev_b32_sdwa v167, v6, v167 dst_sel:DWORD dst_unused:UNUSED_PAD src0_sel:DWORD src1_sel:WORD_1
s_waitcnt lgkmcnt(0)
v_mfma_f32_16x16x32_bf16 v[184:187], v[136:139], v[240:243], 0
ds_read_u16_d16_hi v167, v167
v_rcp_f32 v224, v224
v_lshlrev_b32_sdwa v168, v6, v168 dst_sel:DWORD dst_unused:UNUSED_PAD src0_sel:DWORD src1_sel:WORD_1
v_mfma_f32_16x16x32_bf16 v[188:191], v[148:151], v[240:243], 0
ds_read_u16_d16_hi v168, v168
ds_read_b128 v[248:251], v2 offset:47104
v_rcp_f32 v238, v238
v_lshlrev_b32_sdwa v169, v6, v169 dst_sel:DWORD dst_unused:UNUSED_PAD src0_sel:DWORD src1_sel:WORD_1
v_mfma_f32_16x16x32_bf16 v[184:187], v[140:143], v[244:247], v[184:187]
ds_read_u16_d16_hi v169, v169
v_exp_f32 v239, v239
v_lshlrev_b32_sdwa v170, v6, v170 dst_sel:DWORD dst_unused:UNUSED_PAD src0_sel:DWORD src1_sel:WORD_1
v_mfma_f32_16x16x32_bf16 v[188:191], v[152:155], v[244:247], v[188:191]
ds_read_u16_d16_hi v170, v170
ds_read_b128 v[240:243], v2 offset:57344
v_exp_f32 v225, v225
v_lshlrev_b32_sdwa v171, v6, v171 dst_sel:DWORD dst_unused:UNUSED_PAD src0_sel:DWORD src1_sel:WORD_1
s_waitcnt lgkmcnt(3)
v_mfma_f32_16x16x32_bf16 v[184:187], v[144:147], v[248:251], v[184:187]
ds_read_u16_d16_hi v171, v171
v_exp_f32 v226, v226
v_mfma_f32_16x16x32_bf16 v[188:191], v[156:159], v[248:251], v[188:191]
ds_read_b128 v[244:247], v2 offset:58368
v_exp_f32 v227, v227
s_setprio 0
v_mul_f32 v224, v222, v224
v_mul_f32 v238, v223, v238
v_add_f32 v239, 1.0, v239
v_add_f32 v225, 1.0, v225
v_add_f32 v226, 1.0, v226
v_add_f32 v227, 1.0, v227
v_add_f32 v25, v162, v25
v_add_f32 v25, v163, v25
v_add_f32 v25, v164, v25
v_add_f32 v25, v165, v25
v_add_f32 v25, v166, v25
v_fmac_f32 v26, v224, v224
v_fmac_f32 v26, v238, v238
v_fmaak_f32 v228, v180, v180, 0x409d30fc
v_fmaak_f32 v229, v181, v181, 0x409d30fc
v_fmaak_f32 v230, v182, v182, 0x409d30fc
v_fmaak_f32 v231, v183, v183, 0x409d30fc
v_mul_f32 v228, v180, v228
v_mul_f32 v229, v181, v229
v_mul_f32 v230, v182, v230
v_mul_f32 v231, v183, v231
s_setprio 1
v_lshlrev_b32_sdwa v172, v6, v172 dst_sel:DWORD dst_unused:UNUSED_PAD src0_sel:DWORD src1_sel:WORD_1
s_waitcnt lgkmcnt(0)
v_mfma_f32_16x16x32_bf16 v[192:195], v[136:139], v[240:243], 0
ds_read_u16_d16_hi v172, v172
v_rcp_f32 v239, v239
v_lshlrev_b32_sdwa v173, v6, v173 dst_sel:DWORD dst_unused:UNUSED_PAD src0_sel:DWORD src1_sel:WORD_1
v_mfma_f32_16x16x32_bf16 v[196:199], v[148:151], v[240:243], 0
ds_read_u16_d16_hi v173, v173
ds_read_b128 v[248:251], v2 offset:59392
v_rcp_f32 v225, v225
v_rcp_f32 v226, v226
v_lshlrev_b32_sdwa v174, v6, v174 dst_sel:DWORD dst_unused:UNUSED_PAD src0_sel:DWORD src1_sel:WORD_1
v_mfma_f32_16x16x32_bf16 v[192:195], v[140:143], v[244:247], v[192:195]
ds_read_u16_d16_hi v174, v174
v_rcp_f32 v227, v227
v_lshlrev_b32_sdwa v175, v6, v175 dst_sel:DWORD dst_unused:UNUSED_PAD src0_sel:DWORD src1_sel:WORD_1
v_mfma_f32_16x16x32_bf16 v[196:199], v[152:155], v[244:247], v[196:199]
ds_read_u16_d16_hi v175, v175
ds_read_b128 v[240:243], v2 offset:51200
s_add_u32 s62, s38, 49152
buffer_store_dwordx4 v[136:139], v2, s[8:11], s62 offen offset:0
v_exp_f32 v228, v228
v_lshlrev_b32_sdwa v184, v6, v184 dst_sel:DWORD dst_unused:UNUSED_PAD src0_sel:DWORD src1_sel:WORD_1
s_waitcnt lgkmcnt(3)
v_mfma_f32_16x16x32_bf16 v[192:195], v[144:147], v[248:251], v[192:195]
ds_read_u16_d16_hi v184, v184
v_exp_f32 v229, v229
v_exp_f32 v230, v230
v_lshlrev_b32_sdwa v185, v6, v185 dst_sel:DWORD dst_unused:UNUSED_PAD src0_sel:DWORD src1_sel:WORD_1
v_mfma_f32_16x16x32_bf16 v[196:199], v[156:159], v[248:251], v[196:199]
ds_read_u16_d16_hi v185, v185
ds_read_b128 v[244:247], v2 offset:52224
v_exp_f32 v231, v231
s_setprio 0
v_mul_f32 v239, v176, v239
v_mul_f32 v225, v177, v225
v_mul_f32 v226, v178, v226
v_mul_f32 v227, v179, v227
v_add_f32 v228, 1.0, v228
v_add_f32 v229, 1.0, v229
v_add_f32 v230, 1.0, v230
v_add_f32 v231, 1.0, v231
v_add_f32 v25, v167, v25
v_add_f32 v27, v168, v27
v_add_f32 v27, v169, v27
v_add_f32 v27, v170, v27
v_add_f32 v27, v171, v27
v_fmac_f32 v29, v239, v239
v_fmac_f32 v29, v225, v225
v_fmac_f32 v29, v226, v226
v_fmac_f32 v29, v227, v227
v_fmaak_f32 v232, v192, v192, 0x409d30fc
v_fmaak_f32 v233, v193, v193, 0x409d30fc
v_fmaak_f32 v234, v194, v194, 0x409d30fc
v_mul_f32 v232, v192, v232
v_mul_f32 v233, v193, v233
v_mul_f32 v234, v194, v234
s_setprio 1
v_lshlrev_b32_sdwa v186, v6, v186 dst_sel:DWORD dst_unused:UNUSED_PAD src0_sel:DWORD src1_sel:WORD_1
s_waitcnt lgkmcnt(0)
v_mfma_f32_16x16x32_bf16 v[200:203], v[136:139], v[240:243], 0
ds_read_u16_d16_hi v186, v186
v_rcp_f32 v228, v228
v_lshlrev_b32_sdwa v187, v6, v187 dst_sel:DWORD dst_unused:UNUSED_PAD src0_sel:DWORD src1_sel:WORD_1
v_mfma_f32_16x16x32_bf16 v[204:207], v[148:151], v[240:243], 0
ds_read_u16_d16_hi v187, v187
ds_read_b128 v[248:251], v2 offset:53248
v_rcp_f32 v229, v229
v_lshlrev_b32_sdwa v188, v6, v188 dst_sel:DWORD dst_unused:UNUSED_PAD src0_sel:DWORD src1_sel:WORD_1
v_mfma_f32_16x16x32_bf16 v[200:203], v[140:143], v[244:247], v[200:203]
ds_read_u16_d16_hi v188, v188
v_rcp_f32 v230, v230
v_lshlrev_b32_sdwa v189, v6, v189 dst_sel:DWORD dst_unused:UNUSED_PAD src0_sel:DWORD src1_sel:WORD_1
v_mfma_f32_16x16x32_bf16 v[204:207], v[152:155], v[244:247], v[204:207]
v_rcp_f32 v231, v231
ds_read_u16_d16_hi v189, v189
ds_read_b128 v[240:243], v2 offset:54272
v_exp_f32 v232, v232
v_lshlrev_b32_sdwa v190, v6, v190 dst_sel:DWORD dst_unused:UNUSED_PAD src0_sel:DWORD src1_sel:WORD_1
s_waitcnt lgkmcnt(3)
v_mfma_f32_16x16x32_bf16 v[200:203], v[144:147], v[248:251], v[200:203]
ds_read_u16_d16_hi v190, v190
v_exp_f32 v233, v233
v_mfma_f32_16x16x32_bf16 v[204:207], v[156:159], v[248:251], v[204:207]
ds_read_b128 v[244:247], v2 offset:55296
v_exp_f32 v234, v234
s_setprio 0
v_mul_f32 v228, v180, v228
v_mul_f32 v229, v181, v229
v_mul_f32 v230, v182, v230
v_mul_f32 v231, v183, v231
v_add_f32 v232, 1.0, v232
v_add_f32 v233, 1.0, v233
v_add_f32 v234, 1.0, v234
v_add_f32 v27, v172, v27
v_add_f32 v27, v173, v27
v_add_f32 v27, v174, v27
v_add_f32 v27, v175, v27
v_add_f32 v28, v184, v28
v_add_f32 v28, v185, v28
v_fmac_f32 v29, v228, v228
v_fmac_f32 v29, v229, v229
v_fmac_f32 v29, v230, v230
v_fmac_f32 v29, v231, v231
v_fmaak_f32 v235, v195, v195, 0x409d30fc
v_fmaak_f32 v236, v196, v196, 0x409d30fc
v_fmaak_f32 v237, v197, v197, 0x409d30fc
v_mul_f32 v235, v195, v235
v_mul_f32 v236, v196, v236
v_mul_f32 v237, v197, v237
s_setprio 1
v_lshlrev_b32_sdwa v191, v6, v191 dst_sel:DWORD dst_unused:UNUSED_PAD src0_sel:DWORD src1_sel:WORD_1
s_waitcnt lgkmcnt(0)
v_mfma_f32_16x16x32_bf16 v[208:211], v[136:139], v[240:243], 0
ds_read_u16_d16_hi v191, v191
buffer_store_dwordx4 v[140:143], v2, s[8:11], s62 offen offset:1024
v_rcp_f32 v232, v232
v_lshlrev_b32_sdwa v200, v6, v200 dst_sel:DWORD dst_unused:UNUSED_PAD src0_sel:DWORD src1_sel:WORD_1
v_mfma_f32_16x16x32_bf16 v[212:215], v[148:151], v[240:243], 0
ds_read_u16_d16_hi v200, v200
ds_read_b128 v[248:251], v2 offset:56320
v_rcp_f32 v233, v233
v_lshlrev_b32_sdwa v201, v6, v201 dst_sel:DWORD dst_unused:UNUSED_PAD src0_sel:DWORD src1_sel:WORD_1
v_mfma_f32_16x16x32_bf16 v[208:211], v[140:143], v[244:247], v[208:211]
ds_read_u16_d16_hi v201, v201
v_rcp_f32 v234, v234
v_lshlrev_b32_sdwa v202, v6, v202 dst_sel:DWORD dst_unused:UNUSED_PAD src0_sel:DWORD src1_sel:WORD_1
v_mfma_f32_16x16x32_bf16 v[212:215], v[152:155], v[244:247], v[212:215]
ds_read_u16_d16_hi v202, v202
ds_read_b128 v[240:243], v3 offset:9216
v_exp_f32 v235, v235
v_lshlrev_b32_sdwa v203, v6, v203 dst_sel:DWORD dst_unused:UNUSED_PAD src0_sel:DWORD src1_sel:WORD_1
s_waitcnt lgkmcnt(3)
v_mfma_f32_16x16x32_bf16 v[208:211], v[144:147], v[248:251], v[208:211]
ds_read_u16_d16_hi v203, v203
v_exp_f32 v236, v236
v_lshlrev_b32_sdwa v204, v6, v204 dst_sel:DWORD dst_unused:UNUSED_PAD src0_sel:DWORD src1_sel:WORD_1
v_mfma_f32_16x16x32_bf16 v[212:215], v[156:159], v[248:251], v[212:215]
ds_read_u16_d16_hi v204, v204
ds_read_b128 v[244:247], v3 offset:10240
v_exp_f32 v237, v237
s_setprio 0
v_mul_f32 v232, v192, v232
v_mul_f32 v233, v193, v233
v_mul_f32 v234, v194, v234
v_add_f32 v235, 1.0, v235
v_add_f32 v236, 1.0, v236
v_add_f32 v237, 1.0, v237
v_add_f32 v28, v186, v28
v_add_f32 v28, v187, v28
v_add_f32 v28, v188, v28
v_add_f32 v28, v189, v28
v_add_f32 v28, v190, v28
v_fmac_f32 v32, v232, v232
v_fmac_f32 v32, v233, v233
v_fmac_f32 v32, v234, v234
v_fmaak_f32 v224, v198, v198, 0x409d30fc
v_fmaak_f32 v238, v199, v199, 0x409d30fc
v_mul_f32 v224, v198, v224
v_mul_f32 v238, v199, v238
s_setprio 1
v_lshlrev_b32_sdwa v205, v6, v205 dst_sel:DWORD dst_unused:UNUSED_PAD src0_sel:DWORD src1_sel:WORD_1
s_waitcnt lgkmcnt(0)
v_mfma_f32_16x16x32_bf16 v[216:219], v[136:139], v[240:243], 0
ds_read_u16_d16_hi v205, v205
v_rcp_f32 v235, v235
v_lshlrev_b32_sdwa v206, v6, v206 dst_sel:DWORD dst_unused:UNUSED_PAD src0_sel:DWORD src1_sel:WORD_1
v_mfma_f32_16x16x32_bf16 v[220:223], v[148:151], v[240:243], 0
ds_read_u16_d16_hi v206, v206
ds_read_b128 v[248:251], v3 offset:11264
v_rcp_f32 v236, v236
v_lshlrev_b32_sdwa v207, v6, v207 dst_sel:DWORD dst_unused:UNUSED_PAD src0_sel:DWORD src1_sel:WORD_1
v_mfma_f32_16x16x32_bf16 v[216:219], v[140:143], v[244:247], v[216:219]
ds_read_u16_d16_hi v207, v207
v_lshlrev_b32_sdwa v208, v6, v208 dst_sel:DWORD dst_unused:UNUSED_PAD src0_sel:DWORD src1_sel:WORD_1
v_mfma_f32_16x16x32_bf16 v[220:223], v[152:155], v[244:247], v[220:223]
v_rcp_f32 v237, v237
ds_read_u16_d16_hi v208, v208
ds_read_b128 v[240:243], v2 offset:60416
buffer_store_dwordx4 v[144:147], v2, s[8:11], s62 offen offset:2048
v_lshlrev_b32_sdwa v209, v6, v209 dst_sel:DWORD dst_unused:UNUSED_PAD src0_sel:DWORD src1_sel:WORD_1
s_waitcnt lgkmcnt(3)
v_mfma_f32_16x16x32_bf16 v[216:219], v[144:147], v[248:251], v[216:219]
ds_read_u16_d16_hi v209, v209
v_exp_f32 v224, v224
v_mfma_f32_16x16x32_bf16 v[220:223], v[156:159], v[248:251], v[220:223]
ds_read_b128 v[244:247], v2 offset:61440
v_exp_f32 v238, v238
s_setprio 0
v_mul_f32 v235, v195, v235
v_mul_f32 v236, v196, v236
v_mul_f32 v237, v197, v237
v_add_f32 v224, 1.0, v224
v_add_f32 v238, 1.0, v238
v_add_f32 v28, v191, v28
v_add_f32 v30, v200, v30
v_add_f32 v30, v201, v30
v_add_f32 v30, v202, v30
v_add_f32 v30, v203, v30
v_add_f32 v30, v204, v30
v_fmac_f32 v32, v235, v235
v_fmac_f32 v32, v236, v236
v_fmac_f32 v32, v237, v237
v_fmaak_f32 v225, v216, v216, 0x409d30fc
v_fmaak_f32 v226, v217, v217, 0x409d30fc
v_fmaak_f32 v227, v218, v218, 0x409d30fc
v_fmaak_f32 v239, v219, v219, 0x409d30fc
v_fmaak_f32 v228, v220, v220, 0x409d30fc
v_mul_f32 v225, v216, v225
v_mul_f32 v226, v217, v226
v_mul_f32 v227, v218, v227
v_mul_f32 v239, v219, v239
v_mul_f32 v228, v220, v228
s_setprio 1
v_lshlrev_b32_sdwa v210, v6, v210 dst_sel:DWORD dst_unused:UNUSED_PAD src0_sel:DWORD src1_sel:WORD_1
s_waitcnt lgkmcnt(0)
v_mfma_f32_16x16x32_bf16 v[160:163], v[136:139], v[240:243], 0
ds_read_u16_d16_hi v210, v210
v_rcp_f32 v224, v224
v_lshlrev_b32_sdwa v211, v6, v211 dst_sel:DWORD dst_unused:UNUSED_PAD src0_sel:DWORD src1_sel:WORD_1
v_mfma_f32_16x16x32_bf16 v[164:167], v[148:151], v[240:243], 0
ds_read_u16_d16_hi v211, v211
ds_read_b128 v[248:251], v2 offset:62464
v_rcp_f32 v238, v238
v_lshlrev_b32_sdwa v212, v6, v212 dst_sel:DWORD dst_unused:UNUSED_PAD src0_sel:DWORD src1_sel:WORD_1
v_mfma_f32_16x16x32_bf16 v[160:163], v[140:143], v[244:247], v[160:163]
ds_read_u16_d16_hi v212, v212
v_exp_f32 v225, v225
v_lshlrev_b32_sdwa v213, v6, v213 dst_sel:DWORD dst_unused:UNUSED_PAD src0_sel:DWORD src1_sel:WORD_1
v_mfma_f32_16x16x32_bf16 v[164:167], v[152:155], v[244:247], v[164:167]
v_exp_f32 v226, v226
ds_read_u16_d16_hi v213, v213
ds_read_b128 v[240:243], v2 offset:63488
v_exp_f32 v227, v227
v_lshlrev_b32_sdwa v214, v6, v214 dst_sel:DWORD dst_unused:UNUSED_PAD src0_sel:DWORD src1_sel:WORD_1
s_waitcnt lgkmcnt(3)
v_mfma_f32_16x16x32_bf16 v[160:163], v[144:147], v[248:251], v[160:163]
ds_read_u16_d16_hi v214, v214
v_exp_f32 v239, v239
v_lshlrev_b32_sdwa v215, v6, v215 dst_sel:DWORD dst_unused:UNUSED_PAD src0_sel:DWORD src1_sel:WORD_1
v_mfma_f32_16x16x32_bf16 v[164:167], v[156:159], v[248:251], v[164:167]
ds_read_u16_d16_hi v215, v215
ds_read_b128 v[244:247], v2 offset:64512
v_exp_f32 v228, v228
s_setprio 0
v_mul_f32 v224, v198, v224
v_mul_f32 v238, v199, v238
v_add_f32 v225, 1.0, v225
v_add_f32 v226, 1.0, v226
v_add_f32 v227, 1.0, v227
v_add_f32 v239, 1.0, v239
v_add_f32 v228, 1.0, v228
v_add_f32 v31, v208, v31
v_add_f32 v31, v209, v31
v_add_f32 v30, v205, v30
v_add_f32 v30, v206, v30
v_add_f32 v30, v207, v30
v_fmac_f32 v32, v224, v224
v_fmac_f32 v32, v238, v238
v_fmaak_f32 v229, v221, v221, 0x409d30fc
v_fmaak_f32 v230, v222, v222, 0x409d30fc
v_fmaak_f32 v231, v223, v223, 0x409d30fc
v_mul_f32 v229, v221, v229
v_mul_f32 v230, v222, v230
v_mul_f32 v231, v223, v231
s_setprio 1
v_lshlrev_b32_sdwa v160, v6, v160 dst_sel:DWORD dst_unused:UNUSED_PAD src0_sel:DWORD src1_sel:WORD_1
s_waitcnt lgkmcnt(0)
v_mfma_f32_16x16x32_bf16 v[168:171], v[136:139], v[240:243], 0
ds_read_u16_d16_hi v160, v160
s_add_u32 s62, s38, 52224
buffer_store_dwordx4 v[148:151], v2, s[8:11], s62 offen offset:0
v_rcp_f32 v225, v225
v_lshlrev_b32_sdwa v161, v6, v161 dst_sel:DWORD dst_unused:UNUSED_PAD src0_sel:DWORD src1_sel:WORD_1
v_mfma_f32_16x16x32_bf16 v[172:175], v[148:151], v[240:243], 0
ds_read_u16_d16_hi v161, v161
ds_read_b128 v[248:251], v3 offset:8192
v_rcp_f32 v226, v226
v_rcp_f32 v227, v227
v_lshlrev_b32_sdwa v162, v6, v162 dst_sel:DWORD dst_unused:UNUSED_PAD src0_sel:DWORD src1_sel:WORD_1
v_mfma_f32_16x16x32_bf16 v[168:171], v[140:143], v[244:247], v[168:171]
ds_read_u16_d16_hi v162, v162
v_rcp_f32 v239, v239
v_lshlrev_b32_sdwa v163, v6, v163 dst_sel:DWORD dst_unused:UNUSED_PAD src0_sel:DWORD src1_sel:WORD_1
v_mfma_f32_16x16x32_bf16 v[172:175], v[152:155], v[244:247], v[172:175]
ds_read_u16_d16_hi v163, v163
ds_read_b128 v[240:243], v3 offset:12288
v_rcp_f32 v228, v228
v_lshlrev_b32_sdwa v164, v6, v164 dst_sel:DWORD dst_unused:UNUSED_PAD src0_sel:DWORD src1_sel:WORD_1
s_waitcnt lgkmcnt(3)
v_mfma_f32_16x16x32_bf16 v[168:171], v[144:147], v[248:251], v[168:171]
ds_read_u16_d16_hi v164, v164
v_exp_f32 v229, v229
v_exp_f32 v230, v230
v_mfma_f32_16x16x32_bf16 v[172:175], v[156:159], v[248:251], v[172:175]
ds_read_b128 v[244:247], v3 offset:13312
v_exp_f32 v231, v231
s_setprio 0
v_mul_f32 v225, v216, v225
v_mul_f32 v226, v217, v226
v_mul_f32 v227, v218, v227
v_mul_f32 v239, v219, v239
v_mul_f32 v228, v220, v228
v_add_f32 v229, 1.0, v229
v_add_f32 v230, 1.0, v230
v_add_f32 v231, 1.0, v231
v_add_f32 v31, v210, v31
v_add_f32 v31, v211, v31
v_add_f32 v31, v212, v31
v_add_f32 v31, v213, v31
v_add_f32 v31, v214, v31
v_add_f32 v31, v215, v31
v_fmac_f32 v35, v225, v225
v_fmac_f32 v35, v226, v226
v_fmac_f32 v35, v227, v227
v_fmac_f32 v35, v239, v239
v_fmac_f32 v35, v228, v228
s_setprio 1
v_lshlrev_b32_sdwa v165, v6, v165 dst_sel:DWORD dst_unused:UNUSED_PAD src0_sel:DWORD src1_sel:WORD_1
s_waitcnt lgkmcnt(0)
v_mfma_f32_16x16x32_bf16 v[176:179], v[136:139], v[240:243], 0
ds_read_u16_d16_hi v165, v165
v_lshlrev_b32_sdwa v166, v6, v166 dst_sel:DWORD dst_unused:UNUSED_PAD src0_sel:DWORD src1_sel:WORD_1
v_rcp_f32 v229, v229
v_mfma_f32_16x16x32_bf16 v[180:183], v[148:151], v[240:243], 0
ds_read_u16_d16_hi v166, v166
ds_read_b128 v[248:251], v3 offset:14336
v_lshlrev_b32_sdwa v167, v6, v167 dst_sel:DWORD dst_unused:UNUSED_PAD src0_sel:DWORD src1_sel:WORD_1
v_mfma_f32_16x16x32_bf16 v[176:179], v[140:143], v[244:247], v[176:179]
ds_read_u16_d16_hi v167, v167
v_lshlrev_b32_sdwa v168, v6, v168 dst_sel:DWORD dst_unused:UNUSED_PAD src0_sel:DWORD src1_sel:WORD_1
v_mfma_f32_16x16x32_bf16 v[180:183], v[152:155], v[244:247], v[180:183]
v_rcp_f32 v230, v230
ds_read_u16_d16_hi v168, v168
ds_read_b128 v[240:243], v3 offset:15360
buffer_store_dwordx4 v[152:155], v2, s[8:11], s62 offen offset:1024
v_lshlrev_b32_sdwa v169, v6, v169 dst_sel:DWORD dst_unused:UNUSED_PAD src0_sel:DWORD src1_sel:WORD_1
s_waitcnt lgkmcnt(3)
v_mfma_f32_16x16x32_bf16 v[176:179], v[144:147], v[248:251], v[176:179]
ds_read_u16_d16_hi v169, v169
v_lshlrev_b32_sdwa v170, v6, v170 dst_sel:DWORD dst_unused:UNUSED_PAD src0_sel:DWORD src1_sel:WORD_1
v_rcp_f32 v231, v231
v_mfma_f32_16x16x32_bf16 v[180:183], v[156:159], v[248:251], v[180:183]
ds_read_u16_d16_hi v170, v170
ds_read_b128 v[244:247], v3 offset:16384
s_setprio 0
v_mul_f32 v229, v221, v229
v_mul_f32 v230, v222, v230
v_mul_f32 v231, v223, v231
v_add_f32 v33, v160, v33
v_add_f32 v33, v161, v33
v_add_f32 v33, v162, v33
v_add_f32 v33, v163, v33
v_add_f32 v33, v164, v33
v_fmac_f32 v35, v229, v229
v_fmac_f32 v35, v230, v230
v_fmac_f32 v35, v231, v231
v_fmaak_f32 v232, v176, v176, 0x409d30fc
v_fmaak_f32 v233, v177, v177, 0x409d30fc
v_fmaak_f32 v234, v178, v178, 0x409d30fc
v_fmaak_f32 v235, v179, v179, 0x409d30fc
v_fmaak_f32 v236, v180, v180, 0x409d30fc
v_fmaak_f32 v237, v181, v181, 0x409d30fc
v_fmaak_f32 v224, v182, v182, 0x409d30fc
v_mul_f32 v232, v176, v232
v_mul_f32 v233, v177, v233
v_mul_f32 v234, v178, v234
v_mul_f32 v235, v179, v235
v_mul_f32 v236, v180, v236
v_mul_f32 v237, v181, v237
v_mul_f32 v224, v182, v224
s_setprio 1
v_lshlrev_b32_sdwa v171, v6, v171 dst_sel:DWORD dst_unused:UNUSED_PAD src0_sel:DWORD src1_sel:WORD_1
s_waitcnt lgkmcnt(0)
v_mfma_f32_16x16x32_bf16 v[184:187], v[136:139], v[240:243], 0
ds_read_u16_d16_hi v171, v171
v_exp_f32 v232, v232
v_lshlrev_b32_sdwa v172, v6, v172 dst_sel:DWORD dst_unused:UNUSED_PAD src0_sel:DWORD src1_sel:WORD_1
v_mfma_f32_16x16x32_bf16 v[188:191], v[148:151], v[240:243], 0
ds_read_u16_d16_hi v172, v172
ds_read_b128 v[248:251], v3 offset:17408
v_exp_f32 v233, v233
v_lshlrev_b32_sdwa v173, v6, v173 dst_sel:DWORD dst_unused:UNUSED_PAD src0_sel:DWORD src1_sel:WORD_1
v_mfma_f32_16x16x32_bf16 v[184:187], v[140:143], v[244:247], v[184:187]
ds_read_u16_d16_hi v173, v173
v_exp_f32 v234, v234
v_lshlrev_b32_sdwa v174, v6, v174 dst_sel:DWORD dst_unused:UNUSED_PAD src0_sel:DWORD src1_sel:WORD_1
v_mfma_f32_16x16x32_bf16 v[188:191], v[152:155], v[244:247], v[188:191]
v_exp_f32 v235, v235
ds_read_u16_d16_hi v174, v174
ds_read_b128 v[240:243], v3 offset:18432
v_exp_f32 v236, v236
v_lshlrev_b32_sdwa v175, v6, v175 dst_sel:DWORD dst_unused:UNUSED_PAD src0_sel:DWORD src1_sel:WORD_1
s_waitcnt lgkmcnt(3)
v_mfma_f32_16x16x32_bf16 v[184:187], v[144:147], v[248:251], v[184:187]
ds_read_u16_d16_hi v175, v175
v_exp_f32 v237, v237
v_mfma_f32_16x16x32_bf16 v[188:191], v[156:159], v[248:251], v[188:191]
ds_read_b128 v[244:247], v3 offset:19456
v_exp_f32 v224, v224
s_setprio 0
v_add_f32 v232, 1.0, v232
v_add_f32 v233, 1.0, v233
v_add_f32 v234, 1.0, v234
v_add_f32 v235, 1.0, v235
v_add_f32 v236, 1.0, v236
v_add_f32 v237, 1.0, v237
v_add_f32 v224, 1.0, v224
v_add_f32 v33, v165, v33
v_add_f32 v33, v166, v33
v_add_f32 v33, v167, v33
v_add_f32 v34, v168, v34
v_add_f32 v34, v169, v34
v_add_f32 v34, v170, v34
v_fmaak_f32 v238, v183, v183, 0x409d30fc
v_mul_f32 v238, v183, v238
s_setprio 1
v_lshlrev_b32_sdwa v184, v6, v184 dst_sel:DWORD dst_unused:UNUSED_PAD src0_sel:DWORD src1_sel:WORD_1
s_waitcnt lgkmcnt(0)
v_mfma_f32_16x16x32_bf16 v[192:195], v[136:139], v[240:243], 0
ds_read_u16_d16_hi v184, v184
buffer_store_dwordx4 v[156:159], v2, s[8:11], s62 offen offset:2048
v_rcp_f32 v232, v232
v_lshlrev_b32_sdwa v185, v6, v185 dst_sel:DWORD dst_unused:UNUSED_PAD src0_sel:DWORD src1_sel:WORD_1
v_mfma_f32_16x16x32_bf16 v[196:199], v[148:151], v[240:243], 0
ds_read_u16_d16_hi v185, v185
ds_read_b128 v[248:251], v3 offset:20480
v_rcp_f32 v233, v233
v_rcp_f32 v234, v234
v_lshlrev_b32_sdwa v186, v6, v186 dst_sel:DWORD dst_unused:UNUSED_PAD src0_sel:DWORD src1_sel:WORD_1
v_mfma_f32_16x16x32_bf16 v[192:195], v[140:143], v[244:247], v[192:195]
ds_read_u16_d16_hi v186, v186
v_rcp_f32 v235, v235
v_lshlrev_b32_sdwa v187, v6, v187 dst_sel:DWORD dst_unused:UNUSED_PAD src0_sel:DWORD src1_sel:WORD_1
v_mfma_f32_16x16x32_bf16 v[196:199], v[152:155], v[244:247], v[196:199]
ds_read_u16_d16_hi v187, v187
ds_read_b128 v[240:243], v3 offset:21504
v_rcp_f32 v236, v236
v_lshlrev_b32_sdwa v188, v6, v188 dst_sel:DWORD dst_unused:UNUSED_PAD src0_sel:DWORD src1_sel:WORD_1
s_waitcnt lgkmcnt(3)
v_mfma_f32_16x16x32_bf16 v[192:195], v[144:147], v[248:251], v[192:195]
ds_read_u16_d16_hi v188, v188
v_rcp_f32 v237, v237
v_rcp_f32 v224, v224
v_lshlrev_b32_sdwa v189, v6, v189 dst_sel:DWORD dst_unused:UNUSED_PAD src0_sel:DWORD src1_sel:WORD_1
v_mfma_f32_16x16x32_bf16 v[196:199], v[156:159], v[248:251], v[196:199]
ds_read_u16_d16_hi v189, v189
ds_read_b128 v[244:247], v3 offset:22528
v_exp_f32 v238, v238
s_setprio 0
v_mul_f32 v232, v176, v232
v_mul_f32 v233, v177, v233
v_mul_f32 v234, v178, v234
v_mul_f32 v235, v179, v235
v_mul_f32 v236, v180, v236
v_mul_f32 v237, v181, v237
v_mul_f32 v224, v182, v224
v_add_f32 v238, 1.0, v238
v_add_f32 v34, v171, v34
v_add_f32 v34, v172, v34
v_add_f32 v34, v173, v34
v_add_f32 v34, v174, v34
v_add_f32 v34, v175, v34
v_fmac_f32 v36, v232, v232
v_fmac_f32 v36, v233, v233
v_fmac_f32 v36, v234, v234
v_fmac_f32 v36, v235, v235
v_fmac_f32 v36, v236, v236
v_fmac_f32 v36, v237, v237
v_fmac_f32 v36, v224, v224
v_fmaak_f32 v239, v192, v192, 0x409d30fc
v_fmaak_f32 v232, v193, v193, 0x409d30fc
v_fmaak_f32 v233, v194, v194, 0x409d30fc
v_fmaak_f32 v234, v195, v195, 0x409d30fc
v_fmaak_f32 v235, v196, v196, 0x409d30fc
v_mul_f32 v239, v192, v239
v_mul_f32 v232, v193, v232
v_mul_f32 v233, v194, v233
v_mul_f32 v234, v195, v234
v_mul_f32 v235, v196, v235
s_setprio 1
v_lshlrev_b32_sdwa v190, v6, v190 dst_sel:DWORD dst_unused:UNUSED_PAD src0_sel:DWORD src1_sel:WORD_1
s_waitcnt lgkmcnt(0)
v_mfma_f32_16x16x32_bf16 v[200:203], v[136:139], v[240:243], 0
ds_read_u16_d16_hi v190, v190
v_rcp_f32 v238, v238
v_mfma_f32_16x16x32_bf16 v[204:207], v[148:151], v[240:243], 0
ds_read_b128 v[248:251], v3 offset:23552
v_exp_f32 v239, v239
v_mfma_f32_16x16x32_bf16 v[200:203], v[140:143], v[244:247], v[200:203]
v_exp_f32 v232, v232
v_lshlrev_b32_sdwa v191, v6, v191 dst_sel:DWORD dst_unused:UNUSED_PAD src0_sel:DWORD src1_sel:WORD_1
v_mfma_f32_16x16x32_bf16 v[204:207], v[152:155], v[244:247], v[204:207]
ds_read_u16_d16_hi v191, v191
v_exp_f32 v233, v233
s_waitcnt lgkmcnt(1)
v_mfma_f32_16x16x32_bf16 v[200:203], v[144:147], v[248:251], v[200:203]
s_lshr_b32 s44, s32, 1
s_add_u32 s44, s44, 3
s_add_u32 s45, s44, 1
s_cmp_ge_u32 s44, 5
s_cselect_b32 s46, 5, 0
s_sub_u32 s44, s44, s46
s_mul_i32 s44, s44, 13312
s_cmp_ge_u32 s45, 5
s_cselect_b32 s46, 5, 0
s_sub_u32 s45, s45, s46
s_mul_i32 s45, s45, 13312
s_sub_u32 s45, s45, s44
s_add_u32 s44, s44, 90112
v_mul_lo_u32 v15, v14, s45
v_add_u32 v15, s44, v15
v_add_u32 v11, v15, v8
v_add_u32 v12, v15, v9
v_add_u32 v13, v15, v10
v_exp_f32 v234, v234
v_mfma_f32_16x16x32_bf16 v[204:207], v[156:159], v[248:251], v[204:207]
v_exp_f32 v235, v235
s_setprio 0
v_mul_f32 v238, v183, v238
v_add_f32 v239, 1.0, v239
v_add_f32 v232, 1.0, v232
v_add_f32 v233, 1.0, v233
v_add_f32 v234, 1.0, v234
v_add_f32 v235, 1.0, v235
v_add_f32 v37, v184, v37
v_add_f32 v37, v185, v37
v_add_f32 v37, v186, v37
v_add_f32 v37, v187, v37
v_add_f32 v37, v188, v37
v_add_f32 v37, v189, v37
v_fmac_f32 v36, v238, v238
v_fmaak_f32 v236, v197, v197, 0x409d30fc
v_fmaak_f32 v237, v198, v198, 0x409d30fc
v_fmaak_f32 v238, v199, v199, 0x409d30fc
v_mul_f32 v236, v197, v236
v_mul_f32 v237, v198, v237
v_mul_f32 v238, v199, v238
s_setprio 1
v_lshlrev_b32_sdwa v200, v6, v200 dst_sel:DWORD dst_unused:UNUSED_PAD src0_sel:DWORD src1_sel:WORD_1
v_lshlrev_b32_sdwa v201, v6, v201 dst_sel:DWORD dst_unused:UNUSED_PAD src0_sel:DWORD src1_sel:WORD_1
ds_read_u16_d16_hi v200, v200
ds_read_u16_d16_hi v201, v201
s_waitcnt vmcnt(0)
s_barrier
v_rcp_f32 v239, v239
ds_read_b128 v[216:219], v13 offset:0
ds_read_b128 v[208:211], v11 offset:0
ds_read_b128 v[212:215], v12 offset:0
v_lshlrev_b32_sdwa v202, v6, v202 dst_sel:DWORD dst_unused:UNUSED_PAD src0_sel:DWORD src1_sel:WORD_1
ds_read_u16_d16_hi v202, v202
v_rcp_f32 v232, v232
v_rcp_f32 v233, v233
v_lshlrev_b32_sdwa v203, v6, v203 dst_sel:DWORD dst_unused:UNUSED_PAD src0_sel:DWORD src1_sel:WORD_1
ds_read_u16_d16_hi v203, v203
ds_read_b128 v[228:231], v13 offset:64
ds_read_b128 v[220:223], v11 offset:64
ds_read_b128 v[224:227], v12 offset:64
v_rcp_f32 v234, v234
v_lshlrev_b32_sdwa v204, v6, v204 dst_sel:DWORD dst_unused:UNUSED_PAD src0_sel:DWORD src1_sel:WORD_1
v_lshlrev_b32_sdwa v205, v6, v205 dst_sel:DWORD dst_unused:UNUSED_PAD src0_sel:DWORD src1_sel:WORD_1
ds_read_u16_d16_hi v204, v204
ds_read_u16_d16_hi v205, v205
v_rcp_f32 v235, v235
s_waitcnt lgkmcnt(6)
v_mfma_f32_16x16x32_bf16 v[160:163], v[88:91], v[216:219], 0
v_smfmac_f32_16x16x64_bf16 v[160:163], v[40:43], v[208:215], v7
v_lshlrev_b32_sdwa v206, v6, v206 dst_sel:DWORD dst_unused:UNUSED_PAD src0_sel:DWORD src1_sel:WORD_1
ds_read_b128 v[248:251], v13 offset:128
ds_read_b128 v[240:243], v11 offset:128
ds_read_b128 v[244:247], v12 offset:128
ds_read_u16_d16_hi v206, v206
v_exp_f32 v236, v236
v_exp_f32 v237, v237
v_lshlrev_b32_sdwa v207, v6, v207 dst_sel:DWORD dst_unused:UNUSED_PAD src0_sel:DWORD src1_sel:WORD_1
ds_read_u16_d16_hi v207, v207
s_waitcnt lgkmcnt(5)
v_mfma_f32_16x16x32_bf16 v[164:167], v[104:107], v[228:231], 0
v_smfmac_f32_16x16x64_bf16 v[164:167], v[56:59], v[220:227], v7
v_exp_f32 v238, v238
v_xor_b32 v11, 16, v11
v_xor_b32 v12, 16, v12
v_xor_b32 v13, 16, v13
ds_read_b128 v[216:219], v13 offset:0
ds_read_b128 v[208:211], v11 offset:0
ds_read_b128 v[212:215], v12 offset:0
s_setprio 0
v_mul_f32 v239, v192, v239
v_mul_f32 v232, v193, v232
v_mul_f32 v233, v194, v233
v_mul_f32 v234, v195, v234
v_mul_f32 v235, v196, v235
v_add_f32 v236, 1.0, v236
v_add_f32 v237, 1.0, v237
v_add_f32 v238, 1.0, v238
v_add_f32 v37, v190, v37
v_add_f32 v37, v191, v37
v_fmac_f32 v38, v239, v239
v_fmac_f32 v38, v232, v232
v_fmac_f32 v38, v233, v233
v_fmac_f32 v38, v234, v234
v_fmac_f32 v38, v235, v235
s_setprio 1
v_mov_b32 v252, v160
v_mul_f32 v253, v160, v160
v_add_f32 v252, v161, v252
v_fmac_f32 v253, v161, v161
v_add_f32 v252, v162, v252
v_fmac_f32 v253, v162, v162
v_add_f32 v252, v163, v252
v_fmac_f32 v253, v163, v163
s_waitcnt lgkmcnt(0)
v_mfma_f32_16x16x32_bf16 v[168:171], v[120:123], v[248:251], 0
v_smfmac_f32_16x16x64_bf16 v[168:171], v[72:75], v[240:247], v7
ds_read_b128 v[228:231], v13 offset:64
ds_read_b128 v[220:223], v11 offset:64
ds_read_b128 v[224:227], v12 offset:64
v_rcp_f32 v236, v236
v_add_f32 v252, v164, v252
v_fmac_f32 v253, v164, v164
v_add_f32 v252, v165, v252
v_fmac_f32 v253, v165, v165
v_add_f32 v252, v166, v252
v_fmac_f32 v253, v166, v166
v_add_f32 v252, v167, v252
v_fmac_f32 v253, v167, v167
v_mfma_f32_16x16x32_bf16 v[172:175], v[92:95], v[216:219], 0
v_smfmac_f32_16x16x64_bf16 v[172:175], v[44:47], v[208:215], v7
ds_read_b128 v[248:251], v13 offset:128
ds_read_b128 v[240:243], v11 offset:128
ds_read_b128 v[244:247], v12 offset:128
v_rcp_f32 v237, v237
v_add_f32 v252, v168, v252
v_fmac_f32 v253, v168, v168
v_add_f32 v252, v169, v252
v_fmac_f32 v253, v169, v169
v_add_f32 v252, v170, v252
v_fmac_f32 v253, v170, v170
v_add_f32 v252, v171, v252
v_fmac_f32 v253, v171, v171
s_waitcnt lgkmcnt(3)
v_mfma_f32_16x16x32_bf16 v[176:179], v[108:111], v[228:231], 0
v_smfmac_f32_16x16x64_bf16 v[176:179], v[60:63], v[220:227], v7
v_xor_b32 v11, 48, v11
v_xor_b32 v12, 48, v12
v_xor_b32 v13, 48, v13
ds_read_b128 v[216:219], v13 offset:0
ds_read_b128 v[208:211], v11 offset:0
ds_read_b128 v[212:215], v12 offset:0
v_rcp_f32 v238, v238
v_add_f32 v252, v172, v252
v_fmac_f32 v253, v172, v172
v_add_f32 v252, v173, v252
v_fmac_f32 v253, v173, v173
v_add_f32 v252, v174, v252
v_fmac_f32 v253, v174, v174
v_add_f32 v252, v175, v252
v_fmac_f32 v253, v175, v175
s_waitcnt lgkmcnt(3)
v_mfma_f32_16x16x32_bf16 v[180:183], v[124:127], v[248:251], 0
v_smfmac_f32_16x16x64_bf16 v[180:183], v[76:79], v[240:247], v7
s_setprio 0
ds_read_b128 v[228:231], v13 offset:64
ds_read_b128 v[220:223], v11 offset:64
ds_read_b128 v[224:227], v12 offset:64
v_mul_f32 v236, v197, v236
v_mul_f32 v237, v198, v237
v_mul_f32 v238, v199, v238
v_add_f32 v39, v200, v39
v_add_f32 v39, v201, v39
v_add_f32 v39, v202, v39
v_add_f32 v39, v203, v39
v_add_f32 v39, v204, v39
v_add_f32 v39, v205, v39
v_add_f32 v39, v206, v39
v_add_f32 v39, v207, v39
v_fmac_f32 v38, v236, v236
v_fmac_f32 v38, v237, v237
v_fmac_f32 v38, v238, v238
v_add_f32 v252, v176, v252
v_fmac_f32 v253, v176, v176
v_add_f32 v252, v177, v252
v_fmac_f32 v253, v177, v177
v_add_f32 v252, v178, v252
v_fmac_f32 v253, v178, v178
v_add_f32 v252, v179, v252
v_fmac_f32 v253, v179, v179
s_waitcnt lgkmcnt(0)
v_mfma_f32_16x16x32_bf16 v[184:187], v[96:99], v[216:219], 0
v_smfmac_f32_16x16x64_bf16 v[184:187], v[48:51], v[208:215], v7
ds_read_b128 v[248:251], v13 offset:128
ds_read_b128 v[240:243], v11 offset:128
ds_read_b128 v[244:247], v12 offset:128
v_add_f32 v252, v180, v252
v_fmac_f32 v253, v180, v180
v_add_f32 v252, v181, v252
v_fmac_f32 v253, v181, v181
v_add_f32 v252, v182, v252
v_fmac_f32 v253, v182, v182
v_add_f32 v252, v183, v252
v_fmac_f32 v253, v183, v183
v_mfma_f32_16x16x32_bf16 v[188:191], v[112:115], v[228:231], 0
v_smfmac_f32_16x16x64_bf16 v[188:191], v[64:67], v[220:227], v7
v_xor_b32 v11, 16, v11
v_xor_b32 v12, 16, v12
v_xor_b32 v13, 16, v13
ds_read_b128 v[216:219], v13 offset:0
ds_read_b128 v[208:211], v11 offset:0
ds_read_b128 v[212:215], v12 offset:0
v_add_f32 v252, v184, v252
v_fmac_f32 v253, v184, v184
v_add_f32 v252, v185, v252
v_fmac_f32 v253, v185, v185
v_add_f32 v252, v186, v252
v_fmac_f32 v253, v186, v186
v_add_f32 v252, v187, v252
v_fmac_f32 v253, v187, v187
s_waitcnt lgkmcnt(3)
v_mfma_f32_16x16x32_bf16 v[192:195], v[128:131], v[248:251], 0
v_smfmac_f32_16x16x64_bf16 v[192:195], v[80:83], v[240:247], v7
ds_read_b128 v[228:231], v13 offset:64
ds_read_b128 v[220:223], v11 offset:64
ds_read_b128 v[224:227], v12 offset:64
v_add_f32 v252, v188, v252
v_fmac_f32 v253, v188, v188
v_add_f32 v252, v189, v252
v_fmac_f32 v253, v189, v189
v_add_f32 v252, v190, v252
v_fmac_f32 v253, v190, v190
v_add_f32 v252, v191, v252
v_fmac_f32 v253, v191, v191
s_waitcnt lgkmcnt(3)
v_mfma_f32_16x16x32_bf16 v[196:199], v[100:103], v[216:219], 0
v_smfmac_f32_16x16x64_bf16 v[196:199], v[52:55], v[208:215], v7
ds_read_b128 v[248:251], v13 offset:128
ds_read_b128 v[240:243], v11 offset:128
ds_read_b128 v[244:247], v12 offset:128
v_add_f32 v252, v192, v252
v_fmac_f32 v253, v192, v192
v_add_f32 v252, v193, v252
v_fmac_f32 v253, v193, v193
v_add_f32 v252, v194, v252
v_fmac_f32 v253, v194, v194
v_add_f32 v252, v195, v252
v_fmac_f32 v253, v195, v195
s_waitcnt lgkmcnt(3)
v_mfma_f32_16x16x32_bf16 v[200:203], v[116:119], v[228:231], 0
v_smfmac_f32_16x16x64_bf16 v[200:203], v[68:71], v[220:227], v7
v_add_f32 v252, v196, v252
v_fmac_f32 v253, v196, v196
v_add_f32 v252, v197, v252
v_fmac_f32 v253, v197, v197
v_add_f32 v252, v198, v252
v_fmac_f32 v253, v198, v198
v_add_f32 v252, v199, v252
v_fmac_f32 v253, v199, v199
s_waitcnt lgkmcnt(0)
v_mfma_f32_16x16x32_bf16 v[204:207], v[132:135], v[248:251], 0
v_smfmac_f32_16x16x64_bf16 v[204:207], v[84:87], v[240:247], v7
v_add_f32 v252, v200, v252
v_fmac_f32 v253, v200, v200
v_add_f32 v252, v201, v252
v_fmac_f32 v253, v201, v201
v_add_f32 v252, v202, v252
v_fmac_f32 v253, v202, v202
v_add_f32 v252, v203, v252
v_fmac_f32 v253, v203, v203
v_add_f32 v252, v204, v252
v_fmac_f32 v253, v204, v204
v_add_f32 v252, v205, v252
v_fmac_f32 v253, v205, v205
v_add_f32 v252, v206, v252
v_fmac_f32 v253, v206, v206
v_add_f32 v252, v207, v252
v_fmac_f32 v253, v207, v207
s_setprio 1
s_nop 0
v_permlane32_swap_b32 v252, v253
v_add_f32 v252, v252, v253
v_mov_b32 v253, v252
s_nop 1
v_permlane32_swap_b32 v252, v253
v_mul_f32 v252, 0x3c2aaaab, v252
v_mul_f32 v253, 0x3c2aaaab, v253
v_mul_f32 v15, v252, v252
v_sub_f32 v253, v253, v15
v_mul_f32 v15, 0x36800000, v15
v_max_f32 v253, v15, v253
v_add_f32 v253, 0x3727c5ac, v253
v_rsq_f32 v253, v253
s_nop 0
v_mul_f32 v253, 0xbeeff558, v253
v_mul_f32 v252, v252, v253
ds_read_b128 v[240:243], v2 offset:8192
ds_read_b128 v[244:247], v2 offset:11264
s_setprio 0
v_fma_f32 v160, v160, v253, -v252
v_fma_f32 v161, v161, v253, -v252
v_fma_f32 v162, v162, v253, -v252
v_fma_f32 v163, v163, v253, -v252
v_fma_f32 v172, v172, v253, -v252
v_fma_f32 v173, v173, v253, -v252
v_fma_f32 v174, v174, v253, -v252
v_fma_f32 v175, v175, v253, -v252
v_fma_f32 v184, v184, v253, -v252
v_fma_f32 v185, v185, v253, -v252
v_fma_f32 v186, v186, v253, -v252
v_fma_f32 v187, v187, v253, -v252
v_fma_f32 v196, v196, v253, -v252
v_fma_f32 v197, v197, v253, -v252
v_fma_f32 v198, v198, v253, -v252
v_fma_f32 v199, v199, v253, -v252
s_setprio 1
v_cvt_pk_bf16_f32 v136, v160, v161
v_cvt_pk_bf16_f32 v137, v162, v163
v_cvt_pk_bf16_f32 v148, v172, v173
v_cvt_pk_bf16_f32 v149, v174, v175
v_cvt_pk_bf16_f32 v138, v184, v185
v_cvt_pk_bf16_f32 v139, v186, v187
v_cvt_pk_bf16_f32 v150, v196, v197
v_cvt_pk_bf16_f32 v151, v198, v199
v_permlane16_swap_b32 v136, v148
v_permlane16_swap_b32 v137, v149
v_permlane16_swap_b32 v138, v150
v_permlane16_swap_b32 v139, v151
s_waitcnt lgkmcnt(0)
s_nop 0
v_mfma_f32_16x16x32_bf16 v[208:211], v[136:139], v[240:243], 0
s_setprio 0
v_fma_f32 v164, v164, v253, -v252
v_fma_f32 v165, v165, v253, -v252
v_fma_f32 v166, v166, v253, -v252
v_fma_f32 v167, v167, v253, -v252
v_fma_f32 v176, v176, v253, -v252
v_fma_f32 v177, v177, v253, -v252
v_fma_f32 v178, v178, v253, -v252
v_fma_f32 v179, v179, v253, -v252
v_fma_f32 v188, v188, v253, -v252
v_fma_f32 v189, v189, v253, -v252
v_fma_f32 v190, v190, v253, -v252
v_fma_f32 v191, v191, v253, -v252
v_fma_f32 v200, v200, v253, -v252
v_fma_f32 v201, v201, v253, -v252
v_fma_f32 v202, v202, v253, -v252
v_fma_f32 v203, v203, v253, -v252
v_mfma_f32_16x16x32_bf16 v[212:215], v[148:151], v[240:243], 0
ds_read_b128 v[248:251], v2 offset:9216
v_mfma_f32_16x16x32_bf16 v[216:219], v[136:139], v[244:247], 0
s_barrier
v_mfma_f32_16x16x32_bf16 v[220:223], v[148:151], v[244:247], 0
s_add_u32 m0, s40, 130048
s_add_u32 s3, s37, 2555904
buffer_load_dwordx4 v4, s[4:7], s3 offen lds
s_setprio 1
ds_read_b128 v[240:243], v2 offset:12288
v_cvt_pk_bf16_f32 v140, v164, v165
v_cvt_pk_bf16_f32 v141, v166, v167
v_cvt_pk_bf16_f32 v152, v176, v177
v_cvt_pk_bf16_f32 v153, v178, v179
v_cvt_pk_bf16_f32 v142, v188, v189
v_cvt_pk_bf16_f32 v143, v190, v191
v_cvt_pk_bf16_f32 v154, v200, v201
v_cvt_pk_bf16_f32 v155, v202, v203
v_permlane16_swap_b32 v140, v152
v_permlane16_swap_b32 v141, v153
v_permlane16_swap_b32 v142, v154
v_permlane16_swap_b32 v143, v155
s_waitcnt lgkmcnt(0)
s_nop 0
v_mfma_f32_16x16x32_bf16 v[208:211], v[140:143], v[248:251], v[208:211]
s_setprio 0
v_fma_f32 v168, v168, v253, -v252
v_fma_f32 v169, v169, v253, -v252
v_fma_f32 v170, v170, v253, -v252
v_fma_f32 v171, v171, v253, -v252
v_fma_f32 v180, v180, v253, -v252
v_fma_f32 v181, v181, v253, -v252
v_fma_f32 v182, v182, v253, -v252
v_fma_f32 v183, v183, v253, -v252
v_fma_f32 v192, v192, v253, -v252
v_fma_f32 v193, v193, v253, -v252
v_fma_f32 v194, v194, v253, -v252
v_fma_f32 v195, v195, v253, -v252
v_fma_f32 v204, v204, v253, -v252
v_fma_f32 v205, v205, v253, -v252
v_fma_f32 v206, v206, v253, -v252
v_fma_f32 v207, v207, v253, -v252
v_mfma_f32_16x16x32_bf16 v[212:215], v[152:155], v[248:251], v[212:215]
ds_read_b128 v[244:247], v2 offset:10240
v_mfma_f32_16x16x32_bf16 v[216:219], v[140:143], v[240:243], v[216:219]
v_mfma_f32_16x16x32_bf16 v[220:223], v[152:155], v[240:243], v[220:223]
s_setprio 1
ds_read_b128 v[248:251], v2 offset:13312
v_cvt_pk_bf16_f32 v144, v168, v169
v_cvt_pk_bf16_f32 v145, v170, v171
v_cvt_pk_bf16_f32 v156, v180, v181
v_cvt_pk_bf16_f32 v157, v182, v183
v_cvt_pk_bf16_f32 v146, v192, v193
v_cvt_pk_bf16_f32 v147, v194, v195
v_cvt_pk_bf16_f32 v158, v204, v205
v_cvt_pk_bf16_f32 v159, v206, v207
v_permlane16_swap_b32 v144, v156
v_permlane16_swap_b32 v145, v157
v_permlane16_swap_b32 v146, v158
v_permlane16_swap_b32 v147, v159
s_waitcnt lgkmcnt(0)
s_nop 0
v_mfma_f32_16x16x32_bf16 v[208:211], v[144:147], v[244:247], v[208:211]
s_setprio 1
v_mfma_f32_16x16x32_bf16 v[212:215], v[156:159], v[244:247], v[212:215]
ds_read_b128 v[240:243], v2 offset:14336
v_mfma_f32_16x16x32_bf16 v[216:219], v[144:147], v[248:251], v[216:219]
v_mfma_f32_16x16x32_bf16 v[220:223], v[156:159], v[248:251], v[220:223]
ds_read_b128 v[244:247], v2 offset:15360
s_waitcnt lgkmcnt(1)
v_mfma_f32_16x16x32_bf16 v[160:163], v[136:139], v[240:243], 0
v_mfma_f32_16x16x32_bf16 v[164:167], v[148:151], v[240:243], 0
ds_read_b128 v[248:251], v2 offset:16384
s_waitcnt lgkmcnt(1)
v_mfma_f32_16x16x32_bf16 v[160:163], v[140:143], v[244:247], v[160:163]
v_mfma_f32_16x16x32_bf16 v[164:167], v[152:155], v[244:247], v[164:167]
s_add_u32 m0, s39, 130048
s_nop 0
buffer_load_dwordx4 v5, s[4:7], s3 offen lds
ds_read_b128 v[240:243], v2 offset:17408
s_waitcnt lgkmcnt(1)
v_mfma_f32_16x16x32_bf16 v[160:163], v[144:147], v[248:251], v[160:163]
v_mfma_f32_16x16x32_bf16 v[164:167], v[156:159], v[248:251], v[164:167]
ds_read_b128 v[244:247], v2 offset:18432
s_setprio 0
v_fmaak_f32 v224, v216, v216, 0x409d30fc
v_fmaak_f32 v225, v217, v217, 0x409d30fc
v_fmaak_f32 v226, v218, v218, 0x409d30fc
v_fmaak_f32 v227, v219, v219, 0x409d30fc
v_mul_f32 v224, v216, v224
v_mul_f32 v225, v217, v225
v_mul_f32 v226, v218, v226
v_mul_f32 v227, v219, v227
s_setprio 1
v_lshlrev_b32_sdwa v208, v6, v208 dst_sel:DWORD dst_unused:UNUSED_PAD src0_sel:DWORD src1_sel:WORD_1
s_waitcnt lgkmcnt(1)
v_mfma_f32_16x16x32_bf16 v[168:171], v[136:139], v[240:243], 0
ds_read_u16_d16_hi v208, v208
s_cmp_eq_u32 s42, 0
s_cbranch_scc0 L_tk2
s_lshl_b32 s44, s41, 2
v_mov_b32 v254, 1
v_mov_b32 v255, 0
s_mov_b64 exec, 1
buffer_atomic_add v254, v255, s[28:31], s44 offen offset:64
s_mov_b64 exec, -1
s_nop 1
L_tk2:
v_exp_f32 v224, v224
v_lshlrev_b32_sdwa v209, v6, v209 dst_sel:DWORD dst_unused:UNUSED_PAD src0_sel:DWORD src1_sel:WORD_1
v_mfma_f32_16x16x32_bf16 v[172:175], v[148:151], v[240:243], 0
ds_read_u16_d16_hi v209, v209
ds_read_b128 v[248:251], v2 offset:19456
v_lshlrev_b32_sdwa v210, v6, v210 dst_sel:DWORD dst_unused:UNUSED_PAD src0_sel:DWORD src1_sel:WORD_1
s_waitcnt lgkmcnt(3)
v_mfma_f32_16x16x32_bf16 v[168:171], v[140:143], v[244:247], v[168:171]
ds_read_u16_d16_hi v210, v210
v_exp_f32 v225, v225
v_lshlrev_b32_sdwa v211, v6, v211 dst_sel:DWORD dst_unused:UNUSED_PAD src0_sel:DWORD src1_sel:WORD_1
v_mfma_f32_16x16x32_bf16 v[172:175], v[152:155], v[244:247], v[172:175]
ds_read_u16_d16_hi v211, v211
ds_read_b128 v[240:243], v2 offset:20480
v_exp_f32 v226, v226
v_lshlrev_b32_sdwa v212, v6, v212 dst_sel:DWORD dst_unused:UNUSED_PAD src0_sel:DWORD src1_sel:WORD_1
s_waitcnt lgkmcnt(3)
v_mfma_f32_16x16x32_bf16 v[168:171], v[144:147], v[248:251], v[168:171]
ds_read_u16_d16_hi v212, v212
v_lshlrev_b32_sdwa v213, v6, v213 dst_sel:DWORD dst_unused:UNUSED_PAD src0_sel:DWORD src1_sel:WORD_1
v_mfma_f32_16x16x32_bf16 v[172:175], v[156:159], v[248:251], v[172:175]
ds_read_u16_d16_hi v213, v213
ds_read_b128 v[244:247], v2 offset:21504
v_exp_f32 v227, v227
s_setprio 0
v_add_f32 v224, 1.0, v224
v_add_f32 v225, 1.0, v225
v_add_f32 v226, 1.0, v226
v_add_f32 v227, 1.0, v227
v_fmaak_f32 v228, v220, v220, 0x409d30fc
v_fmaak_f32 v229, v221, v221, 0x409d30fc
v_fmaak_f32 v230, v222, v222, 0x409d30fc
v_mul_f32 v228, v220, v228
v_mul_f32 v229, v221, v229
v_mul_f32 v230, v222, v230
s_setprio 1
v_lshlrev_b32_sdwa v214, v6, v214 dst_sel:DWORD dst_unused:UNUSED_PAD src0_sel:DWORD src1_sel:WORD_1
s_waitcnt lgkmcnt(0)
v_mfma_f32_16x16x32_bf16 v[176:179], v[136:139], v[240:243], 0
ds_read_u16_d16_hi v214, v214
v_rcp_f32 v224, v224
v_lshlrev_b32_sdwa v215, v6, v215 dst_sel:DWORD dst_unused:UNUSED_PAD src0_sel:DWORD src1_sel:WORD_1
v_mfma_f32_16x16x32_bf16 v[180:183], v[148:151], v[240:243], 0
ds_read_u16_d16_hi v215, v215
ds_read_b128 v[248:251], v2 offset:22528
v_rcp_f32 v225, v225
s_add_u32 m0, s40, 143360
s_add_u32 s3, s37, 2752512
buffer_load_dwordx4 v4, s[4:7], s3 offen lds
v_lshlrev_b32_sdwa v160, v6, v160 dst_sel:DWORD dst_unused:UNUSED_PAD src0_sel:DWORD src1_sel:WORD_1
v_mfma_f32_16x16x32_bf16 v[176:179], v[140:143], v[244:247], v[176:179]
ds_read_u16_d16_hi v160, v160
v_rcp_f32 v226, v226
v_lshlrev_b32_sdwa v161, v6, v161 dst_sel:DWORD dst_unused:UNUSED_PAD src0_sel:DWORD src1_sel:WORD_1
v_mfma_f32_16x16x32_bf16 v[180:183], v[152:155], v[244:247], v[180:183]
v_rcp_f32 v227, v227
ds_read_u16_d16_hi v161, v161
ds_read_b128 v[240:243], v2 offset:23552
v_exp_f32 v228, v228
v_lshlrev_b32_sdwa v162, v6, v162 dst_sel:DWORD dst_unused:UNUSED_PAD src0_sel:DWORD src1_sel:WORD_1
s_waitcnt lgkmcnt(3)
v_mfma_f32_16x16x32_bf16 v[176:179], v[144:147], v[248:251], v[176:179]
ds_read_u16_d16_hi v162, v162
v_exp_f32 v229, v229
v_mfma_f32_16x16x32_bf16 v[180:183], v[156:159], v[248:251], v[180:183]
ds_read_b128 v[244:247], v2 offset:24576
v_exp_f32 v230, v230
s_setprio 0
v_mul_f32 v224, v216, v224
v_mul_f32 v225, v217, v225
v_mul_f32 v226, v218, v226
v_mul_f32 v227, v219, v227
v_add_f32 v228, 1.0, v228
v_add_f32 v229, 1.0, v229
v_add_f32 v230, 1.0, v230
v_add_f32 v16, v208, v16
v_add_f32 v16, v209, v16
v_add_f32 v16, v210, v16
v_add_f32 v16, v211, v16
v_add_f32 v16, v212, v16
v_add_f32 v16, v213, v16
v_fmac_f32 v17, v224, v224
v_fmac_f32 v17, v225, v225
v_fmac_f32 v17, v226, v226
v_fmac_f32 v17, v227, v227
v_fmaak_f32 v231, v223, v223, 0x409d30fc
v_fmaak_f32 v232, v176, v176, 0x409d30fc
v_fmaak_f32 v233, v177, v177, 0x409d30fc
v_mul_f32 v231, v223, v231
v_mul_f32 v232, v176, v232
v_mul_f32 v233, v177, v233
s_setprio 1
v_lshlrev_b32_sdwa v163, v6, v163 dst_sel:DWORD dst_unused:UNUSED_PAD src0_sel:DWORD src1_sel:WORD_1
s_waitcnt lgkmcnt(0)
v_mfma_f32_16x16x32_bf16 v[184:187], v[136:139], v[240:243], 0
ds_read_u16_d16_hi v163, v163
v_rcp_f32 v228, v228
v_lshlrev_b32_sdwa v164, v6, v164 dst_sel:DWORD dst_unused:UNUSED_PAD src0_sel:DWORD src1_sel:WORD_1
v_mfma_f32_16x16x32_bf16 v[188:191], v[148:151], v[240:243], 0
ds_read_u16_d16_hi v164, v164
ds_read_b128 v[248:251], v2 offset:25600
v_rcp_f32 v229, v229
v_lshlrev_b32_sdwa v165, v6, v165 dst_sel:DWORD dst_unused:UNUSED_PAD src0_sel:DWORD src1_sel:WORD_1
v_mfma_f32_16x16x32_bf16 v[184:187], v[140:143], v[244:247], v[184:187]
ds_read_u16_d16_hi v165, v165
v_rcp_f32 v230, v230
v_lshlrev_b32_sdwa v166, v6, v166 dst_sel:DWORD dst_unused:UNUSED_PAD src0_sel:DWORD src1_sel:WORD_1
v_mfma_f32_16x16x32_bf16 v[188:191], v[152:155], v[244:247], v[188:191]
ds_read_u16_d16_hi v166, v166
ds_read_b128 v[240:243], v2 offset:29696
v_exp_f32 v231, v231
v_lshlrev_b32_sdwa v167, v6, v167 dst_sel:DWORD dst_unused:UNUSED_PAD src0_sel:DWORD src1_sel:WORD_1
s_waitcnt lgkmcnt(3)
v_mfma_f32_16x16x32_bf16 v[184:187], v[144:147], v[248:251], v[184:187]
ds_read_u16_d16_hi v167, v167
v_exp_f32 v232, v232
v_lshlrev_b32_sdwa v168, v6, v168 dst_sel:DWORD dst_unused:UNUSED_PAD src0_sel:DWORD src1_sel:WORD_1
v_mfma_f32_16x16x32_bf16 v[188:191], v[156:159], v[248:251], v[188:191]
ds_read_u16_d16_hi v168, v168
ds_read_b128 v[244:247], v2 offset:30720
s_add_u32 m0, s39, 143360
s_nop 0
buffer_load_dwordx4 v5, s[4:7], s3 offen lds
v_exp_f32 v233, v233
s_setprio 0
v_mul_f32 v228, v220, v228
v_mul_f32 v229, v221, v229
v_mul_f32 v230, v222, v230
v_add_f32 v231, 1.0, v231
v_add_f32 v232, 1.0, v232
v_add_f32 v233, 1.0, v233
v_add_f32 v16, v214, v16
v_add_f32 v16, v215, v16
v_add_f32 v18, v160, v18
v_add_f32 v18, v161, v18
v_add_f32 v18, v162, v18
v_fmac_f32 v17, v228, v228
v_fmac_f32 v17, v229, v229
v_fmac_f32 v17, v230, v230
v_fmaak_f32 v234, v178, v178, 0x409d30fc
v_fmaak_f32 v235, v179, v179, 0x409d30fc
v_fmaak_f32 v236, v180, v180, 0x409d30fc
v_fmaak_f32 v237, v181, v181, 0x409d30fc
v_mul_f32 v234, v178, v234
v_mul_f32 v235, v179, v235
v_mul_f32 v236, v180, v236
v_mul_f32 v237, v181, v237
s_setprio 1
v_lshlrev_b32_sdwa v169, v6, v169 dst_sel:DWORD dst_unused:UNUSED_PAD src0_sel:DWORD src1_sel:WORD_1
s_waitcnt lgkmcnt(0)
v_mfma_f32_16x16x32_bf16 v[192:195], v[136:139], v[240:243], 0
ds_read_u16_d16_hi v169, v169
v_rcp_f32 v231, v231
v_lshlrev_b32_sdwa v170, v6, v170 dst_sel:DWORD dst_unused:UNUSED_PAD src0_sel:DWORD src1_sel:WORD_1
v_mfma_f32_16x16x32_bf16 v[196:199], v[148:151], v[240:243], 0
ds_read_u16_d16_hi v170, v170
ds_read_b128 v[248:251], v2 offset:31744
v_rcp_f32 v232, v232
v_lshlrev_b32_sdwa v171, v6, v171 dst_sel:DWORD dst_unused:UNUSED_PAD src0_sel:DWORD src1_sel:WORD_1
v_mfma_f32_16x16x32_bf16 v[192:195], v[140:143], v[244:247], v[192:195]
ds_read_u16_d16_hi v171, v171
v_rcp_f32 v233, v233
v_lshlrev_b32_sdwa v172, v6, v172 dst_sel:DWORD dst_unused:UNUSED_PAD src0_sel:DWORD src1_sel:WORD_1
v_mfma_f32_16x16x32_bf16 v[196:199], v[152:155], v[244:247], v[196:199]
v_exp_f32 v234, v234
ds_read_u16_d16_hi v172, v172
ds_read_b128 v[240:243], v2 offset:26624
v_exp_f32 v235, v235
v_lshlrev_b32_sdwa v173, v6, v173 dst_sel:DWORD dst_unused:UNUSED_PAD src0_sel:DWORD src1_sel:WORD_1
s_waitcnt lgkmcnt(3)
v_mfma_f32_16x16x32_bf16 v[192:195], v[144:147], v[248:251], v[192:195]
ds_read_u16_d16_hi v173, v173
v_exp_f32 v236, v236
v_mfma_f32_16x16x32_bf16 v[196:199], v[156:159], v[248:251], v[196:199]
ds_read_b128 v[244:247], v2 offset:27648
v_exp_f32 v237, v237
s_setprio 0
v_mul_f32 v231, v223, v231
v_mul_f32 v232, v176, v232
v_mul_f32 v233, v177, v233
v_add_f32 v234, 1.0, v234
v_add_f32 v235, 1.0, v235
v_add_f32 v236, 1.0, v236
v_add_f32 v237, 1.0, v237
v_add_f32 v18, v163, v18
v_add_f32 v18, v164, v18
v_add_f32 v18, v165, v18
v_add_f32 v18, v166, v18
v_add_f32 v18, v167, v18
v_add_f32 v19, v168, v19
v_fmac_f32 v17, v231, v231
v_fmac_f32 v20, v232, v232
v_fmac_f32 v20, v233, v233
v_fmaak_f32 v238, v182, v182, 0x409d30fc
v_fmaak_f32 v239, v183, v183, 0x409d30fc
v_fmaak_f32 v224, v192, v192, 0x409d30fc
v_mul_f32 v238, v182, v238
v_mul_f32 v239, v183, v239
v_mul_f32 v224, v192, v224
s_setprio 1
v_lshlrev_b32_sdwa v174, v6, v174 dst_sel:DWORD dst_unused:UNUSED_PAD src0_sel:DWORD src1_sel:WORD_1
s_waitcnt lgkmcnt(0)
v_mfma_f32_16x16x32_bf16 v[200:203], v[136:139], v[240:243], 0
ds_read_u16_d16_hi v174, v174
v_rcp_f32 v234, v234
v_lshlrev_b32_sdwa v175, v6, v175 dst_sel:DWORD dst_unused:UNUSED_PAD src0_sel:DWORD src1_sel:WORD_1
v_mfma_f32_16x16x32_bf16 v[204:207], v[148:151], v[240:243], 0
ds_read_u16_d16_hi v175, v175
ds_read_b128 v[248:251], v2 offset:28672
v_rcp_f32 v235, v235
v_lshlrev_b32_sdwa v184, v6, v184 dst_sel:DWORD dst_unused:UNUSED_PAD src0_sel:DWORD src1_sel:WORD_1
v_mfma_f32_16x16x32_bf16 v[200:203], v[140:143], v[244:247], v[200:203]
ds_read_u16_d16_hi v184, v184
v_rcp_f32 v236, v236
s_add_u32 m0, s40, 90112
s_add_u32 s3, s37, 2949120
buffer_load_dwordx4 v4, s[4:7], s3 offen lds
v_lshlrev_b32_sdwa v185, v6, v185 dst_sel:DWORD dst_unused:UNUSED_PAD src0_sel:DWORD src1_sel:WORD_1
v_mfma_f32_16x16x32_bf16 v[204:207], v[152:155], v[244:247], v[204:207]
v_rcp_f32 v237, v237
ds_read_u16_d16_hi v185, v185
ds_read_b128 v[240:243], v2 offset:32768
v_exp_f32 v238, v238
v_lshlrev_b32_sdwa v186, v6, v186 dst_sel:DWORD dst_unused:UNUSED_PAD src0_sel:DWORD src1_sel:WORD_1
s_waitcnt lgkmcnt(3)
v_mfma_f32_16x16x32_bf16 v[200:203], v[144:147], v[248:251], v[200:203]
ds_read_u16_d16_hi v186, v186
v_exp_f32 v239, v239
v_lshlrev_b32_sdwa v187, v6, v187 dst_sel:DWORD dst_unused:UNUSED_PAD src0_sel:DWORD src1_sel:WORD_1
v_mfma_f32_16x16x32_bf16 v[204:207], v[156:159], v[248:251], v[204:207]
ds_read_u16_d16_hi v187, v187
ds_read_b128 v[244:247], v2 offset:33792
v_exp_f32 v224, v224
s_setprio 0
v_mul_f32 v234, v178, v234
v_mul_f32 v235, v179, v235
v_mul_f32 v236, v180, v236
v_mul_f32 v237, v181, v237
v_add_f32 v238, 1.0, v238
v_add_f32 v239, 1.0, v239
v_add_f32 v224, 1.0, v224
v_add_f32 v19, v169, v19
v_add_f32 v19, v170, v19
v_add_f32 v19, v171, v19
v_add_f32 v19, v172, v19
v_add_f32 v19, v173, v19
v_fmac_f32 v20, v234, v234
v_fmac_f32 v20, v235, v235
v_fmac_f32 v20, v236, v236
v_fmac_f32 v20, v237, v237
v_fmaak_f32 v225, v193, v193, 0x409d30fc
v_fmaak_f32 v226, v194, v194, 0x409d30fc
v_fmaak_f32 v227, v195, v195, 0x409d30fc
v_mul_f32 v225, v193, v225
v_mul_f32 v226, v194, v226
v_mul_f32 v227, v195, v227
s_setprio 1
v_lshlrev_b32_sdwa v188, v6, v188 dst_sel:DWORD dst_unused:UNUSED_PAD src0_sel:DWORD src1_sel:WORD_1
s_waitcnt lgkmcnt(0)
v_mfma_f32_16x16x32_bf16 v[208:211], v[136:139], v[240:243], 0
ds_read_u16_d16_hi v188, v188
v_rcp_f32 v238, v238
v_lshlrev_b32_sdwa v189, v6, v189 dst_sel:DWORD dst_unused:UNUSED_PAD src0_sel:DWORD src1_sel:WORD_1
v_mfma_f32_16x16x32_bf16 v[212:215], v[148:151], v[240:243], 0
ds_read_u16_d16_hi v189, v189
ds_read_b128 v[248:251], v2 offset:34816
v_rcp_f32 v239, v239
v_lshlrev_b32_sdwa v190, v6, v190 dst_sel:DWORD dst_unused:UNUSED_PAD src0_sel:DWORD src1_sel:WORD_1
v_mfma_f32_16x16x32_bf16 v[208:211], v[140:143], v[244:247], v[208:211]
ds_read_u16_d16_hi v190, v190
v_rcp_f32 v224, v224
v_lshlrev_b32_sdwa v191, v6, v191 dst_sel:DWORD dst_unused:UNUSED_PAD src0_sel:DWORD src1_sel:WORD_1
v_mfma_f32_16x16x32_bf16 v[212:215], v[152:155], v[244:247], v[212:215]
ds_read_u16_d16_hi v191, v191
ds_read_b128 v[240:243], v2 offset:38912
v_exp_f32 v225, v225
v_lshlrev_b32_sdwa v200, v6, v200 dst_sel:DWORD dst_unused:UNUSED_PAD src0_sel:DWORD src1_sel:WORD_1
s_waitcnt lgkmcnt(3)
v_mfma_f32_16x16x32_bf16 v[208:211], v[144:147], v[248:251], v[208:211]
ds_read_u16_d16_hi v200, v200
v_exp_f32 v226, v226
v_mfma_f32_16x16x32_bf16 v[212:215], v[156:159], v[248:251], v[212:215]
ds_read_b128 v[244:247], v2 offset:39936
v_exp_f32 v227, v227
s_setprio 0
v_mul_f32 v238, v182, v238
v_mul_f32 v239, v183, v239
v_mul_f32 v224, v192, v224
v_add_f32 v225, 1.0, v225
v_add_f32 v226, 1.0, v226
v_add_f32 v227, 1.0, v227
v_add_f32 v19, v174, v19
v_add_f32 v19, v175, v19
v_add_f32 v21, v184, v21
v_add_f32 v21, v185, v21
v_add_f32 v21, v186, v21
v_add_f32 v21, v187, v21
v_fmac_f32 v20, v238, v238
v_fmac_f32 v20, v239, v239
v_fmac_f32 v23, v224, v224
v_fmaak_f32 v228, v196, v196, 0x409d30fc
v_fmaak_f32 v229, v197, v197, 0x409d30fc
v_fmaak_f32 v230, v198, v198, 0x409d30fc
v_mul_f32 v228, v196, v228
v_mul_f32 v229, v197, v229
v_mul_f32 v230, v198, v230
s_setprio 1
v_lshlrev_b32_sdwa v201, v6, v201 dst_sel:DWORD dst_unused:UNUSED_PAD src0_sel:DWORD src1_sel:WORD_1
s_waitcnt lgkmcnt(0)
v_mfma_f32_16x16x32_bf16 v[216:219], v[136:139], v[240:243], 0
ds_read_u16_d16_hi v201, v201
s_add_u32 m0, s39, 90112
s_nop 0
buffer_load_dwordx4 v5, s[4:7], s3 offen lds
v_rcp_f32 v225, v225
v_lshlrev_b32_sdwa v202, v6, v202 dst_sel:DWORD dst_unused:UNUSED_PAD src0_sel:DWORD src1_sel:WORD_1
v_mfma_f32_16x16x32_bf16 v[220:223], v[148:151], v[240:243], 0
ds_read_u16_d16_hi v202, v202
ds_read_b128 v[248:251], v2 offset:40960
v_rcp_f32 v226, v226
v_lshlrev_b32_sdwa v203, v6, v203 dst_sel:DWORD dst_unused:UNUSED_PAD src0_sel:DWORD src1_sel:WORD_1
v_mfma_f32_16x16x32_bf16 v[216:219], v[140:143], v[244:247], v[216:219]
ds_read_u16_d16_hi v203, v203
v_rcp_f32 v227, v227
v_lshlrev_b32_sdwa v204, v6, v204 dst_sel:DWORD dst_unused:UNUSED_PAD src0_sel:DWORD src1_sel:WORD_1
v_mfma_f32_16x16x32_bf16 v[220:223], v[152:155], v[244:247], v[220:223]
ds_read_u16_d16_hi v204, v204
ds_read_b128 v[240:243], v2 offset:35840
v_exp_f32 v228, v228
v_lshlrev_b32_sdwa v205, v6, v205 dst_sel:DWORD dst_unused:UNUSED_PAD src0_sel:DWORD src1_sel:WORD_1
s_waitcnt lgkmcnt(3)
v_mfma_f32_16x16x32_bf16 v[216:219], v[144:147], v[248:251], v[216:219]
ds_read_u16_d16_hi v205, v205
v_exp_f32 v229, v229
v_lshlrev_b32_sdwa v206, v6, v206 dst_sel:DWORD dst_unused:UNUSED_PAD src0_sel:DWORD src1_sel:WORD_1
v_mfma_f32_16x16x32_bf16 v[220:223], v[156:159], v[248:251], v[220:223]
ds_read_u16_d16_hi v206, v206
ds_read_b128 v[244:247], v2 offset:36864
v_exp_f32 v230, v230
s_setprio 0
v_mul_f32 v225, v193, v225
v_mul_f32 v226, v194, v226
v_mul_f32 v227, v195, v227
v_add_f32 v228, 1.0, v228
v_add_f32 v229, 1.0, v229
v_add_f32 v230, 1.0, v230
v_add_f32 v21, v188, v21
v_add_f32 v21, v189, v21
v_add_f32 v21, v190, v21
v_add_f32 v21, v191, v21
v_add_f32 v22, v200, v22
v_fmac_f32 v23, v225, v225
v_fmac_f32 v23, v226, v226
v_fmac_f32 v23, v227, v227
v_fmaak_f32 v232, v216, v216, 0x409d30fc
v_fmaak_f32 v233, v217, v217, 0x409d30fc
v_fmaak_f32 v234, v218, v218, 0x409d30fc
v_fmaak_f32 v231, v199, v199, 0x409d30fc
v_mul_f32 v232, v216, v232
v_mul_f32 v233, v217, v233
v_mul_f32 v234, v218, v234
v_mul_f32 v231, v199, v231
s_setprio 1
v_lshlrev_b32_sdwa v207, v6, v207 dst_sel:DWORD dst_unused:UNUSED_PAD src0_sel:DWORD src1_sel:WORD_1
s_waitcnt lgkmcnt(0)
v_mfma_f32_16x16x32_bf16 v[160:163], v[136:139], v[240:243], 0
ds_read_u16_d16_hi v207, v207
v_rcp_f32 v228, v228
v_lshlrev_b32_sdwa v208, v6, v208 dst_sel:DWORD dst_unused:UNUSED_PAD src0_sel:DWORD src1_sel:WORD_1
v_mfma_f32_16x16x32_bf16 v[164:167], v[148:151], v[240:243], 0
ds_read_u16_d16_hi v208, v208
ds_read_b128 v[248:251], v2 offset:37888
v_rcp_f32 v229, v229
v_lshlrev_b32_sdwa v209, v6, v209 dst_sel:DWORD dst_unused:UNUSED_PAD src0_sel:DWORD src1_sel:WORD_1
v_mfma_f32_16x16x32_bf16 v[160:163], v[140:143], v[244:247], v[160:163]
ds_read_u16_d16_hi v209, v209
v_rcp_f32 v230, v230
v_lshlrev_b32_sdwa v210, v6, v210 dst_sel:DWORD dst_unused:UNUSED_PAD src0_sel:DWORD src1_sel:WORD_1
v_exp_f32 v231, v231
v_mfma_f32_16x16x32_bf16 v[164:167], v[152:155], v[244:247], v[164:167]
ds_read_u16_d16_hi v210, v210
ds_read_b128 v[240:243], v2 offset:41984
v_exp_f32 v232, v232
v_lshlrev_b32_sdwa v211, v6, v211 dst_sel:DWORD dst_unused:UNUSED_PAD src0_sel:DWORD src1_sel:WORD_1
s_waitcnt lgkmcnt(3)
v_mfma_f32_16x16x32_bf16 v[160:163], v[144:147], v[248:251], v[160:163]
ds_read_u16_d16_hi v211, v211
s_add_u32 m0, s40, 103424
s_add_u32 s3, s37, 3145728
buffer_load_dwordx4 v4, s[4:7], s3 offen lds
v_exp_f32 v233, v233
v_mfma_f32_16x16x32_bf16 v[164:167], v[156:159], v[248:251], v[164:167]
ds_read_b128 v[244:247], v2 offset:43008
v_exp_f32 v234, v234
s_setprio 0
v_mul_f32 v228, v196, v228
v_mul_f32 v229, v197, v229
v_mul_f32 v230, v198, v230
v_add_f32 v232, 1.0, v232
v_add_f32 v233, 1.0, v233
v_add_f32 v234, 1.0, v234
v_add_f32 v231, 1.0, v231
v_add_f32 v22, v201, v22
v_add_f32 v22, v202, v22
v_add_f32 v22, v203, v22
v_add_f32 v22, v204, v22
v_add_f32 v22, v205, v22
v_add_f32 v22, v206, v22
v_fmac_f32 v23, v228, v228
v_fmac_f32 v23, v229, v229
v_fmac_f32 v23, v230, v230
v_fmaak_f32 v235, v219, v219, 0x409d30fc
v_fmaak_f32 v236, v220, v220, 0x409d30fc
v_fmaak_f32 v237, v221, v221, 0x409d30fc
v_mul_f32 v235, v219, v235
v_mul_f32 v236, v220, v236
v_mul_f32 v237, v221, v237
s_setprio 1
v_lshlrev_b32_sdwa v212, v6, v212 dst_sel:DWORD dst_unused:UNUSED_PAD src0_sel:DWORD src1_sel:WORD_1
s_waitcnt lgkmcnt(0)
v_mfma_f32_16x16x32_bf16 v[168:171], v[136:139], v[240:243], 0
ds_read_u16_d16_hi v212, v212
v_rcp_f32 v231, v231
v_lshlrev_b32_sdwa v213, v6, v213 dst_sel:DWORD dst_unused:UNUSED_PAD src0_sel:DWORD src1_sel:WORD_1
v_mfma_f32_16x16x32_bf16 v[172:175], v[148:151], v[240:243], 0
ds_read_u16_d16_hi v213, v213
ds_read_b128 v[248:251], v2 offset:44032
v_rcp_f32 v232, v232
v_lshlrev_b32_sdwa v214, v6, v214 dst_sel:DWORD dst_unused:UNUSED_PAD src0_sel:DWORD src1_sel:WORD_1
v_mfma_f32_16x16x32_bf16 v[168:171], v[140:143], v[244:247], v[168:171]
ds_read_u16_d16_hi v214, v214
v_rcp_f32 v233, v233
v_lshlrev_b32_sdwa v215, v6, v215 dst_sel:DWORD dst_unused:UNUSED_PAD src0_sel:DWORD src1_sel:WORD_1
v_rcp_f32 v234, v234
v_mfma_f32_16x16x32_bf16 v[172:175], v[152:155], v[244:247], v[172:175]
ds_read_u16_d16_hi v215, v215
ds_read_b128 v[240:243], v2 offset:48128
v_exp_f32 v235, v235
v_lshlrev_b32_sdwa v160, v6, v160 dst_sel:DWORD dst_unused:UNUSED_PAD src0_sel:DWORD src1_sel:WORD_1
s_waitcnt lgkmcnt(3)
v_mfma_f32_16x16x32_bf16 v[168:171], v[144:147], v[248:251], v[168:171]
ds_read_u16_d16_hi v160, v160
v_exp_f32 v236, v236
v_lshlrev_b32_sdwa v161, v6, v161 dst_sel:DWORD dst_unused:UNUSED_PAD src0_sel:DWORD src1_sel:WORD_1
v_mfma_f32_16x16x32_bf16 v[172:175], v[156:159], v[248:251], v[172:175]
ds_read_u16_d16_hi v161, v161
ds_read_b128 v[244:247], v2 offset:49152
v_exp_f32 v237, v237
s_setprio 0
v_mul_f32 v232, v216, v232
v_mul_f32 v233, v217, v233
v_mul_f32 v234, v218, v234
v_mul_f32 v231, v199, v231
v_add_f32 v235, 1.0, v235
v_add_f32 v236, 1.0, v236
v_add_f32 v237, 1.0, v237
v_add_f32 v24, v208, v24
v_add_f32 v24, v209, v24
v_add_f32 v24, v210, v24
v_add_f32 v24, v211, v24
v_add_f32 v22, v207, v22
v_fmac_f32 v26, v232, v232
v_fmac_f32 v26, v233, v233
v_fmac_f32 v26, v234, v234
v_fmac_f32 v23, v231, v231
v_fmaak_f32 v224, v222, v222, 0x409d30fc
v_fmaak_f32 v238, v223, v223, 0x409d30fc
v_mul_f32 v224, v222, v224
v_mul_f32 v238, v223, v238
s_setprio 1
v_lshlrev_b32_sdwa v162, v6, v162 dst_sel:DWORD dst_unused:UNUSED_PAD src0_sel:DWORD src1_sel:WORD_1
s_waitcnt lgkmcnt(0)
v_mfma_f32_16x16x32_bf16 v[176:179], v[136:139], v[240:243], 0
ds_read_u16_d16_hi v162, v162
v_rcp_f32 v235, v235
v_lshlrev_b32_sdwa v163, v6, v163 dst_sel:DWORD dst_unused:UNUSED_PAD src0_sel:DWORD src1_sel:WORD_1
v_mfma_f32_16x16x32_bf16 v[180:183], v[148:151], v[240:243], 0
ds_read_u16_d16_hi v163, v163
ds_read_b128 v[248:251], v2 offset:50176
s_add_u32 m0, s39, 103424
s_nop 0
buffer_load_dwordx4 v5, s[4:7], s3 offen lds
v_rcp_f32 v236, v236
v_lshlrev_b32_sdwa v164, v6, v164 dst_sel:DWORD dst_unused:UNUSED_PAD src0_sel:DWORD src1_sel:WORD_1
v_mfma_f32_16x16x32_bf16 v[176:179], v[140:143], v[244:247], v[176:179]
ds_read_u16_d16_hi v164, v164
v_lshlrev_b32_sdwa v165, v6, v165 dst_sel:DWORD dst_unused:UNUSED_PAD src0_sel:DWORD src1_sel:WORD_1
v_rcp_f32 v237, v237
v_mfma_f32_16x16x32_bf16 v[180:183], v[152:155], v[244:247], v[180:183]
ds_read_u16_d16_hi v165, v165
ds_read_b128 v[240:243], v2 offset:45056
v_lshlrev_b32_sdwa v166, v6, v166 dst_sel:DWORD dst_unused:UNUSED_PAD src0_sel:DWORD src1_sel:WORD_1
s_waitcnt lgkmcnt(3)
v_mfma_f32_16x16x32_bf16 v[176:179], v[144:147], v[248:251], v[176:179]
ds_read_u16_d16_hi v166, v166
v_exp_f32 v224, v224
v_mfma_f32_16x16x32_bf16 v[180:183], v[156:159], v[248:251], v[180:183]
ds_read_b128 v[244:247], v2 offset:46080
v_exp_f32 v238, v238
s_setprio 0
v_mul_f32 v235, v219, v235
v_mul_f32 v236, v220, v236
v_mul_f32 v237, v221, v237
v_add_f32 v224, 1.0, v224
v_add_f32 v238, 1.0, v238
v_add_f32 v24, v212, v24
v_add_f32 v24, v213, v24
v_add_f32 v24, v214, v24
v_add_f32 v24, v215, v24
v_add_f32 v25, v160, v25
v_add_f32 v25, v161, v25
v_fmac_f32 v26, v235, v235
v_fmac_f32 v26, v236, v236
v_fmac_f32 v26, v237, v237
v_fmaak_f32 v239, v176, v176, 0x409d30fc
v_fmaak_f32 v225, v177, v177, 0x409d30fc
v_fmaak_f32 v226, v178, v178, 0x409d30fc
v_fmaak_f32 v227, v179, v179, 0x409d30fc
v_mul_f32 v239, v176, v239
v_mul_f32 v225, v177, v225
v_mul_f32 v226, v178, v226
v_mul_f32 v227, v179, v227
s_setprio 1
v_lshlrev_b32_sdwa v167, v6, v167 dst_sel:DWORD dst_unused:UNUSED_PAD src0_sel:DWORD src1_sel:WORD_1
s_waitcnt lgkmcnt(0)
v_mfma_f32_16x16x32_bf16 v[184:187], v[136:139], v[240:243], 0
ds_read_u16_d16_hi v167, v167
v_rcp_f32 v224, v224
v_lshlrev_b32_sdwa v168, v6, v168 dst_sel:DWORD dst_unused:UNUSED_PAD src0_sel:DWORD src1_sel:WORD_1
v_mfma_f32_16x16x32_bf16 v[188:191], v[148:151], v[240:243], 0
ds_read_u16_d16_hi v168, v168
ds_read_b128 v[248:251], v2 offset:47104
v_rcp_f32 v238, v238
v_lshlrev_b32_sdwa v169, v6, v169 dst_sel:DWORD dst_unused:UNUSED_PAD src0_sel:DWORD src1_sel:WORD_1
v_mfma_f32_16x16x32_bf16 v[184:187], v[140:143], v[244:247], v[184:187]
ds_read_u16_d16_hi v169, v169
v_exp_f32 v239, v239
v_lshlrev_b32_sdwa v170, v6, v170 dst_sel:DWORD dst_unused:UNUSED_PAD src0_sel:DWORD src1_sel:WORD_1
v_mfma_f32_16x16x32_bf16 v[188:191], v[152:155], v[244:247], v[188:191]
ds_read_u16_d16_hi v170, v170
ds_read_b128 v[240:243], v2 offset:57344
v_exp_f32 v225, v225
v_lshlrev_b32_sdwa v171, v6, v171 dst_sel:DWORD dst_unused:UNUSED_PAD src0_sel:DWORD src1_sel:WORD_1
s_waitcnt lgkmcnt(3)
v_mfma_f32_16x16x32_bf16 v[184:187], v[144:147], v[248:251], v[184:187]
ds_read_u16_d16_hi v171, v171
v_exp_f32 v226, v226
v_mfma_f32_16x16x32_bf16 v[188:191], v[156:159], v[248:251], v[188:191]
ds_read_b128 v[244:247], v2 offset:58368
v_exp_f32 v227, v227
s_setprio 0
v_mul_f32 v224, v222, v224
v_mul_f32 v238, v223, v238
v_add_f32 v239, 1.0, v239
v_add_f32 v225, 1.0, v225
v_add_f32 v226, 1.0, v226
v_add_f32 v227, 1.0, v227
v_add_f32 v25, v162, v25
v_add_f32 v25, v163, v25
v_add_f32 v25, v164, v25
v_add_f32 v25, v165, v25
v_add_f32 v25, v166, v25
v_fmac_f32 v26, v224, v224
v_fmac_f32 v26, v238, v238
v_fmaak_f32 v228, v180, v180, 0x409d30fc
v_fmaak_f32 v229, v181, v181, 0x409d30fc
v_fmaak_f32 v230, v182, v182, 0x409d30fc
v_fmaak_f32 v231, v183, v183, 0x409d30fc
v_mul_f32 v228, v180, v228
v_mul_f32 v229, v181, v229
v_mul_f32 v230, v182, v230
v_mul_f32 v231, v183, v231
s_setprio 1
v_lshlrev_b32_sdwa v172, v6, v172 dst_sel:DWORD dst_unused:UNUSED_PAD src0_sel:DWORD src1_sel:WORD_1
s_waitcnt lgkmcnt(0)
v_mfma_f32_16x16x32_bf16 v[192:195], v[136:139], v[240:243], 0
ds_read_u16_d16_hi v172, v172
v_rcp_f32 v239, v239
v_lshlrev_b32_sdwa v173, v6, v173 dst_sel:DWORD dst_unused:UNUSED_PAD src0_sel:DWORD src1_sel:WORD_1
v_mfma_f32_16x16x32_bf16 v[196:199], v[148:151], v[240:243], 0
ds_read_u16_d16_hi v173, v173
ds_read_b128 v[248:251], v2 offset:59392
v_rcp_f32 v225, v225
v_rcp_f32 v226, v226
v_lshlrev_b32_sdwa v174, v6, v174 dst_sel:DWORD dst_unused:UNUSED_PAD src0_sel:DWORD src1_sel:WORD_1
v_mfma_f32_16x16x32_bf16 v[192:195], v[140:143], v[244:247], v[192:195]
ds_read_u16_d16_hi v174, v174
v_rcp_f32 v227, v227
v_lshlrev_b32_sdwa v175, v6, v175 dst_sel:DWORD dst_unused:UNUSED_PAD src0_sel:DWORD src1_sel:WORD_1
v_mfma_f32_16x16x32_bf16 v[196:199], v[152:155], v[244:247], v[196:199]
ds_read_u16_d16_hi v175, v175
ds_read_b128 v[240:243], v2 offset:51200
v_exp_f32 v228, v228
v_lshlrev_b32_sdwa v184, v6, v184 dst_sel:DWORD dst_unused:UNUSED_PAD src0_sel:DWORD src1_sel:WORD_1
s_waitcnt lgkmcnt(3)
v_mfma_f32_16x16x32_bf16 v[192:195], v[144:147], v[248:251], v[192:195]
ds_read_u16_d16_hi v184, v184
v_exp_f32 v229, v229
v_exp_f32 v230, v230
v_lshlrev_b32_sdwa v185, v6, v185 dst_sel:DWORD dst_unused:UNUSED_PAD src0_sel:DWORD src1_sel:WORD_1
v_mfma_f32_16x16x32_bf16 v[196:199], v[156:159], v[248:251], v[196:199]
ds_read_u16_d16_hi v185, v185
ds_read_b128 v[244:247], v2 offset:52224
v_exp_f32 v231, v231
s_setprio 0
v_mul_f32 v239, v176, v239
v_mul_f32 v225, v177, v225
v_mul_f32 v226, v178, v226
v_mul_f32 v227, v179, v227
v_add_f32 v228, 1.0, v228
v_add_f32 v229, 1.0, v229
v_add_f32 v230, 1.0, v230
v_add_f32 v231, 1.0, v231
v_add_f32 v25, v167, v25
v_add_f32 v27, v168, v27
v_add_f32 v27, v169, v27
v_add_f32 v27, v170, v27
v_add_f32 v27, v171, v27
v_fmac_f32 v29, v239, v239
v_fmac_f32 v29, v225, v225
v_fmac_f32 v29, v226, v226
v_fmac_f32 v29, v227, v227
v_fmaak_f32 v232, v192, v192, 0x409d30fc
v_fmaak_f32 v233, v193, v193, 0x409d30fc
v_fmaak_f32 v234, v194, v194, 0x409d30fc
v_mul_f32 v232, v192, v232
v_mul_f32 v233, v193, v233
v_mul_f32 v234, v194, v234
s_setprio 1
v_lshlrev_b32_sdwa v186, v6, v186 dst_sel:DWORD dst_unused:UNUSED_PAD src0_sel:DWORD src1_sel:WORD_1
s_waitcnt lgkmcnt(0)
v_mfma_f32_16x16x32_bf16 v[200:203], v[136:139], v[240:243], 0
ds_read_u16_d16_hi v186, v186
v_rcp_f32 v228, v228
v_lshlrev_b32_sdwa v187, v6, v187 dst_sel:DWORD dst_unused:UNUSED_PAD src0_sel:DWORD src1_sel:WORD_1
v_mfma_f32_16x16x32_bf16 v[204:207], v[148:151], v[240:243], 0
ds_read_u16_d16_hi v187, v187
ds_read_b128 v[248:251], v2 offset:53248
v_rcp_f32 v229, v229
v_lshlrev_b32_sdwa v188, v6, v188 dst_sel:DWORD dst_unused:UNUSED_PAD src0_sel:DWORD src1_sel:WORD_1
v_mfma_f32_16x16x32_bf16 v[200:203], v[140:143], v[244:247], v[200:203]
ds_read_u16_d16_hi v188, v188
v_rcp_f32 v230, v230
v_lshlrev_b32_sdwa v189, v6, v189 dst_sel:DWORD dst_unused:UNUSED_PAD src0_sel:DWORD src1_sel:WORD_1
v_rcp_f32 v231, v231
v_mfma_f32_16x16x32_bf16 v[204:207], v[152:155], v[244:247], v[204:207]
ds_read_u16_d16_hi v189, v189
ds_read_b128 v[240:243], v2 offset:54272
v_exp_f32 v232, v232
v_lshlrev_b32_sdwa v190, v6, v190 dst_sel:DWORD dst_unused:UNUSED_PAD src0_sel:DWORD src1_sel:WORD_1
s_waitcnt lgkmcnt(3)
v_mfma_f32_16x16x32_bf16 v[200:203], v[144:147], v[248:251], v[200:203]
ds_read_u16_d16_hi v190, v190
v_exp_f32 v233, v233
v_mfma_f32_16x16x32_bf16 v[204:207], v[156:159], v[248:251], v[204:207]
ds_read_b128 v[244:247], v2 offset:55296
v_exp_f32 v234, v234
s_setprio 0
v_mul_f32 v228, v180, v228
v_mul_f32 v229, v181, v229
v_mul_f32 v230, v182, v230
v_mul_f32 v231, v183, v231
v_add_f32 v232, 1.0, v232
v_add_f32 v233, 1.0, v233
v_add_f32 v234, 1.0, v234
v_add_f32 v27, v172, v27
v_add_f32 v27, v173, v27
v_add_f32 v27, v174, v27
v_add_f32 v27, v175, v27
v_add_f32 v28, v184, v28
v_add_f32 v28, v185, v28
v_fmac_f32 v29, v228, v228
v_fmac_f32 v29, v229, v229
v_fmac_f32 v29, v230, v230
v_fmac_f32 v29, v231, v231
v_fmaak_f32 v235, v195, v195, 0x409d30fc
v_fmaak_f32 v236, v196, v196, 0x409d30fc
v_fmaak_f32 v237, v197, v197, 0x409d30fc
v_mul_f32 v235, v195, v235
v_mul_f32 v236, v196, v236
v_mul_f32 v237, v197, v237
s_setprio 1
v_lshlrev_b32_sdwa v191, v6, v191 dst_sel:DWORD dst_unused:UNUSED_PAD src0_sel:DWORD src1_sel:WORD_1
s_waitcnt lgkmcnt(0)
v_mfma_f32_16x16x32_bf16 v[208:211], v[136:139], v[240:243], 0
ds_read_u16_d16_hi v191, v191
v_rcp_f32 v232, v232
v_lshlrev_b32_sdwa v200, v6, v200 dst_sel:DWORD dst_unused:UNUSED_PAD src0_sel:DWORD src1_sel:WORD_1
v_mfma_f32_16x16x32_bf16 v[212:215], v[148:151], v[240:243], 0
ds_read_u16_d16_hi v200, v200
ds_read_b128 v[248:251], v2 offset:56320
v_rcp_f32 v233, v233
v_lshlrev_b32_sdwa v201, v6, v201 dst_sel:DWORD dst_unused:UNUSED_PAD src0_sel:DWORD src1_sel:WORD_1
v_mfma_f32_16x16x32_bf16 v[208:211], v[140:143], v[244:247], v[208:211]
ds_read_u16_d16_hi v201, v201
v_rcp_f32 v234, v234
v_lshlrev_b32_sdwa v202, v6, v202 dst_sel:DWORD dst_unused:UNUSED_PAD src0_sel:DWORD src1_sel:WORD_1
v_mfma_f32_16x16x32_bf16 v[212:215], v[152:155], v[244:247], v[212:215]
ds_read_u16_d16_hi v202, v202
ds_read_b128 v[240:243], v3 offset:9216
v_exp_f32 v235, v235
v_lshlrev_b32_sdwa v203, v6, v203 dst_sel:DWORD dst_unused:UNUSED_PAD src0_sel:DWORD src1_sel:WORD_1
s_waitcnt lgkmcnt(3)
v_mfma_f32_16x16x32_bf16 v[208:211], v[144:147], v[248:251], v[208:211]
ds_read_u16_d16_hi v203, v203
v_exp_f32 v236, v236
v_lshlrev_b32_sdwa v204, v6, v204 dst_sel:DWORD dst_unused:UNUSED_PAD src0_sel:DWORD src1_sel:WORD_1
v_mfma_f32_16x16x32_bf16 v[212:215], v[156:159], v[248:251], v[212:215]
ds_read_u16_d16_hi v204, v204
ds_read_b128 v[244:247], v3 offset:10240
v_exp_f32 v237, v237
s_setprio 0
v_mul_f32 v232, v192, v232
v_mul_f32 v233, v193, v233
v_mul_f32 v234, v194, v234
v_add_f32 v235, 1.0, v235
v_add_f32 v236, 1.0, v236
v_add_f32 v237, 1.0, v237
v_add_f32 v28, v186, v28
v_add_f32 v28, v187, v28
v_add_f32 v28, v188, v28
v_add_f32 v28, v189, v28
v_add_f32 v28, v190, v28
v_fmac_f32 v32, v232, v232
v_fmac_f32 v32, v233, v233
v_fmac_f32 v32, v234, v234
v_fmaak_f32 v224, v198, v198, 0x409d30fc
v_fmaak_f32 v238, v199, v199, 0x409d30fc
v_mul_f32 v224, v198, v224
v_mul_f32 v238, v199, v238
s_setprio 1
v_lshlrev_b32_sdwa v205, v6, v205 dst_sel:DWORD dst_unused:UNUSED_PAD src0_sel:DWORD src1_sel:WORD_1
s_waitcnt lgkmcnt(0)
v_mfma_f32_16x16x32_bf16 v[216:219], v[136:139], v[240:243], 0
ds_read_u16_d16_hi v205, v205
v_rcp_f32 v235, v235
v_lshlrev_b32_sdwa v206, v6, v206 dst_sel:DWORD dst_unused:UNUSED_PAD src0_sel:DWORD src1_sel:WORD_1
v_mfma_f32_16x16x32_bf16 v[220:223], v[148:151], v[240:243], 0
ds_read_u16_d16_hi v206, v206
ds_read_b128 v[248:251], v3 offset:11264
v_rcp_f32 v236, v236
v_lshlrev_b32_sdwa v207, v6, v207 dst_sel:DWORD dst_unused:UNUSED_PAD src0_sel:DWORD src1_sel:WORD_1
v_mfma_f32_16x16x32_bf16 v[216:219], v[140:143], v[244:247], v[216:219]
ds_read_u16_d16_hi v207, v207
v_lshlrev_b32_sdwa v208, v6, v208 dst_sel:DWORD dst_unused:UNUSED_PAD src0_sel:DWORD src1_sel:WORD_1
v_rcp_f32 v237, v237
v_mfma_f32_16x16x32_bf16 v[220:223], v[152:155], v[244:247], v[220:223]
ds_read_u16_d16_hi v208, v208
ds_read_b128 v[240:243], v2 offset:60416
v_lshlrev_b32_sdwa v209, v6, v209 dst_sel:DWORD dst_unused:UNUSED_PAD src0_sel:DWORD src1_sel:WORD_1
s_waitcnt lgkmcnt(3)
v_mfma_f32_16x16x32_bf16 v[216:219], v[144:147], v[248:251], v[216:219]
ds_read_u16_d16_hi v209, v209
v_exp_f32 v224, v224
v_mfma_f32_16x16x32_bf16 v[220:223], v[156:159], v[248:251], v[220:223]
ds_read_b128 v[244:247], v2 offset:61440
v_exp_f32 v238, v238
s_setprio 0
v_mul_f32 v235, v195, v235
v_mul_f32 v236, v196, v236
v_mul_f32 v237, v197, v237
v_add_f32 v224, 1.0, v224
v_add_f32 v238, 1.0, v238
v_add_f32 v28, v191, v28
v_add_f32 v30, v200, v30
v_add_f32 v30, v201, v30
v_add_f32 v30, v202, v30
v_add_f32 v30, v203, v30
v_add_f32 v30, v204, v30
v_fmac_f32 v32, v235, v235
v_fmac_f32 v32, v236, v236
v_fmac_f32 v32, v237, v237
v_fmaak_f32 v225, v216, v216, 0x409d30fc
v_fmaak_f32 v226, v217, v217, 0x409d30fc
v_fmaak_f32 v227, v218, v218, 0x409d30fc
v_fmaak_f32 v239, v219, v219, 0x409d30fc
v_fmaak_f32 v228, v220, v220, 0x409d30fc
v_mul_f32 v225, v216, v225
v_mul_f32 v226, v217, v226
v_mul_f32 v227, v218, v227
v_mul_f32 v239, v219, v239
v_mul_f32 v228, v220, v228
s_setprio 1
v_lshlrev_b32_sdwa v210, v6, v210 dst_sel:DWORD dst_unused:UNUSED_PAD src0_sel:DWORD src1_sel:WORD_1
s_waitcnt lgkmcnt(0)
v_mfma_f32_16x16x32_bf16 v[160:163], v[136:139], v[240:243], 0
ds_read_u16_d16_hi v210, v210
v_rcp_f32 v224, v224
v_lshlrev_b32_sdwa v211, v6, v211 dst_sel:DWORD dst_unused:UNUSED_PAD src0_sel:DWORD src1_sel:WORD_1
v_mfma_f32_16x16x32_bf16 v[164:167], v[148:151], v[240:243], 0
ds_read_u16_d16_hi v211, v211
ds_read_b128 v[248:251], v2 offset:62464
v_rcp_f32 v238, v238
v_lshlrev_b32_sdwa v212, v6, v212 dst_sel:DWORD dst_unused:UNUSED_PAD src0_sel:DWORD src1_sel:WORD_1
v_mfma_f32_16x16x32_bf16 v[160:163], v[140:143], v[244:247], v[160:163]
ds_read_u16_d16_hi v212, v212
v_exp_f32 v225, v225
v_lshlrev_b32_sdwa v213, v6, v213 dst_sel:DWORD dst_unused:UNUSED_PAD src0_sel:DWORD src1_sel:WORD_1
v_exp_f32 v226, v226
v_mfma_f32_16x16x32_bf16 v[164:167], v[152:155], v[244:247], v[164:167]
ds_read_u16_d16_hi v213, v213
ds_read_b128 v[240:243], v2 offset:63488
v_exp_f32 v227, v227
v_lshlrev_b32_sdwa v214, v6, v214 dst_sel:DWORD dst_unused:UNUSED_PAD src0_sel:DWORD src1_sel:WORD_1
s_waitcnt lgkmcnt(3)
v_mfma_f32_16x16x32_bf16 v[160:163], v[144:147], v[248:251], v[160:163]
ds_read_u16_d16_hi v214, v214
v_exp_f32 v239, v239
v_lshlrev_b32_sdwa v215, v6, v215 dst_sel:DWORD dst_unused:UNUSED_PAD src0_sel:DWORD src1_sel:WORD_1
v_mfma_f32_16x16x32_bf16 v[164:167], v[156:159], v[248:251], v[164:167]
ds_read_u16_d16_hi v215, v215
ds_read_b128 v[244:247], v2 offset:64512
v_exp_f32 v228, v228
s_setprio 0
v_mul_f32 v224, v198, v224
v_mul_f32 v238, v199, v238
v_add_f32 v225, 1.0, v225
v_add_f32 v226, 1.0, v226
v_add_f32 v227, 1.0, v227
v_add_f32 v239, 1.0, v239
v_add_f32 v228, 1.0, v228
v_add_f32 v31, v208, v31
v_add_f32 v31, v209, v31
v_add_f32 v30, v205, v30
v_add_f32 v30, v206, v30
v_add_f32 v30, v207, v30
v_fmac_f32 v32, v224, v224
v_fmac_f32 v32, v238, v238
v_fmaak_f32 v229, v221, v221, 0x409d30fc
v_fmaak_f32 v230, v222, v222, 0x409d30fc
v_fmaak_f32 v231, v223, v223, 0x409d30fc
v_mul_f32 v229, v221, v229
v_mul_f32 v230, v222, v230
v_mul_f32 v231, v223, v231
s_setprio 1
v_lshlrev_b32_sdwa v160, v6, v160 dst_sel:DWORD dst_unused:UNUSED_PAD src0_sel:DWORD src1_sel:WORD_1
s_waitcnt lgkmcnt(0)
v_mfma_f32_16x16x32_bf16 v[168:171], v[136:139], v[240:243], 0
ds_read_u16_d16_hi v160, v160
v_rcp_f32 v225, v225
v_lshlrev_b32_sdwa v161, v6, v161 dst_sel:DWORD dst_unused:UNUSED_PAD src0_sel:DWORD src1_sel:WORD_1
v_mfma_f32_16x16x32_bf16 v[172:175], v[148:151], v[240:243], 0
ds_read_u16_d16_hi v161, v161
ds_read_b128 v[248:251], v3 offset:8192
v_rcp_f32 v226, v226
v_rcp_f32 v227, v227
v_lshlrev_b32_sdwa v162, v6, v162 dst_sel:DWORD dst_unused:UNUSED_PAD src0_sel:DWORD src1_sel:WORD_1
v_mfma_f32_16x16x32_bf16 v[168:171], v[140:143], v[244:247], v[168:171]
ds_read_u16_d16_hi v162, v162
v_rcp_f32 v239, v239
v_lshlrev_b32_sdwa v163, v6, v163 dst_sel:DWORD dst_unused:UNUSED_PAD src0_sel:DWORD src1_sel:WORD_1
v_mfma_f32_16x16x32_bf16 v[172:175], v[152:155], v[244:247], v[172:175]
ds_read_u16_d16_hi v163, v163
ds_read_b128 v[240:243], v3 offset:12288
v_rcp_f32 v228, v228
v_lshlrev_b32_sdwa v164, v6, v164 dst_sel:DWORD dst_unused:UNUSED_PAD src0_sel:DWORD src1_sel:WORD_1
s_waitcnt lgkmcnt(3)
v_mfma_f32_16x16x32_bf16 v[168:171], v[144:147], v[248:251], v[168:171]
ds_read_u16_d16_hi v164, v164
v_exp_f32 v229, v229
v_exp_f32 v230, v230
v_mfma_f32_16x16x32_bf16 v[172:175], v[156:159], v[248:251], v[172:175]
ds_read_b128 v[244:247], v3 offset:13312
v_exp_f32 v231, v231
s_setprio 0
v_mul_f32 v225, v216, v225
v_mul_f32 v226, v217, v226
v_mul_f32 v227, v218, v227
v_mul_f32 v239, v219, v239
v_mul_f32 v228, v220, v228
v_add_f32 v229, 1.0, v229
v_add_f32 v230, 1.0, v230
v_add_f32 v231, 1.0, v231
v_add_f32 v31, v210, v31
v_add_f32 v31, v211, v31
v_add_f32 v31, v212, v31
v_add_f32 v31, v213, v31
v_add_f32 v31, v214, v31
v_add_f32 v31, v215, v31
v_fmac_f32 v35, v225, v225
v_fmac_f32 v35, v226, v226
v_fmac_f32 v35, v227, v227
v_fmac_f32 v35, v239, v239
v_fmac_f32 v35, v228, v228
s_setprio 1
v_lshlrev_b32_sdwa v165, v6, v165 dst_sel:DWORD dst_unused:UNUSED_PAD src0_sel:DWORD src1_sel:WORD_1
s_waitcnt lgkmcnt(0)
v_mfma_f32_16x16x32_bf16 v[176:179], v[136:139], v[240:243], 0
ds_read_u16_d16_hi v165, v165
v_lshlrev_b32_sdwa v166, v6, v166 dst_sel:DWORD dst_unused:UNUSED_PAD src0_sel:DWORD src1_sel:WORD_1
v_rcp_f32 v229, v229
v_mfma_f32_16x16x32_bf16 v[180:183], v[148:151], v[240:243], 0
ds_read_u16_d16_hi v166, v166
ds_read_b128 v[248:251], v3 offset:14336
v_lshlrev_b32_sdwa v167, v6, v167 dst_sel:DWORD dst_unused:UNUSED_PAD src0_sel:DWORD src1_sel:WORD_1
v_mfma_f32_16x16x32_bf16 v[176:179], v[140:143], v[244:247], v[176:179]
ds_read_u16_d16_hi v167, v167
v_lshlrev_b32_sdwa v168, v6, v168 dst_sel:DWORD dst_unused:UNUSED_PAD src0_sel:DWORD src1_sel:WORD_1
v_rcp_f32 v230, v230
v_mfma_f32_16x16x32_bf16 v[180:183], v[152:155], v[244:247], v[180:183]
ds_read_u16_d16_hi v168, v168
ds_read_b128 v[240:243], v3 offset:15360
v_lshlrev_b32_sdwa v169, v6, v169 dst_sel:DWORD dst_unused:UNUSED_PAD src0_sel:DWORD src1_sel:WORD_1
s_waitcnt lgkmcnt(3)
v_mfma_f32_16x16x32_bf16 v[176:179], v[144:147], v[248:251], v[176:179]
ds_read_u16_d16_hi v169, v169
v_lshlrev_b32_sdwa v170, v6, v170 dst_sel:DWORD dst_unused:UNUSED_PAD src0_sel:DWORD src1_sel:WORD_1
v_rcp_f32 v231, v231
v_mfma_f32_16x16x32_bf16 v[180:183], v[156:159], v[248:251], v[180:183]
ds_read_u16_d16_hi v170, v170
ds_read_b128 v[244:247], v3 offset:16384
s_setprio 0
v_mul_f32 v229, v221, v229
v_mul_f32 v230, v222, v230
v_mul_f32 v231, v223, v231
v_add_f32 v33, v160, v33
v_add_f32 v33, v161, v33
v_add_f32 v33, v162, v33
v_add_f32 v33, v163, v33
v_add_f32 v33, v164, v33
v_fmac_f32 v35, v229, v229
v_fmac_f32 v35, v230, v230
v_fmac_f32 v35, v231, v231
v_fmaak_f32 v232, v176, v176, 0x409d30fc
v_fmaak_f32 v233, v177, v177, 0x409d30fc
v_fmaak_f32 v234, v178, v178, 0x409d30fc
v_fmaak_f32 v235, v179, v179, 0x409d30fc
v_fmaak_f32 v236, v180, v180, 0x409d30fc
v_fmaak_f32 v237, v181, v181, 0x409d30fc
v_fmaak_f32 v224, v182, v182, 0x409d30fc
v_mul_f32 v232, v176, v232
v_mul_f32 v233, v177, v233
v_mul_f32 v234, v178, v234
v_mul_f32 v235, v179, v235
v_mul_f32 v236, v180, v236
v_mul_f32 v237, v181, v237
v_mul_f32 v224, v182, v224
s_setprio 1
v_lshlrev_b32_sdwa v171, v6, v171 dst_sel:DWORD dst_unused:UNUSED_PAD src0_sel:DWORD src1_sel:WORD_1
s_waitcnt lgkmcnt(0)
v_mfma_f32_16x16x32_bf16 v[184:187], v[136:139], v[240:243], 0
ds_read_u16_d16_hi v171, v171
v_exp_f32 v232, v232
v_lshlrev_b32_sdwa v172, v6, v172 dst_sel:DWORD dst_unused:UNUSED_PAD src0_sel:DWORD src1_sel:WORD_1
v_mfma_f32_16x16x32_bf16 v[188:191], v[148:151], v[240:243], 0
ds_read_u16_d16_hi v172, v172
ds_read_b128 v[248:251], v3 offset:17408
v_exp_f32 v233, v233
v_lshlrev_b32_sdwa v173, v6, v173 dst_sel:DWORD dst_unused:UNUSED_PAD src0_sel:DWORD src1_sel:WORD_1
v_mfma_f32_16x16x32_bf16 v[184:187], v[140:143], v[244:247], v[184:187]
ds_read_u16_d16_hi v173, v173
v_exp_f32 v234, v234
v_lshlrev_b32_sdwa v174, v6, v174 dst_sel:DWORD dst_unused:UNUSED_PAD src0_sel:DWORD src1_sel:WORD_1
v_exp_f32 v235, v235
v_mfma_f32_16x16x32_bf16 v[188:191], v[152:155], v[244:247], v[188:191]
ds_read_u16_d16_hi v174, v174
ds_read_b128 v[240:243], v3 offset:18432
v_exp_f32 v236, v236
v_lshlrev_b32_sdwa v175, v6, v175 dst_sel:DWORD dst_unused:UNUSED_PAD src0_sel:DWORD src1_sel:WORD_1
s_waitcnt lgkmcnt(3)
v_mfma_f32_16x16x32_bf16 v[184:187], v[144:147], v[248:251], v[184:187]
ds_read_u16_d16_hi v175, v175
v_exp_f32 v237, v237
v_mfma_f32_16x16x32_bf16 v[188:191], v[156:159], v[248:251], v[188:191]
ds_read_b128 v[244:247], v3 offset:19456
v_exp_f32 v224, v224
s_setprio 0
v_add_f32 v232, 1.0, v232
v_add_f32 v233, 1.0, v233
v_add_f32 v234, 1.0, v234
v_add_f32 v235, 1.0, v235
v_add_f32 v236, 1.0, v236
v_add_f32 v237, 1.0, v237
v_add_f32 v224, 1.0, v224
v_add_f32 v33, v165, v33
v_add_f32 v33, v166, v33
v_add_f32 v33, v167, v33
v_add_f32 v34, v168, v34
v_add_f32 v34, v169, v34
v_add_f32 v34, v170, v34
v_fmaak_f32 v238, v183, v183, 0x409d30fc
v_mul_f32 v238, v183, v238
s_setprio 1
v_lshlrev_b32_sdwa v184, v6, v184 dst_sel:DWORD dst_unused:UNUSED_PAD src0_sel:DWORD src1_sel:WORD_1
s_waitcnt lgkmcnt(0)
v_mfma_f32_16x16x32_bf16 v[192:195], v[136:139], v[240:243], 0
ds_read_u16_d16_hi v184, v184
v_rcp_f32 v232, v232
v_lshlrev_b32_sdwa v185, v6, v185 dst_sel:DWORD dst_unused:UNUSED_PAD src0_sel:DWORD src1_sel:WORD_1
v_mfma_f32_16x16x32_bf16 v[196:199], v[148:151], v[240:243], 0
ds_read_u16_d16_hi v185, v185
ds_read_b128 v[248:251], v3 offset:20480
v_rcp_f32 v233, v233
v_rcp_f32 v234, v234
v_lshlrev_b32_sdwa v186, v6, v186 dst_sel:DWORD dst_unused:UNUSED_PAD src0_sel:DWORD src1_sel:WORD_1
v_mfma_f32_16x16x32_bf16 v[192:195], v[140:143], v[244:247], v[192:195]
ds_read_u16_d16_hi v186, v186
v_rcp_f32 v235, v235
v_lshlrev_b32_sdwa v187, v6, v187 dst_sel:DWORD dst_unused:UNUSED_PAD src0_sel:DWORD src1_sel:WORD_1
v_mfma_f32_16x16x32_bf16 v[196:199], v[152:155], v[244:247], v[196:199]
ds_read_u16_d16_hi v187, v187
ds_read_b128 v[240:243], v3 offset:21504
v_rcp_f32 v236, v236
v_lshlrev_b32_sdwa v188, v6, v188 dst_sel:DWORD dst_unused:UNUSED_PAD src0_sel:DWORD src1_sel:WORD_1
s_waitcnt lgkmcnt(3)
v_mfma_f32_16x16x32_bf16 v[192:195], v[144:147], v[248:251], v[192:195]
ds_read_u16_d16_hi v188, v188
v_rcp_f32 v237, v237
v_rcp_f32 v224, v224
v_lshlrev_b32_sdwa v189, v6, v189 dst_sel:DWORD dst_unused:UNUSED_PAD src0_sel:DWORD src1_sel:WORD_1
v_mfma_f32_16x16x32_bf16 v[196:199], v[156:159], v[248:251], v[196:199]
ds_read_u16_d16_hi v189, v189
ds_read_b128 v[244:247], v3 offset:22528
v_exp_f32 v238, v238
s_setprio 0
v_mul_f32 v232, v176, v232
v_mul_f32 v233, v177, v233
v_mul_f32 v234, v178, v234
v_mul_f32 v235, v179, v235
v_mul_f32 v236, v180, v236
v_mul_f32 v237, v181, v237
v_mul_f32 v224, v182, v224
v_add_f32 v238, 1.0, v238
v_add_f32 v34, v171, v34
v_add_f32 v34, v172, v34
v_add_f32 v34, v173, v34
v_add_f32 v34, v174, v34
v_add_f32 v34, v175, v34
v_fmac_f32 v36, v232, v232
v_fmac_f32 v36, v233, v233
v_fmac_f32 v36, v234, v234
v_fmac_f32 v36, v235, v235
v_fmac_f32 v36, v236, v236
v_fmac_f32 v36, v237, v237
v_fmac_f32 v36, v224, v224
v_fmaak_f32 v239, v192, v192, 0x409d30fc
v_fmaak_f32 v232, v193, v193, 0x409d30fc
v_fmaak_f32 v233, v194, v194, 0x409d30fc
v_fmaak_f32 v234, v195, v195, 0x409d30fc
v_fmaak_f32 v235, v196, v196, 0x409d30fc
v_mul_f32 v239, v192, v239
v_mul_f32 v232, v193, v232
v_mul_f32 v233, v194, v233
v_mul_f32 v234, v195, v234
v_mul_f32 v235, v196, v235
s_setprio 1
v_lshlrev_b32_sdwa v190, v6, v190 dst_sel:DWORD dst_unused:UNUSED_PAD src0_sel:DWORD src1_sel:WORD_1
s_waitcnt lgkmcnt(0)
v_mfma_f32_16x16x32_bf16 v[200:203], v[136:139], v[240:243], 0
ds_read_u16_d16_hi v190, v190
v_rcp_f32 v238, v238
v_mfma_f32_16x16x32_bf16 v[204:207], v[148:151], v[240:243], 0
ds_read_b128 v[248:251], v3 offset:23552
v_exp_f32 v239, v239
v_mfma_f32_16x16x32_bf16 v[200:203], v[140:143], v[244:247], v[200:203]
v_exp_f32 v232, v232
v_lshlrev_b32_sdwa v191, v6, v191 dst_sel:DWORD dst_unused:UNUSED_PAD src0_sel:DWORD src1_sel:WORD_1
v_mfma_f32_16x16x32_bf16 v[204:207], v[152:155], v[244:247], v[204:207]
ds_read_u16_d16_hi v191, v191
v_exp_f32 v233, v233
s_waitcnt lgkmcnt(1)
v_mfma_f32_16x16x32_bf16 v[200:203], v[144:147], v[248:251], v[200:203]
s_lshr_b32 s44, s32, 1
s_add_u32 s44, s44, 2
s_add_u32 s45, s44, 1
s_cmp_ge_u32 s44, 5
s_cselect_b32 s46, 5, 0
s_sub_u32 s44, s44, s46
s_mul_i32 s44, s44, 13312
s_cmp_ge_u32 s45, 5
s_cselect_b32 s46, 5, 0
s_sub_u32 s45, s45, s46
s_mul_i32 s45, s45, 13312
s_sub_u32 s45, s45, s44
s_add_u32 s44, s44, 90112
v_mul_lo_u32 v15, v14, s45
v_add_u32 v15, s44, v15
v_add_u32 v11, v15, v8
v_add_u32 v12, v15, v9
v_add_u32 v13, v15, v10
v_exp_f32 v234, v234
v_mfma_f32_16x16x32_bf16 v[204:207], v[156:159], v[248:251], v[204:207]
v_exp_f32 v235, v235
s_setprio 0
v_mul_f32 v238, v183, v238
v_add_f32 v239, 1.0, v239
v_add_f32 v232, 1.0, v232
v_add_f32 v233, 1.0, v233
v_add_f32 v234, 1.0, v234
v_add_f32 v235, 1.0, v235
v_add_f32 v37, v184, v37
v_add_f32 v37, v185, v37
v_add_f32 v37, v186, v37
v_add_f32 v37, v187, v37
v_add_f32 v37, v188, v37
v_add_f32 v37, v189, v37
v_fmac_f32 v36, v238, v238
v_fmaak_f32 v236, v197, v197, 0x409d30fc
v_fmaak_f32 v237, v198, v198, 0x409d30fc
v_fmaak_f32 v238, v199, v199, 0x409d30fc
v_mul_f32 v236, v197, v236
v_mul_f32 v237, v198, v237
v_mul_f32 v238, v199, v238
s_setprio 1
v_lshlrev_b32_sdwa v200, v6, v200 dst_sel:DWORD dst_unused:UNUSED_PAD src0_sel:DWORD src1_sel:WORD_1
v_lshlrev_b32_sdwa v201, v6, v201 dst_sel:DWORD dst_unused:UNUSED_PAD src0_sel:DWORD src1_sel:WORD_1
ds_read_u16_d16_hi v200, v200
ds_read_u16_d16_hi v201, v201
s_waitcnt vmcnt(0)
s_barrier
v_rcp_f32 v239, v239
ds_read_b128 v[216:219], v13 offset:0
ds_read_b128 v[208:211], v11 offset:0
ds_read_b128 v[212:215], v12 offset:0
v_lshlrev_b32_sdwa v202, v6, v202 dst_sel:DWORD dst_unused:UNUSED_PAD src0_sel:DWORD src1_sel:WORD_1
ds_read_u16_d16_hi v202, v202
v_rcp_f32 v232, v232
v_rcp_f32 v233, v233
v_lshlrev_b32_sdwa v203, v6, v203 dst_sel:DWORD dst_unused:UNUSED_PAD src0_sel:DWORD src1_sel:WORD_1
ds_read_u16_d16_hi v203, v203
ds_read_b128 v[228:231], v13 offset:64
ds_read_b128 v[220:223], v11 offset:64
ds_read_b128 v[224:227], v12 offset:64
v_rcp_f32 v234, v234
v_lshlrev_b32_sdwa v204, v6, v204 dst_sel:DWORD dst_unused:UNUSED_PAD src0_sel:DWORD src1_sel:WORD_1
v_lshlrev_b32_sdwa v205, v6, v205 dst_sel:DWORD dst_unused:UNUSED_PAD src0_sel:DWORD src1_sel:WORD_1
ds_read_u16_d16_hi v204, v204
ds_read_u16_d16_hi v205, v205
v_rcp_f32 v235, v235
s_waitcnt lgkmcnt(6)
v_mfma_f32_16x16x32_bf16 v[160:163], v[88:91], v[216:219], 0
v_smfmac_f32_16x16x64_bf16 v[160:163], v[40:43], v[208:215], v7
v_lshlrev_b32_sdwa v206, v6, v206 dst_sel:DWORD dst_unused:UNUSED_PAD src0_sel:DWORD src1_sel:WORD_1
ds_read_b128 v[248:251], v13 offset:128
ds_read_b128 v[240:243], v11 offset:128
ds_read_b128 v[244:247], v12 offset:128
ds_read_u16_d16_hi v206, v206
v_exp_f32 v236, v236
v_exp_f32 v237, v237
v_lshlrev_b32_sdwa v207, v6, v207 dst_sel:DWORD dst_unused:UNUSED_PAD src0_sel:DWORD src1_sel:WORD_1
ds_read_u16_d16_hi v207, v207
s_waitcnt lgkmcnt(5)
v_mfma_f32_16x16x32_bf16 v[164:167], v[104:107], v[228:231], 0
v_smfmac_f32_16x16x64_bf16 v[164:167], v[56:59], v[220:227], v7
v_exp_f32 v238, v238
v_xor_b32 v11, 16, v11
v_xor_b32 v12, 16, v12
v_xor_b32 v13, 16, v13
ds_read_b128 v[216:219], v13 offset:0
ds_read_b128 v[208:211], v11 offset:0
ds_read_b128 v[212:215], v12 offset:0
s_setprio 0
v_mul_f32 v239, v192, v239
v_mul_f32 v232, v193, v232
v_mul_f32 v233, v194, v233
v_mul_f32 v234, v195, v234
v_mul_f32 v235, v196, v235
v_add_f32 v236, 1.0, v236
v_add_f32 v237, 1.0, v237
v_add_f32 v238, 1.0, v238
v_add_f32 v37, v190, v37
v_add_f32 v37, v191, v37
v_fmac_f32 v38, v239, v239
v_fmac_f32 v38, v232, v232
v_fmac_f32 v38, v233, v233
v_fmac_f32 v38, v234, v234
v_fmac_f32 v38, v235, v235
s_setprio 1
v_mov_b32 v252, v160
v_mul_f32 v253, v160, v160
v_add_f32 v252, v161, v252
v_fmac_f32 v253, v161, v161
v_add_f32 v252, v162, v252
v_fmac_f32 v253, v162, v162
v_add_f32 v252, v163, v252
v_fmac_f32 v253, v163, v163
s_waitcnt lgkmcnt(0)
v_mfma_f32_16x16x32_bf16 v[168:171], v[120:123], v[248:251], 0
v_smfmac_f32_16x16x64_bf16 v[168:171], v[72:75], v[240:247], v7
ds_read_b128 v[228:231], v13 offset:64
ds_read_b128 v[220:223], v11 offset:64
ds_read_b128 v[224:227], v12 offset:64
v_rcp_f32 v236, v236
v_add_f32 v252, v164, v252
v_fmac_f32 v253, v164, v164
v_add_f32 v252, v165, v252
v_fmac_f32 v253, v165, v165
v_add_f32 v252, v166, v252
v_fmac_f32 v253, v166, v166
v_add_f32 v252, v167, v252
v_fmac_f32 v253, v167, v167
v_mfma_f32_16x16x32_bf16 v[172:175], v[92:95], v[216:219], 0
v_smfmac_f32_16x16x64_bf16 v[172:175], v[44:47], v[208:215], v7
ds_read_b128 v[248:251], v13 offset:128
ds_read_b128 v[240:243], v11 offset:128
ds_read_b128 v[244:247], v12 offset:128
v_rcp_f32 v237, v237
v_add_f32 v252, v168, v252
v_fmac_f32 v253, v168, v168
v_add_f32 v252, v169, v252
v_fmac_f32 v253, v169, v169
v_add_f32 v252, v170, v252
v_fmac_f32 v253, v170, v170
v_add_f32 v252, v171, v252
v_fmac_f32 v253, v171, v171
s_waitcnt lgkmcnt(3)
v_mfma_f32_16x16x32_bf16 v[176:179], v[108:111], v[228:231], 0
v_smfmac_f32_16x16x64_bf16 v[176:179], v[60:63], v[220:227], v7
v_xor_b32 v11, 48, v11
v_xor_b32 v12, 48, v12
v_xor_b32 v13, 48, v13
ds_read_b128 v[216:219], v13 offset:0
ds_read_b128 v[208:211], v11 offset:0
ds_read_b128 v[212:215], v12 offset:0
v_rcp_f32 v238, v238
v_add_f32 v252, v172, v252
v_fmac_f32 v253, v172, v172
v_add_f32 v252, v173, v252
v_fmac_f32 v253, v173, v173
v_add_f32 v252, v174, v252
v_fmac_f32 v253, v174, v174
v_add_f32 v252, v175, v252
v_fmac_f32 v253, v175, v175
s_waitcnt lgkmcnt(3)
v_mfma_f32_16x16x32_bf16 v[180:183], v[124:127], v[248:251], 0
v_smfmac_f32_16x16x64_bf16 v[180:183], v[76:79], v[240:247], v7
s_setprio 0
ds_read_b128 v[228:231], v13 offset:64
ds_read_b128 v[220:223], v11 offset:64
ds_read_b128 v[224:227], v12 offset:64
v_mul_f32 v236, v197, v236
v_mul_f32 v237, v198, v237
v_mul_f32 v238, v199, v238
v_add_f32 v39, v200, v39
v_add_f32 v39, v201, v39
v_add_f32 v39, v202, v39
v_add_f32 v39, v203, v39
v_add_f32 v39, v204, v39
v_add_f32 v39, v205, v39
v_add_f32 v39, v206, v39
v_add_f32 v39, v207, v39
v_fmac_f32 v38, v236, v236
v_fmac_f32 v38, v237, v237
v_fmac_f32 v38, v238, v238
v_add_f32 v252, v176, v252
v_fmac_f32 v253, v176, v176
v_add_f32 v252, v177, v252
v_fmac_f32 v253, v177, v177
v_add_f32 v252, v178, v252
v_fmac_f32 v253, v178, v178
v_add_f32 v252, v179, v252
v_fmac_f32 v253, v179, v179
s_waitcnt lgkmcnt(0)
v_mfma_f32_16x16x32_bf16 v[184:187], v[96:99], v[216:219], 0
v_smfmac_f32_16x16x64_bf16 v[184:187], v[48:51], v[208:215], v7
ds_read_b128 v[248:251], v13 offset:128
ds_read_b128 v[240:243], v11 offset:128
ds_read_b128 v[244:247], v12 offset:128
v_add_f32 v252, v180, v252
v_fmac_f32 v253, v180, v180
v_add_f32 v252, v181, v252
v_fmac_f32 v253, v181, v181
v_add_f32 v252, v182, v252
v_fmac_f32 v253, v182, v182
v_add_f32 v252, v183, v252
v_fmac_f32 v253, v183, v183
v_mfma_f32_16x16x32_bf16 v[188:191], v[112:115], v[228:231], 0
v_smfmac_f32_16x16x64_bf16 v[188:191], v[64:67], v[220:227], v7
v_xor_b32 v11, 16, v11
v_xor_b32 v12, 16, v12
v_xor_b32 v13, 16, v13
ds_read_b128 v[216:219], v13 offset:0
ds_read_b128 v[208:211], v11 offset:0
ds_read_b128 v[212:215], v12 offset:0
v_add_f32 v252, v184, v252
v_fmac_f32 v253, v184, v184
v_add_f32 v252, v185, v252
v_fmac_f32 v253, v185, v185
v_add_f32 v252, v186, v252
v_fmac_f32 v253, v186, v186
v_add_f32 v252, v187, v252
v_fmac_f32 v253, v187, v187
s_waitcnt lgkmcnt(3)
v_mfma_f32_16x16x32_bf16 v[192:195], v[128:131], v[248:251], 0
v_smfmac_f32_16x16x64_bf16 v[192:195], v[80:83], v[240:247], v7
ds_read_b128 v[228:231], v13 offset:64
ds_read_b128 v[220:223], v11 offset:64
ds_read_b128 v[224:227], v12 offset:64
v_add_f32 v252, v188, v252
v_fmac_f32 v253, v188, v188
v_add_f32 v252, v189, v252
v_fmac_f32 v253, v189, v189
v_add_f32 v252, v190, v252
v_fmac_f32 v253, v190, v190
v_add_f32 v252, v191, v252
v_fmac_f32 v253, v191, v191
s_waitcnt lgkmcnt(3)
v_mfma_f32_16x16x32_bf16 v[196:199], v[100:103], v[216:219], 0
v_smfmac_f32_16x16x64_bf16 v[196:199], v[52:55], v[208:215], v7
ds_read_b128 v[248:251], v13 offset:128
ds_read_b128 v[240:243], v11 offset:128
ds_read_b128 v[244:247], v12 offset:128
v_add_f32 v252, v192, v252
v_fmac_f32 v253, v192, v192
v_add_f32 v252, v193, v252
v_fmac_f32 v253, v193, v193
v_add_f32 v252, v194, v252
v_fmac_f32 v253, v194, v194
v_add_f32 v252, v195, v252
v_fmac_f32 v253, v195, v195
s_waitcnt lgkmcnt(3)
v_mfma_f32_16x16x32_bf16 v[200:203], v[116:119], v[228:231], 0
v_smfmac_f32_16x16x64_bf16 v[200:203], v[68:71], v[220:227], v7
v_add_f32 v252, v196, v252
v_fmac_f32 v253, v196, v196
v_add_f32 v252, v197, v252
v_fmac_f32 v253, v197, v197
v_add_f32 v252, v198, v252
v_fmac_f32 v253, v198, v198
v_add_f32 v252, v199, v252
v_fmac_f32 v253, v199, v199
s_waitcnt lgkmcnt(0)
v_mfma_f32_16x16x32_bf16 v[204:207], v[132:135], v[248:251], 0
v_smfmac_f32_16x16x64_bf16 v[204:207], v[84:87], v[240:247], v7
v_add_f32 v252, v200, v252
v_fmac_f32 v253, v200, v200
v_add_f32 v252, v201, v252
v_fmac_f32 v253, v201, v201
v_add_f32 v252, v202, v252
v_fmac_f32 v253, v202, v202
v_add_f32 v252, v203, v252
v_fmac_f32 v253, v203, v203
v_add_f32 v252, v204, v252
v_fmac_f32 v253, v204, v204
v_add_f32 v252, v205, v252
v_fmac_f32 v253, v205, v205
v_add_f32 v252, v206, v252
v_fmac_f32 v253, v206, v206
v_add_f32 v252, v207, v252
v_fmac_f32 v253, v207, v207
s_setprio 1
s_nop 0
v_permlane32_swap_b32 v252, v253
v_add_f32 v252, v252, v253
v_mov_b32 v253, v252
s_nop 1
v_permlane32_swap_b32 v252, v253
v_mul_f32 v252, 0x3c2aaaab, v252
v_mul_f32 v253, 0x3c2aaaab, v253
v_mul_f32 v15, v252, v252
v_sub_f32 v253, v253, v15
v_mul_f32 v15, 0x36800000, v15
v_max_f32 v253, v15, v253
v_add_f32 v253, 0x3727c5ac, v253
v_rsq_f32 v253, v253
s_nop 0
v_mul_f32 v253, 0xbeeff558, v253
v_mul_f32 v252, v252, v253
ds_read_b128 v[240:243], v2 offset:8192
ds_read_b128 v[244:247], v2 offset:11264
s_setprio 0
v_fma_f32 v160, v160, v253, -v252
v_fma_f32 v161, v161, v253, -v252
v_fma_f32 v162, v162, v253, -v252
v_fma_f32 v163, v163, v253, -v252
v_fma_f32 v172, v172, v253, -v252
v_fma_f32 v173, v173, v253, -v252
v_fma_f32 v174, v174, v253, -v252
v_fma_f32 v175, v175, v253, -v252
v_fma_f32 v184, v184, v253, -v252
v_fma_f32 v185, v185, v253, -v252
v_fma_f32 v186, v186, v253, -v252
v_fma_f32 v187, v187, v253, -v252
v_fma_f32 v196, v196, v253, -v252
v_fma_f32 v197, v197, v253, -v252
v_fma_f32 v198, v198, v253, -v252
v_fma_f32 v199, v199, v253, -v252
s_setprio 1
v_cvt_pk_bf16_f32 v112, v160, v161
v_cvt_pk_bf16_f32 v113, v162, v163
v_cvt_pk_bf16_f32 v124, v172, v173
v_cvt_pk_bf16_f32 v125, v174, v175
v_cvt_pk_bf16_f32 v114, v184, v185
v_cvt_pk_bf16_f32 v115, v186, v187
v_cvt_pk_bf16_f32 v126, v196, v197
v_cvt_pk_bf16_f32 v127, v198, v199
v_permlane16_swap_b32 v112, v124
v_permlane16_swap_b32 v113, v125
v_permlane16_swap_b32 v114, v126
v_permlane16_swap_b32 v115, v127
s_waitcnt lgkmcnt(0)
s_nop 0
v_mfma_f32_16x16x32_bf16 v[208:211], v[112:115], v[240:243], 0
s_setprio 0
v_fma_f32 v164, v164, v253, -v252
v_fma_f32 v165, v165, v253, -v252
v_fma_f32 v166, v166, v253, -v252
v_fma_f32 v167, v167, v253, -v252
v_fma_f32 v176, v176, v253, -v252
v_fma_f32 v177, v177, v253, -v252
v_fma_f32 v178, v178, v253, -v252
v_fma_f32 v179, v179, v253, -v252
v_fma_f32 v188, v188, v253, -v252
v_fma_f32 v189, v189, v253, -v252
v_fma_f32 v190, v190, v253, -v252
v_fma_f32 v191, v191, v253, -v252
v_fma_f32 v200, v200, v253, -v252
v_fma_f32 v201, v201, v253, -v252
v_fma_f32 v202, v202, v253, -v252
v_fma_f32 v203, v203, v253, -v252
v_mfma_f32_16x16x32_bf16 v[212:215], v[124:127], v[240:243], 0
ds_read_b128 v[248:251], v2 offset:9216
v_mfma_f32_16x16x32_bf16 v[216:219], v[112:115], v[244:247], 0
v_mfma_f32_16x16x32_bf16 v[220:223], v[124:127], v[244:247], 0
s_setprio 1
ds_read_b128 v[240:243], v2 offset:12288
v_cvt_pk_bf16_f32 v116, v164, v165
v_cvt_pk_bf16_f32 v117, v166, v167
v_cvt_pk_bf16_f32 v128, v176, v177
v_cvt_pk_bf16_f32 v129, v178, v179
v_cvt_pk_bf16_f32 v118, v188, v189
v_cvt_pk_bf16_f32 v119, v190, v191
v_cvt_pk_bf16_f32 v130, v200, v201
v_cvt_pk_bf16_f32 v131, v202, v203
v_permlane16_swap_b32 v116, v128
v_permlane16_swap_b32 v117, v129
v_permlane16_swap_b32 v118, v130
v_permlane16_swap_b32 v119, v131
s_waitcnt lgkmcnt(0)
s_nop 0
v_mfma_f32_16x16x32_bf16 v[208:211], v[116:119], v[248:251], v[208:211]
v_mfma_f32_16x16x32_bf16 v[212:215], v[128:131], v[248:251], v[212:215]
s_setprio 0
v_fma_f32 v168, v168, v253, -v252
v_fma_f32 v169, v169, v253, -v252
v_fma_f32 v170, v170, v253, -v252
v_fma_f32 v171, v171, v253, -v252
v_fma_f32 v180, v180, v253, -v252
v_fma_f32 v181, v181, v253, -v252
v_fma_f32 v182, v182, v253, -v252
v_fma_f32 v183, v183, v253, -v252
v_fma_f32 v192, v192, v253, -v252
v_fma_f32 v193, v193, v253, -v252
v_fma_f32 v194, v194, v253, -v252
v_fma_f32 v195, v195, v253, -v252
v_fma_f32 v204, v204, v253, -v252
v_fma_f32 v205, v205, v253, -v252
v_fma_f32 v206, v206, v253, -v252
v_fma_f32 v207, v207, v253, -v252
ds_read_b128 v[244:247], v2 offset:10240
v_mfma_f32_16x16x32_bf16 v[216:219], v[116:119], v[240:243], v[216:219]
v_mfma_f32_16x16x32_bf16 v[220:223], v[128:131], v[240:243], v[220:223]
s_setprio 1
ds_read_b128 v[248:251], v2 offset:13312
v_cvt_pk_bf16_f32 v120, v168, v169
v_cvt_pk_bf16_f32 v121, v170, v171
v_cvt_pk_bf16_f32 v132, v180, v181
v_cvt_pk_bf16_f32 v133, v182, v183
v_cvt_pk_bf16_f32 v122, v192, v193
v_cvt_pk_bf16_f32 v123, v194, v195
v_cvt_pk_bf16_f32 v134, v204, v205
v_cvt_pk_bf16_f32 v135, v206, v207
v_permlane16_swap_b32 v120, v132
v_permlane16_swap_b32 v121, v133
v_permlane16_swap_b32 v122, v134
v_permlane16_swap_b32 v123, v135
s_waitcnt lgkmcnt(0)
s_nop 0
v_mfma_f32_16x16x32_bf16 v[208:211], v[120:123], v[244:247], v[208:211]
s_setprio 1
v_mfma_f32_16x16x32_bf16 v[212:215], v[132:135], v[244:247], v[212:215]
ds_read_b128 v[240:243], v2 offset:14336
v_mfma_f32_16x16x32_bf16 v[216:219], v[120:123], v[248:251], v[216:219]
v_mfma_f32_16x16x32_bf16 v[220:223], v[132:135], v[248:251], v[220:223]
ds_read_b128 v[244:247], v2 offset:15360
s_waitcnt lgkmcnt(1)
v_mfma_f32_16x16x32_bf16 v[160:163], v[112:115], v[240:243], 0
v_mfma_f32_16x16x32_bf16 v[164:167], v[124:127], v[240:243], 0
ds_read_b128 v[248:251], v2 offset:16384
s_waitcnt lgkmcnt(1)
v_mfma_f32_16x16x32_bf16 v[160:163], v[116:119], v[244:247], v[160:163]
v_lshrrev_b32 v102, 4, v1
v_mul_u32_u24 v102, 4608, v102
v_and_b32 v101, 15, v1
v_mul_u32_u24 v101, 12, v101
v_add_u32 v101, v101, v102
s_mul_i32 s49, s32, 3
s_lshr_b32 s48, s32, 1
s_mul_i32 s47, s48, 90
s_add_u32 s49, s49, s47
s_mov_b32 s39, 0xa414a1
s_cmp_ge_u32 s48, 2
s_cselect_b32 s39, 0xa5041a, s39
s_and_b32 s48, s48, 1
s_mul_i32 s48, s48, 12
s_lshr_b32 s39, s39, s48
v_mfma_f32_16x16x32_bf16 v[164:167], v[128:131], v[244:247], v[164:167]
ds_read_b128 v[240:243], v2 offset:17408
s_waitcnt lgkmcnt(1)
v_mfma_f32_16x16x32_bf16 v[160:163], v[120:123], v[248:251], v[160:163]
v_mfma_f32_16x16x32_bf16 v[164:167], v[132:135], v[248:251], v[164:167]
ds_read_b128 v[244:247], v2 offset:18432
s_setprio 0
v_fmaak_f32 v224, v216, v216, 0x409d30fc
v_fmaak_f32 v225, v217, v217, 0x409d30fc
v_fmaak_f32 v226, v218, v218, 0x409d30fc
v_fmaak_f32 v227, v219, v219, 0x409d30fc
v_mul_f32 v224, v216, v224
v_mul_f32 v225, v217, v225
v_mul_f32 v226, v218, v226
v_mul_f32 v227, v219, v227
s_setprio 1
v_lshlrev_b32_sdwa v208, v6, v208 dst_sel:DWORD dst_unused:UNUSED_PAD src0_sel:DWORD src1_sel:WORD_1
s_waitcnt lgkmcnt(1)
v_mfma_f32_16x16x32_bf16 v[168:171], v[112:115], v[240:243], 0
ds_read_u16_d16_hi v208, v208
v_exp_f32 v224, v224
v_lshlrev_b32_sdwa v209, v6, v209 dst_sel:DWORD dst_unused:UNUSED_PAD src0_sel:DWORD src1_sel:WORD_1
v_mfma_f32_16x16x32_bf16 v[172:175], v[124:127], v[240:243], 0
ds_read_u16_d16_hi v209, v209
ds_read_b128 v[248:251], v2 offset:19456
s_mov_b32 s12, s60
s_and_b32 s13, s61, 0xffff
s_mov_b32 s14, 50331648
s_mov_b32 s15, 0x20000
s_mov_b32 s16, s56
s_and_b32 s17, s57, 0xffff
s_mov_b32 s18, 768
s_mov_b32 s19, 0x20000
v_lshlrev_b32_sdwa v210, v6, v210 dst_sel:DWORD dst_unused:UNUSED_PAD src0_sel:DWORD src1_sel:WORD_1
s_waitcnt lgkmcnt(2)
v_mfma_f32_16x16x32_bf16 v[168:171], v[116:119], v[244:247], v[168:171]
ds_read_u16_d16_hi v210, v210
v_exp_f32 v225, v225
v_lshlrev_b32_sdwa v211, v6, v211 dst_sel:DWORD dst_unused:UNUSED_PAD src0_sel:DWORD src1_sel:WORD_1
v_mfma_f32_16x16x32_bf16 v[172:175], v[128:131], v[244:247], v[172:175]
ds_read_u16_d16_hi v211, v211
ds_read_b128 v[240:243], v2 offset:20480
v_exp_f32 v226, v226
v_lshlrev_b32_sdwa v212, v6, v212 dst_sel:DWORD dst_unused:UNUSED_PAD src0_sel:DWORD src1_sel:WORD_1
s_waitcnt lgkmcnt(3)
v_mfma_f32_16x16x32_bf16 v[168:171], v[120:123], v[248:251], v[168:171]
ds_read_u16_d16_hi v212, v212
v_lshlrev_b32_sdwa v213, v6, v213 dst_sel:DWORD dst_unused:UNUSED_PAD src0_sel:DWORD src1_sel:WORD_1
v_mfma_f32_16x16x32_bf16 v[172:175], v[132:135], v[248:251], v[172:175]
ds_read_u16_d16_hi v213, v213
ds_read_b128 v[244:247], v2 offset:21504
v_exp_f32 v227, v227
s_setprio 0
v_add_f32 v224, 1.0, v224
v_add_f32 v225, 1.0, v225
v_add_f32 v226, 1.0, v226
v_add_f32 v227, 1.0, v227
v_fmaak_f32 v228, v220, v220, 0x409d30fc
v_fmaak_f32 v229, v221, v221, 0x409d30fc
v_fmaak_f32 v230, v222, v222, 0x409d30fc
v_mul_f32 v228, v220, v228
v_mul_f32 v229, v221, v229
v_mul_f32 v230, v222, v230
s_setprio 1
v_lshlrev_b32_sdwa v214, v6, v214 dst_sel:DWORD dst_unused:UNUSED_PAD src0_sel:DWORD src1_sel:WORD_1
s_waitcnt lgkmcnt(0)
v_mfma_f32_16x16x32_bf16 v[176:179], v[112:115], v[240:243], 0
ds_read_u16_d16_hi v214, v214
s_bfe_u32 s47, s39, 0x20000
s_add_u32 s47, s47, s49
s_mul_i32 s48, s47, 192
buffer_load_dwordx3 v[40:42], v101, s[20:23], s48 offen offset:0
v_rcp_f32 v224, v224
v_lshlrev_b32_sdwa v215, v6, v215 dst_sel:DWORD dst_unused:UNUSED_PAD src0_sel:DWORD src1_sel:WORD_1
v_mfma_f32_16x16x32_bf16 v[180:183], v[124:127], v[240:243], 0
ds_read_u16_d16_hi v215, v215
ds_read_b128 v[248:251], v2 offset:22528
v_rcp_f32 v225, v225
v_lshlrev_b32_sdwa v160, v6, v160 dst_sel:DWORD dst_unused:UNUSED_PAD src0_sel:DWORD src1_sel:WORD_1
v_mfma_f32_16x16x32_bf16 v[176:179], v[116:119], v[244:247], v[176:179]
ds_read_u16_d16_hi v160, v160
v_rcp_f32 v226, v226
v_lshlrev_b32_sdwa v161, v6, v161 dst_sel:DWORD dst_unused:UNUSED_PAD src0_sel:DWORD src1_sel:WORD_1
v_rcp_f32 v227, v227
v_mfma_f32_16x16x32_bf16 v[180:183], v[128:131], v[244:247], v[180:183]
ds_read_u16_d16_hi v161, v161
ds_read_b128 v[240:243], v2 offset:23552
v_exp_f32 v228, v228
v_lshlrev_b32_sdwa v162, v6, v162 dst_sel:DWORD dst_unused:UNUSED_PAD src0_sel:DWORD src1_sel:WORD_1
s_waitcnt lgkmcnt(3)
v_mfma_f32_16x16x32_bf16 v[176:179], v[120:123], v[248:251], v[176:179]
ds_read_u16_d16_hi v162, v162
v_add_u32 v4, 0x20000, v2
v_lshrrev_b32 v104, 4, v1
v_mul_u32_u24 v104, 192, v104
v_and_b32 v105, 15, v1
v_mul_u32_u24 v105, 12, v105
v_add_u32 v5, v104, v105
v_exp_f32 v229, v229
v_mfma_f32_16x16x32_bf16 v[180:183], v[132:135], v[248:251], v[180:183]
ds_read_b128 v[244:247], v2 offset:24576
v_exp_f32 v230, v230
s_setprio 0
v_mul_f32 v224, v216, v224
v_mul_f32 v225, v217, v225
v_mul_f32 v226, v218, v226
v_mul_f32 v227, v219, v227
v_add_f32 v228, 1.0, v228
v_add_f32 v229, 1.0, v229
v_add_f32 v230, 1.0, v230
v_add_f32 v16, v208, v16
v_add_f32 v16, v209, v16
v_add_f32 v16, v210, v16
v_add_f32 v16, v211, v16
v_add_f32 v16, v212, v16
v_add_f32 v16, v213, v16
v_fmac_f32 v17, v224, v224
v_fmac_f32 v17, v225, v225
v_fmac_f32 v17, v226, v226
v_fmac_f32 v17, v227, v227
v_fmaak_f32 v231, v223, v223, 0x409d30fc
v_fmaak_f32 v232, v176, v176, 0x409d30fc
v_fmaak_f32 v233, v177, v177, 0x409d30fc
v_mul_f32 v231, v223, v231
v_mul_f32 v232, v176, v232
v_mul_f32 v233, v177, v233
s_setprio 1
v_lshlrev_b32_sdwa v163, v6, v163 dst_sel:DWORD dst_unused:UNUSED_PAD src0_sel:DWORD src1_sel:WORD_1
s_waitcnt lgkmcnt(0)
v_mfma_f32_16x16x32_bf16 v[184:187], v[112:115], v[240:243], 0
ds_read_u16_d16_hi v163, v163
v_rcp_f32 v228, v228
v_lshlrev_b32_sdwa v164, v6, v164 dst_sel:DWORD dst_unused:UNUSED_PAD src0_sel:DWORD src1_sel:WORD_1
v_mfma_f32_16x16x32_bf16 v[188:191], v[124:127], v[240:243], 0
ds_read_u16_d16_hi v164, v164
ds_read_b128 v[248:251], v2 offset:25600
v_rcp_f32 v229, v229
v_lshlrev_b32_sdwa v165, v6, v165 dst_sel:DWORD dst_unused:UNUSED_PAD src0_sel:DWORD src1_sel:WORD_1
v_mfma_f32_16x16x32_bf16 v[184:187], v[116:119], v[244:247], v[184:187]
ds_read_u16_d16_hi v165, v165
v_rcp_f32 v230, v230
v_lshlrev_b32_sdwa v166, v6, v166 dst_sel:DWORD dst_unused:UNUSED_PAD src0_sel:DWORD src1_sel:WORD_1
v_mfma_f32_16x16x32_bf16 v[188:191], v[128:131], v[244:247], v[188:191]
ds_read_u16_d16_hi v166, v166
ds_read_b128 v[240:243], v2 offset:29696
buffer_load_dwordx3 v[44:46], v101, s[20:23], s48 offen offset:1152
v_exp_f32 v231, v231
v_lshlrev_b32_sdwa v167, v6, v167 dst_sel:DWORD dst_unused:UNUSED_PAD src0_sel:DWORD src1_sel:WORD_1
s_waitcnt lgkmcnt(3)
v_mfma_f32_16x16x32_bf16 v[184:187], v[120:123], v[248:251], v[184:187]
ds_read_u16_d16_hi v167, v167
v_exp_f32 v232, v232
v_lshlrev_b32_sdwa v168, v6, v168 dst_sel:DWORD dst_unused:UNUSED_PAD src0_sel:DWORD src1_sel:WORD_1
v_mfma_f32_16x16x32_bf16 v[188:191], v[132:135], v[248:251], v[188:191]
ds_read_u16_d16_hi v168, v168
ds_read_b128 v[244:247], v2 offset:30720
v_exp_f32 v233, v233
s_setprio 0
v_mul_f32 v228, v220, v228
v_mul_f32 v229, v221, v229
v_mul_f32 v230, v222, v230
v_add_f32 v231, 1.0, v231
v_add_f32 v232, 1.0, v232
v_add_f32 v233, 1.0, v233
v_add_f32 v16, v214, v16
v_add_f32 v16, v215, v16
v_add_f32 v18, v160, v18
v_add_f32 v18, v161, v18
v_add_f32 v18, v162, v18
v_fmac_f32 v17, v228, v228
v_fmac_f32 v17, v229, v229
v_fmac_f32 v17, v230, v230
v_fmaak_f32 v234, v178, v178, 0x409d30fc
v_fmaak_f32 v235, v179, v179, 0x409d30fc
v_fmaak_f32 v236, v180, v180, 0x409d30fc
v_fmaak_f32 v237, v181, v181, 0x409d30fc
v_mul_f32 v234, v178, v234
v_mul_f32 v235, v179, v235
v_mul_f32 v236, v180, v236
v_mul_f32 v237, v181, v237
s_setprio 1
v_lshlrev_b32_sdwa v169, v6, v169 dst_sel:DWORD dst_unused:UNUSED_PAD src0_sel:DWORD src1_sel:WORD_1
s_waitcnt lgkmcnt(0)
v_mfma_f32_16x16x32_bf16 v[192:195], v[112:115], v[240:243], 0
ds_read_u16_d16_hi v169, v169
v_rcp_f32 v231, v231
v_lshlrev_b32_sdwa v170, v6, v170 dst_sel:DWORD dst_unused:UNUSED_PAD src0_sel:DWORD src1_sel:WORD_1
v_mfma_f32_16x16x32_bf16 v[196:199], v[124:127], v[240:243], 0
ds_read_u16_d16_hi v170, v170
ds_read_b128 v[248:251], v2 offset:31744
v_rcp_f32 v232, v232
v_lshrrev_b32 v104, 4, v1
s_mul_i32 s44, s32, 3
s_lshr_b32 s45, s32, 1
s_mul_i32 s45, s45, 90
s_add_u32 s44, s44, s45
v_add_u32 v104, s44, v104
v_and_b32 v105, 15, v1
v_mul_u32_u24 v105, 6, v105
v_add_u32 v104, v104, v105
v_lshlrev_b32 v104, 1, v104
buffer_load_ushort v111, v104, s[16:19], 0 offen
v_mov_b32 v13, 0
buffer_load_short_d16_hi v13, v104, s[24:27], 0 offen
v_lshlrev_b32_sdwa v171, v6, v171 dst_sel:DWORD dst_unused:UNUSED_PAD src0_sel:DWORD src1_sel:WORD_1
v_mfma_f32_16x16x32_bf16 v[192:195], v[116:119], v[244:247], v[192:195]
ds_read_u16_d16_hi v171, v171
v_rcp_f32 v233, v233
v_lshlrev_b32_sdwa v172, v6, v172 dst_sel:DWORD dst_unused:UNUSED_PAD src0_sel:DWORD src1_sel:WORD_1
v_exp_f32 v234, v234
v_mfma_f32_16x16x32_bf16 v[196:199], v[128:131], v[244:247], v[196:199]
ds_read_u16_d16_hi v172, v172
ds_read_b128 v[240:243], v2 offset:26624
v_exp_f32 v235, v235
v_lshlrev_b32_sdwa v173, v6, v173 dst_sel:DWORD dst_unused:UNUSED_PAD src0_sel:DWORD src1_sel:WORD_1
s_waitcnt lgkmcnt(3)
v_mfma_f32_16x16x32_bf16 v[192:195], v[120:123], v[248:251], v[192:195]
ds_read_u16_d16_hi v173, v173
v_exp_f32 v236, v236
v_mfma_f32_16x16x32_bf16 v[196:199], v[132:135], v[248:251], v[196:199]
ds_read_b128 v[244:247], v2 offset:27648
v_exp_f32 v237, v237
s_setprio 0
v_mul_f32 v231, v223, v231
v_mul_f32 v232, v176, v232
v_mul_f32 v233, v177, v233
v_add_f32 v234, 1.0, v234
v_add_f32 v235, 1.0, v235
v_add_f32 v236, 1.0, v236
v_add_f32 v237, 1.0, v237
v_add_f32 v18, v163, v18
v_add_f32 v18, v164, v18
v_add_f32 v18, v165, v18
v_add_f32 v18, v166, v18
v_add_f32 v18, v167, v18
v_add_f32 v19, v168, v19
v_fmac_f32 v17, v231, v231
v_fmac_f32 v20, v232, v232
v_fmac_f32 v20, v233, v233
v_fmaak_f32 v238, v182, v182, 0x409d30fc
v_fmaak_f32 v239, v183, v183, 0x409d30fc
v_fmaak_f32 v224, v192, v192, 0x409d30fc
v_mul_f32 v238, v182, v238
v_mul_f32 v239, v183, v239
v_mul_f32 v224, v192, v224
s_setprio 1
v_lshlrev_b32_sdwa v174, v6, v174 dst_sel:DWORD dst_unused:UNUSED_PAD src0_sel:DWORD src1_sel:WORD_1
s_waitcnt lgkmcnt(0)
v_mfma_f32_16x16x32_bf16 v[200:203], v[112:115], v[240:243], 0
ds_read_u16_d16_hi v174, v174
s_bfe_u32 s47, s39, 0x20002
s_add_u32 s47, s47, s49
s_mul_i32 s48, s47, 192
buffer_load_dwordx3 v[48:50], v101, s[20:23], s48 offen offset:2304
v_rcp_f32 v234, v234
v_lshlrev_b32_sdwa v175, v6, v175 dst_sel:DWORD dst_unused:UNUSED_PAD src0_sel:DWORD src1_sel:WORD_1
v_mfma_f32_16x16x32_bf16 v[204:207], v[124:127], v[240:243], 0
ds_read_u16_d16_hi v175, v175
ds_read_b128 v[248:251], v2 offset:28672
v_rcp_f32 v235, v235
v_lshlrev_b32_sdwa v184, v6, v184 dst_sel:DWORD dst_unused:UNUSED_PAD src0_sel:DWORD src1_sel:WORD_1
v_mfma_f32_16x16x32_bf16 v[200:203], v[116:119], v[244:247], v[200:203]
ds_read_u16_d16_hi v184, v184
v_rcp_f32 v236, v236
v_lshlrev_b32_sdwa v185, v6, v185 dst_sel:DWORD dst_unused:UNUSED_PAD src0_sel:DWORD src1_sel:WORD_1
v_rcp_f32 v237, v237
v_mfma_f32_16x16x32_bf16 v[204:207], v[128:131], v[244:247], v[204:207]
ds_read_u16_d16_hi v185, v185
ds_read_b128 v[240:243], v2 offset:32768
v_exp_f32 v238, v238
v_lshlrev_b32_sdwa v186, v6, v186 dst_sel:DWORD dst_unused:UNUSED_PAD src0_sel:DWORD src1_sel:WORD_1
s_waitcnt lgkmcnt(3)
v_mfma_f32_16x16x32_bf16 v[200:203], v[120:123], v[248:251], v[200:203]
ds_read_u16_d16_hi v186, v186
v_bfe_u32 v104, v1, 1, 1
v_mul_u32_u24 v104, 3072, v104
v_add_u32 v14, v104, v2
v_sub_u32 v104, 3072, v104
v_add_u32 v15, v104, v2
v_exp_f32 v239, v239
v_lshlrev_b32_sdwa v187, v6, v187 dst_sel:DWORD dst_unused:UNUSED_PAD src0_sel:DWORD src1_sel:WORD_1
v_mfma_f32_16x16x32_bf16 v[204:207], v[132:135], v[248:251], v[204:207]
ds_read_u16_d16_hi v187, v187
ds_read_b128 v[244:247], v2 offset:33792
v_exp_f32 v224, v224
s_setprio 0
v_mul_f32 v234, v178, v234
v_mul_f32 v235, v179, v235
v_mul_f32 v236, v180, v236
v_mul_f32 v237, v181, v237
v_add_f32 v238, 1.0, v238
v_add_f32 v239, 1.0, v239
v_add_f32 v224, 1.0, v224
v_add_f32 v19, v169, v19
v_add_f32 v19, v170, v19
v_add_f32 v19, v171, v19
v_add_f32 v19, v172, v19
v_add_f32 v19, v173, v19
v_fmac_f32 v20, v234, v234
v_fmac_f32 v20, v235, v235
v_fmac_f32 v20, v236, v236
v_fmac_f32 v20, v237, v237
v_fmaak_f32 v225, v193, v193, 0x409d30fc
v_fmaak_f32 v226, v194, v194, 0x409d30fc
v_fmaak_f32 v227, v195, v195, 0x409d30fc
v_mul_f32 v225, v193, v225
v_mul_f32 v226, v194, v226
v_mul_f32 v227, v195, v227
s_setprio 1
v_lshlrev_b32_sdwa v188, v6, v188 dst_sel:DWORD dst_unused:UNUSED_PAD src0_sel:DWORD src1_sel:WORD_1
s_waitcnt lgkmcnt(0)
v_mfma_f32_16x16x32_bf16 v[208:211], v[112:115], v[240:243], 0
ds_read_u16_d16_hi v188, v188
v_rcp_f32 v238, v238
v_lshlrev_b32_sdwa v189, v6, v189 dst_sel:DWORD dst_unused:UNUSED_PAD src0_sel:DWORD src1_sel:WORD_1
v_mfma_f32_16x16x32_bf16 v[212:215], v[124:127], v[240:243], 0
ds_read_u16_d16_hi v189, v189
ds_read_b128 v[248:251], v2 offset:34816
v_rcp_f32 v239, v239
v_lshlrev_b32_sdwa v190, v6, v190 dst_sel:DWORD dst_unused:UNUSED_PAD src0_sel:DWORD src1_sel:WORD_1
v_mfma_f32_16x16x32_bf16 v[208:211], v[116:119], v[244:247], v[208:211]
ds_read_u16_d16_hi v190, v190
v_rcp_f32 v224, v224
v_lshlrev_b32_sdwa v191, v6, v191 dst_sel:DWORD dst_unused:UNUSED_PAD src0_sel:DWORD src1_sel:WORD_1
v_mfma_f32_16x16x32_bf16 v[212:215], v[128:131], v[244:247], v[212:215]
ds_read_u16_d16_hi v191, v191
ds_read_b128 v[240:243], v2 offset:38912
buffer_load_dwordx3 v[52:54], v101, s[20:23], s48 offen offset:3456
v_exp_f32 v225, v225
v_lshlrev_b32_sdwa v200, v6, v200 dst_sel:DWORD dst_unused:UNUSED_PAD src0_sel:DWORD src1_sel:WORD_1
s_waitcnt lgkmcnt(3)
v_mfma_f32_16x16x32_bf16 v[208:211], v[120:123], v[248:251], v[208:211]
ds_read_u16_d16_hi v200, v200
v_exp_f32 v226, v226
v_mfma_f32_16x16x32_bf16 v[212:215], v[132:135], v[248:251], v[212:215]
ds_read_b128 v[244:247], v2 offset:39936
v_exp_f32 v227, v227
s_setprio 0
v_mul_f32 v238, v182, v238
v_mul_f32 v239, v183, v239
v_mul_f32 v224, v192, v224
v_add_f32 v225, 1.0, v225
v_add_f32 v226, 1.0, v226
v_add_f32 v227, 1.0, v227
v_add_f32 v19, v174, v19
v_add_f32 v19, v175, v19
v_add_f32 v21, v184, v21
v_add_f32 v21, v185, v21
v_add_f32 v21, v186, v21
v_add_f32 v21, v187, v21
v_fmac_f32 v20, v238, v238
v_fmac_f32 v20, v239, v239
v_fmac_f32 v23, v224, v224
v_fmaak_f32 v228, v196, v196, 0x409d30fc
v_fmaak_f32 v229, v197, v197, 0x409d30fc
v_fmaak_f32 v230, v198, v198, 0x409d30fc
v_mul_f32 v228, v196, v228
v_mul_f32 v229, v197, v229
v_mul_f32 v230, v198, v230
s_setprio 1
v_lshlrev_b32_sdwa v201, v6, v201 dst_sel:DWORD dst_unused:UNUSED_PAD src0_sel:DWORD src1_sel:WORD_1
s_waitcnt lgkmcnt(0)
v_mfma_f32_16x16x32_bf16 v[216:219], v[112:115], v[240:243], 0
ds_read_u16_d16_hi v201, v201
v_rcp_f32 v225, v225
v_lshlrev_b32_sdwa v202, v6, v202 dst_sel:DWORD dst_unused:UNUSED_PAD src0_sel:DWORD src1_sel:WORD_1
v_mfma_f32_16x16x32_bf16 v[220:223], v[124:127], v[240:243], 0
ds_read_u16_d16_hi v202, v202
ds_read_b128 v[248:251], v2 offset:40960
v_lshlrev_b32 v7, 7, v1
v_mul_u32_u24 v104, 11, v1
v_lshrrev_b32 v104, 8, v104
v_min_u32 v104, 1, v104
v_lshlrev_b32 v104, 31, v104
v_or_b32 v7, v7, v104
v_rcp_f32 v226, v226
v_lshlrev_b32_sdwa v203, v6, v203 dst_sel:DWORD dst_unused:UNUSED_PAD src0_sel:DWORD src1_sel:WORD_1
v_mfma_f32_16x16x32_bf16 v[216:219], v[116:119], v[244:247], v[216:219]
ds_read_u16_d16_hi v203, v203
v_rcp_f32 v227, v227
v_lshlrev_b32_sdwa v204, v6, v204 dst_sel:DWORD dst_unused:UNUSED_PAD src0_sel:DWORD src1_sel:WORD_1
v_mfma_f32_16x16x32_bf16 v[220:223], v[128:131], v[244:247], v[220:223]
ds_read_u16_d16_hi v204, v204
ds_read_b128 v[240:243], v2 offset:35840
v_exp_f32 v228, v228
v_lshlrev_b32_sdwa v205, v6, v205 dst_sel:DWORD dst_unused:UNUSED_PAD src0_sel:DWORD src1_sel:WORD_1
s_waitcnt lgkmcnt(3)
v_mfma_f32_16x16x32_bf16 v[216:219], v[120:123], v[248:251], v[216:219]
ds_read_u16_d16_hi v205, v205
v_exp_f32 v229, v229
v_lshlrev_b32_sdwa v206, v6, v206 dst_sel:DWORD dst_unused:UNUSED_PAD src0_sel:DWORD src1_sel:WORD_1
v_mfma_f32_16x16x32_bf16 v[220:223], v[132:135], v[248:251], v[220:223]
ds_read_u16_d16_hi v206, v206
ds_read_b128 v[244:247], v2 offset:36864
v_exp_f32 v230, v230
s_setprio 0
v_mul_f32 v225, v193, v225
v_mul_f32 v226, v194, v226
v_mul_f32 v227, v195, v227
v_add_f32 v228, 1.0, v228
v_add_f32 v229, 1.0, v229
v_add_f32 v230, 1.0, v230
v_add_f32 v21, v188, v21
v_add_f32 v21, v189, v21
v_add_f32 v21, v190, v21
v_add_f32 v21, v191, v21
v_add_f32 v22, v200, v22
v_fmac_f32 v23, v225, v225
v_fmac_f32 v23, v226, v226
v_fmac_f32 v23, v227, v227
v_fmaak_f32 v232, v216, v216, 0x409d30fc
v_fmaak_f32 v233, v217, v217, 0x409d30fc
v_fmaak_f32 v234, v218, v218, 0x409d30fc
v_fmaak_f32 v231, v199, v199, 0x409d30fc
v_mul_f32 v232, v216, v232
v_mul_f32 v233, v217, v233
v_mul_f32 v234, v218, v234
v_mul_f32 v231, v199, v231
s_setprio 1
v_lshlrev_b32_sdwa v207, v6, v207 dst_sel:DWORD dst_unused:UNUSED_PAD src0_sel:DWORD src1_sel:WORD_1
s_waitcnt lgkmcnt(0)
v_mfma_f32_16x16x32_bf16 v[160:163], v[112:115], v[240:243], 0
ds_read_u16_d16_hi v207, v207
s_bfe_u32 s47, s39, 0x20004
s_add_u32 s47, s47, s49
s_mul_i32 s48, s47, 192
buffer_load_dwordx3 v[56:58], v101, s[20:23], s48 offen offset:0
v_rcp_f32 v228, v228
v_lshlrev_b32_sdwa v208, v6, v208 dst_sel:DWORD dst_unused:UNUSED_PAD src0_sel:DWORD src1_sel:WORD_1
v_mfma_f32_16x16x32_bf16 v[164:167], v[124:127], v[240:243], 0
ds_read_u16_d16_hi v208, v208
ds_read_b128 v[248:251], v2 offset:37888
v_rcp_f32 v229, v229
v_lshlrev_b32_sdwa v209, v6, v209 dst_sel:DWORD dst_unused:UNUSED_PAD src0_sel:DWORD src1_sel:WORD_1
v_mfma_f32_16x16x32_bf16 v[160:163], v[116:119], v[244:247], v[160:163]
ds_read_u16_d16_hi v209, v209
v_rcp_f32 v230, v230
v_lshlrev_b32_sdwa v210, v6, v210 dst_sel:DWORD dst_unused:UNUSED_PAD src0_sel:DWORD src1_sel:WORD_1
v_exp_f32 v231, v231
v_mfma_f32_16x16x32_bf16 v[164:167], v[128:131], v[244:247], v[164:167]
ds_read_u16_d16_hi v210, v210
ds_read_b128 v[240:243], v2 offset:41984
v_exp_f32 v232, v232
v_lshlrev_b32_sdwa v211, v6, v211 dst_sel:DWORD dst_unused:UNUSED_PAD src0_sel:DWORD src1_sel:WORD_1
s_waitcnt lgkmcnt(3)
v_mfma_f32_16x16x32_bf16 v[160:163], v[120:123], v[248:251], v[160:163]
ds_read_u16_d16_hi v211, v211
s_mov_b32 s58, 0x05040100
s_mov_b32 s59, 0x07060302
v_exp_f32 v233, v233
v_mfma_f32_16x16x32_bf16 v[164:167], v[132:135], v[248:251], v[164:167]
ds_read_b128 v[244:247], v2 offset:43008
v_exp_f32 v234, v234
s_setprio 0
v_mul_f32 v228, v196, v228
v_mul_f32 v229, v197, v229
v_mul_f32 v230, v198, v230
v_add_f32 v232, 1.0, v232
v_add_f32 v233, 1.0, v233
v_add_f32 v234, 1.0, v234
v_add_f32 v231, 1.0, v231
v_add_f32 v22, v201, v22
v_add_f32 v22, v202, v22
v_add_f32 v22, v203, v22
v_add_f32 v22, v204, v22
v_add_f32 v22, v205, v22
v_add_f32 v22, v206, v22
v_fmac_f32 v23, v228, v228
v_fmac_f32 v23, v229, v229
v_fmac_f32 v23, v230, v230
v_fmaak_f32 v235, v219, v219, 0x409d30fc
v_fmaak_f32 v236, v220, v220, 0x409d30fc
v_fmaak_f32 v237, v221, v221, 0x409d30fc
v_mul_f32 v235, v219, v235
v_mul_f32 v236, v220, v236
v_mul_f32 v237, v221, v237
s_setprio 1
v_lshlrev_b32_sdwa v212, v6, v212 dst_sel:DWORD dst_unused:UNUSED_PAD src0_sel:DWORD src1_sel:WORD_1
s_waitcnt lgkmcnt(0)
v_mfma_f32_16x16x32_bf16 v[168:171], v[112:115], v[240:243], 0
ds_read_u16_d16_hi v212, v212
v_rcp_f32 v231, v231
v_lshlrev_b32_sdwa v213, v6, v213 dst_sel:DWORD dst_unused:UNUSED_PAD src0_sel:DWORD src1_sel:WORD_1
v_mfma_f32_16x16x32_bf16 v[172:175], v[124:127], v[240:243], 0
ds_read_u16_d16_hi v213, v213
ds_read_b128 v[248:251], v2 offset:44032
v_rcp_f32 v232, v232
v_lshlrev_b32_sdwa v214, v6, v214 dst_sel:DWORD dst_unused:UNUSED_PAD src0_sel:DWORD src1_sel:WORD_1
v_mfma_f32_16x16x32_bf16 v[168:171], v[116:119], v[244:247], v[168:171]
ds_read_u16_d16_hi v214, v214
v_rcp_f32 v233, v233
v_lshlrev_b32_sdwa v215, v6, v215 dst_sel:DWORD dst_unused:UNUSED_PAD src0_sel:DWORD src1_sel:WORD_1
v_rcp_f32 v234, v234
v_mfma_f32_16x16x32_bf16 v[172:175], v[128:131], v[244:247], v[172:175]
ds_read_u16_d16_hi v215, v215
ds_read_b128 v[240:243], v2 offset:48128
buffer_load_dwordx3 v[60:62], v101, s[20:23], s48 offen offset:1152
v_exp_f32 v235, v235
v_lshlrev_b32_sdwa v160, v6, v160 dst_sel:DWORD dst_unused:UNUSED_PAD src0_sel:DWORD src1_sel:WORD_1
s_waitcnt lgkmcnt(3)
v_mfma_f32_16x16x32_bf16 v[168:171], v[120:123], v[248:251], v[168:171]
ds_read_u16_d16_hi v160, v160
v_exp_f32 v236, v236
v_lshlrev_b32_sdwa v161, v6, v161 dst_sel:DWORD dst_unused:UNUSED_PAD src0_sel:DWORD src1_sel:WORD_1
v_mfma_f32_16x16x32_bf16 v[172:175], v[132:135], v[248:251], v[172:175]
ds_read_u16_d16_hi v161, v161
ds_read_b128 v[244:247], v2 offset:49152
v_exp_f32 v237, v237
s_setprio 0
v_mul_f32 v232, v216, v232
v_mul_f32 v233, v217, v233
v_mul_f32 v234, v218, v234
v_mul_f32 v231, v199, v231
v_add_f32 v235, 1.0, v235
v_add_f32 v236, 1.0, v236
v_add_f32 v237, 1.0, v237
v_add_f32 v24, v208, v24
v_add_f32 v24, v209, v24
v_add_f32 v24, v210, v24
v_add_f32 v24, v211, v24
v_add_f32 v22, v207, v22
v_fmac_f32 v26, v232, v232
v_fmac_f32 v26, v233, v233
v_fmac_f32 v26, v234, v234
v_fmac_f32 v23, v231, v231
v_fmaak_f32 v224, v222, v222, 0x409d30fc
v_fmaak_f32 v238, v223, v223, 0x409d30fc
v_mul_f32 v224, v222, v224
v_mul_f32 v238, v223, v238
s_setprio 1
v_lshlrev_b32_sdwa v162, v6, v162 dst_sel:DWORD dst_unused:UNUSED_PAD src0_sel:DWORD src1_sel:WORD_1
s_waitcnt lgkmcnt(0)
v_mfma_f32_16x16x32_bf16 v[176:179], v[112:115], v[240:243], 0
ds_read_u16_d16_hi v162, v162
v_rcp_f32 v235, v235
v_lshlrev_b32_sdwa v163, v6, v163 dst_sel:DWORD dst_unused:UNUSED_PAD src0_sel:DWORD src1_sel:WORD_1
v_mfma_f32_16x16x32_bf16 v[180:183], v[124:127], v[240:243], 0
ds_read_u16_d16_hi v163, v163
ds_read_b128 v[248:251], v2 offset:50176
s_mov_b32 s46, 0x31040
s_cmp_ge_u32 s32, 4
s_cselect_b32 s46, 0x39461, s46
s_and_b32 s44, s32, 3
s_mul_i32 s44, s44, 5
s_lshr_b32 s46, s46, s44
s_and_b32 s45, s46, 1
s_lshl_b32 s45, s45, 3
s_bfe_u32 s46, s46, 0x40001
s_mul_i32 s46, s46, 6144
s_add_u32 s45, s45, s46
s_add_u32 s33, s45, 90112
v_rcp_f32 v236, v236
v_lshlrev_b32_sdwa v164, v6, v164 dst_sel:DWORD dst_unused:UNUSED_PAD src0_sel:DWORD src1_sel:WORD_1
v_mfma_f32_16x16x32_bf16 v[176:179], v[116:119], v[244:247], v[176:179]
ds_read_u16_d16_hi v164, v164
v_lshlrev_b32_sdwa v165, v6, v165 dst_sel:DWORD dst_unused:UNUSED_PAD src0_sel:DWORD src1_sel:WORD_1
v_rcp_f32 v237, v237
v_mfma_f32_16x16x32_bf16 v[180:183], v[128:131], v[244:247], v[180:183]
ds_read_u16_d16_hi v165, v165
ds_read_b128 v[240:243], v2 offset:45056
v_lshlrev_b32_sdwa v166, v6, v166 dst_sel:DWORD dst_unused:UNUSED_PAD src0_sel:DWORD src1_sel:WORD_1
s_waitcnt lgkmcnt(3)
v_mfma_f32_16x16x32_bf16 v[176:179], v[120:123], v[248:251], v[176:179]
ds_read_u16_d16_hi v166, v166
v_exp_f32 v224, v224
v_mfma_f32_16x16x32_bf16 v[180:183], v[132:135], v[248:251], v[180:183]
ds_read_b128 v[244:247], v2 offset:46080
v_exp_f32 v238, v238
s_setprio 0
v_mul_f32 v235, v219, v235
v_mul_f32 v236, v220, v236
v_mul_f32 v237, v221, v237
v_add_f32 v224, 1.0, v224
v_add_f32 v238, 1.0, v238
v_add_f32 v24, v212, v24
v_add_f32 v24, v213, v24
v_add_f32 v24, v214, v24
v_add_f32 v24, v215, v24
v_add_f32 v25, v160, v25
v_add_f32 v25, v161, v25
v_fmac_f32 v26, v235, v235
v_fmac_f32 v26, v236, v236
v_fmac_f32 v26, v237, v237
v_fmaak_f32 v239, v176, v176, 0x409d30fc
v_fmaak_f32 v225, v177, v177, 0x409d30fc
v_fmaak_f32 v226, v178, v178, 0x409d30fc
v_fmaak_f32 v227, v179, v179, 0x409d30fc
v_mul_f32 v239, v176, v239
v_mul_f32 v225, v177, v225
v_mul_f32 v226, v178, v226
v_mul_f32 v227, v179, v227
s_setprio 1
v_lshlrev_b32_sdwa v167, v6, v167 dst_sel:DWORD dst_unused:UNUSED_PAD src0_sel:DWORD src1_sel:WORD_1
s_waitcnt lgkmcnt(0)
v_mfma_f32_16x16x32_bf16 v[184:187], v[112:115], v[240:243], 0
ds_read_u16_d16_hi v167, v167
s_bfe_u32 s47, s39, 0x20006
s_add_u32 s47, s47, s49
s_mul_i32 s48, s47, 192
buffer_load_dwordx3 v[64:66], v101, s[20:23], s48 offen offset:2304
v_rcp_f32 v224, v224
v_lshlrev_b32_sdwa v168, v6, v168 dst_sel:DWORD dst_unused:UNUSED_PAD src0_sel:DWORD src1_sel:WORD_1
v_mfma_f32_16x16x32_bf16 v[188:191], v[124:127], v[240:243], 0
ds_read_u16_d16_hi v168, v168
ds_read_b128 v[248:251], v2 offset:47104
v_rcp_f32 v238, v238
v_lshlrev_b32_sdwa v169, v6, v169 dst_sel:DWORD dst_unused:UNUSED_PAD src0_sel:DWORD src1_sel:WORD_1
v_mfma_f32_16x16x32_bf16 v[184:187], v[116:119], v[244:247], v[184:187]
ds_read_u16_d16_hi v169, v169
v_exp_f32 v239, v239
v_lshlrev_b32_sdwa v170, v6, v170 dst_sel:DWORD dst_unused:UNUSED_PAD src0_sel:DWORD src1_sel:WORD_1
v_mfma_f32_16x16x32_bf16 v[188:191], v[128:131], v[244:247], v[188:191]
ds_read_u16_d16_hi v170, v170
ds_read_b128 v[240:243], v2 offset:57344
v_exp_f32 v225, v225
v_lshlrev_b32_sdwa v171, v6, v171 dst_sel:DWORD dst_unused:UNUSED_PAD src0_sel:DWORD src1_sel:WORD_1
s_waitcnt lgkmcnt(3)
v_mfma_f32_16x16x32_bf16 v[184:187], v[120:123], v[248:251], v[184:187]
ds_read_u16_d16_hi v171, v171
v_exp_f32 v226, v226
s_mov_b32 s46, 0x52169
s_cmp_ge_u32 s32, 4
s_cselect_b32 s46, 0x7b5cc, s46
s_and_b32 s44, s32, 3
s_mul_i32 s44, s44, 5
s_lshr_b32 s46, s46, s44
s_and_b32 s45, s46, 1
s_lshl_b32 s45, s45, 3
s_bfe_u32 s46, s46, 0x40001
s_mul_i32 s46, s46, 6144
s_add_u32 s45, s45, s46
s_add_u32 s34, s45, 90112
v_mfma_f32_16x16x32_bf16 v[188:191], v[132:135], v[248:251], v[188:191]
ds_read_b128 v[244:247], v2 offset:58368
v_exp_f32 v227, v227
s_setprio 0
v_mul_f32 v224, v222, v224
v_mul_f32 v238, v223, v238
v_add_f32 v239, 1.0, v239
v_add_f32 v225, 1.0, v225
v_add_f32 v226, 1.0, v226
v_add_f32 v227, 1.0, v227
v_add_f32 v25, v162, v25
v_add_f32 v25, v163, v25
v_add_f32 v25, v164, v25
v_add_f32 v25, v165, v25
v_add_f32 v25, v166, v25
v_fmac_f32 v26, v224, v224
v_fmac_f32 v26, v238, v238
v_fmaak_f32 v228, v180, v180, 0x409d30fc
v_fmaak_f32 v229, v181, v181, 0x409d30fc
v_fmaak_f32 v230, v182, v182, 0x409d30fc
v_fmaak_f32 v231, v183, v183, 0x409d30fc
v_mul_f32 v228, v180, v228
v_mul_f32 v229, v181, v229
v_mul_f32 v230, v182, v230
v_mul_f32 v231, v183, v231
s_setprio 1
v_lshlrev_b32_sdwa v172, v6, v172 dst_sel:DWORD dst_unused:UNUSED_PAD src0_sel:DWORD src1_sel:WORD_1
s_waitcnt lgkmcnt(0)
v_mfma_f32_16x16x32_bf16 v[192:195], v[112:115], v[240:243], 0
ds_read_u16_d16_hi v172, v172
v_rcp_f32 v239, v239
v_lshlrev_b32_sdwa v173, v6, v173 dst_sel:DWORD dst_unused:UNUSED_PAD src0_sel:DWORD src1_sel:WORD_1
v_mfma_f32_16x16x32_bf16 v[196:199], v[124:127], v[240:243], 0
ds_read_u16_d16_hi v173, v173
ds_read_b128 v[248:251], v2 offset:59392
v_rcp_f32 v225, v225
v_rcp_f32 v226, v226
v_lshlrev_b32_sdwa v174, v6, v174 dst_sel:DWORD dst_unused:UNUSED_PAD src0_sel:DWORD src1_sel:WORD_1
v_mfma_f32_16x16x32_bf16 v[192:195], v[116:119], v[244:247], v[192:195]
ds_read_u16_d16_hi v174, v174
v_rcp_f32 v227, v227
v_lshlrev_b32_sdwa v175, v6, v175 dst_sel:DWORD dst_unused:UNUSED_PAD src0_sel:DWORD src1_sel:WORD_1
v_mfma_f32_16x16x32_bf16 v[196:199], v[128:131], v[244:247], v[196:199]
ds_read_u16_d16_hi v175, v175
ds_read_b128 v[240:243], v2 offset:51200
buffer_load_dwordx3 v[68:70], v101, s[20:23], s48 offen offset:3456
v_exp_f32 v228, v228
v_lshlrev_b32_sdwa v184, v6, v184 dst_sel:DWORD dst_unused:UNUSED_PAD src0_sel:DWORD src1_sel:WORD_1
s_waitcnt lgkmcnt(3)
v_mfma_f32_16x16x32_bf16 v[192:195], v[120:123], v[248:251], v[192:195]
ds_read_u16_d16_hi v184, v184
v_exp_f32 v229, v229
v_exp_f32 v230, v230
v_lshlrev_b32_sdwa v185, v6, v185 dst_sel:DWORD dst_unused:UNUSED_PAD src0_sel:DWORD src1_sel:WORD_1
v_mfma_f32_16x16x32_bf16 v[196:199], v[132:135], v[248:251], v[196:199]
ds_read_u16_d16_hi v185, v185
ds_read_b128 v[244:247], v2 offset:52224
v_exp_f32 v231, v231
s_setprio 0
v_mul_f32 v239, v176, v239
v_mul_f32 v225, v177, v225
v_mul_f32 v226, v178, v226
v_mul_f32 v227, v179, v227
v_add_f32 v228, 1.0, v228
v_add_f32 v229, 1.0, v229
v_add_f32 v230, 1.0, v230
v_add_f32 v231, 1.0, v231
v_add_f32 v25, v167, v25
v_add_f32 v27, v168, v27
v_add_f32 v27, v169, v27
v_add_f32 v27, v170, v27
v_add_f32 v27, v171, v27
v_fmac_f32 v29, v239, v239
v_fmac_f32 v29, v225, v225
v_fmac_f32 v29, v226, v226
v_fmac_f32 v29, v227, v227
v_fmaak_f32 v232, v192, v192, 0x409d30fc
v_fmaak_f32 v233, v193, v193, 0x409d30fc
v_fmaak_f32 v234, v194, v194, 0x409d30fc
v_mul_f32 v232, v192, v232
v_mul_f32 v233, v193, v233
v_mul_f32 v234, v194, v234
s_setprio 1
v_lshlrev_b32_sdwa v186, v6, v186 dst_sel:DWORD dst_unused:UNUSED_PAD src0_sel:DWORD src1_sel:WORD_1
s_waitcnt lgkmcnt(0)
v_mfma_f32_16x16x32_bf16 v[200:203], v[112:115], v[240:243], 0
ds_read_u16_d16_hi v186, v186
v_rcp_f32 v228, v228
v_lshlrev_b32_sdwa v187, v6, v187 dst_sel:DWORD dst_unused:UNUSED_PAD src0_sel:DWORD src1_sel:WORD_1
v_mfma_f32_16x16x32_bf16 v[204:207], v[124:127], v[240:243], 0
ds_read_u16_d16_hi v187, v187
ds_read_b128 v[248:251], v2 offset:53248
v_rcp_f32 v229, v229
s_mov_b32 s46, 0x9c650
s_cmp_ge_u32 s32, 4
s_cselect_b32 s46, 0xbd6d4, s46
s_and_b32 s44, s32, 3
s_mul_i32 s44, s44, 5
s_lshr_b32 s46, s46, s44
s_and_b32 s45, s46, 1
s_lshl_b32 s45, s45, 3
s_bfe_u32 s46, s46, 0x40001
s_mul_i32 s46, s46, 6144
s_add_u32 s45, s45, s46
s_add_u32 s37, s45, 90112
v_lshlrev_b32_sdwa v188, v6, v188 dst_sel:DWORD dst_unused:UNUSED_PAD src0_sel:DWORD src1_sel:WORD_1
v_mfma_f32_16x16x32_bf16 v[200:203], v[116:119], v[244:247], v[200:203]
ds_read_u16_d16_hi v188, v188
v_rcp_f32 v230, v230
v_lshlrev_b32_sdwa v189, v6, v189 dst_sel:DWORD dst_unused:UNUSED_PAD src0_sel:DWORD src1_sel:WORD_1
v_rcp_f32 v231, v231
v_mfma_f32_16x16x32_bf16 v[204:207], v[128:131], v[244:247], v[204:207]
ds_read_u16_d16_hi v189, v189
ds_read_b128 v[240:243], v2 offset:54272
v_exp_f32 v232, v232
v_lshlrev_b32_sdwa v190, v6, v190 dst_sel:DWORD dst_unused:UNUSED_PAD src0_sel:DWORD src1_sel:WORD_1
s_waitcnt lgkmcnt(3)
v_mfma_f32_16x16x32_bf16 v[200:203], v[120:123], v[248:251], v[200:203]
ds_read_u16_d16_hi v190, v190
v_exp_f32 v233, v233
v_mfma_f32_16x16x32_bf16 v[204:207], v[132:135], v[248:251], v[204:207]
ds_read_b128 v[244:247], v2 offset:55296
v_exp_f32 v234, v234
s_setprio 0
v_mul_f32 v228, v180, v228
v_mul_f32 v229, v181, v229
v_mul_f32 v230, v182, v230
v_mul_f32 v231, v183, v231
v_add_f32 v232, 1.0, v232
v_add_f32 v233, 1.0, v233
v_add_f32 v234, 1.0, v234
v_add_f32 v27, v172, v27
v_add_f32 v27, v173, v27
v_add_f32 v27, v174, v27
v_add_f32 v27, v175, v27
v_add_f32 v28, v184, v28
v_add_f32 v28, v185, v28
v_fmac_f32 v29, v228, v228
v_fmac_f32 v29, v229, v229
v_fmac_f32 v29, v230, v230
v_fmac_f32 v29, v231, v231
v_fmaak_f32 v235, v195, v195, 0x409d30fc
v_fmaak_f32 v236, v196, v196, 0x409d30fc
v_fmaak_f32 v237, v197, v197, 0x409d30fc
v_mul_f32 v235, v195, v235
v_mul_f32 v236, v196, v236
v_mul_f32 v237, v197, v237
s_setprio 1
v_lshlrev_b32_sdwa v191, v6, v191 dst_sel:DWORD dst_unused:UNUSED_PAD src0_sel:DWORD src1_sel:WORD_1
s_waitcnt lgkmcnt(0)
v_mfma_f32_16x16x32_bf16 v[208:211], v[112:115], v[240:243], 0
ds_read_u16_d16_hi v191, v191
s_bfe_u32 s47, s39, 0x20008
s_add_u32 s47, s47, s49
s_mul_i32 s48, s47, 192
buffer_load_dwordx3 v[72:74], v101, s[20:23], s48 offen offset:0
v_rcp_f32 v232, v232
v_lshlrev_b32_sdwa v200, v6, v200 dst_sel:DWORD dst_unused:UNUSED_PAD src0_sel:DWORD src1_sel:WORD_1
v_mfma_f32_16x16x32_bf16 v[212:215], v[124:127], v[240:243], 0
ds_read_u16_d16_hi v200, v200
ds_read_b128 v[248:251], v2 offset:56320
v_rcp_f32 v233, v233
v_lshlrev_b32_sdwa v201, v6, v201 dst_sel:DWORD dst_unused:UNUSED_PAD src0_sel:DWORD src1_sel:WORD_1
v_mfma_f32_16x16x32_bf16 v[208:211], v[116:119], v[244:247], v[208:211]
ds_read_u16_d16_hi v201, v201
v_rcp_f32 v234, v234
s_cmp_eq_u32 s32, 6
s_cbranch_scc0 L_cpf2
s_bfe_u32 s44, s2, 0x30003
s_mul_i32 s44, s44, 4864
s_add_u32 s44, s44, 41232
v_lshlrev_b32 v106, 7, v1
v_min_u32 v106, 4736, v106
v_add_u32 v106, s44, v106
v_min_u32 v106, 79168, v106
v_mov_b32 v107, s67
v_add_co_u32 v106, vcc, s66, v106
s_nop 1
v_addc_co_u32 v107, vcc, 0, v107, vcc
global_load_dword v12, v[106:107], off
s_nop 1
L_cpf2:
v_lshlrev_b32_sdwa v202, v6, v202 dst_sel:DWORD dst_unused:UNUSED_PAD src0_sel:DWORD src1_sel:WORD_1
v_mfma_f32_16x16x32_bf16 v[212:215], v[128:131], v[244:247], v[212:215]
ds_read_u16_d16_hi v202, v202
ds_read_b128 v[240:243], v3 offset:9216
v_exp_f32 v235, v235
v_lshlrev_b32_sdwa v203, v6, v203 dst_sel:DWORD dst_unused:UNUSED_PAD src0_sel:DWORD src1_sel:WORD_1
s_waitcnt lgkmcnt(3)
v_mfma_f32_16x16x32_bf16 v[208:211], v[120:123], v[248:251], v[208:211]
ds_read_u16_d16_hi v203, v203
v_exp_f32 v236, v236
v_lshlrev_b32_sdwa v204, v6, v204 dst_sel:DWORD dst_unused:UNUSED_PAD src0_sel:DWORD src1_sel:WORD_1
v_mfma_f32_16x16x32_bf16 v[212:215], v[132:135], v[248:251], v[212:215]
ds_read_u16_d16_hi v204, v204
ds_read_b128 v[244:247], v3 offset:10240
v_exp_f32 v237, v237
s_setprio 0
v_mul_f32 v232, v192, v232
v_mul_f32 v233, v193, v233
v_mul_f32 v234, v194, v234
v_add_f32 v235, 1.0, v235
v_add_f32 v236, 1.0, v236
v_add_f32 v237, 1.0, v237
v_add_f32 v28, v186, v28
v_add_f32 v28, v187, v28
v_add_f32 v28, v188, v28
v_add_f32 v28, v189, v28
v_add_f32 v28, v190, v28
v_fmac_f32 v32, v232, v232
v_fmac_f32 v32, v233, v233
v_fmac_f32 v32, v234, v234
v_fmaak_f32 v224, v198, v198, 0x409d30fc
v_fmaak_f32 v238, v199, v199, 0x409d30fc
v_mul_f32 v224, v198, v224
v_mul_f32 v238, v199, v238
s_setprio 1
v_lshlrev_b32_sdwa v205, v6, v205 dst_sel:DWORD dst_unused:UNUSED_PAD src0_sel:DWORD src1_sel:WORD_1
s_waitcnt lgkmcnt(0)
v_mfma_f32_16x16x32_bf16 v[216:219], v[112:115], v[240:243], 0
ds_read_u16_d16_hi v205, v205
v_rcp_f32 v235, v235
v_lshlrev_b32_sdwa v206, v6, v206 dst_sel:DWORD dst_unused:UNUSED_PAD src0_sel:DWORD src1_sel:WORD_1
v_mfma_f32_16x16x32_bf16 v[220:223], v[124:127], v[240:243], 0
ds_read_u16_d16_hi v206, v206
ds_read_b128 v[248:251], v3 offset:11264
v_rcp_f32 v236, v236
v_lshlrev_b32_sdwa v207, v6, v207 dst_sel:DWORD dst_unused:UNUSED_PAD src0_sel:DWORD src1_sel:WORD_1
v_mfma_f32_16x16x32_bf16 v[216:219], v[116:119], v[244:247], v[216:219]
ds_read_u16_d16_hi v207, v207
v_lshlrev_b32_sdwa v208, v6, v208 dst_sel:DWORD dst_unused:UNUSED_PAD src0_sel:DWORD src1_sel:WORD_1
v_rcp_f32 v237, v237
v_mfma_f32_16x16x32_bf16 v[220:223], v[128:131], v[244:247], v[220:223]
ds_read_u16_d16_hi v208, v208
ds_read_b128 v[240:243], v2 offset:60416
buffer_load_dwordx3 v[76:78], v101, s[20:23], s48 offen offset:1152
v_lshlrev_b32_sdwa v209, v6, v209 dst_sel:DWORD dst_unused:UNUSED_PAD src0_sel:DWORD src1_sel:WORD_1
s_waitcnt lgkmcnt(3)
v_mfma_f32_16x16x32_bf16 v[216:219], v[120:123], v[248:251], v[216:219]
ds_read_u16_d16_hi v209, v209
v_exp_f32 v224, v224
v_mfma_f32_16x16x32_bf16 v[220:223], v[132:135], v[248:251], v[220:223]
ds_read_b128 v[244:247], v2 offset:61440
v_exp_f32 v238, v238
s_setprio 0
v_mul_f32 v235, v195, v235
v_mul_f32 v236, v196, v236
v_mul_f32 v237, v197, v237
v_add_f32 v224, 1.0, v224
v_add_f32 v238, 1.0, v238
v_add_f32 v28, v191, v28
v_add_f32 v30, v200, v30
v_add_f32 v30, v201, v30
v_add_f32 v30, v202, v30
v_add_f32 v30, v203, v30
v_add_f32 v30, v204, v30
v_fmac_f32 v32, v235, v235
v_fmac_f32 v32, v236, v236
v_fmac_f32 v32, v237, v237
v_fmaak_f32 v225, v216, v216, 0x409d30fc
v_fmaak_f32 v226, v217, v217, 0x409d30fc
v_fmaak_f32 v227, v218, v218, 0x409d30fc
v_fmaak_f32 v239, v219, v219, 0x409d30fc
v_fmaak_f32 v228, v220, v220, 0x409d30fc
v_mul_f32 v225, v216, v225
v_mul_f32 v226, v217, v226
v_mul_f32 v227, v218, v227
v_mul_f32 v239, v219, v239
v_mul_f32 v228, v220, v228
s_setprio 1
v_lshlrev_b32_sdwa v210, v6, v210 dst_sel:DWORD dst_unused:UNUSED_PAD src0_sel:DWORD src1_sel:WORD_1
s_waitcnt lgkmcnt(0)
v_mfma_f32_16x16x32_bf16 v[160:163], v[112:115], v[240:243], 0
ds_read_u16_d16_hi v210, v210
v_rcp_f32 v224, v224
v_lshlrev_b32_sdwa v211, v6, v211 dst_sel:DWORD dst_unused:UNUSED_PAD src0_sel:DWORD src1_sel:WORD_1
v_mfma_f32_16x16x32_bf16 v[164:167], v[124:127], v[240:243], 0
ds_read_u16_d16_hi v211, v211
ds_read_b128 v[248:251], v2 offset:62464
v_rcp_f32 v238, v238
v_lshlrev_b32_sdwa v212, v6, v212 dst_sel:DWORD dst_unused:UNUSED_PAD src0_sel:DWORD src1_sel:WORD_1
v_mfma_f32_16x16x32_bf16 v[160:163], v[116:119], v[244:247], v[160:163]
ds_read_u16_d16_hi v212, v212
v_exp_f32 v225, v225
v_lshlrev_b32_sdwa v213, v6, v213 dst_sel:DWORD dst_unused:UNUSED_PAD src0_sel:DWORD src1_sel:WORD_1
v_exp_f32 v226, v226
v_mfma_f32_16x16x32_bf16 v[164:167], v[128:131], v[244:247], v[164:167]
ds_read_u16_d16_hi v213, v213
ds_read_b128 v[240:243], v2 offset:63488
v_exp_f32 v227, v227
v_lshlrev_b32_sdwa v214, v6, v214 dst_sel:DWORD dst_unused:UNUSED_PAD src0_sel:DWORD src1_sel:WORD_1
s_waitcnt lgkmcnt(3)
v_mfma_f32_16x16x32_bf16 v[160:163], v[120:123], v[248:251], v[160:163]
ds_read_u16_d16_hi v214, v214
v_exp_f32 v239, v239
v_lshlrev_b32_sdwa v215, v6, v215 dst_sel:DWORD dst_unused:UNUSED_PAD src0_sel:DWORD src1_sel:WORD_1
v_mfma_f32_16x16x32_bf16 v[164:167], v[132:135], v[248:251], v[164:167]
ds_read_u16_d16_hi v215, v215
ds_read_b128 v[244:247], v2 offset:64512
v_exp_f32 v228, v228
s_setprio 0
v_mul_f32 v224, v198, v224
v_mul_f32 v238, v199, v238
v_add_f32 v225, 1.0, v225
v_add_f32 v226, 1.0, v226
v_add_f32 v227, 1.0, v227
v_add_f32 v239, 1.0, v239
v_add_f32 v228, 1.0, v228
v_add_f32 v31, v208, v31
v_add_f32 v31, v209, v31
v_add_f32 v30, v205, v30
v_add_f32 v30, v206, v30
v_add_f32 v30, v207, v30
v_fmac_f32 v32, v224, v224
v_fmac_f32 v32, v238, v238
v_fmaak_f32 v229, v221, v221, 0x409d30fc
v_fmaak_f32 v230, v222, v222, 0x409d30fc
v_fmaak_f32 v231, v223, v223, 0x409d30fc
v_mul_f32 v229, v221, v229
v_mul_f32 v230, v222, v230
v_mul_f32 v231, v223, v231
s_setprio 1
v_lshlrev_b32_sdwa v160, v6, v160 dst_sel:DWORD dst_unused:UNUSED_PAD src0_sel:DWORD src1_sel:WORD_1
s_waitcnt lgkmcnt(0)
v_mfma_f32_16x16x32_bf16 v[168:171], v[112:115], v[240:243], 0
ds_read_u16_d16_hi v160, v160
s_bfe_u32 s47, s39, 0x2000a
s_add_u32 s47, s47, s49
s_mul_i32 s48, s47, 192
buffer_load_dwordx3 v[80:82], v101, s[20:23], s48 offen offset:2304
v_rcp_f32 v225, v225
v_lshlrev_b32 v104, 4, v0
s_add_u32 s46, s43, 50360320
buffer_load_dwordx4 v[8:11], v104, s[8:11], s46 offen
s_add_u32 s46, s43, 50368512
buffer_load_dwordx4 v[252:255], v104, s[8:11], s46 offen
v_lshlrev_b32_sdwa v161, v6, v161 dst_sel:DWORD dst_unused:UNUSED_PAD src0_sel:DWORD src1_sel:WORD_1
v_mfma_f32_16x16x32_bf16 v[172:175], v[124:127], v[240:243], 0
ds_read_u16_d16_hi v161, v161
ds_read_b128 v[248:251], v3 offset:8192
v_rcp_f32 v226, v226
v_rcp_f32 v227, v227
v_lshlrev_b32_sdwa v162, v6, v162 dst_sel:DWORD dst_unused:UNUSED_PAD src0_sel:DWORD src1_sel:WORD_1
v_mfma_f32_16x16x32_bf16 v[168:171], v[116:119], v[244:247], v[168:171]
ds_read_u16_d16_hi v162, v162
v_rcp_f32 v239, v239
v_lshlrev_b32_sdwa v163, v6, v163 dst_sel:DWORD dst_unused:UNUSED_PAD src0_sel:DWORD src1_sel:WORD_1
v_mfma_f32_16x16x32_bf16 v[172:175], v[128:131], v[244:247], v[172:175]
ds_read_u16_d16_hi v163, v163
ds_read_b128 v[240:243], v3 offset:12288
v_rcp_f32 v228, v228
v_lshlrev_b32_sdwa v164, v6, v164 dst_sel:DWORD dst_unused:UNUSED_PAD src0_sel:DWORD src1_sel:WORD_1
s_waitcnt lgkmcnt(3)
v_mfma_f32_16x16x32_bf16 v[168:171], v[120:123], v[248:251], v[168:171]
ds_read_u16_d16_hi v164, v164
v_exp_f32 v229, v229
v_exp_f32 v230, v230
v_mfma_f32_16x16x32_bf16 v[172:175], v[132:135], v[248:251], v[172:175]
ds_read_b128 v[244:247], v3 offset:13312
v_exp_f32 v231, v231
s_setprio 0
v_mul_f32 v225, v216, v225
v_mul_f32 v226, v217, v226
v_mul_f32 v227, v218, v227
v_mul_f32 v239, v219, v239
v_mul_f32 v228, v220, v228
v_add_f32 v229, 1.0, v229
v_add_f32 v230, 1.0, v230
v_add_f32 v231, 1.0, v231
v_add_f32 v31, v210, v31
v_add_f32 v31, v211, v31
v_add_f32 v31, v212, v31
v_add_f32 v31, v213, v31
v_add_f32 v31, v214, v31
v_add_f32 v31, v215, v31
v_fmac_f32 v35, v225, v225
v_fmac_f32 v35, v226, v226
v_fmac_f32 v35, v227, v227
v_fmac_f32 v35, v239, v239
v_fmac_f32 v35, v228, v228
s_setprio 1
v_lshlrev_b32_sdwa v165, v6, v165 dst_sel:DWORD dst_unused:UNUSED_PAD src0_sel:DWORD src1_sel:WORD_1
s_waitcnt lgkmcnt(0)
v_mfma_f32_16x16x32_bf16 v[176:179], v[112:115], v[240:243], 0
ds_read_u16_d16_hi v165, v165
v_lshlrev_b32_sdwa v166, v6, v166 dst_sel:DWORD dst_unused:UNUSED_PAD src0_sel:DWORD src1_sel:WORD_1
v_rcp_f32 v229, v229
v_mfma_f32_16x16x32_bf16 v[180:183], v[124:127], v[240:243], 0
ds_read_u16_d16_hi v166, v166
ds_read_b128 v[248:251], v3 offset:14336
v_lshlrev_b32_sdwa v167, v6, v167 dst_sel:DWORD dst_unused:UNUSED_PAD src0_sel:DWORD src1_sel:WORD_1
v_mfma_f32_16x16x32_bf16 v[176:179], v[116:119], v[244:247], v[176:179]
ds_read_u16_d16_hi v167, v167
v_lshlrev_b32_sdwa v168, v6, v168 dst_sel:DWORD dst_unused:UNUSED_PAD src0_sel:DWORD src1_sel:WORD_1
v_rcp_f32 v230, v230
v_mfma_f32_16x16x32_bf16 v[180:183], v[128:131], v[244:247], v[180:183]
ds_read_u16_d16_hi v168, v168
ds_read_b128 v[240:243], v3 offset:15360
buffer_load_dwordx3 v[84:86], v101, s[20:23], s48 offen offset:3456
v_lshlrev_b32_sdwa v169, v6, v169 dst_sel:DWORD dst_unused:UNUSED_PAD src0_sel:DWORD src1_sel:WORD_1
s_waitcnt lgkmcnt(3)
v_mfma_f32_16x16x32_bf16 v[176:179], v[120:123], v[248:251], v[176:179]
ds_read_u16_d16_hi v169, v169
v_lshlrev_b32_sdwa v170, v6, v170 dst_sel:DWORD dst_unused:UNUSED_PAD src0_sel:DWORD src1_sel:WORD_1
v_rcp_f32 v231, v231
v_mfma_f32_16x16x32_bf16 v[180:183], v[132:135], v[248:251], v[180:183]
ds_read_u16_d16_hi v170, v170
ds_read_b128 v[244:247], v3 offset:16384
s_setprio 0
v_mul_f32 v229, v221, v229
v_mul_f32 v230, v222, v230
v_mul_f32 v231, v223, v231
v_add_f32 v33, v160, v33
v_add_f32 v33, v161, v33
v_add_f32 v33, v162, v33
v_add_f32 v33, v163, v33
v_add_f32 v33, v164, v33
v_fmac_f32 v35, v229, v229
v_fmac_f32 v35, v230, v230
v_fmac_f32 v35, v231, v231
v_fmaak_f32 v232, v176, v176, 0x409d30fc
v_fmaak_f32 v233, v177, v177, 0x409d30fc
v_fmaak_f32 v234, v178, v178, 0x409d30fc
v_fmaak_f32 v235, v179, v179, 0x409d30fc
v_fmaak_f32 v236, v180, v180, 0x409d30fc
v_fmaak_f32 v237, v181, v181, 0x409d30fc
v_fmaak_f32 v224, v182, v182, 0x409d30fc
v_mul_f32 v232, v176, v232
v_mul_f32 v233, v177, v233
v_mul_f32 v234, v178, v234
v_mul_f32 v235, v179, v235
v_mul_f32 v236, v180, v236
v_mul_f32 v237, v181, v237
v_mul_f32 v224, v182, v224
s_setprio 1
v_lshlrev_b32_sdwa v171, v6, v171 dst_sel:DWORD dst_unused:UNUSED_PAD src0_sel:DWORD src1_sel:WORD_1
s_waitcnt lgkmcnt(0)
v_mfma_f32_16x16x32_bf16 v[184:187], v[112:115], v[240:243], 0
ds_read_u16_d16_hi v171, v171
v_exp_f32 v232, v232
v_lshlrev_b32_sdwa v172, v6, v172 dst_sel:DWORD dst_unused:UNUSED_PAD src0_sel:DWORD src1_sel:WORD_1
v_mfma_f32_16x16x32_bf16 v[188:191], v[124:127], v[240:243], 0
ds_read_u16_d16_hi v172, v172
ds_read_b128 v[248:251], v3 offset:17408
v_exp_f32 v233, v233
v_lshlrev_b32_sdwa v173, v6, v173 dst_sel:DWORD dst_unused:UNUSED_PAD src0_sel:DWORD src1_sel:WORD_1
v_mfma_f32_16x16x32_bf16 v[184:187], v[116:119], v[244:247], v[184:187]
ds_read_u16_d16_hi v173, v173
v_exp_f32 v234, v234
v_lshlrev_b32_sdwa v174, v6, v174 dst_sel:DWORD dst_unused:UNUSED_PAD src0_sel:DWORD src1_sel:WORD_1
v_exp_f32 v235, v235
v_mfma_f32_16x16x32_bf16 v[188:191], v[128:131], v[244:247], v[188:191]
ds_read_u16_d16_hi v174, v174
ds_read_b128 v[240:243], v3 offset:18432
v_exp_f32 v236, v236
v_lshlrev_b32_sdwa v175, v6, v175 dst_sel:DWORD dst_unused:UNUSED_PAD src0_sel:DWORD src1_sel:WORD_1
s_waitcnt lgkmcnt(3)
v_mfma_f32_16x16x32_bf16 v[184:187], v[120:123], v[248:251], v[184:187]
ds_read_u16_d16_hi v175, v175
v_exp_f32 v237, v237
v_mfma_f32_16x16x32_bf16 v[188:191], v[132:135], v[248:251], v[188:191]
ds_read_b128 v[244:247], v3 offset:19456
v_exp_f32 v224, v224
s_setprio 0
v_add_f32 v232, 1.0, v232
v_add_f32 v233, 1.0, v233
v_add_f32 v234, 1.0, v234
v_add_f32 v235, 1.0, v235
v_add_f32 v236, 1.0, v236
v_add_f32 v237, 1.0, v237
v_add_f32 v224, 1.0, v224
v_add_f32 v33, v165, v33
v_add_f32 v33, v166, v33
v_add_f32 v33, v167, v33
v_add_f32 v34, v168, v34
v_add_f32 v34, v169, v34
v_add_f32 v34, v170, v34
v_fmaak_f32 v238, v183, v183, 0x409d30fc
v_mul_f32 v238, v183, v238
s_setprio 1
v_lshlrev_b32_sdwa v184, v6, v184 dst_sel:DWORD dst_unused:UNUSED_PAD src0_sel:DWORD src1_sel:WORD_1
s_waitcnt lgkmcnt(0)
v_mfma_f32_16x16x32_bf16 v[192:195], v[112:115], v[240:243], 0
ds_read_u16_d16_hi v184, v184
v_and_b32 v103, 7, v1
v_lshlrev_b32 v103, 2, v103
buffer_load_dword v102, v103, s[28:31], 0 offen offset:64 sc0 sc1
v_rcp_f32 v232, v232
v_lshlrev_b32_sdwa v185, v6, v185 dst_sel:DWORD dst_unused:UNUSED_PAD src0_sel:DWORD src1_sel:WORD_1
v_mfma_f32_16x16x32_bf16 v[196:199], v[124:127], v[240:243], 0
ds_read_u16_d16_hi v185, v185
ds_read_b128 v[248:251], v3 offset:20480
v_rcp_f32 v233, v233
v_rcp_f32 v234, v234
v_lshlrev_b32_sdwa v186, v6, v186 dst_sel:DWORD dst_unused:UNUSED_PAD src0_sel:DWORD src1_sel:WORD_1
v_mfma_f32_16x16x32_bf16 v[192:195], v[116:119], v[244:247], v[192:195]
ds_read_u16_d16_hi v186, v186
v_rcp_f32 v235, v235
v_lshlrev_b32_sdwa v187, v6, v187 dst_sel:DWORD dst_unused:UNUSED_PAD src0_sel:DWORD src1_sel:WORD_1
v_mfma_f32_16x16x32_bf16 v[196:199], v[128:131], v[244:247], v[196:199]
ds_read_u16_d16_hi v187, v187
ds_read_b128 v[240:243], v3 offset:21504
v_rcp_f32 v236, v236
v_lshlrev_b32_sdwa v188, v6, v188 dst_sel:DWORD dst_unused:UNUSED_PAD src0_sel:DWORD src1_sel:WORD_1
s_waitcnt lgkmcnt(3)
v_mfma_f32_16x16x32_bf16 v[192:195], v[120:123], v[248:251], v[192:195]
ds_read_u16_d16_hi v188, v188
v_rcp_f32 v237, v237
v_rcp_f32 v224, v224
v_lshlrev_b32_sdwa v189, v6, v189 dst_sel:DWORD dst_unused:UNUSED_PAD src0_sel:DWORD src1_sel:WORD_1
v_mfma_f32_16x16x32_bf16 v[196:199], v[132:135], v[248:251], v[196:199]
ds_read_u16_d16_hi v189, v189
ds_read_b128 v[244:247], v3 offset:22528
v_exp_f32 v238, v238
s_setprio 0
v_mul_f32 v232, v176, v232
v_mul_f32 v233, v177, v233
v_mul_f32 v234, v178, v234
v_mul_f32 v235, v179, v235
v_mul_f32 v236, v180, v236
v_mul_f32 v237, v181, v237
v_mul_f32 v224, v182, v224
v_add_f32 v238, 1.0, v238
v_add_f32 v34, v171, v34
v_add_f32 v34, v172, v34
v_add_f32 v34, v173, v34
v_add_f32 v34, v174, v34
v_add_f32 v34, v175, v34
v_fmac_f32 v36, v232, v232
v_fmac_f32 v36, v233, v233
v_fmac_f32 v36, v234, v234
v_fmac_f32 v36, v235, v235
v_fmac_f32 v36, v236, v236
v_fmac_f32 v36, v237, v237
v_fmac_f32 v36, v224, v224
v_fmaak_f32 v239, v192, v192, 0x409d30fc
v_fmaak_f32 v232, v193, v193, 0x409d30fc
v_fmaak_f32 v233, v194, v194, 0x409d30fc
v_fmaak_f32 v234, v195, v195, 0x409d30fc
v_fmaak_f32 v235, v196, v196, 0x409d30fc
v_mul_f32 v239, v192, v239
v_mul_f32 v232, v193, v232
v_mul_f32 v233, v194, v233
v_mul_f32 v234, v195, v234
v_mul_f32 v235, v196, v235
s_setprio 1
v_lshlrev_b32_sdwa v190, v6, v190 dst_sel:DWORD dst_unused:UNUSED_PAD src0_sel:DWORD src1_sel:WORD_1
s_waitcnt lgkmcnt(0)
v_mfma_f32_16x16x32_bf16 v[200:203], v[112:115], v[240:243], 0
ds_read_u16_d16_hi v190, v190
v_rcp_f32 v238, v238
v_mfma_f32_16x16x32_bf16 v[204:207], v[124:127], v[240:243], 0
ds_read_b128 v[248:251], v3 offset:23552
v_exp_f32 v239, v239
v_mfma_f32_16x16x32_bf16 v[200:203], v[116:119], v[244:247], v[200:203]
v_exp_f32 v232, v232
v_lshlrev_b32_sdwa v191, v6, v191 dst_sel:DWORD dst_unused:UNUSED_PAD src0_sel:DWORD src1_sel:WORD_1
v_mfma_f32_16x16x32_bf16 v[204:207], v[128:131], v[244:247], v[204:207]
ds_read_u16_d16_hi v191, v191
v_exp_f32 v233, v233
s_waitcnt lgkmcnt(1)
v_mfma_f32_16x16x32_bf16 v[200:203], v[120:123], v[248:251], v[200:203]
v_exp_f32 v234, v234
v_mfma_f32_16x16x32_bf16 v[204:207], v[132:135], v[248:251], v[204:207]
v_exp_f32 v235, v235
s_setprio 0
v_mul_f32 v238, v183, v238
v_add_f32 v239, 1.0, v239
v_add_f32 v232, 1.0, v232
v_add_f32 v233, 1.0, v233
v_add_f32 v234, 1.0, v234
v_add_f32 v235, 1.0, v235
v_add_f32 v37, v184, v37
v_add_f32 v37, v185, v37
v_add_f32 v37, v186, v37
v_add_f32 v37, v187, v37
v_add_f32 v37, v188, v37
v_add_f32 v37, v189, v37
v_fmac_f32 v36, v238, v238
v_fmaak_f32 v236, v197, v197, 0x409d30fc
v_fmaak_f32 v237, v198, v198, 0x409d30fc
v_fmaak_f32 v238, v199, v199, 0x409d30fc
v_mul_f32 v236, v197, v236
v_mul_f32 v237, v198, v237
v_mul_f32 v238, v199, v238
s_setprio 1
v_lshlrev_b32_sdwa v200, v6, v200 dst_sel:DWORD dst_unused:UNUSED_PAD src0_sel:DWORD src1_sel:WORD_1
v_lshlrev_b32_sdwa v201, v6, v201 dst_sel:DWORD dst_unused:UNUSED_PAD src0_sel:DWORD src1_sel:WORD_1
ds_read_u16_d16_hi v200, v200
ds_read_u16_d16_hi v201, v201
v_rcp_f32 v239, v239
v_lshlrev_b32_sdwa v202, v6, v202 dst_sel:DWORD dst_unused:UNUSED_PAD src0_sel:DWORD src1_sel:WORD_1
ds_read_u16_d16_hi v202, v202
v_rcp_f32 v232, v232
v_rcp_f32 v233, v233
v_lshlrev_b32_sdwa v203, v6, v203 dst_sel:DWORD dst_unused:UNUSED_PAD src0_sel:DWORD src1_sel:WORD_1
ds_read_u16_d16_hi v203, v203
v_rcp_f32 v234, v234
v_lshlrev_b32_sdwa v204, v6, v204 dst_sel:DWORD dst_unused:UNUSED_PAD src0_sel:DWORD src1_sel:WORD_1
v_lshlrev_b32_sdwa v205, v6, v205 dst_sel:DWORD dst_unused:UNUSED_PAD src0_sel:DWORD src1_sel:WORD_1
ds_read_u16_d16_hi v204, v204
ds_read_u16_d16_hi v205, v205
v_rcp_f32 v235, v235
v_lshlrev_b32_sdwa v206, v6, v206 dst_sel:DWORD dst_unused:UNUSED_PAD src0_sel:DWORD src1_sel:WORD_1
ds_read_u16_d16_hi v206, v206
v_exp_f32 v236, v236
v_exp_f32 v237, v237
v_lshlrev_b32_sdwa v207, v6, v207 dst_sel:DWORD dst_unused:UNUSED_PAD src0_sel:DWORD src1_sel:WORD_1
ds_read_u16_d16_hi v207, v207
v_exp_f32 v238, v238
s_setprio 0
v_mul_f32 v239, v192, v239
v_mul_f32 v232, v193, v232
v_mul_f32 v233, v194, v233
v_mul_f32 v234, v195, v234
v_mul_f32 v235, v196, v235
v_add_f32 v236, 1.0, v236
v_add_f32 v237, 1.0, v237
v_add_f32 v238, 1.0, v238
v_add_f32 v37, v190, v37
s_waitcnt lgkmcnt(1)
v_add_f32 v37, v191, v37
v_fmac_f32 v38, v239, v239
v_fmac_f32 v38, v232, v232
v_fmac_f32 v38, v233, v233
v_fmac_f32 v38, v234, v234
v_fmac_f32 v38, v235, v235
s_setprio 1
v_rcp_f32 v236, v236
v_rcp_f32 v237, v237
v_rcp_f32 v238, v238
s_setprio 0
v_mul_f32 v236, v197, v236
v_mul_f32 v237, v198, v237
v_mul_f32 v238, v199, v238
v_add_f32 v39, v200, v39
v_add_f32 v39, v201, v39
v_add_f32 v39, v202, v39
v_add_f32 v39, v203, v39
v_add_f32 v39, v204, v39
v_add_f32 v39, v205, v39
v_add_f32 v39, v206, v39
s_waitcnt lgkmcnt(0)
v_add_f32 v39, v207, v39
v_fmac_f32 v38, v236, v236
v_fmac_f32 v38, v237, v237
v_fmac_f32 v38, v238, v238
L_sync:
v_permlane16_swap_b32 v16, v17
v_permlane16_swap_b32 v18, v19
v_permlane16_swap_b32 v20, v21
v_permlane16_swap_b32 v22, v23
v_permlane16_swap_b32 v24, v25
v_permlane16_swap_b32 v26, v27
v_permlane16_swap_b32 v28, v29
v_permlane16_swap_b32 v30, v31
v_permlane16_swap_b32 v32, v33
v_permlane16_swap_b32 v34, v35
v_permlane16_swap_b32 v36, v37
v_permlane16_swap_b32 v38, v39
v_add_f32 v16, v16, v17
v_add_f32 v18, v18, v19
v_add_f32 v20, v20, v21
v_add_f32 v22, v22, v23
v_add_f32 v24, v24, v25
v_add_f32 v26, v26, v27
v_add_f32 v28, v28, v29
v_add_f32 v30, v30, v31
v_add_f32 v32, v32, v33
v_add_f32 v34, v34, v35
v_add_f32 v36, v36, v37
v_add_f32 v38, v38, v39
v_permlane32_swap_b32 v16, v18
v_permlane32_swap_b32 v20, v22
v_permlane32_swap_b32 v24, v26
v_permlane32_swap_b32 v28, v30
v_permlane32_swap_b32 v32, v34
v_permlane32_swap_b32 v36, v38
v_add_f32 v16, v16, v18
v_add_f32 v20, v20, v22
v_add_f32 v24, v24, v26
v_add_f32 v28, v28, v30
v_add_f32 v32, v32, v34
v_add_f32 v36, v36, v38
s_mul_i32 s44, s32, 1536
s_add_u32 s44, s44, 90112
v_lshlrev_b32 v160, 2, v1
v_add_u32 v160, s44, v160
ds_write_b32 v160, v16 offset:0
ds_write_b32 v160, v20 offset:256
ds_write_b32 v160, v24 offset:512
ds_write_b32 v160, v28 offset:768
ds_write_b32 v160, v32 offset:1024
ds_write_b32 v160, v36 offset:1280
s_mov_b32 s45, 32768
s_waitcnt vmcnt(0)
v_cmp_eq_u32 vcc, 0, v102
s_nop 4
s_cbranch_vccz L_flagged
L_flag:
buffer_load_dword v102, v103, s[28:31], 0 offen offset:64 sc0 sc1
s_waitcnt vmcnt(0)
v_cmp_eq_u32 vcc, 0, v102
s_sub_u32 s45, s45, 1
s_cmp_eq_u32 s45, 0
s_cbranch_scc1 L_flagged
s_nop 4
s_cbranch_vccnz L_flag
L_flagged:
s_nop 1
s_waitcnt lgkmcnt(0)
s_barrier
v_lshlrev_b32 v160, 2, v0
v_add_u32 v161, 90112, v160
ds_read_b32 v164, v161 offset:0
ds_read_b32 v165, v161 offset:1536
ds_read_b32 v166, v161 offset:3072
ds_read_b32 v167, v161 offset:4608
ds_read_b32 v168, v161 offset:6144
ds_read_b32 v169, v161 offset:7680
ds_read_b32 v170, v161 offset:9216
ds_read_b32 v171, v161 offset:10752
s_mov_b32 s44, 159744
s_cmp_eq_u32 s32, 0
s_cselect_b32 s44, 74752, s44
s_cmp_eq_u32 s32, 1
s_cselect_b32 s44, 75776, s44
s_cmp_eq_u32 s32, 2
s_cselect_b32 s44, 76800, s44
s_cmp_eq_u32 s32, 3
s_cselect_b32 s44, 77824, s44
s_cmp_eq_u32 s32, 4
s_cselect_b32 s44, 78848, s44
s_cmp_eq_u32 s32, 5
s_cselect_b32 s44, 79872, s44
s_cmp_eq_u32 s32, 6
s_cselect_b32 s44, 83968, s44
s_cmp_eq_u32 s32, 7
s_cselect_b32 s44, 84992, s44
v_add_u32 v172, s44, v2
ds_read_b128 v[196:199], v172
s_mov_b32 s44, 159744
s_cmp_eq_u32 s32, 0
s_cselect_b32 s44, 86016, s44
v_add_u32 v173, s44, v2
ds_read_b128 v[208:211], v173
v_lshlrev_b32 v176, 4, v0
v_add_u32 v177, 0x10000, v176
ds_write_b128 v176, v[8:11]
ds_write_b128 v177, v[252:255]
s_mul_i32 s44, s41, 3072
s_add_u32 s44, s44, 50331648
s_cmp_lt_u32 s32, 6
s_cselect_b32 s44, s44, 0x40000000
s_waitcnt lgkmcnt(10)
v_add_f32 v164, v164, v165
s_waitcnt lgkmcnt(9)
v_add_f32 v164, v164, v166
s_waitcnt lgkmcnt(8)
v_add_f32 v164, v164, v167
s_waitcnt lgkmcnt(7)
v_add_f32 v164, v164, v168
s_waitcnt lgkmcnt(6)
v_add_f32 v164, v164, v169
s_waitcnt lgkmcnt(5)
v_add_f32 v164, v164, v170
s_waitcnt lgkmcnt(4)
v_add_f32 v164, v164, v171
s_lshl_b32 s45, s35, 1
s_sub_u32 s45, 208, s45
v_ldexp_f32 v164, v164, s45
v_cvt_u32_f32 v167, v164
v_cvt_f32_u32 v165, v167
v_sub_f32 v164, v164, v165
v_ldexp_f32 v164, v164, 32
v_cvt_u32_f32 v164, v164
v_and_b32 v164, 0xffffffc0, v164
v_or_b32 v166, 1, v164
v_lshlrev_b32 v160, 1, v160
buffer_atomic_add_x2 v[166:167], v160, s[8:11], s44 offen
v_mov_b32 v174, 0x7fff7fff
s_waitcnt lgkmcnt(3)
v_and_b32 v200, v174, v196
v_and_b32 v201, v174, v197
v_and_b32 v202, v174, v198
v_and_b32 v203, v174, v199
v_pk_sub_u16 v200, v200, s36 clamp
v_pk_sub_u16 v201, v201, s36 clamp
v_pk_sub_u16 v202, v202, s36 clamp
v_pk_sub_u16 v203, v203, s36 clamp
v_bitop3_b32 v196, v200, v196, v174 bitop3:0xf4
v_bitop3_b32 v197, v201, v197, v174 bitop3:0xf4
v_bitop3_b32 v198, v202, v198, v174 bitop3:0xf4
v_bitop3_b32 v199, v203, v199, v174 bitop3:0xf4
ds_write_b128 v172, v[196:199]
v_mov_b32 v174, 0x7fff7fff
s_waitcnt lgkmcnt(3)
v_and_b32 v200, v174, v208
v_and_b32 v201, v174, v209
v_and_b32 v202, v174, v210
v_and_b32 v203, v174, v211
v_pk_sub_u16 v200, v200, s36 clamp
v_pk_sub_u16 v201, v201, s36 clamp
v_pk_sub_u16 v202, v202, s36 clamp
v_pk_sub_u16 v203, v203, s36 clamp
v_bitop3_b32 v208, v200, v208, v174 bitop3:0xf4
v_bitop3_b32 v209, v201, v209, v174 bitop3:0xf4
v_bitop3_b32 v210, v202, v210, v174 bitop3:0xf4
v_bitop3_b32 v211, v203, v211, v174 bitop3:0xf4
ds_write_b128 v173, v[208:211]
v_lshrrev_b32 v200, 4, v1
v_and_b32 v201, 15, v1
v_lshlrev_b32 v202, 2, v200
v_sub_u32 v201, v201, v202
v_and_b32 v202, 1, v201
v_lshlrev_b32 v202, 4, v202
v_mov_b32 v203, 0x3f80
v_lshlrev_b32 v202, v202, v203
v_lshrrev_b32 v201, 1, v201
v_xor_b32 v203, 0, v201
v_min_u32 v203, 1, v203
v_subrev_u32 v203, 1, v203
v_and_b32 v228, v203, v202
v_xor_b32 v203, 1, v201
v_min_u32 v203, 1, v203
v_subrev_u32 v203, 1, v203
v_and_b32 v229, v203, v202
v_min_u32 v200, 1, v200
v_subrev_u32 v200, 1, v200
v_and_b32 v230, 0x3f803f80, v200
v_mov_b32 v231, 0
v_subrev_u32 v100, 384, v0
v_lshlrev_b32 v100, 2, v100
s_waitcnt lgkmcnt(0)
s_barrier
s_setprio 3
ds_read_b128 v[240:243], v15 offset:8192
s_waitcnt lgkmcnt(0)
v_mfma_f32_16x16x32_bf16 v[160:163], v[240:243], v[112:115], 0
ds_read_b128 v[244:247], v15 offset:9216
ds_read_b128 v[248:251], v15 offset:10240
v_lshrrev_b32 v107, 8, v2
v_lshlrev_b32 v107, 4, v107
s_waitcnt lgkmcnt(1)
v_mfma_f32_16x16x32_bf16 v[160:163], v[244:247], v[116:119], v[160:163]
ds_read_b128 v[240:243], v2 offset:51200
s_bfe_u32 s44, s39, 0x20000
s_lshl_b32 s44, s44, 6
v_add_u32 v108, s44, v107
ds_bpermute_b32 v88, v108, v13 offset:0
ds_bpermute_b32 v89, v108, v13 offset:4
s_waitcnt lgkmcnt(3)
v_mfma_f32_16x16x32_bf16 v[160:163], v[248:251], v[120:123], v[160:163]
ds_read_b128 v[244:247], v2 offset:52224
s_bfe_u32 s44, s39, 0x20002
s_lshl_b32 s44, s44, 6
v_add_u32 v108, s44, v107
ds_bpermute_b32 v90, v108, v13 offset:8
s_waitcnt lgkmcnt(4)
v_mfma_f32_16x16x32_bf16 v[164:167], v[240:243], v[112:115], 0
ds_read_b128 v[248:251], v2 offset:53248
ds_bpermute_b32 v91, v108, v13 offset:12
s_bfe_u32 s44, s39, 0x20004
s_lshl_b32 s44, s44, 6
v_add_u32 v108, s44, v107
ds_bpermute_b32 v92, v108, v13 offset:0
s_waitcnt lgkmcnt(4)
v_mfma_f32_16x16x32_bf16 v[164:167], v[244:247], v[116:119], v[164:167]
ds_bpermute_b32 v93, v108, v13 offset:4
s_bfe_u32 s44, s39, 0x20006
s_lshl_b32 s44, s44, 6
v_add_u32 v108, s44, v107
s_waitcnt lgkmcnt(3)
v_mfma_f32_16x16x32_bf16 v[164:167], v[248:251], v[120:123], v[164:167]
ds_bpermute_b32 v94, v108, v13 offset:8
ds_bpermute_b32 v95, v108, v13 offset:12
s_bfe_u32 s44, s39, 0x20008
s_lshl_b32 s44, s44, 6
v_add_u32 v108, s44, v107
ds_bpermute_b32 v96, v108, v13 offset:0
v_fmaak_f32 v224, v160, v160, 0x409d30fc
ds_bpermute_b32 v97, v108, v13 offset:4
v_fmaak_f32 v225, v161, v161, 0x409d30fc
v_lshlrev_b32_sdwa v162, v6, v162 dst_sel:DWORD dst_unused:UNUSED_PAD src0_sel:DWORD src1_sel:WORD_1
v_lshlrev_b32_sdwa v163, v6, v163 dst_sel:DWORD dst_unused:UNUSED_PAD src0_sel:DWORD src1_sel:WORD_1
ds_read_u16_d16 v162, v162
ds_read_u16_d16_hi v163, v163
ds_read_b128 v[240:243], v15 offset:17408
s_bfe_u32 s44, s39, 0x2000a
v_mul_f32 v224, v160, v224
s_lshl_b32 s44, s44, 6
v_mul_f32 v225, v161, v225
v_lshlrev_b32_sdwa v164, v6, v164 dst_sel:DWORD dst_unused:UNUSED_PAD src0_sel:DWORD src1_sel:WORD_1
v_lshlrev_b32_sdwa v165, v6, v165 dst_sel:DWORD dst_unused:UNUSED_PAD src0_sel:DWORD src1_sel:WORD_1
ds_read_u16_d16 v164, v164
ds_read_u16_d16_hi v165, v165
v_add_u32 v108, s44, v107
ds_bpermute_b32 v98, v108, v13 offset:8
v_exp_f32 v224, v224
v_exp_f32 v225, v225
v_lshlrev_b32_sdwa v166, v6, v166 dst_sel:DWORD dst_unused:UNUSED_PAD src0_sel:DWORD src1_sel:WORD_1
v_lshlrev_b32_sdwa v167, v6, v167 dst_sel:DWORD dst_unused:UNUSED_PAD src0_sel:DWORD src1_sel:WORD_1
ds_bpermute_b32 v99, v108, v13 offset:12
ds_read_u16_d16 v166, v166
ds_read_u16_d16_hi v167, v167
v_lshlrev_b32 v16, 16, v40
v_add_f32 v224, 1.0, v224
v_add_f32 v225, 1.0, v225
v_and_b32 v17, 0xffff0000, v40
v_lshlrev_b32 v18, 16, v41
v_rcp_f32 v224, v224
v_and_b32 v19, 0xffff0000, v41
v_rcp_f32 v225, v225
v_and_b32 v21, 0xffff0000, v42
v_mul_f32 v224, v160, v224
v_lshlrev_b32 v20, 16, v42
v_mul_f32 v225, v161, v225
v_mul_f32 v101, v16, v88
v_mul_f32 v102, v17, v88
v_cvt_pk_bf16_f32 v160, v224, v225
v_mul_f32 v103, v18, v88
v_mul_f32 v104, v19, v88
s_waitcnt lgkmcnt(0)
v_or_b32 v161, v162, v163
v_or_b32 v162, v164, v165
v_or_b32 v163, v166, v167
v_mul_f32 v105, v20, v88
v_mul_f32 v106, v21, v88
v_lshlrev_b32 v22, 16, v44
v_and_b32 v23, 0xffff0000, v44
v_lshlrev_b32 v24, 16, v45
v_and_b32 v25, 0xffff0000, v45
v_and_b32 v27, 0xffff0000, v46
v_lshlrev_b32 v26, 16, v46
v_fmac_f32 v101, v22, v89
v_fmac_f32 v102, v23, v89
v_mfma_f32_16x16x32_bf16 v[192:195], v[240:243], v[112:115], 0
ds_read_b128 v[244:247], v15 offset:18432
ds_read_b128 v[248:251], v15 offset:19456
v_fmac_f32 v103, v24, v89
v_mfma_f32_16x16x32_bf16 v[200:203], v[240:243], v[124:127], 0
v_fmac_f32 v104, v25, v89
v_fmac_f32 v105, v26, v89
v_fmac_f32 v106, v27, v89
s_waitcnt lgkmcnt(1)
v_mfma_f32_16x16x32_bf16 v[192:195], v[244:247], v[116:119], v[192:195]
ds_read_b128 v[240:243], v2 offset:60416
v_lshlrev_b32 v28, 16, v48
s_add_u32 s3, s55, 0
buffer_load_dwordx3 v[232:234], v5, s[4:7], s3 offen offset:0
v_mfma_f32_16x16x32_bf16 v[200:203], v[244:247], v[128:131], v[200:203]
v_and_b32 v29, 0xffff0000, v48
v_lshlrev_b32 v30, 16, v49
v_and_b32 v31, 0xffff0000, v49
v_and_b32 v33, 0xffff0000, v50
s_waitcnt lgkmcnt(1)
v_mfma_f32_16x16x32_bf16 v[192:195], v[248:251], v[120:123], v[192:195]
ds_read_b128 v[244:247], v2 offset:61440
v_lshlrev_b32 v32, 16, v50
v_mfma_f32_16x16x32_bf16 v[200:203], v[248:251], v[132:135], v[200:203]
s_setprio 2
buffer_load_dwordx3 v[236:238], v5, s[4:7], s3 offen offset:768
v_fmac_f32 v101, v28, v90
v_fmac_f32 v102, v29, v90
v_fmac_f32 v103, v30, v90
s_waitcnt lgkmcnt(1)
v_mfma_f32_16x16x32_bf16 v[196:199], v[240:243], v[112:115], 0
ds_read_b128 v[248:251], v2 offset:62464
v_fmac_f32 v104, v31, v90
v_mfma_f32_16x16x32_bf16 v[204:207], v[240:243], v[124:127], 0
v_fmac_f32 v105, v32, v90
v_fmac_f32 v106, v33, v90
buffer_load_dwordx3 v[252:254], v5, s[4:7], s3 offen offset:1536
v_lshlrev_b32 v34, 16, v52
v_and_b32 v35, 0xffff0000, v52
s_waitcnt lgkmcnt(1)
v_mfma_f32_16x16x32_bf16 v[196:199], v[244:247], v[116:119], v[196:199]
v_lshlrev_b32 v36, 16, v53
v_mfma_f32_16x16x32_bf16 v[204:207], v[244:247], v[128:131], v[204:207]
v_and_b32 v37, 0xffff0000, v53
v_and_b32 v39, 0xffff0000, v54
buffer_load_dwordx2 v[0:1], v5, s[4:7], s3 offen offset:2304
buffer_load_dword v235, v5, s[4:7], s3 offen offset:2312
v_lshlrev_b32 v38, 16, v54
s_waitcnt lgkmcnt(0)
v_mfma_f32_16x16x32_bf16 v[196:199], v[248:251], v[120:123], v[196:199]
v_fmac_f32 v101, v34, v91
v_mfma_f32_16x16x32_bf16 v[204:207], v[248:251], v[132:135], v[204:207]
v_fmac_f32 v102, v35, v91
v_fmac_f32 v103, v36, v91
v_fmac_f32 v104, v37, v91
v_fmac_f32 v105, v38, v91
v_fmac_f32 v106, v39, v91
v_fmaak_f32 v226, v192, v192, 0x409d30fc
v_lshlrev_b32 v40, 16, v56
v_fmaak_f32 v227, v193, v193, 0x409d30fc
v_lshlrev_b32_sdwa v194, v6, v194 dst_sel:DWORD dst_unused:UNUSED_PAD src0_sel:DWORD src1_sel:WORD_1
v_lshlrev_b32_sdwa v195, v6, v195 dst_sel:DWORD dst_unused:UNUSED_PAD src0_sel:DWORD src1_sel:WORD_1
ds_read_u16_d16 v194, v194
ds_read_u16_d16_hi v195, v195
v_and_b32 v41, 0xffff0000, v56
v_mul_f32 v226, v192, v226
ds_read_b128 v[240:243], v15 offset:26624
v_lshlrev_b32 v42, 16, v57
v_mul_f32 v227, v193, v227
v_lshlrev_b32_sdwa v196, v6, v196 dst_sel:DWORD dst_unused:UNUSED_PAD src0_sel:DWORD src1_sel:WORD_1
v_lshlrev_b32_sdwa v197, v6, v197 dst_sel:DWORD dst_unused:UNUSED_PAD src0_sel:DWORD src1_sel:WORD_1
ds_read_u16_d16 v196, v196
ds_read_u16_d16_hi v197, v197
v_and_b32 v43, 0xffff0000, v57
v_exp_f32 v226, v226
v_and_b32 v45, 0xffff0000, v58
v_exp_f32 v227, v227
v_lshlrev_b32_sdwa v198, v6, v198 dst_sel:DWORD dst_unused:UNUSED_PAD src0_sel:DWORD src1_sel:WORD_1
v_lshlrev_b32_sdwa v199, v6, v199 dst_sel:DWORD dst_unused:UNUSED_PAD src0_sel:DWORD src1_sel:WORD_1
ds_read_u16_d16 v198, v198
ds_read_u16_d16_hi v199, v199
v_lshlrev_b32 v44, 16, v58
v_fmac_f32 v101, v40, v92
v_add_f32 v226, 1.0, v226
v_add_f32 v227, 1.0, v227
v_fmac_f32 v102, v41, v92
v_fmac_f32 v103, v42, v92
v_rcp_f32 v226, v226
v_rcp_f32 v227, v227
v_fmac_f32 v104, v43, v92
v_fmac_f32 v105, v44, v92
v_mul_f32 v226, v192, v226
v_fmac_f32 v106, v45, v92
v_mul_f32 v227, v193, v227
v_fmaak_f32 v224, v200, v200, 0x409d30fc
v_fmaak_f32 v225, v201, v201, 0x409d30fc
v_lshlrev_b32 v46, 16, v60
v_lshlrev_b32_sdwa v202, v6, v202 dst_sel:DWORD dst_unused:UNUSED_PAD src0_sel:DWORD src1_sel:WORD_1
v_lshlrev_b32_sdwa v203, v6, v203 dst_sel:DWORD dst_unused:UNUSED_PAD src0_sel:DWORD src1_sel:WORD_1
ds_read_u16_d16 v202, v202
ds_read_u16_d16_hi v203, v203
v_and_b32 v47, 0xffff0000, v60
v_cvt_pk_bf16_f32 v192, v226, v227
v_mul_f32 v224, v200, v224
v_lshlrev_b32 v48, 16, v61
v_mul_f32 v225, v201, v225
v_lshlrev_b32_sdwa v204, v6, v204 dst_sel:DWORD dst_unused:UNUSED_PAD src0_sel:DWORD src1_sel:WORD_1
v_lshlrev_b32_sdwa v205, v6, v205 dst_sel:DWORD dst_unused:UNUSED_PAD src0_sel:DWORD src1_sel:WORD_1
ds_read_u16_d16 v204, v204
ds_read_u16_d16_hi v205, v205
v_and_b32 v49, 0xffff0000, v61
s_waitcnt lgkmcnt(4)
v_or_b32 v193, v194, v195
v_or_b32 v194, v196, v197
v_or_b32 v195, v198, v199
v_exp_f32 v224, v224
v_and_b32 v51, 0xffff0000, v62
v_exp_f32 v225, v225
v_lshlrev_b32_sdwa v206, v6, v206 dst_sel:DWORD dst_unused:UNUSED_PAD src0_sel:DWORD src1_sel:WORD_1
v_lshlrev_b32_sdwa v207, v6, v207 dst_sel:DWORD dst_unused:UNUSED_PAD src0_sel:DWORD src1_sel:WORD_1
v_lshlrev_b32 v50, 16, v62
ds_read_u16_d16 v206, v206
ds_read_u16_d16_hi v207, v207
v_fmac_f32 v101, v46, v93
v_add_f32 v224, 1.0, v224
v_add_f32 v225, 1.0, v225
v_fmac_f32 v102, v47, v93
v_fmac_f32 v103, v48, v93
v_rcp_f32 v224, v224
v_rcp_f32 v225, v225
v_fmac_f32 v104, v49, v93
v_fmac_f32 v105, v50, v93
v_mul_f32 v224, v200, v224
v_fmac_f32 v106, v51, v93
v_mul_f32 v225, v201, v225
v_lshlrev_b32 v52, 16, v64
v_and_b32 v53, 0xffff0000, v64
v_cvt_pk_bf16_f32 v200, v224, v225
v_mfma_f32_16x16x32_bf16 v[168:171], v[240:243], v[124:127], 0
v_lshlrev_b32 v54, 16, v65
ds_read_b128 v[244:247], v15 offset:27648
ds_read_b128 v[248:251], v15 offset:28672
v_and_b32 v55, 0xffff0000, v65
v_mfma_f32_16x16x32_bf16 v[176:179], v[240:243], v[136:139], 0
s_waitcnt lgkmcnt(2)
v_or_b32 v201, v202, v203
v_or_b32 v202, v204, v205
v_or_b32 v203, v206, v207
v_and_b32 v57, 0xffff0000, v66
v_lshlrev_b32 v56, 16, v66
v_fmac_f32 v101, v52, v94
s_waitcnt lgkmcnt(1)
v_mfma_f32_16x16x32_bf16 v[168:171], v[244:247], v[128:131], v[168:171]
ds_read_b128 v[240:243], v2 offset:63488
v_fmac_f32 v102, v53, v94
v_mfma_f32_16x16x32_bf16 v[176:179], v[244:247], v[140:143], v[176:179]
v_fmac_f32 v103, v54, v94
v_fmac_f32 v104, v55, v94
v_fmac_f32 v105, v56, v94
s_waitcnt lgkmcnt(1)
v_mfma_f32_16x16x32_bf16 v[168:171], v[248:251], v[132:135], v[168:171]
ds_read_b128 v[244:247], v2 offset:64512
v_fmac_f32 v106, v57, v94
v_lshlrev_b32 v58, 16, v68
v_mfma_f32_16x16x32_bf16 v[176:179], v[248:251], v[144:147], v[176:179]
s_setprio 1
v_and_b32 v59, 0xffff0000, v68
v_lshlrev_b32 v60, 16, v69
v_and_b32 v61, 0xffff0000, v69
s_waitcnt lgkmcnt(1)
v_mfma_f32_16x16x32_bf16 v[172:175], v[240:243], v[124:127], 0
ds_read_b128 v[248:251], v3 offset:8192
v_and_b32 v63, 0xffff0000, v70
v_mfma_f32_16x16x32_bf16 v[180:183], v[240:243], v[136:139], 0
v_lshlrev_b32 v62, 16, v70
v_fmac_f32 v101, v58, v95
v_fmac_f32 v102, v59, v95
s_waitcnt lgkmcnt(1)
v_mfma_f32_16x16x32_bf16 v[172:175], v[244:247], v[128:131], v[172:175]
v_fmac_f32 v103, v60, v95
v_fmac_f32 v104, v61, v95
v_mfma_f32_16x16x32_bf16 v[180:183], v[244:247], v[140:143], v[180:183]
v_fmac_f32 v105, v62, v95
v_fmac_f32 v106, v63, v95
v_lshlrev_b32 v64, 16, v72
s_waitcnt lgkmcnt(0)
v_mfma_f32_16x16x32_bf16 v[172:175], v[248:251], v[132:135], v[172:175]
v_and_b32 v65, 0xffff0000, v72
v_mfma_f32_16x16x32_bf16 v[180:183], v[248:251], v[144:147], v[180:183]
v_lshlrev_b32 v66, 16, v73
v_and_b32 v67, 0xffff0000, v73
v_and_b32 v69, 0xffff0000, v74
v_lshlrev_b32 v68, 16, v74
v_fmac_f32 v101, v64, v96
v_fmac_f32 v102, v65, v96
v_fmac_f32 v103, v66, v96
ds_read_b128 v[240:243], v15 offset:35840
v_fmac_f32 v104, v67, v96
v_fmac_f32 v105, v68, v96
v_fmac_f32 v106, v69, v96
v_lshlrev_b32 v70, 16, v76
v_and_b32 v71, 0xffff0000, v76
v_lshlrev_b32 v72, 16, v77
v_and_b32 v73, 0xffff0000, v77
v_and_b32 v75, 0xffff0000, v78
v_lshlrev_b32 v74, 16, v78
v_fmaak_f32 v226, v168, v168, 0x409d30fc
v_fmaak_f32 v227, v169, v169, 0x409d30fc
v_fmac_f32 v101, v70, v97
v_lshlrev_b32_sdwa v170, v6, v170 dst_sel:DWORD dst_unused:UNUSED_PAD src0_sel:DWORD src1_sel:WORD_1
v_lshlrev_b32_sdwa v171, v6, v171 dst_sel:DWORD dst_unused:UNUSED_PAD src0_sel:DWORD src1_sel:WORD_1
ds_read_u16_d16 v170, v170
ds_read_u16_d16_hi v171, v171
v_fmac_f32 v102, v71, v97
v_mul_f32 v226, v168, v226
v_mul_f32 v227, v169, v227
v_fmac_f32 v103, v72, v97
v_lshlrev_b32_sdwa v172, v6, v172 dst_sel:DWORD dst_unused:UNUSED_PAD src0_sel:DWORD src1_sel:WORD_1
v_lshlrev_b32_sdwa v173, v6, v173 dst_sel:DWORD dst_unused:UNUSED_PAD src0_sel:DWORD src1_sel:WORD_1
ds_read_u16_d16 v172, v172
ds_read_u16_d16_hi v173, v173
v_fmac_f32 v104, v73, v97
v_exp_f32 v226, v226
v_fmac_f32 v105, v74, v97
v_exp_f32 v227, v227
v_lshlrev_b32_sdwa v174, v6, v174 dst_sel:DWORD dst_unused:UNUSED_PAD src0_sel:DWORD src1_sel:WORD_1
v_lshlrev_b32_sdwa v175, v6, v175 dst_sel:DWORD dst_unused:UNUSED_PAD src0_sel:DWORD src1_sel:WORD_1
ds_read_u16_d16 v174, v174
ds_read_u16_d16_hi v175, v175
v_fmac_f32 v106, v75, v97
v_add_f32 v226, 1.0, v226
v_lshlrev_b32 v76, 16, v80
v_add_f32 v227, 1.0, v227
v_and_b32 v77, 0xffff0000, v80
s_cmp_lg_u32 s32, 7
s_cbranch_scc1 L_nopoll
v_bfe_u32 v110, v2, 4, 3
v_mul_u32_u24 v110, 3072, v110
s_mov_b32 s46, 50334712
buffer_load_dword v109, v110, s[8:11], s46 offen sc0 sc1
L_nopoll:
v_lshlrev_b32 v78, 16, v81
v_rcp_f32 v226, v226
v_rcp_f32 v227, v227
v_and_b32 v79, 0xffff0000, v81
v_and_b32 v81, 0xffff0000, v82
v_mul_f32 v226, v168, v226
v_mul_f32 v227, v169, v227
v_lshlrev_b32 v80, 16, v82
v_fmaak_f32 v224, v176, v176, 0x409d30fc
v_lshlrev_b32_sdwa v178, v6, v178 dst_sel:DWORD dst_unused:UNUSED_PAD src0_sel:DWORD src1_sel:WORD_1
v_lshlrev_b32_sdwa v179, v6, v179 dst_sel:DWORD dst_unused:UNUSED_PAD src0_sel:DWORD src1_sel:WORD_1
ds_read_u16_d16 v178, v178
ds_read_u16_d16_hi v179, v179
v_fmaak_f32 v225, v177, v177, 0x409d30fc
v_fmac_f32 v101, v76, v98
v_cvt_pk_bf16_f32 v168, v226, v227
v_fmac_f32 v102, v77, v98
v_mul_f32 v224, v176, v224
v_lshlrev_b32_sdwa v180, v6, v180 dst_sel:DWORD dst_unused:UNUSED_PAD src0_sel:DWORD src1_sel:WORD_1
v_lshlrev_b32_sdwa v181, v6, v181 dst_sel:DWORD dst_unused:UNUSED_PAD src0_sel:DWORD src1_sel:WORD_1
ds_read_u16_d16 v180, v180
ds_read_u16_d16_hi v181, v181
v_mul_f32 v225, v177, v225
v_fmac_f32 v103, v78, v98
s_waitcnt lgkmcnt(3)
v_mfma_f32_16x16x32_bf16 v[208:211], v[240:243], v[136:139], 0
ds_read_b128 v[244:247], v15 offset:36864
ds_read_b128 v[248:251], v15 offset:37888
v_fmac_f32 v104, v79, v98
v_or_b32 v169, v170, v171
v_or_b32 v170, v172, v173
v_or_b32 v171, v174, v175
v_exp_f32 v224, v224
v_lshlrev_b32_sdwa v182, v6, v182 dst_sel:DWORD dst_unused:UNUSED_PAD src0_sel:DWORD src1_sel:WORD_1
v_lshlrev_b32_sdwa v183, v6, v183 dst_sel:DWORD dst_unused:UNUSED_PAD src0_sel:DWORD src1_sel:WORD_1
v_fmac_f32 v105, v80, v98
v_mfma_f32_16x16x32_bf16 v[216:219], v[240:243], v[148:151], 0
ds_read_u16_d16 v182, v182
ds_read_u16_d16_hi v183, v183
v_exp_f32 v225, v225
v_fmac_f32 v106, v81, v98
v_add_f32 v224, 1.0, v224
v_lshlrev_b32 v82, 16, v84
v_add_f32 v225, 1.0, v225
v_and_b32 v83, 0xffff0000, v84
s_waitcnt lgkmcnt(2)
v_mfma_f32_16x16x32_bf16 v[208:211], v[244:247], v[140:143], v[208:211]
ds_read_b128 v[240:243], v3 offset:15360
v_rcp_f32 v224, v224
v_lshlrev_b32 v84, 16, v85
v_mfma_f32_16x16x32_bf16 v[216:219], v[244:247], v[152:155], v[216:219]
v_rcp_f32 v225, v225
v_and_b32 v85, 0xffff0000, v85
v_and_b32 v87, 0xffff0000, v86
v_mul_f32 v224, v176, v224
v_mul_f32 v225, v177, v225
v_lshlrev_b32 v86, 16, v86
v_mfma_f32_16x16x32_bf16 v[208:211], v[248:251], v[144:147], v[208:211]
ds_read_b128 v[244:247], v3 offset:16384
v_fmac_f32 v101, v82, v99
v_cvt_pk_bf16_f32 v176, v224, v225
v_mfma_f32_16x16x32_bf16 v[216:219], v[248:251], v[156:159], v[216:219]
s_setprio 0
v_fmac_f32 v102, v83, v99
v_fmac_f32 v103, v84, v99
v_or_b32 v177, v178, v179
v_fmac_f32 v104, v85, v99
v_or_b32 v178, v180, v181
s_waitcnt lgkmcnt(1)
v_or_b32 v179, v182, v183
v_fmac_f32 v105, v86, v99
v_mfma_f32_16x16x32_bf16 v[212:215], v[240:243], v[136:139], 0
ds_read_b128 v[248:251], v3 offset:17408
v_fmac_f32 v106, v87, v99
v_mfma_f32_16x16x32_bf16 v[220:223], v[240:243], v[148:151], 0
v_permlane16_swap_b32 v101, v102
v_permlane16_swap_b32 v103, v104
v_permlane16_swap_b32 v105, v106
s_waitcnt lgkmcnt(1)
v_mfma_f32_16x16x32_bf16 v[212:215], v[244:247], v[140:143], v[212:215]
v_add_f32 v101, v101, v102
v_mfma_f32_16x16x32_bf16 v[220:223], v[244:247], v[152:155], v[220:223]
v_add_f32 v103, v103, v104
v_add_f32 v105, v105, v106
v_mov_b32 v106, v105
v_permlane32_swap_b32 v101, v103
s_waitcnt lgkmcnt(0)
v_mfma_f32_16x16x32_bf16 v[212:215], v[248:251], v[144:147], v[212:215]
v_permlane32_swap_b32 v105, v106
v_mfma_f32_16x16x32_bf16 v[220:223], v[248:251], v[156:159], v[220:223]
v_add_f32 v101, v101, v103
v_add_f32 v105, v105, v106
v_bfe_u32 v107, v2, 4, 4
v_mul_u32_u24 v107, 6, v107
v_lshrrev_b32 v108, 8, v2
ds_read_b128 v[240:243], v14 offset:26624
v_add_u32 v102, v107, v108
v_and_b32 v108, 1, v108
v_add3_u32 v104, v107, v108, 4
s_mul_i32 s44, s32, 384
s_add_u32 s44, s44, 102400
v_lshl_add_u32 v102, v102, 2, s44
v_lshl_add_u32 v104, v104, 2, s44
ds_write_b32 v102, v101
ds_write_b32 v104, v105
v_mov_b32 v110, 73280
s_cmp_lg_u32 s32, 7
s_cbranch_scc1 L_nook
s_waitcnt vmcnt(0)
v_and_b32 v109, 63, v109
v_cmp_ne_u32 vcc, 32, v109
s_nop 4
s_cmp_eq_u64 vcc, 0
s_cselect_b32 s40, 1, 0
v_mov_b32 v109, s40
ds_write_b32 v110, v109
L_nook:
s_nop 1
s_waitcnt lgkmcnt(0)
s_barrier
s_cmp_lt_u32 s32, 6
s_cbranch_scc1 L_nob2
v_add_u32 v109, 102400, v100
ds_read_b32 v101, v109 offset:0
ds_read_b32 v102, v109 offset:384
ds_read_b32 v103, v109 offset:768
ds_read_b32 v104, v109 offset:1152
ds_read_b32 v105, v109 offset:1536
ds_read_b32 v106, v109 offset:1920
ds_read_b32 v107, v109 offset:2304
ds_read_b32 v108, v109 offset:2688
s_waitcnt lgkmcnt(6)
v_add_f32 v101, v101, v102
s_waitcnt lgkmcnt(5)
v_add_f32 v101, v101, v103
s_waitcnt lgkmcnt(4)
v_add_f32 v101, v101, v104
s_waitcnt lgkmcnt(3)
v_add_f32 v101, v101, v105
s_waitcnt lgkmcnt(2)
v_add_f32 v101, v101, v106
s_waitcnt lgkmcnt(1)
v_add_f32 v101, v101, v107
s_waitcnt lgkmcnt(0)
v_add_f32 v101, v101, v108
v_add_u32 v100, 7680, v100
ds_write_b32 v100, v101
s_waitcnt lgkmcnt(0)
L_nob2:
s_nop 1
ds_read_b32 v109, v110
v_fmaak_f32 v226, v208, v208, 0x409d30fc
v_lshlrev_b32_sdwa v210, v6, v210 dst_sel:DWORD dst_unused:UNUSED_PAD src0_sel:DWORD src1_sel:WORD_1
v_lshlrev_b32_sdwa v211, v6, v211 dst_sel:DWORD dst_unused:UNUSED_PAD src0_sel:DWORD src1_sel:WORD_1
s_waitcnt lgkmcnt(0)
v_readfirstlane_b32 s40, v109
v_lshrrev_b32 v110, 1, v2
s_mul_i32 s47, s32, 384
s_add_u32 s47, s47, 50331648
s_cmp_lg_u32 s40, 0
s_cselect_b32 s47, s47, 0x80000000
ds_read_u16_d16 v210, v210
ds_read_u16_d16_hi v211, v211
v_fmaak_f32 v227, v209, v209, 0x409d30fc
v_mul_f32 v226, v208, v226
v_lshlrev_b32_sdwa v212, v6, v212 dst_sel:DWORD dst_unused:UNUSED_PAD src0_sel:DWORD src1_sel:WORD_1
v_lshlrev_b32_sdwa v213, v6, v213 dst_sel:DWORD dst_unused:UNUSED_PAD src0_sel:DWORD src1_sel:WORD_1
ds_read_u16_d16 v212, v212
ds_read_u16_d16_hi v213, v213
v_mul_f32 v227, v209, v227
buffer_load_dwordx2 v[88:89], v110, s[8:11], s47 offen sc0 sc1
s_add_u32 s47, s47, 3072
v_exp_f32 v226, v226
v_lshlrev_b32_sdwa v214, v6, v214 dst_sel:DWORD dst_unused:UNUSED_PAD src0_sel:DWORD src1_sel:WORD_1
v_lshlrev_b32_sdwa v215, v6, v215 dst_sel:DWORD dst_unused:UNUSED_PAD src0_sel:DWORD src1_sel:WORD_1
v_mfma_f32_16x16x32_bf16 v[184:187], v[240:243], v[148:151], 0
ds_read_b128 v[244:247], v14 offset:27648
ds_read_b128 v[248:251], v14 offset:28672
ds_read_u16_d16 v214, v214
ds_read_u16_d16_hi v215, v215
v_exp_f32 v227, v227
buffer_load_dwordx2 v[90:91], v110, s[8:11], s47 offen sc0 sc1
s_add_u32 s47, s47, 3072
v_add_f32 v226, 1.0, v226
v_add_f32 v227, 1.0, v227
buffer_load_dwordx2 v[92:93], v110, s[8:11], s47 offen sc0 sc1
s_add_u32 s47, s47, 3072
v_rcp_f32 v226, v226
s_waitcnt lgkmcnt(3)
v_mfma_f32_16x16x32_bf16 v[184:187], v[244:247], v[152:155], v[184:187]
ds_read_b128 v[240:243], v2 offset:14336
v_rcp_f32 v227, v227
v_mul_f32 v226, v208, v226
buffer_load_dwordx2 v[94:95], v110, s[8:11], s47 offen sc0 sc1
s_add_u32 s47, s47, 3072
v_mul_f32 v227, v209, v227
v_fmaak_f32 v224, v216, v216, 0x409d30fc
v_fmaak_f32 v225, v217, v217, 0x409d30fc
v_lshlrev_b32_sdwa v218, v6, v218 dst_sel:DWORD dst_unused:UNUSED_PAD src0_sel:DWORD src1_sel:WORD_1
v_lshlrev_b32_sdwa v219, v6, v219 dst_sel:DWORD dst_unused:UNUSED_PAD src0_sel:DWORD src1_sel:WORD_1
ds_read_u16_d16 v218, v218
ds_read_u16_d16_hi v219, v219
v_cvt_pk_bf16_f32 v208, v226, v227
s_waitcnt lgkmcnt(2)
v_mfma_f32_16x16x32_bf16 v[184:187], v[248:251], v[156:159], v[184:187]
ds_read_b128 v[244:247], v2 offset:15360
buffer_load_dwordx2 v[96:97], v110, s[8:11], s47 offen sc0 sc1
s_add_u32 s47, s47, 3072
v_mul_f32 v224, v216, v224
v_mul_f32 v225, v217, v225
v_lshlrev_b32_sdwa v220, v6, v220 dst_sel:DWORD dst_unused:UNUSED_PAD src0_sel:DWORD src1_sel:WORD_1
v_lshlrev_b32_sdwa v221, v6, v221 dst_sel:DWORD dst_unused:UNUSED_PAD src0_sel:DWORD src1_sel:WORD_1
ds_read_u16_d16 v220, v220
ds_read_u16_d16_hi v221, v221
v_or_b32 v209, v210, v211
v_or_b32 v210, v212, v213
v_or_b32 v211, v214, v215
v_exp_f32 v224, v224
buffer_load_dwordx2 v[98:99], v110, s[8:11], s47 offen sc0 sc1
s_add_u32 s47, s47, 3072
v_exp_f32 v225, v225
v_lshlrev_b32_sdwa v222, v6, v222 dst_sel:DWORD dst_unused:UNUSED_PAD src0_sel:DWORD src1_sel:WORD_1
v_lshlrev_b32_sdwa v223, v6, v223 dst_sel:DWORD dst_unused:UNUSED_PAD src0_sel:DWORD src1_sel:WORD_1
ds_read_u16_d16 v222, v222
ds_read_u16_d16_hi v223, v223
v_mfma_f32_16x16x32_bf16 v[188:191], v[240:243], v[148:151], 0
ds_read_b128 v[248:251], v2 offset:16384
v_add_f32 v224, 1.0, v224
v_add_f32 v225, 1.0, v225
buffer_load_dwordx2 v[102:103], v110, s[8:11], s47 offen sc0 sc1
s_add_u32 s47, s47, 3072
v_rcp_f32 v224, v224
v_rcp_f32 v225, v225
buffer_load_dwordx2 v[104:105], v110, s[8:11], s47 offen sc0 sc1
s_add_u32 s47, s47, 3072
s_waitcnt lgkmcnt(3)
v_mfma_f32_16x16x32_bf16 v[188:191], v[244:247], v[152:155], v[188:191]
v_mul_f32 v224, v216, v224
v_mul_f32 v225, v217, v225
v_cvt_pk_bf16_f32 v216, v224, v225
s_waitcnt lgkmcnt(0)
v_mfma_f32_16x16x32_bf16 v[188:191], v[248:251], v[156:159], v[188:191]
s_setprio 3
v_or_b32 v217, v218, v219
v_or_b32 v218, v220, v221
v_or_b32 v219, v222, v223
v_fmaak_f32 v226, v186, v186, 0x409d30fc
v_fmaak_f32 v227, v187, v187, 0x409d30fc
v_lshlrev_b32_sdwa v184, v6, v184 dst_sel:DWORD dst_unused:UNUSED_PAD src0_sel:DWORD src1_sel:WORD_1
v_lshlrev_b32_sdwa v185, v6, v185 dst_sel:DWORD dst_unused:UNUSED_PAD src0_sel:DWORD src1_sel:WORD_1
ds_read_u16_d16 v184, v184
ds_read_u16_d16_hi v185, v185
v_mul_f32 v226, v186, v226
v_mul_f32 v227, v187, v227
v_lshlrev_b32_sdwa v188, v6, v188 dst_sel:DWORD dst_unused:UNUSED_PAD src0_sel:DWORD src1_sel:WORD_1
v_lshlrev_b32_sdwa v189, v6, v189 dst_sel:DWORD dst_unused:UNUSED_PAD src0_sel:DWORD src1_sel:WORD_1
ds_read_u16_d16 v188, v188
ds_read_u16_d16_hi v189, v189
v_exp_f32 v226, v226
v_exp_f32 v227, v227
v_lshlrev_b32_sdwa v190, v6, v190 dst_sel:DWORD dst_unused:UNUSED_PAD src0_sel:DWORD src1_sel:WORD_1
v_lshlrev_b32_sdwa v191, v6, v191 dst_sel:DWORD dst_unused:UNUSED_PAD src0_sel:DWORD src1_sel:WORD_1
ds_read_u16_d16 v190, v190
ds_read_u16_d16_hi v191, v191
v_add_f32 v226, 1.0, v226
v_add_f32 v227, 1.0, v227
v_rcp_f32 v226, v226
v_rcp_f32 v227, v227
v_mul_f32 v226, v186, v226
v_mul_f32 v227, v187, v227
s_waitcnt lgkmcnt(2)
v_or_b32 v184, v184, v185
v_cvt_pk_bf16_f32 v185, v226, v227
v_or_b32 v186, v188, v189
s_waitcnt lgkmcnt(0)
v_or_b32 v187, v190, v191
s_setprio 0
s_mov_b32 s42, 32768
s_cmp_lg_u32 s40, 0
s_cbranch_scc1 L_havesums
s_cmp_lg_u32 s32, 7
s_cbranch_scc1 L_arrived
s_mov_b32 s45, 32768
L_poll:
v_bfe_u32 v110, v2, 4, 3
v_mul_u32_u24 v110, 3072, v110
s_mov_b32 s46, 50334712
buffer_load_dword v109, v110, s[8:11], s46 offen sc0 sc1
s_waitcnt vmcnt(0)
v_and_b32 v109, 63, v109
v_cmp_ne_u32 vcc, 32, v109
s_sub_u32 s45, s45, 1
s_cmp_eq_u32 s45, 0
s_cbranch_scc1 L_arrived
s_nop 4
s_cbranch_vccnz L_poll
L_arrived:
s_nop 1
s_barrier
L_again:
s_mul_i32 s44, s32, 384
s_add_u32 s44, s44, 50331648
v_lshrrev_b32 v110, 1, v2
buffer_load_dwordx2 v[88:89], v110, s[8:11], s44 offen sc0 sc1
s_add_u32 s44, s44, 3072
buffer_load_dwordx2 v[90:91], v110, s[8:11], s44 offen sc0 sc1
s_add_u32 s44, s44, 3072
buffer_load_dwordx2 v[92:93], v110, s[8:11], s44 offen sc0 sc1
s_add_u32 s44, s44, 3072
buffer_load_dwordx2 v[94:95], v110, s[8:11], s44 offen sc0 sc1
s_add_u32 s44, s44, 3072
buffer_load_dwordx2 v[96:97], v110, s[8:11], s44 offen sc0 sc1
s_add_u32 s44, s44, 3072
buffer_load_dwordx2 v[98:99], v110, s[8:11], s44 offen sc0 sc1
s_add_u32 s44, s44, 3072
buffer_load_dwordx2 v[102:103], v110, s[8:11], s44 offen sc0 sc1
s_add_u32 s44, s44, 3072
buffer_load_dwordx2 v[104:105], v110, s[8:11], s44 offen sc0 sc1
s_add_u32 s44, s44, 3072
L_havesums:
s_nop 1
s_waitcnt vmcnt(0)
v_mov_b32 v106, 32
v_xor_b32 v107, v106, v88
v_bitop3_b32 v107, v107, v90, v106 bitop3:0xf6
v_bitop3_b32 v107, v107, v92, v106 bitop3:0xf6
v_bitop3_b32 v107, v107, v94, v106 bitop3:0xf6
v_bitop3_b32 v107, v107, v96, v106 bitop3:0xf6
v_bitop3_b32 v107, v107, v98, v106 bitop3:0xf6
v_bitop3_b32 v107, v107, v102, v106 bitop3:0xf6
v_bitop3_b32 v107, v107, v104, v106 bitop3:0xf6
v_and_b32 v107, 63, v107
v_cmp_ne_u32 vcc, 0, v107
s_and_b32 vcc_hi, vcc_hi, 0xffff
s_sub_u32 s42, s42, 1
s_cselect_b64 vcc, 0, vcc
s_nop 1
s_cbranch_vccnz L_again
v_lshrrev_b32 v88, 6, v88
v_lshrrev_b32 v90, 6, v90
v_lshrrev_b32 v92, 6, v92
v_lshrrev_b32 v94, 6, v94
v_lshrrev_b32 v96, 6, v96
v_lshrrev_b32 v98, 6, v98
v_lshrrev_b32 v102, 6, v102
v_lshrrev_b32 v104, 6, v104
v_add3_u32 v106, v88, v90, v92
v_add3_u32 v106, v106, v94, v96
v_add3_u32 v106, v106, v98, v102
v_add_u32 v106, v106, v104
v_add3_u32 v107, v89, v91, v93
v_add3_u32 v107, v107, v95, v97
v_add3_u32 v107, v107, v99, v103
v_add_u32 v107, v107, v105
v_cvt_f32_u32 v106, v106
v_cvt_f32_u32 v107, v107
s_lshl_b32 s44, s35, 1
s_sub_u32 s44, s44, 234
v_fmac_f32 v106, 0x4c800000, v107
v_ldexp_f32 v101, v106, s44
v_mov_b32 v103, 0x358637bd
v_fmac_f32 v103, 0x4091afa4, v101
v_sqrt_f32 v103, v103
v_cmp_gt_u32 vcc, 768, v2
s_nop 1
v_cndmask_b32 v104, 0, v103, vcc
s_nop 1
v_add_f32_dpp v104, v104, v104 row_shr:1 row_mask:0xf bank_mask:0xf
s_nop 1
v_add_f32_dpp v104, v104, v104 row_shr:2 row_mask:0xf bank_mask:0xf
s_nop 1
v_add_f32_dpp v104, v104, v104 row_shr:4 row_mask:0xf bank_mask:0xf
s_nop 1
v_add_f32_dpp v104, v104, v104 row_shr:8 row_mask:0xf bank_mask:0xf
s_nop 1
v_add_f32_dpp v104, v104, v104 row_bcast:15 row_mask:0xa bank_mask:0xf
s_nop 1
v_add_f32_dpp v104, v104, v104 row_bcast:31 row_mask:0xc bank_mask:0xf
s_lshl_b32 s45, s32, 2
s_add_u32 s45, s45, 73216
v_mov_b32 v105, s45
s_mov_b32 exec_lo, 0
s_mov_b32 exec_hi, 0x80000000
ds_write_b32 v105, v104
s_mov_b64 exec, -1
v_lshlrev_b32 v111, 16, v111
v_mul_f32 v103, v103, v111
v_lshrrev_b32 v104, 8, v2
v_lshlrev_b32 v104, 4, v104
s_bfe_u32 s44, s39, 0x20000
s_lshl_b32 s44, s44, 6
v_add_u32 v105, s44, v104
ds_bpermute_b32 v88, v105, v103 offset:0
ds_bpermute_b32 v89, v105, v103 offset:4
s_bfe_u32 s44, s39, 0x20002
s_lshl_b32 s44, s44, 6
v_add_u32 v105, s44, v104
ds_bpermute_b32 v90, v105, v103 offset:8
ds_bpermute_b32 v91, v105, v103 offset:12
s_bfe_u32 s44, s39, 0x20004
s_lshl_b32 s44, s44, 6
v_add_u32 v105, s44, v104
ds_bpermute_b32 v92, v105, v103 offset:0
ds_bpermute_b32 v93, v105, v103 offset:4
s_bfe_u32 s44, s39, 0x20006
s_lshl_b32 s44, s44, 6
v_add_u32 v105, s44, v104
ds_bpermute_b32 v94, v105, v103 offset:8
ds_bpermute_b32 v95, v105, v103 offset:12
s_bfe_u32 s44, s39, 0x20008
s_lshl_b32 s44, s44, 6
v_add_u32 v105, s44, v104
ds_bpermute_b32 v96, v105, v103 offset:0
ds_bpermute_b32 v97, v105, v103 offset:4
s_bfe_u32 s44, s39, 0x2000a
s_lshl_b32 s44, s44, 6
v_add_u32 v105, s44, v104
ds_bpermute_b32 v98, v105, v103 offset:8
ds_bpermute_b32 v99, v105, v103 offset:12
s_waitcnt lgkmcnt(0)
s_barrier
v_mov_b32 v105, 73216
ds_read_b128 v[100:103], v105
ds_read_b128 v[104:107], v105 offset:16
v_bfe_u32 v110, v2, 4, 4
v_mul_u32_u24 v110, 24, v110
ds_read_b64 v[8:9], v110 offset:7680
ds_read_b64 v[10:11], v110 offset:7688
ds_read_b64 v[12:13], v110 offset:7696
s_waitcnt lgkmcnt(4)
v_add_f32 v100, v100, v101
v_add_f32 v100, v100, v102
v_add_f32 v100, v100, v103
s_waitcnt lgkmcnt(3)
v_add_f32 v100, v100, v104
v_add_f32 v100, v100, v105
v_add_f32 v100, v100, v106
v_add_f32 v100, v100, v107
v_mov_b32 v101, 0x358637bd
v_fmac_f32 v101, 0x3b2aaaab, v100
v_rcp_f32 v101, v101
v_mov_b32 v102, 0xc0088e99
v_mul_f32 v101, v101, v102
v_fma_f32 v88, v88, v101, v102
v_fma_f32 v89, v89, v101, v102
v_fma_f32 v90, v90, v101, v102
v_fma_f32 v91, v91, v101, v102
v_fma_f32 v92, v92, v101, v102
v_fma_f32 v93, v93, v101, v102
v_fma_f32 v94, v94, v101, v102
v_fma_f32 v95, v95, v101, v102
v_fma_f32 v96, v96, v101, v102
v_fma_f32 v97, v97, v101, v102
v_fma_f32 v98, v98, v101, v102
v_fma_f32 v99, v99, v101, v102
v_add_u32 v100, s33, v2
v_mul_f32 v16, v16, v88
v_mul_f32 v22, v22, v89
v_mul_f32 v28, v28, v90
v_mul_f32 v34, v34, v91
v_cvt_pk_bf16_f32 v104, v16, v22
v_cvt_pk_bf16_f32 v105, v28, v34
ds_write_b64 v100, v[104:105] offset:0
v_mul_f32 v17, v17, v88
v_mul_f32 v23, v23, v89
v_mul_f32 v29, v29, v90
v_mul_f32 v35, v35, v91
v_cvt_pk_bf16_f32 v106, v17, v23
v_cvt_pk_bf16_f32 v107, v29, v35
ds_write_b64 v100, v[106:107] offset:1024
v_mul_f32 v18, v18, v88
v_mul_f32 v24, v24, v89
v_mul_f32 v30, v30, v90
v_mul_f32 v36, v36, v91
v_cvt_pk_bf16_f32 v108, v18, v24
v_cvt_pk_bf16_f32 v109, v30, v36
ds_write_b64 v100, v[108:109] offset:2048
v_mul_f32 v19, v19, v88
v_mul_f32 v25, v25, v89
v_mul_f32 v31, v31, v90
v_mul_f32 v37, v37, v91
v_cvt_pk_bf16_f32 v104, v19, v25
v_cvt_pk_bf16_f32 v105, v31, v37
ds_write_b64 v100, v[104:105] offset:3072
v_mul_f32 v20, v20, v88
v_mul_f32 v26, v26, v89
v_mul_f32 v32, v32, v90
v_mul_f32 v38, v38, v91
v_cvt_pk_bf16_f32 v106, v20, v26
v_cvt_pk_bf16_f32 v107, v32, v38
ds_write_b64 v100, v[106:107] offset:4096
v_mul_f32 v21, v21, v88
v_mul_f32 v27, v27, v89
v_mul_f32 v33, v33, v90
v_mul_f32 v39, v39, v91
v_cvt_pk_bf16_f32 v108, v21, v27
v_cvt_pk_bf16_f32 v109, v33, v39
ds_write_b64 v100, v[108:109] offset:5120
s_waitcnt lgkmcnt(0)
s_barrier
s_setprio 3
ds_read_b128 v[240:243], v3 offset:24576
s_waitcnt lgkmcnt(0)
v_mfma_f32_16x16x32_bf16 v[16:19], v[160:163], v[240:243], 0
ds_read_b128 v[244:247], v3 offset:25600
ds_read_b128 v[248:251], v3 offset:26624
v_cvt_pk_bf16_f32 v103, v8, v8
v_lshlrev_b32 v103, 16, v103
v_sub_f32 v110, v8, v103
v_cvt_pk_bf16_f32 v8, v103, v110
v_cvt_pk_bf16_f32 v103, v9, v9
s_waitcnt lgkmcnt(1)
v_mfma_f32_16x16x32_bf16 v[20:23], v[160:163], v[244:247], 0
ds_read_b128 v[240:243], v3 offset:27648
v_lshlrev_b32 v103, 16, v103
v_sub_f32 v110, v9, v103
v_cvt_pk_bf16_f32 v9, v103, v110
v_cvt_pk_bf16_f32 v103, v10, v10
v_lshlrev_b32 v103, 16, v103
v_sub_f32 v110, v10, v103
s_waitcnt lgkmcnt(1)
v_mfma_f32_16x16x32_bf16 v[24:27], v[160:163], v[248:251], 0
ds_read_b128 v[244:247], v3 offset:28672
v_cvt_pk_bf16_f32 v10, v103, v110
v_cvt_pk_bf16_f32 v103, v11, v11
v_lshlrev_b32 v103, 16, v103
v_sub_f32 v110, v11, v103
v_cvt_pk_bf16_f32 v11, v103, v110
v_cvt_pk_bf16_f32 v103, v12, v12
s_waitcnt lgkmcnt(1)
v_mfma_f32_16x16x32_bf16 v[28:31], v[160:163], v[240:243], 0
ds_read_b128 v[248:251], v3 offset:29696
v_lshlrev_b32 v103, 16, v103
v_sub_f32 v110, v12, v103
v_cvt_pk_bf16_f32 v12, v103, v110
v_cvt_pk_bf16_f32 v103, v13, v13
v_lshlrev_b32 v103, 16, v103
v_sub_f32 v110, v13, v103
s_waitcnt lgkmcnt(1)
v_mfma_f32_16x16x32_bf16 v[32:35], v[160:163], v[244:247], 0
ds_read_b128 v[240:243], v15 offset:26624
v_cvt_pk_bf16_f32 v13, v103, v110
v_add_u32 v101, s34, v2
v_mul_f32 v40, v40, v92
v_mul_f32 v46, v46, v93
v_mul_f32 v52, v52, v94
s_waitcnt lgkmcnt(1)
v_mfma_f32_16x16x32_bf16 v[36:39], v[160:163], v[248:251], 0
v_mul_f32 v58, v58, v95
ds_read_b128 v[244:247], v15 offset:27648
v_cvt_pk_bf16_f32 v104, v40, v46
v_cvt_pk_bf16_f32 v105, v52, v58
ds_write_b64 v101, v[104:105] offset:0
v_mul_f32 v41, v41, v92
v_mul_f32 v47, v47, v93
s_waitcnt lgkmcnt(2)
v_mfma_f32_16x16x32_bf16 v[160:163], v[240:243], v[112:115], 0
ds_read_b128 v[248:251], v15 offset:28672
v_mul_f32 v53, v53, v94
v_mul_f32 v59, v59, v95
v_cvt_pk_bf16_f32 v106, v41, v47
v_cvt_pk_bf16_f32 v107, v53, v59
ds_write_b64 v101, v[106:107] offset:1024
v_mul_f32 v42, v42, v92
s_waitcnt lgkmcnt(3)
v_mfma_f32_16x16x32_bf16 v[160:163], v[244:247], v[116:119], v[160:163]
ds_read_b128 v[240:243], v2 offset:63488
v_mul_f32 v48, v48, v93
v_mul_f32 v54, v54, v94
v_mul_f32 v60, v60, v95
v_cvt_pk_bf16_f32 v108, v42, v48
v_cvt_pk_bf16_f32 v109, v54, v60
ds_write_b64 v101, v[108:109] offset:2048
s_waitcnt lgkmcnt(3)
v_mfma_f32_16x16x32_bf16 v[160:163], v[248:251], v[120:123], v[160:163]
ds_read_b128 v[244:247], v2 offset:64512
v_mul_f32 v43, v43, v92
v_mul_f32 v49, v49, v93
v_mul_f32 v55, v55, v94
v_mul_f32 v61, v61, v95
v_cvt_pk_bf16_f32 v104, v43, v49
v_cvt_pk_bf16_f32 v105, v55, v61
s_waitcnt lgkmcnt(2)
v_mfma_f32_16x16x32_bf16 v[164:167], v[240:243], v[112:115], 0
ds_read_b128 v[248:251], v3 offset:8192
ds_write_b64 v101, v[104:105] offset:3072
v_mul_f32 v44, v44, v92
v_mul_f32 v50, v50, v93
v_mul_f32 v56, v56, v94
v_mul_f32 v62, v62, v95
v_cvt_pk_bf16_f32 v106, v44, v50
s_waitcnt lgkmcnt(2)
v_mfma_f32_16x16x32_bf16 v[164:167], v[244:247], v[116:119], v[164:167]
ds_read_b128 v[240:243], v3 offset:30720
v_cvt_pk_bf16_f32 v107, v56, v62
ds_write_b64 v101, v[106:107] offset:4096
v_mul_f32 v45, v45, v92
v_mul_f32 v51, v51, v93
v_mul_f32 v57, v57, v94
v_mul_f32 v63, v63, v95
s_waitcnt lgkmcnt(2)
v_mfma_f32_16x16x32_bf16 v[164:167], v[248:251], v[120:123], v[164:167]
s_setprio 2
ds_read_b128 v[244:247], v3 offset:31744
v_cvt_pk_bf16_f32 v108, v45, v51
v_cvt_pk_bf16_f32 v109, v57, v63
ds_write_b64 v101, v[108:109] offset:5120
s_waitcnt lgkmcnt(3)
v_mfma_f32_16x16x32_bf16 v[16:19], v[192:195], v[240:243], v[16:19]
ds_read_b128 v[248:251], v3 offset:32768
v_perm_b32 v196, v236, v232, s58
v_perm_b32 v197, v0, v252, s58
v_add_u32 v102, s37, v2
v_mfma_f32_16x16x32_bf16 v[40:43], v[200:203], v[240:243], 0
v_mov_b32 v198, v8
v_mul_f32 v64, v64, v96
s_nop 0
v_mfma_f32_16x16x32_bf16 v[16:19], v[228:231], v[196:199], v[16:19]
v_fmaak_f32 v224, v160, v160, 0x409d30fc
v_lshlrev_b32_sdwa v162, v6, v162 dst_sel:DWORD dst_unused:UNUSED_PAD src0_sel:DWORD src1_sel:WORD_1
v_mul_f32 v70, v70, v97
s_waitcnt lgkmcnt(1)
v_mfma_f32_16x16x32_bf16 v[20:23], v[192:195], v[244:247], v[20:23]
ds_read_b128 v[240:243], v3 offset:33792
ds_read_u16_d16 v162, v162
v_mul_f32 v76, v76, v98
v_perm_b32 v196, v236, v232, s59
v_perm_b32 v197, v0, v252, s59
v_mfma_f32_16x16x32_bf16 v[44:47], v[200:203], v[244:247], 0
v_mul_f32 v82, v82, v99
v_mov_b32 v198, v9
v_cvt_pk_bf16_f32 v104, v64, v70
s_nop 0
v_mfma_f32_16x16x32_bf16 v[20:23], v[228:231], v[196:199], v[20:23]
v_fmaak_f32 v225, v161, v161, 0x409d30fc
v_cvt_pk_bf16_f32 v105, v76, v82
s_waitcnt lgkmcnt(2)
v_mfma_f32_16x16x32_bf16 v[24:27], v[192:195], v[248:251], v[24:27]
ds_read_b128 v[244:247], v3 offset:34816
v_lshlrev_b32_sdwa v163, v6, v163 dst_sel:DWORD dst_unused:UNUSED_PAD src0_sel:DWORD src1_sel:WORD_1
v_perm_b32 v196, v237, v233, s58
ds_write_b64 v102, v[104:105] offset:0
v_perm_b32 v197, v1, v253, s58
v_mfma_f32_16x16x32_bf16 v[48:51], v[200:203], v[248:251], 0
ds_read_u16_d16_hi v163, v163
v_mul_f32 v224, v160, v224
v_mov_b32 v198, v10
v_mul_f32 v65, v65, v96
s_nop 0
v_mfma_f32_16x16x32_bf16 v[24:27], v[228:231], v[196:199], v[24:27]
v_mul_f32 v71, v71, v97
v_mul_f32 v77, v77, v98
s_waitcnt lgkmcnt(2)
v_mfma_f32_16x16x32_bf16 v[28:31], v[192:195], v[240:243], v[28:31]
ds_read_b128 v[248:251], v3 offset:35840
v_perm_b32 v196, v237, v233, s59
v_mul_f32 v83, v83, v99
v_perm_b32 v197, v1, v253, s59
v_mfma_f32_16x16x32_bf16 v[52:55], v[200:203], v[240:243], 0
v_lshlrev_b32_sdwa v164, v6, v164 dst_sel:DWORD dst_unused:UNUSED_PAD src0_sel:DWORD src1_sel:WORD_1
v_mov_b32 v198, v11
v_cvt_pk_bf16_f32 v106, v65, v71
s_nop 0
v_mfma_f32_16x16x32_bf16 v[28:31], v[228:231], v[196:199], v[28:31]
s_setprio 1
ds_read_u16_d16 v164, v164
v_mul_f32 v225, v161, v225
v_cvt_pk_bf16_f32 v107, v77, v83
ds_write_b64 v102, v[106:107] offset:1024
v_mfma_f32_16x16x32_bf16 v[32:35], v[192:195], v[244:247], v[32:35]
ds_read_b128 v[240:243], v15 offset:35840
v_perm_b32 v196, v238, v234, s58
v_perm_b32 v197, v235, v254, s58
v_mul_f32 v66, v66, v96
v_mfma_f32_16x16x32_bf16 v[56:59], v[200:203], v[244:247], 0
v_lshlrev_b32_sdwa v165, v6, v165 dst_sel:DWORD dst_unused:UNUSED_PAD src0_sel:DWORD src1_sel:WORD_1
v_mov_b32 v198, v12
v_mul_f32 v72, v72, v97
s_nop 0
v_mfma_f32_16x16x32_bf16 v[32:35], v[228:231], v[196:199], v[32:35]
ds_read_u16_d16_hi v165, v165
v_exp_f32 v224, v224
v_mul_f32 v78, v78, v98
s_waitcnt lgkmcnt(2)
v_mfma_f32_16x16x32_bf16 v[36:39], v[192:195], v[248:251], v[36:39]
ds_read_b128 v[244:247], v15 offset:36864
v_mul_f32 v84, v84, v99
v_perm_b32 v196, v238, v234, s59
v_perm_b32 v197, v235, v254, s59
v_mfma_f32_16x16x32_bf16 v[60:63], v[200:203], v[248:251], 0
v_cvt_pk_bf16_f32 v108, v66, v72
v_mov_b32 v198, v13
v_cvt_pk_bf16_f32 v109, v78, v84
s_nop 0
v_mfma_f32_16x16x32_bf16 v[36:39], v[228:231], v[196:199], v[36:39]
v_lshlrev_b32_sdwa v166, v6, v166 dst_sel:DWORD dst_unused:UNUSED_PAD src0_sel:DWORD src1_sel:WORD_1
ds_write_b64 v102, v[108:109] offset:2048
s_waitcnt lgkmcnt(2)
v_mfma_f32_16x16x32_bf16 v[192:195], v[240:243], v[112:115], 0
ds_read_b128 v[248:251], v15 offset:37888
ds_read_u16_d16 v166, v166
v_exp_f32 v225, v225
v_mul_f32 v67, v67, v96
v_mfma_f32_16x16x32_bf16 v[200:203], v[240:243], v[124:127], 0
v_mul_f32 v73, v73, v97
v_mul_f32 v79, v79, v98
v_mul_f32 v85, v85, v99
s_waitcnt lgkmcnt(3)
v_mfma_f32_16x16x32_bf16 v[192:195], v[244:247], v[116:119], v[192:195]
ds_read_b128 v[240:243], v3 offset:15360
v_lshlrev_b32_sdwa v167, v6, v167 dst_sel:DWORD dst_unused:UNUSED_PAD src0_sel:DWORD src1_sel:WORD_1
v_add_f32 v224, 1.0, v224
v_cvt_pk_bf16_f32 v104, v67, v73
s_add_u32 s3, s55, 98304
buffer_load_dwordx3 v[232:234], v5, s[4:7], s3 offen offset:0
v_mfma_f32_16x16x32_bf16 v[200:203], v[244:247], v[128:131], v[200:203]
ds_read_u16_d16_hi v167, v167
v_cvt_pk_bf16_f32 v105, v79, v85
ds_write_b64 v102, v[104:105] offset:3072
v_mul_f32 v68, v68, v96
s_waitcnt lgkmcnt(3)
v_mfma_f32_16x16x32_bf16 v[192:195], v[248:251], v[120:123], v[192:195]
ds_read_b128 v[244:247], v3 offset:16384
v_add_f32 v225, 1.0, v225
v_rcp_f32 v224, v224
v_mul_f32 v74, v74, v97
v_mfma_f32_16x16x32_bf16 v[200:203], v[248:251], v[132:135], v[200:203]
s_setprio 0
buffer_load_dwordx3 v[236:238], v5, s[4:7], s3 offen offset:768
v_mul_f32 v80, v80, v98
v_mul_f32 v86, v86, v99
v_cvt_pk_bf16_f32 v106, v68, v74
s_waitcnt lgkmcnt(1)
v_mfma_f32_16x16x32_bf16 v[196:199], v[240:243], v[112:115], 0
ds_read_b128 v[248:251], v3 offset:17408
v_rcp_f32 v225, v225
v_mfma_f32_16x16x32_bf16 v[204:207], v[240:243], v[124:127], 0
v_cvt_pk_bf16_f32 v107, v80, v86
ds_write_b64 v102, v[106:107] offset:4096
buffer_load_dwordx3 v[252:254], v5, s[4:7], s3 offen offset:1536
v_mul_f32 v69, v69, v96
s_waitcnt lgkmcnt(2)
v_mfma_f32_16x16x32_bf16 v[196:199], v[244:247], v[116:119], v[196:199]
ds_read_b128 v[240:243], v3 offset:36864
v_mul_f32 v224, v160, v224
v_mul_f32 v225, v161, v225
v_mul_f32 v75, v75, v97
v_mfma_f32_16x16x32_bf16 v[204:207], v[244:247], v[128:131], v[204:207]
v_mul_f32 v81, v81, v98
v_mul_f32 v87, v87, v99
buffer_load_dwordx2 v[0:1], v5, s[4:7], s3 offen offset:2304
buffer_load_dword v235, v5, s[4:7], s3 offen offset:2312
v_cvt_pk_bf16_f32 v108, v69, v75
s_waitcnt lgkmcnt(1)
v_mfma_f32_16x16x32_bf16 v[196:199], v[248:251], v[120:123], v[196:199]
ds_read_b128 v[244:247], v3 offset:37888
v_cvt_pk_bf16_f32 v160, v224, v225
v_cvt_pk_bf16_f32 v109, v81, v87
v_mfma_f32_16x16x32_bf16 v[204:207], v[248:251], v[132:135], v[204:207]
v_or_b32 v161, v162, v163
v_or_b32 v162, v164, v165
v_or_b32 v163, v166, v167
ds_write_b64 v102, v[108:109] offset:5120
s_waitcnt lgkmcnt(2)
v_mfma_f32_16x16x32_bf16 v[16:19], v[160:163], v[240:243], v[16:19]
ds_read_b128 v[248:251], v3 offset:38912
v_fmaak_f32 v226, v192, v192, 0x409d30fc
v_mfma_f32_16x16x32_bf16 v[40:43], v[168:171], v[240:243], v[40:43]
v_lshlrev_b32_sdwa v194, v6, v194 dst_sel:DWORD dst_unused:UNUSED_PAD src0_sel:DWORD src1_sel:WORD_1
v_fmaak_f32 v227, v193, v193, 0x409d30fc
v_mfma_f32_16x16x32_bf16 v[64:67], v[176:179], v[240:243], 0
ds_read_u16_d16 v194, v194
v_lshlrev_b32_sdwa v195, v6, v195 dst_sel:DWORD dst_unused:UNUSED_PAD src0_sel:DWORD src1_sel:WORD_1
s_waitcnt lgkmcnt(3)
v_mfma_f32_16x16x32_bf16 v[20:23], v[160:163], v[244:247], v[20:23]
ds_read_b128 v[240:243], v3 offset:39936
ds_read_u16_d16_hi v195, v195
v_mul_f32 v226, v192, v226
v_lshlrev_b32_sdwa v196, v6, v196 dst_sel:DWORD dst_unused:UNUSED_PAD src0_sel:DWORD src1_sel:WORD_1
v_mfma_f32_16x16x32_bf16 v[44:47], v[168:171], v[244:247], v[44:47]
ds_read_u16_d16 v196, v196
v_mul_f32 v227, v193, v227
v_mfma_f32_16x16x32_bf16 v[68:71], v[176:179], v[244:247], 0
s_setprio 3
v_lshlrev_b32_sdwa v197, v6, v197 dst_sel:DWORD dst_unused:UNUSED_PAD src0_sel:DWORD src1_sel:WORD_1
s_waitcnt lgkmcnt(3)
v_mfma_f32_16x16x32_bf16 v[24:27], v[160:163], v[248:251], v[24:27]
ds_read_b128 v[244:247], v3 offset:40960
ds_read_u16_d16_hi v197, v197
v_exp_f32 v226, v226
v_mfma_f32_16x16x32_bf16 v[48:51], v[168:171], v[248:251], v[48:51]
v_lshlrev_b32_sdwa v198, v6, v198 dst_sel:DWORD dst_unused:UNUSED_PAD src0_sel:DWORD src1_sel:WORD_1
v_mfma_f32_16x16x32_bf16 v[72:75], v[176:179], v[248:251], 0
ds_read_u16_d16 v198, v198
v_exp_f32 v227, v227
s_waitcnt lgkmcnt(3)
v_mfma_f32_16x16x32_bf16 v[28:31], v[160:163], v[240:243], v[28:31]
ds_read_b128 v[248:251], v3 offset:41984
v_lshlrev_b32_sdwa v199, v6, v199 dst_sel:DWORD dst_unused:UNUSED_PAD src0_sel:DWORD src1_sel:WORD_1
v_mfma_f32_16x16x32_bf16 v[52:55], v[168:171], v[240:243], v[52:55]
ds_read_u16_d16_hi v199, v199
v_add_f32 v226, 1.0, v226
v_add_f32 v227, 1.0, v227
v_mfma_f32_16x16x32_bf16 v[76:79], v[176:179], v[240:243], 0
v_rcp_f32 v226, v226
s_waitcnt lgkmcnt(3)
v_mfma_f32_16x16x32_bf16 v[32:35], v[160:163], v[244:247], v[32:35]
ds_read_b128 v[240:243], v14 offset:26624
v_mfma_f32_16x16x32_bf16 v[56:59], v[168:171], v[244:247], v[56:59]
v_rcp_f32 v227, v227
v_mfma_f32_16x16x32_bf16 v[80:83], v[176:179], v[244:247], 0
v_mul_f32 v226, v192, v226
v_mul_f32 v227, v193, v227
s_waitcnt lgkmcnt(2)
v_mfma_f32_16x16x32_bf16 v[36:39], v[160:163], v[248:251], v[36:39]
ds_read_b128 v[244:247], v14 offset:27648
v_fmaak_f32 v224, v200, v200, 0x409d30fc
v_mfma_f32_16x16x32_bf16 v[60:63], v[168:171], v[248:251], v[60:63]
v_lshlrev_b32_sdwa v202, v6, v202 dst_sel:DWORD dst_unused:UNUSED_PAD src0_sel:DWORD src1_sel:WORD_1
v_fmaak_f32 v225, v201, v201, 0x409d30fc
v_mfma_f32_16x16x32_bf16 v[84:87], v[176:179], v[248:251], 0
s_setprio 2
ds_read_u16_d16 v202, v202
v_lshlrev_b32_sdwa v203, v6, v203 dst_sel:DWORD dst_unused:UNUSED_PAD src0_sel:DWORD src1_sel:WORD_1
s_waitcnt lgkmcnt(2)
v_mfma_f32_16x16x32_bf16 v[160:163], v[240:243], v[112:115], 0
ds_read_b128 v[248:251], v14 offset:28672
ds_read_u16_d16_hi v203, v203
v_cvt_pk_bf16_f32 v192, v226, v227
v_mfma_f32_16x16x32_bf16 v[168:171], v[240:243], v[124:127], 0
v_mul_f32 v224, v200, v224
v_lshlrev_b32_sdwa v204, v6, v204 dst_sel:DWORD dst_unused:UNUSED_PAD src0_sel:DWORD src1_sel:WORD_1
v_mfma_f32_16x16x32_bf16 v[176:179], v[240:243], v[136:139], 0
ds_read_u16_d16 v204, v204
v_mul_f32 v225, v201, v225
s_waitcnt lgkmcnt(4)
v_mfma_f32_16x16x32_bf16 v[160:163], v[244:247], v[116:119], v[160:163]
ds_read_b128 v[240:243], v2 offset:14336
v_lshlrev_b32_sdwa v205, v6, v205 dst_sel:DWORD dst_unused:UNUSED_PAD src0_sel:DWORD src1_sel:WORD_1
v_or_b32 v193, v194, v195
s_waitcnt lgkmcnt(0)
s_barrier
v_mfma_f32_16x16x32_bf16 v[168:171], v[244:247], v[128:131], v[168:171]
ds_read_u16_d16_hi v205, v205
v_or_b32 v194, v196, v197
v_mfma_f32_16x16x32_bf16 v[176:179], v[244:247], v[140:143], v[176:179]
v_or_b32 v195, v198, v199
v_mfma_f32_16x16x32_bf16 v[160:163], v[248:251], v[120:123], v[160:163]
ds_read_b128 v[244:247], v2 offset:15360
v_exp_f32 v224, v224
v_mfma_f32_16x16x32_bf16 v[168:171], v[248:251], v[132:135], v[168:171]
v_lshlrev_b32_sdwa v206, v6, v206 dst_sel:DWORD dst_unused:UNUSED_PAD src0_sel:DWORD src1_sel:WORD_1
v_mfma_f32_16x16x32_bf16 v[176:179], v[248:251], v[144:147], v[176:179]
ds_read_u16_d16 v206, v206
v_exp_f32 v225, v225
v_mfma_f32_16x16x32_bf16 v[164:167], v[240:243], v[112:115], 0
ds_read_b128 v[248:251], v2 offset:16384
v_lshlrev_b32_sdwa v207, v6, v207 dst_sel:DWORD dst_unused:UNUSED_PAD src0_sel:DWORD src1_sel:WORD_1
v_mfma_f32_16x16x32_bf16 v[172:175], v[240:243], v[124:127], 0
ds_read_u16_d16_hi v207, v207
v_add_f32 v224, 1.0, v224
v_add_f32 v225, 1.0, v225
v_mfma_f32_16x16x32_bf16 v[180:183], v[240:243], v[136:139], 0
s_setprio 1
v_rcp_f32 v224, v224
s_waitcnt lgkmcnt(3)
v_mfma_f32_16x16x32_bf16 v[164:167], v[244:247], v[116:119], v[164:167]
ds_read_b128 v[240:243], v3 offset:43008
v_mfma_f32_16x16x32_bf16 v[172:175], v[244:247], v[128:131], v[172:175]
v_rcp_f32 v225, v225
v_mfma_f32_16x16x32_bf16 v[180:183], v[244:247], v[140:143], v[180:183]
v_mul_f32 v224, v200, v224
v_mul_f32 v225, v201, v225
s_waitcnt lgkmcnt(1)
v_mfma_f32_16x16x32_bf16 v[164:167], v[248:251], v[120:123], v[164:167]
ds_read_b128 v[244:247], v3 offset:44032
v_cvt_pk_bf16_f32 v200, v224, v225
v_mfma_f32_16x16x32_bf16 v[172:175], v[248:251], v[132:135], v[172:175]
v_or_b32 v201, v202, v203
v_or_b32 v202, v204, v205
v_mfma_f32_16x16x32_bf16 v[180:183], v[248:251], v[144:147], v[180:183]
v_or_b32 v203, v206, v207
s_waitcnt lgkmcnt(1)
v_mfma_f32_16x16x32_bf16 v[16:19], v[192:195], v[240:243], v[16:19]
ds_read_b128 v[248:251], v3 offset:45056
v_fmaak_f32 v226, v162, v162, 0x409d30fc
v_lshlrev_b32_sdwa v160, v6, v160 dst_sel:DWORD dst_unused:UNUSED_PAD src0_sel:DWORD src1_sel:WORD_1
v_mfma_f32_16x16x32_bf16 v[40:43], v[200:203], v[240:243], v[40:43]
ds_read_u16_d16 v160, v160
v_fmaak_f32 v227, v163, v163, 0x409d30fc
v_mfma_f32_16x16x32_bf16 v[64:67], v[208:211], v[240:243], v[64:67]
v_lshlrev_b32_sdwa v161, v6, v161 dst_sel:DWORD dst_unused:UNUSED_PAD src0_sel:DWORD src1_sel:WORD_1
v_mul_f32 v226, v162, v226
v_mfma_f32_16x16x32_bf16 v[88:91], v[216:219], v[240:243], 0
ds_read_u16_d16_hi v161, v161
v_lshlrev_b32_sdwa v164, v6, v164 dst_sel:DWORD dst_unused:UNUSED_PAD src0_sel:DWORD src1_sel:WORD_1
v_mul_f32 v227, v163, v227
s_waitcnt lgkmcnt(2)
v_mfma_f32_16x16x32_bf16 v[20:23], v[192:195], v[244:247], v[20:23]
ds_read_b128 v[240:243], v3 offset:46080
ds_read_u16_d16 v164, v164
v_lshlrev_b32_sdwa v165, v6, v165 dst_sel:DWORD dst_unused:UNUSED_PAD src0_sel:DWORD src1_sel:WORD_1
v_mfma_f32_16x16x32_bf16 v[44:47], v[200:203], v[244:247], v[44:47]
s_setprio 0
ds_read_u16_d16_hi v165, v165
v_exp_f32 v226, v226
v_mfma_f32_16x16x32_bf16 v[68:71], v[208:211], v[244:247], v[68:71]
v_lshlrev_b32_sdwa v166, v6, v166 dst_sel:DWORD dst_unused:UNUSED_PAD src0_sel:DWORD src1_sel:WORD_1
v_mfma_f32_16x16x32_bf16 v[92:95], v[216:219], v[244:247], 0
ds_read_u16_d16 v166, v166
v_exp_f32 v227, v227
v_mfma_f32_16x16x32_bf16 v[24:27], v[192:195], v[248:251], v[24:27]
ds_read_b128 v[244:247], v3 offset:47104
v_lshlrev_b32_sdwa v167, v6, v167 dst_sel:DWORD dst_unused:UNUSED_PAD src0_sel:DWORD src1_sel:WORD_1
v_add_f32 v226, 1.0, v226
v_mfma_f32_16x16x32_bf16 v[48:51], v[200:203], v[248:251], v[48:51]
ds_read_u16_d16_hi v167, v167
v_add_f32 v227, 1.0, v227
v_mfma_f32_16x16x32_bf16 v[72:75], v[208:211], v[248:251], v[72:75]
v_rcp_f32 v226, v226
v_mfma_f32_16x16x32_bf16 v[96:99], v[216:219], v[248:251], 0
v_rcp_f32 v227, v227
s_waitcnt lgkmcnt(2)
v_mfma_f32_16x16x32_bf16 v[28:31], v[192:195], v[240:243], v[28:31]
ds_read_b128 v[248:251], v3 offset:48128
v_mul_f32 v226, v162, v226
v_mfma_f32_16x16x32_bf16 v[52:55], v[200:203], v[240:243], v[52:55]
v_mul_f32 v227, v163, v227
v_fmaak_f32 v224, v170, v170, 0x409d30fc
v_mfma_f32_16x16x32_bf16 v[76:79], v[208:211], v[240:243], v[76:79]
v_lshlrev_b32_sdwa v168, v6, v168 dst_sel:DWORD dst_unused:UNUSED_PAD src0_sel:DWORD src1_sel:WORD_1
v_mfma_f32_16x16x32_bf16 v[100:103], v[216:219], v[240:243], 0
ds_read_u16_d16 v168, v168
v_fmaak_f32 v225, v171, v171, 0x409d30fc
v_lshlrev_b32_sdwa v169, v6, v169 dst_sel:DWORD dst_unused:UNUSED_PAD src0_sel:DWORD src1_sel:WORD_1
s_waitcnt lgkmcnt(2)
v_mfma_f32_16x16x32_bf16 v[32:35], v[192:195], v[244:247], v[32:35]
ds_read_b128 v[240:243], v14 offset:35840
ds_read_u16_d16_hi v169, v169
v_mul_f32 v224, v170, v224
v_lshlrev_b32_sdwa v172, v6, v172 dst_sel:DWORD dst_unused:UNUSED_PAD src0_sel:DWORD src1_sel:WORD_1
v_mfma_f32_16x16x32_bf16 v[56:59], v[200:203], v[244:247], v[56:59]
s_setprio 3
ds_read_u16_d16 v172, v172
v_mul_f32 v225, v171, v225
v_mfma_f32_16x16x32_bf16 v[80:83], v[208:211], v[244:247], v[80:83]
v_lshlrev_b32_sdwa v173, v6, v173 dst_sel:DWORD dst_unused:UNUSED_PAD src0_sel:DWORD src1_sel:WORD_1
v_or_b32 v160, v160, v161
v_mfma_f32_16x16x32_bf16 v[104:107], v[216:219], v[244:247], 0
ds_read_u16_d16_hi v173, v173
v_cvt_pk_bf16_f32 v161, v226, v227
v_or_b32 v162, v164, v165
s_waitcnt lgkmcnt(2)
v_mfma_f32_16x16x32_bf16 v[36:39], v[192:195], v[248:251], v[36:39]
ds_read_b128 v[244:247], v14 offset:36864
v_or_b32 v163, v166, v167
v_mfma_f32_16x16x32_bf16 v[60:63], v[200:203], v[248:251], v[60:63]
v_exp_f32 v224, v224
v_mfma_f32_16x16x32_bf16 v[84:87], v[208:211], v[248:251], v[84:87]
v_lshlrev_b32_sdwa v174, v6, v174 dst_sel:DWORD dst_unused:UNUSED_PAD src0_sel:DWORD src1_sel:WORD_1
v_mfma_f32_16x16x32_bf16 v[108:111], v[216:219], v[248:251], 0
ds_read_u16_d16 v174, v174
v_exp_f32 v225, v225
v_mfma_f32_16x16x32_bf16 v[192:195], v[240:243], v[112:115], 0
ds_read_b128 v[248:251], v14 offset:37888
v_lshlrev_b32_sdwa v175, v6, v175 dst_sel:DWORD dst_unused:UNUSED_PAD src0_sel:DWORD src1_sel:WORD_1
v_add_f32 v224, 1.0, v224
v_mfma_f32_16x16x32_bf16 v[200:203], v[240:243], v[124:127], 0
ds_read_u16_d16_hi v175, v175
v_add_f32 v225, 1.0, v225
v_mfma_f32_16x16x32_bf16 v[208:211], v[240:243], v[136:139], 0
v_rcp_f32 v224, v224
v_mfma_f32_16x16x32_bf16 v[216:219], v[240:243], v[148:151], 0
v_rcp_f32 v225, v225
s_waitcnt lgkmcnt(2)
v_mfma_f32_16x16x32_bf16 v[192:195], v[244:247], v[116:119], v[192:195]
ds_read_b128 v[240:243], v2 offset:23552
v_mul_f32 v224, v170, v224
v_mfma_f32_16x16x32_bf16 v[200:203], v[244:247], v[128:131], v[200:203]
s_setprio 2
v_mul_f32 v225, v171, v225
v_fmaak_f32 v226, v178, v178, 0x409d30fc
v_mfma_f32_16x16x32_bf16 v[208:211], v[244:247], v[140:143], v[208:211]
v_lshlrev_b32_sdwa v176, v6, v176 dst_sel:DWORD dst_unused:UNUSED_PAD src0_sel:DWORD src1_sel:WORD_1
v_mfma_f32_16x16x32_bf16 v[216:219], v[244:247], v[152:155], v[216:219]
ds_read_u16_d16 v176, v176
v_fmaak_f32 v227, v179, v179, 0x409d30fc
v_lshlrev_b32_sdwa v177, v6, v177 dst_sel:DWORD dst_unused:UNUSED_PAD src0_sel:DWORD src1_sel:WORD_1
s_waitcnt lgkmcnt(2)
v_mfma_f32_16x16x32_bf16 v[192:195], v[248:251], v[120:123], v[192:195]
ds_read_b128 v[244:247], v2 offset:24576
ds_read_u16_d16_hi v177, v177
v_mul_f32 v226, v178, v226
v_lshlrev_b32_sdwa v180, v6, v180 dst_sel:DWORD dst_unused:UNUSED_PAD src0_sel:DWORD src1_sel:WORD_1
v_mfma_f32_16x16x32_bf16 v[200:203], v[248:251], v[132:135], v[200:203]
ds_read_u16_d16 v180, v180
v_mul_f32 v227, v179, v227
v_mfma_f32_16x16x32_bf16 v[208:211], v[248:251], v[144:147], v[208:211]
v_lshlrev_b32_sdwa v181, v6, v181 dst_sel:DWORD dst_unused:UNUSED_PAD src0_sel:DWORD src1_sel:WORD_1
v_or_b32 v168, v168, v169
v_mfma_f32_16x16x32_bf16 v[216:219], v[248:251], v[156:159], v[216:219]
ds_read_u16_d16_hi v181, v181
v_cvt_pk_bf16_f32 v169, v224, v225
v_or_b32 v170, v172, v173
s_waitcnt lgkmcnt(2)
v_mfma_f32_16x16x32_bf16 v[196:199], v[240:243], v[112:115], 0
ds_read_b128 v[248:251], v2 offset:25600
v_or_b32 v171, v174, v175
v_mfma_f32_16x16x32_bf16 v[204:207], v[240:243], v[124:127], 0
v_exp_f32 v226, v226
v_mfma_f32_16x16x32_bf16 v[212:215], v[240:243], v[136:139], 0
v_lshlrev_b32_sdwa v182, v6, v182 dst_sel:DWORD dst_unused:UNUSED_PAD src0_sel:DWORD src1_sel:WORD_1
v_mfma_f32_16x16x32_bf16 v[220:223], v[240:243], v[148:151], 0
ds_read_u16_d16 v182, v182
v_exp_f32 v227, v227
v_mfma_f32_16x16x32_bf16 v[196:199], v[244:247], v[116:119], v[196:199]
ds_read_b128 v[240:243], v3 offset:49152
v_lshlrev_b32_sdwa v183, v6, v183 dst_sel:DWORD dst_unused:UNUSED_PAD src0_sel:DWORD src1_sel:WORD_1
v_add_f32 v226, 1.0, v226
v_mfma_f32_16x16x32_bf16 v[204:207], v[244:247], v[128:131], v[204:207]
s_setprio 1
ds_read_u16_d16_hi v183, v183
v_add_f32 v227, 1.0, v227
v_mfma_f32_16x16x32_bf16 v[212:215], v[244:247], v[140:143], v[212:215]
v_rcp_f32 v226, v226
v_mfma_f32_16x16x32_bf16 v[220:223], v[244:247], v[152:155], v[220:223]
v_rcp_f32 v227, v227
s_waitcnt lgkmcnt(2)
v_mfma_f32_16x16x32_bf16 v[196:199], v[248:251], v[120:123], v[196:199]
ds_read_b128 v[244:247], v3 offset:50176
v_mul_f32 v226, v178, v226
v_mfma_f32_16x16x32_bf16 v[204:207], v[248:251], v[132:135], v[204:207]
v_mul_f32 v227, v179, v227
v_or_b32 v176, v176, v177
v_mfma_f32_16x16x32_bf16 v[212:215], v[248:251], v[144:147], v[212:215]
v_cvt_pk_bf16_f32 v177, v226, v227
v_mfma_f32_16x16x32_bf16 v[220:223], v[248:251], v[156:159], v[220:223]
v_or_b32 v178, v180, v181
s_waitcnt lgkmcnt(1)
v_or_b32 v179, v182, v183
v_mfma_f32_16x16x32_bf16 v[16:19], v[160:163], v[240:243], v[16:19]
ds_read_b128 v[248:251], v3 offset:51200
v_fmaak_f32 v224, v194, v194, 0x409d30fc
v_lshlrev_b32_sdwa v192, v6, v192 dst_sel:DWORD dst_unused:UNUSED_PAD src0_sel:DWORD src1_sel:WORD_1
v_mfma_f32_16x16x32_bf16 v[40:43], v[168:171], v[240:243], v[40:43]
ds_read_u16_d16 v192, v192
v_fmaak_f32 v225, v195, v195, 0x409d30fc
s_waitcnt vmcnt(3)
v_perm_b32 v172, v236, v232, s58
s_waitcnt vmcnt(1)
v_perm_b32 v173, v0, v252, s58
v_mfma_f32_16x16x32_bf16 v[64:67], v[176:179], v[240:243], v[64:67]
v_lshlrev_b32_sdwa v193, v6, v193 dst_sel:DWORD dst_unused:UNUSED_PAD src0_sel:DWORD src1_sel:WORD_1
v_mov_b32 v174, v8
v_mfma_f32_16x16x32_bf16 v[88:91], v[184:187], v[240:243], v[88:91]
ds_read_u16_d16_hi v193, v193
v_mul_f32 v224, v194, v224
v_lshlrev_b32_sdwa v196, v6, v196 dst_sel:DWORD dst_unused:UNUSED_PAD src0_sel:DWORD src1_sel:WORD_1
v_mfma_f32_16x16x32_bf16 v[40:43], v[228:231], v[172:175], v[40:43]
ds_read_u16_d16 v196, v196
v_mul_f32 v225, v195, v225
v_lshlrev_b32_sdwa v197, v6, v197 dst_sel:DWORD dst_unused:UNUSED_PAD src0_sel:DWORD src1_sel:WORD_1
s_waitcnt lgkmcnt(2)
v_mfma_f32_16x16x32_bf16 v[20:23], v[160:163], v[244:247], v[20:23]
s_setprio 0
ds_read_b128 v[240:243], v3 offset:52224
ds_read_u16_d16_hi v197, v197
v_exp_f32 v224, v224
v_lshlrev_b32_sdwa v198, v6, v198 dst_sel:DWORD dst_unused:UNUSED_PAD src0_sel:DWORD src1_sel:WORD_1
v_mfma_f32_16x16x32_bf16 v[44:47], v[168:171], v[244:247], v[44:47]
ds_read_u16_d16 v198, v198
v_perm_b32 v172, v236, v232, s59
v_perm_b32 v173, v0, v252, s59
v_mfma_f32_16x16x32_bf16 v[68:71], v[176:179], v[244:247], v[68:71]
v_exp_f32 v225, v225
v_mov_b32 v174, v9
v_mfma_f32_16x16x32_bf16 v[92:95], v[184:187], v[244:247], v[92:95]
v_lshlrev_b32_sdwa v199, v6, v199 dst_sel:DWORD dst_unused:UNUSED_PAD src0_sel:DWORD src1_sel:WORD_1
v_mfma_f32_16x16x32_bf16 v[44:47], v[228:231], v[172:175], v[44:47]
ds_read_u16_d16_hi v199, v199
v_add_f32 v224, 1.0, v224
v_add_f32 v225, 1.0, v225
v_mfma_f32_16x16x32_bf16 v[24:27], v[160:163], v[248:251], v[24:27]
ds_read_b128 v[244:247], v3 offset:53248
v_rcp_f32 v224, v224
v_mfma_f32_16x16x32_bf16 v[48:51], v[168:171], v[248:251], v[48:51]
v_rcp_f32 v225, v225
v_perm_b32 v172, v237, v233, s58
v_perm_b32 v173, v1, v253, s58
v_mfma_f32_16x16x32_bf16 v[72:75], v[176:179], v[248:251], v[72:75]
v_mov_b32 v174, v10
v_mfma_f32_16x16x32_bf16 v[96:99], v[184:187], v[248:251], v[96:99]
v_mul_f32 v224, v194, v224
v_mul_f32 v225, v195, v225
v_fmaak_f32 v226, v202, v202, 0x409d30fc
v_mfma_f32_16x16x32_bf16 v[48:51], v[228:231], v[172:175], v[48:51]
v_lshlrev_b32_sdwa v200, v6, v200 dst_sel:DWORD dst_unused:UNUSED_PAD src0_sel:DWORD src1_sel:WORD_1
v_fmaak_f32 v227, v203, v203, 0x409d30fc
s_waitcnt lgkmcnt(0)
v_mfma_f32_16x16x32_bf16 v[28:31], v[160:163], v[240:243], v[28:31]
ds_read_b128 v[248:251], v3 offset:54272
ds_read_u16_d16 v200, v200
v_lshlrev_b32_sdwa v201, v6, v201 dst_sel:DWORD dst_unused:UNUSED_PAD src0_sel:DWORD src1_sel:WORD_1
v_mul_f32 v226, v202, v226
v_mfma_f32_16x16x32_bf16 v[52:55], v[168:171], v[240:243], v[52:55]
ds_read_u16_d16_hi v201, v201
v_perm_b32 v172, v237, v233, s59
v_perm_b32 v173, v1, v253, s59
v_mfma_f32_16x16x32_bf16 v[76:79], v[176:179], v[240:243], v[76:79]
s_setprio 3
v_lshlrev_b32_sdwa v204, v6, v204 dst_sel:DWORD dst_unused:UNUSED_PAD src0_sel:DWORD src1_sel:WORD_1
v_mul_f32 v227, v203, v227
v_mov_b32 v174, v11
v_mfma_f32_16x16x32_bf16 v[100:103], v[184:187], v[240:243], v[100:103]
ds_read_u16_d16 v204, v204
v_lshlrev_b32_sdwa v205, v6, v205 dst_sel:DWORD dst_unused:UNUSED_PAD src0_sel:DWORD src1_sel:WORD_1
v_or_b32 v192, v192, v193
v_mfma_f32_16x16x32_bf16 v[52:55], v[228:231], v[172:175], v[52:55]
ds_read_u16_d16_hi v205, v205
v_cvt_pk_bf16_f32 v193, v224, v225
v_or_b32 v194, v196, v197
v_mfma_f32_16x16x32_bf16 v[32:35], v[160:163], v[244:247], v[32:35]
ds_read_b128 v[240:243], v15 offset:45056
v_or_b32 v195, v198, v199
v_exp_f32 v226, v226
v_mfma_f32_16x16x32_bf16 v[56:59], v[168:171], v[244:247], v[56:59]
v_perm_b32 v172, v238, v234, s58
s_waitcnt vmcnt(0)
v_perm_b32 v173, v235, v254, s58
v_mfma_f32_16x16x32_bf16 v[80:83], v[176:179], v[244:247], v[80:83]
v_lshlrev_b32_sdwa v206, v6, v206 dst_sel:DWORD dst_unused:UNUSED_PAD src0_sel:DWORD src1_sel:WORD_1
v_mov_b32 v174, v12
v_mfma_f32_16x16x32_bf16 v[104:107], v[184:187], v[244:247], v[104:107]
ds_read_u16_d16 v206, v206
v_exp_f32 v227, v227
v_mfma_f32_16x16x32_bf16 v[56:59], v[228:231], v[172:175], v[56:59]
v_lshlrev_b32_sdwa v207, v6, v207 dst_sel:DWORD dst_unused:UNUSED_PAD src0_sel:DWORD src1_sel:WORD_1
v_add_f32 v226, 1.0, v226
s_waitcnt lgkmcnt(1)
v_mfma_f32_16x16x32_bf16 v[36:39], v[160:163], v[248:251], v[36:39]
ds_read_b128 v[244:247], v15 offset:46080
ds_read_u16_d16_hi v207, v207
v_add_f32 v227, 1.0, v227
v_rcp_f32 v226, v226
v_mfma_f32_16x16x32_bf16 v[60:63], v[168:171], v[248:251], v[60:63]
v_perm_b32 v172, v238, v234, s59
v_perm_b32 v173, v235, v254, s59
v_mfma_f32_16x16x32_bf16 v[84:87], v[176:179], v[248:251], v[84:87]
v_rcp_f32 v227, v227
v_mov_b32 v174, v13
v_mfma_f32_16x16x32_bf16 v[108:111], v[184:187], v[248:251], v[108:111]
v_mul_f32 v226, v202, v226
v_mul_f32 v227, v203, v227
v_mfma_f32_16x16x32_bf16 v[60:63], v[228:231], v[172:175], v[60:63]
s_setprio 2
v_fmaak_f32 v224, v210, v210, 0x409d30fc
v_lshlrev_b32_sdwa v208, v6, v208 dst_sel:DWORD dst_unused:UNUSED_PAD src0_sel:DWORD src1_sel:WORD_1
v_mfma_f32_16x16x32_bf16 v[160:163], v[240:243], v[112:115], 0
ds_read_b128 v[248:251], v15 offset:47104
ds_read_u16_d16 v208, v208
v_fmaak_f32 v225, v211, v211, 0x409d30fc
v_lshlrev_b32_sdwa v209, v6, v209 dst_sel:DWORD dst_unused:UNUSED_PAD src0_sel:DWORD src1_sel:WORD_1
v_mfma_f32_16x16x32_bf16 v[168:171], v[240:243], v[124:127], 0
ds_read_u16_d16_hi v209, v209
v_mul_f32 v224, v210, v224
v_lshlrev_b32_sdwa v212, v6, v212 dst_sel:DWORD dst_unused:UNUSED_PAD src0_sel:DWORD src1_sel:WORD_1
v_mfma_f32_16x16x32_bf16 v[176:179], v[240:243], v[136:139], 0
ds_read_u16_d16 v212, v212
v_mul_f32 v225, v211, v225
v_lshlrev_b32_sdwa v213, v6, v213 dst_sel:DWORD dst_unused:UNUSED_PAD src0_sel:DWORD src1_sel:WORD_1
v_or_b32 v200, v200, v201
v_mfma_f32_16x16x32_bf16 v[184:187], v[240:243], v[148:151], 0
ds_read_u16_d16_hi v213, v213
v_cvt_pk_bf16_f32 v201, v226, v227
v_or_b32 v202, v204, v205
s_waitcnt lgkmcnt(3)
v_mfma_f32_16x16x32_bf16 v[160:163], v[244:247], v[116:119], v[160:163]
ds_read_b128 v[240:243], v3 offset:9216
v_or_b32 v203, v206, v207
v_exp_f32 v224, v224
s_add_u32 s3, s54, 0
buffer_load_dwordx3 v[232:234], v5, s[4:7], s3 offen offset:0
v_mfma_f32_16x16x32_bf16 v[168:171], v[244:247], v[128:131], v[168:171]
v_lshlrev_b32_sdwa v214, v6, v214 dst_sel:DWORD dst_unused:UNUSED_PAD src0_sel:DWORD src1_sel:WORD_1
v_mfma_f32_16x16x32_bf16 v[176:179], v[244:247], v[140:143], v[176:179]
ds_read_u16_d16 v214, v214
v_exp_f32 v225, v225
v_lshlrev_b32_sdwa v215, v6, v215 dst_sel:DWORD dst_unused:UNUSED_PAD src0_sel:DWORD src1_sel:WORD_1
v_mfma_f32_16x16x32_bf16 v[184:187], v[244:247], v[152:155], v[184:187]
ds_read_u16_d16_hi v215, v215
v_add_f32 v224, 1.0, v224
v_add_f32 v225, 1.0, v225
v_mfma_f32_16x16x32_bf16 v[160:163], v[248:251], v[120:123], v[160:163]
ds_read_b128 v[244:247], v3 offset:10240
v_rcp_f32 v224, v224
v_mfma_f32_16x16x32_bf16 v[168:171], v[248:251], v[132:135], v[168:171]
v_rcp_f32 v225, v225
buffer_load_dwordx3 v[236:238], v5, s[4:7], s3 offen offset:768
v_mfma_f32_16x16x32_bf16 v[176:179], v[248:251], v[144:147], v[176:179]
v_mul_f32 v224, v210, v224
v_mul_f32 v225, v211, v225
v_fmaak_f32 v226, v218, v218, 0x409d30fc
v_mfma_f32_16x16x32_bf16 v[184:187], v[248:251], v[156:159], v[184:187]
s_setprio 1
v_lshlrev_b32_sdwa v216, v6, v216 dst_sel:DWORD dst_unused:UNUSED_PAD src0_sel:DWORD src1_sel:WORD_1
v_fmaak_f32 v227, v219, v219, 0x409d30fc
s_waitcnt lgkmcnt(0)
v_mfma_f32_16x16x32_bf16 v[164:167], v[240:243], v[112:115], 0
ds_read_b128 v[248:251], v3 offset:11264
ds_read_u16_d16 v216, v216
v_lshlrev_b32_sdwa v217, v6, v217 dst_sel:DWORD dst_unused:UNUSED_PAD src0_sel:DWORD src1_sel:WORD_1
v_mul_f32 v226, v218, v226
v_mfma_f32_16x16x32_bf16 v[172:175], v[240:243], v[124:127], 0
ds_read_u16_d16_hi v217, v217
v_lshlrev_b32_sdwa v220, v6, v220 dst_sel:DWORD dst_unused:UNUSED_PAD src0_sel:DWORD src1_sel:WORD_1
v_mul_f32 v227, v219, v227
v_mfma_f32_16x16x32_bf16 v[180:183], v[240:243], v[136:139], 0
ds_read_u16_d16 v220, v220
v_lshlrev_b32_sdwa v221, v6, v221 dst_sel:DWORD dst_unused:UNUSED_PAD src0_sel:DWORD src1_sel:WORD_1
v_or_b32 v208, v208, v209
v_cvt_pk_bf16_f32 v209, v224, v225
buffer_load_dwordx3 v[252:254], v5, s[4:7], s3 offen offset:1536
v_mfma_f32_16x16x32_bf16 v[188:191], v[240:243], v[148:151], 0
ds_read_u16_d16_hi v221, v221
v_or_b32 v210, v212, v213
v_or_b32 v211, v214, v215
v_mfma_f32_16x16x32_bf16 v[164:167], v[244:247], v[116:119], v[164:167]
ds_read_b128 v[240:243], v3 offset:55296
v_exp_f32 v226, v226
v_mfma_f32_16x16x32_bf16 v[172:175], v[244:247], v[128:131], v[172:175]
v_lshlrev_b32_sdwa v222, v6, v222 dst_sel:DWORD dst_unused:UNUSED_PAD src0_sel:DWORD src1_sel:WORD_1
v_exp_f32 v227, v227
v_mfma_f32_16x16x32_bf16 v[180:183], v[244:247], v[140:143], v[180:183]
ds_read_u16_d16 v222, v222
v_lshlrev_b32_sdwa v223, v6, v223 dst_sel:DWORD dst_unused:UNUSED_PAD src0_sel:DWORD src1_sel:WORD_1
v_add_f32 v226, 1.0, v226
v_mfma_f32_16x16x32_bf16 v[188:191], v[244:247], v[152:155], v[188:191]
ds_read_u16_d16_hi v223, v223
v_add_f32 v227, 1.0, v227
buffer_load_dwordx2 v[0:1], v5, s[4:7], s3 offen offset:2304
buffer_load_dword v235, v5, s[4:7], s3 offen offset:2312
s_waitcnt lgkmcnt(2)
v_mfma_f32_16x16x32_bf16 v[164:167], v[248:251], v[120:123], v[164:167]
ds_read_b128 v[244:247], v3 offset:56320
v_rcp_f32 v226, v226
v_rcp_f32 v227, v227
v_mfma_f32_16x16x32_bf16 v[172:175], v[248:251], v[132:135], v[172:175]
v_mul_f32 v226, v218, v226
v_mfma_f32_16x16x32_bf16 v[180:183], v[248:251], v[144:147], v[180:183]
v_mul_f32 v227, v219, v227
v_or_b32 v216, v216, v217
v_cvt_pk_bf16_f32 v217, v226, v227
v_mfma_f32_16x16x32_bf16 v[188:191], v[248:251], v[156:159], v[188:191]
s_setprio 0
v_or_b32 v218, v220, v221
s_waitcnt lgkmcnt(1)
v_or_b32 v219, v222, v223
v_mfma_f32_16x16x32_bf16 v[16:19], v[192:195], v[240:243], v[16:19]
ds_read_b128 v[248:251], v3 offset:57344
v_fmaak_f32 v224, v160, v160, 0x409d30fc
v_lshlrev_b32_sdwa v162, v6, v162 dst_sel:DWORD dst_unused:UNUSED_PAD src0_sel:DWORD src1_sel:WORD_1
v_mfma_f32_16x16x32_bf16 v[40:43], v[200:203], v[240:243], v[40:43]
ds_read_u16_d16 v162, v162
v_fmaak_f32 v225, v161, v161, 0x409d30fc
v_lshlrev_b32_sdwa v163, v6, v163 dst_sel:DWORD dst_unused:UNUSED_PAD src0_sel:DWORD src1_sel:WORD_1
v_mfma_f32_16x16x32_bf16 v[64:67], v[208:211], v[240:243], v[64:67]
ds_read_u16_d16_hi v163, v163
v_mul_f32 v224, v160, v224
v_lshlrev_b32_sdwa v164, v6, v164 dst_sel:DWORD dst_unused:UNUSED_PAD src0_sel:DWORD src1_sel:WORD_1
v_mul_f32 v225, v161, v225
v_mfma_f32_16x16x32_bf16 v[88:91], v[216:219], v[240:243], v[88:91]
ds_read_u16_d16 v164, v164
v_lshlrev_b32_sdwa v165, v6, v165 dst_sel:DWORD dst_unused:UNUSED_PAD src0_sel:DWORD src1_sel:WORD_1
s_waitcnt lgkmcnt(3)
v_mfma_f32_16x16x32_bf16 v[20:23], v[192:195], v[244:247], v[20:23]
ds_read_b128 v[240:243], v3 offset:58368
ds_read_u16_d16_hi v165, v165
v_exp_f32 v224, v224
v_lshlrev_b32_sdwa v166, v6, v166 dst_sel:DWORD dst_unused:UNUSED_PAD src0_sel:DWORD src1_sel:WORD_1
v_mfma_f32_16x16x32_bf16 v[44:47], v[200:203], v[244:247], v[44:47]
ds_read_u16_d16 v166, v166
v_exp_f32 v225, v225
v_mfma_f32_16x16x32_bf16 v[68:71], v[208:211], v[244:247], v[68:71]
v_lshlrev_b32_sdwa v167, v6, v167 dst_sel:DWORD dst_unused:UNUSED_PAD src0_sel:DWORD src1_sel:WORD_1
v_add_f32 v224, 1.0, v224
v_mfma_f32_16x16x32_bf16 v[92:95], v[216:219], v[244:247], v[92:95]
ds_read_u16_d16_hi v167, v167
v_add_f32 v225, 1.0, v225
v_rcp_f32 v224, v224
v_mfma_f32_16x16x32_bf16 v[24:27], v[192:195], v[248:251], v[24:27]
ds_read_b128 v[244:247], v3 offset:59392
v_rcp_f32 v225, v225
v_mfma_f32_16x16x32_bf16 v[48:51], v[200:203], v[248:251], v[48:51]
v_mul_f32 v224, v160, v224
v_mul_f32 v225, v161, v225
v_mfma_f32_16x16x32_bf16 v[72:75], v[208:211], v[248:251], v[72:75]
v_fmaak_f32 v226, v168, v168, 0x409d30fc
v_lshlrev_b32_sdwa v170, v6, v170 dst_sel:DWORD dst_unused:UNUSED_PAD src0_sel:DWORD src1_sel:WORD_1
v_mfma_f32_16x16x32_bf16 v[96:99], v[216:219], v[248:251], v[96:99]
s_setprio 3
ds_read_u16_d16 v170, v170
v_fmaak_f32 v227, v169, v169, 0x409d30fc
v_lshlrev_b32_sdwa v171, v6, v171 dst_sel:DWORD dst_unused:UNUSED_PAD src0_sel:DWORD src1_sel:WORD_1
s_waitcnt lgkmcnt(1)
v_mfma_f32_16x16x32_bf16 v[28:31], v[192:195], v[240:243], v[28:31]
ds_read_b128 v[248:251], v3 offset:60416
ds_read_u16_d16_hi v171, v171
v_cvt_pk_bf16_f32 v160, v224, v225
v_mul_f32 v226, v168, v226
v_mfma_f32_16x16x32_bf16 v[52:55], v[200:203], v[240:243], v[52:55]
v_lshlrev_b32_sdwa v172, v6, v172 dst_sel:DWORD dst_unused:UNUSED_PAD src0_sel:DWORD src1_sel:WORD_1
v_mul_f32 v227, v169, v227
v_mfma_f32_16x16x32_bf16 v[76:79], v[208:211], v[240:243], v[76:79]
ds_read_u16_d16 v172, v172
v_lshlrev_b32_sdwa v173, v6, v173 dst_sel:DWORD dst_unused:UNUSED_PAD src0_sel:DWORD src1_sel:WORD_1
v_or_b32 v161, v162, v163
v_or_b32 v162, v164, v165
v_mfma_f32_16x16x32_bf16 v[100:103], v[216:219], v[240:243], v[100:103]
ds_read_u16_d16_hi v173, v173
v_or_b32 v163, v166, v167
v_mfma_f32_16x16x32_bf16 v[32:35], v[192:195], v[244:247], v[32:35]
ds_read_b128 v[240:243], v15 offset:54272
v_exp_f32 v226, v226
v_lshlrev_b32_sdwa v174, v6, v174 dst_sel:DWORD dst_unused:UNUSED_PAD src0_sel:DWORD src1_sel:WORD_1
v_mfma_f32_16x16x32_bf16 v[56:59], v[200:203], v[244:247], v[56:59]
ds_read_u16_d16 v174, v174
v_exp_f32 v227, v227
v_mfma_f32_16x16x32_bf16 v[80:83], v[208:211], v[244:247], v[80:83]
v_lshlrev_b32_sdwa v175, v6, v175 dst_sel:DWORD dst_unused:UNUSED_PAD src0_sel:DWORD src1_sel:WORD_1
v_add_f32 v226, 1.0, v226
v_mfma_f32_16x16x32_bf16 v[104:107], v[216:219], v[244:247], v[104:107]
ds_read_u16_d16_hi v175, v175
v_add_f32 v227, 1.0, v227
v_rcp_f32 v226, v226
s_waitcnt lgkmcnt(2)
v_mfma_f32_16x16x32_bf16 v[36:39], v[192:195], v[248:251], v[36:39]
ds_read_b128 v[244:247], v15 offset:55296
v_rcp_f32 v227, v227
v_mfma_f32_16x16x32_bf16 v[60:63], v[200:203], v[248:251], v[60:63]
v_mul_f32 v226, v168, v226
v_mul_f32 v227, v169, v227
v_mfma_f32_16x16x32_bf16 v[84:87], v[208:211], v[248:251], v[84:87]
v_fmaak_f32 v224, v176, v176, 0x409d30fc
v_lshlrev_b32_sdwa v178, v6, v178 dst_sel:DWORD dst_unused:UNUSED_PAD src0_sel:DWORD src1_sel:WORD_1
v_mfma_f32_16x16x32_bf16 v[108:111], v[216:219], v[248:251], v[108:111]
s_setprio 2
ds_read_u16_d16 v178, v178
v_fmaak_f32 v225, v177, v177, 0x409d30fc
v_lshlrev_b32_sdwa v179, v6, v179 dst_sel:DWORD dst_unused:UNUSED_PAD src0_sel:DWORD src1_sel:WORD_1
v_mfma_f32_16x16x32_bf16 v[192:195], v[240:243], v[112:115], 0
ds_read_b128 v[248:251], v15 offset:56320
ds_read_u16_d16_hi v179, v179
v_cvt_pk_bf16_f32 v168, v226, v227
v_mul_f32 v224, v176, v224
v_mfma_f32_16x16x32_bf16 v[200:203], v[240:243], v[124:127], 0
v_lshlrev_b32_sdwa v180, v6, v180 dst_sel:DWORD dst_unused:UNUSED_PAD src0_sel:DWORD src1_sel:WORD_1
v_mul_f32 v225, v177, v225
v_mfma_f32_16x16x32_bf16 v[208:211], v[240:243], v[136:139], 0
ds_read_u16_d16 v180, v180
v_lshlrev_b32_sdwa v181, v6, v181 dst_sel:DWORD dst_unused:UNUSED_PAD src0_sel:DWORD src1_sel:WORD_1
v_or_b32 v169, v170, v171
v_mfma_f32_16x16x32_bf16 v[216:219], v[240:243], v[148:151], 0
ds_read_u16_d16_hi v181, v181
v_or_b32 v170, v172, v173
s_waitcnt lgkmcnt(2)
v_or_b32 v171, v174, v175
v_mfma_f32_16x16x32_bf16 v[192:195], v[244:247], v[116:119], v[192:195]
ds_read_b128 v[240:243], v3 offset:18432
v_exp_f32 v224, v224
v_lshlrev_b32_sdwa v182, v6, v182 dst_sel:DWORD dst_unused:UNUSED_PAD src0_sel:DWORD src1_sel:WORD_1
v_mfma_f32_16x16x32_bf16 v[200:203], v[244:247], v[128:131], v[200:203]
ds_read_u16_d16 v182, v182
v_exp_f32 v225, v225
v_mfma_f32_16x16x32_bf16 v[208:211], v[244:247], v[140:143], v[208:211]
v_lshlrev_b32_sdwa v183, v6, v183 dst_sel:DWORD dst_unused:UNUSED_PAD src0_sel:DWORD src1_sel:WORD_1
v_add_f32 v224, 1.0, v224
v_mfma_f32_16x16x32_bf16 v[216:219], v[244:247], v[152:155], v[216:219]
ds_read_u16_d16_hi v183, v183
v_add_f32 v225, 1.0, v225
v_rcp_f32 v224, v224
v_mfma_f32_16x16x32_bf16 v[192:195], v[248:251], v[120:123], v[192:195]
ds_read_b128 v[244:247], v3 offset:19456
v_rcp_f32 v225, v225
v_mfma_f32_16x16x32_bf16 v[200:203], v[248:251], v[132:135], v[200:203]
v_mul_f32 v224, v176, v224
v_mul_f32 v225, v177, v225
v_mfma_f32_16x16x32_bf16 v[208:211], v[248:251], v[144:147], v[208:211]
v_fmaak_f32 v226, v184, v184, 0x409d30fc
v_lshlrev_b32_sdwa v186, v6, v186 dst_sel:DWORD dst_unused:UNUSED_PAD src0_sel:DWORD src1_sel:WORD_1
v_mfma_f32_16x16x32_bf16 v[216:219], v[248:251], v[156:159], v[216:219]
s_setprio 1
ds_read_u16_d16 v186, v186
v_fmaak_f32 v227, v185, v185, 0x409d30fc
v_lshlrev_b32_sdwa v187, v6, v187 dst_sel:DWORD dst_unused:UNUSED_PAD src0_sel:DWORD src1_sel:WORD_1
s_waitcnt lgkmcnt(1)
v_mfma_f32_16x16x32_bf16 v[196:199], v[240:243], v[112:115], 0
ds_read_b128 v[248:251], v3 offset:20480
ds_read_u16_d16_hi v187, v187
v_cvt_pk_bf16_f32 v176, v224, v225
v_mul_f32 v226, v184, v226
v_mfma_f32_16x16x32_bf16 v[204:207], v[240:243], v[124:127], 0
v_lshlrev_b32_sdwa v188, v6, v188 dst_sel:DWORD dst_unused:UNUSED_PAD src0_sel:DWORD src1_sel:WORD_1
v_mul_f32 v227, v185, v227
v_mfma_f32_16x16x32_bf16 v[212:215], v[240:243], v[136:139], 0
ds_read_u16_d16 v188, v188
v_lshlrev_b32_sdwa v189, v6, v189 dst_sel:DWORD dst_unused:UNUSED_PAD src0_sel:DWORD src1_sel:WORD_1
v_or_b32 v177, v178, v179
v_or_b32 v178, v180, v181
v_mfma_f32_16x16x32_bf16 v[220:223], v[240:243], v[148:151], 0
ds_read_u16_d16_hi v189, v189
v_or_b32 v179, v182, v183
v_mfma_f32_16x16x32_bf16 v[196:199], v[244:247], v[116:119], v[196:199]
ds_read_b128 v[240:243], v3 offset:61440
v_exp_f32 v226, v226
v_lshlrev_b32_sdwa v190, v6, v190 dst_sel:DWORD dst_unused:UNUSED_PAD src0_sel:DWORD src1_sel:WORD_1
v_mfma_f32_16x16x32_bf16 v[204:207], v[244:247], v[128:131], v[204:207]
ds_read_u16_d16 v190, v190
v_exp_f32 v227, v227
v_mfma_f32_16x16x32_bf16 v[212:215], v[244:247], v[140:143], v[212:215]
v_lshlrev_b32_sdwa v191, v6, v191 dst_sel:DWORD dst_unused:UNUSED_PAD src0_sel:DWORD src1_sel:WORD_1
v_add_f32 v226, 1.0, v226
v_mfma_f32_16x16x32_bf16 v[220:223], v[244:247], v[152:155], v[220:223]
ds_read_u16_d16_hi v191, v191
v_add_f32 v227, 1.0, v227
v_rcp_f32 v226, v226
s_waitcnt lgkmcnt(2)
v_mfma_f32_16x16x32_bf16 v[196:199], v[248:251], v[120:123], v[196:199]
ds_read_b128 v[244:247], v3 offset:62464
v_rcp_f32 v227, v227
v_mfma_f32_16x16x32_bf16 v[204:207], v[248:251], v[132:135], v[204:207]
v_mul_f32 v226, v184, v226
v_mul_f32 v227, v185, v227
v_mfma_f32_16x16x32_bf16 v[212:215], v[248:251], v[144:147], v[212:215]
v_cvt_pk_bf16_f32 v184, v226, v227
v_or_b32 v185, v186, v187
v_mfma_f32_16x16x32_bf16 v[220:223], v[248:251], v[156:159], v[220:223]
s_setprio 0
v_or_b32 v186, v188, v189
s_waitcnt lgkmcnt(1)
v_or_b32 v187, v190, v191
v_mfma_f32_16x16x32_bf16 v[16:19], v[160:163], v[240:243], v[16:19]
ds_read_b128 v[248:251], v3 offset:63488
v_fmaak_f32 v224, v192, v192, 0x409d30fc
v_lshlrev_b32_sdwa v194, v6, v194 dst_sel:DWORD dst_unused:UNUSED_PAD src0_sel:DWORD src1_sel:WORD_1
v_mfma_f32_16x16x32_bf16 v[40:43], v[168:171], v[240:243], v[40:43]
ds_read_u16_d16 v194, v194
v_fmaak_f32 v225, v193, v193, 0x409d30fc
v_lshlrev_b32_sdwa v195, v6, v195 dst_sel:DWORD dst_unused:UNUSED_PAD src0_sel:DWORD src1_sel:WORD_1
v_mfma_f32_16x16x32_bf16 v[64:67], v[176:179], v[240:243], v[64:67]
ds_read_u16_d16_hi v195, v195
v_mul_f32 v224, v192, v224
v_lshlrev_b32_sdwa v196, v6, v196 dst_sel:DWORD dst_unused:UNUSED_PAD src0_sel:DWORD src1_sel:WORD_1
v_mul_f32 v225, v193, v225
v_mfma_f32_16x16x32_bf16 v[88:91], v[184:187], v[240:243], v[88:91]
ds_read_u16_d16 v196, v196
v_lshlrev_b32_sdwa v197, v6, v197 dst_sel:DWORD dst_unused:UNUSED_PAD src0_sel:DWORD src1_sel:WORD_1
s_waitcnt lgkmcnt(3)
v_mfma_f32_16x16x32_bf16 v[20:23], v[160:163], v[244:247], v[20:23]
ds_read_b128 v[240:243], v3 offset:64512
ds_read_u16_d16_hi v197, v197
v_exp_f32 v224, v224
v_lshlrev_b32_sdwa v198, v6, v198 dst_sel:DWORD dst_unused:UNUSED_PAD src0_sel:DWORD src1_sel:WORD_1
v_mfma_f32_16x16x32_bf16 v[44:47], v[168:171], v[244:247], v[44:47]
ds_read_u16_d16 v198, v198
v_exp_f32 v225, v225
v_mfma_f32_16x16x32_bf16 v[68:71], v[176:179], v[244:247], v[68:71]
v_lshlrev_b32_sdwa v199, v6, v199 dst_sel:DWORD dst_unused:UNUSED_PAD src0_sel:DWORD src1_sel:WORD_1
v_add_f32 v224, 1.0, v224
v_mfma_f32_16x16x32_bf16 v[92:95], v[184:187], v[244:247], v[92:95]
ds_read_u16_d16_hi v199, v199
v_add_f32 v225, 1.0, v225
v_rcp_f32 v224, v224
v_mfma_f32_16x16x32_bf16 v[24:27], v[160:163], v[248:251], v[24:27]
ds_read_b128 v[244:247], v4 offset:0
v_rcp_f32 v225, v225
v_mfma_f32_16x16x32_bf16 v[48:51], v[168:171], v[248:251], v[48:51]
v_mul_f32 v224, v192, v224
v_mul_f32 v225, v193, v225
v_mfma_f32_16x16x32_bf16 v[72:75], v[176:179], v[248:251], v[72:75]
v_fmaak_f32 v226, v200, v200, 0x409d30fc
v_lshlrev_b32_sdwa v202, v6, v202 dst_sel:DWORD dst_unused:UNUSED_PAD src0_sel:DWORD src1_sel:WORD_1
v_mfma_f32_16x16x32_bf16 v[96:99], v[184:187], v[248:251], v[96:99]
s_setprio 3
ds_read_u16_d16 v202, v202
v_fmaak_f32 v227, v201, v201, 0x409d30fc
v_lshlrev_b32_sdwa v203, v6, v203 dst_sel:DWORD dst_unused:UNUSED_PAD src0_sel:DWORD src1_sel:WORD_1
s_waitcnt lgkmcnt(1)
v_mfma_f32_16x16x32_bf16 v[28:31], v[160:163], v[240:243], v[28:31]
ds_read_b128 v[248:251], v4 offset:1024
ds_read_u16_d16_hi v203, v203
v_cvt_pk_bf16_f32 v192, v224, v225
v_mul_f32 v226, v200, v226
v_mfma_f32_16x16x32_bf16 v[52:55], v[168:171], v[240:243], v[52:55]
v_lshlrev_b32_sdwa v204, v6, v204 dst_sel:DWORD dst_unused:UNUSED_PAD src0_sel:DWORD src1_sel:WORD_1
v_mul_f32 v227, v201, v227
v_mfma_f32_16x16x32_bf16 v[76:79], v[176:179], v[240:243], v[76:79]
ds_read_u16_d16 v204, v204
v_lshlrev_b32_sdwa v205, v6, v205 dst_sel:DWORD dst_unused:UNUSED_PAD src0_sel:DWORD src1_sel:WORD_1
v_or_b32 v193, v194, v195
v_or_b32 v194, v196, v197
v_mfma_f32_16x16x32_bf16 v[100:103], v[184:187], v[240:243], v[100:103]
ds_read_u16_d16_hi v205, v205
v_or_b32 v195, v198, v199
v_mfma_f32_16x16x32_bf16 v[32:35], v[160:163], v[244:247], v[32:35]
ds_read_b128 v[240:243], v14 offset:8192
v_exp_f32 v226, v226
v_lshlrev_b32_sdwa v206, v6, v206 dst_sel:DWORD dst_unused:UNUSED_PAD src0_sel:DWORD src1_sel:WORD_1
v_mfma_f32_16x16x32_bf16 v[56:59], v[168:171], v[244:247], v[56:59]
ds_read_u16_d16 v206, v206
v_exp_f32 v227, v227
v_mfma_f32_16x16x32_bf16 v[80:83], v[176:179], v[244:247], v[80:83]
v_lshlrev_b32_sdwa v207, v6, v207 dst_sel:DWORD dst_unused:UNUSED_PAD src0_sel:DWORD src1_sel:WORD_1
v_add_f32 v226, 1.0, v226
v_mfma_f32_16x16x32_bf16 v[104:107], v[184:187], v[244:247], v[104:107]
ds_read_u16_d16_hi v207, v207
v_add_f32 v227, 1.0, v227
v_rcp_f32 v226, v226
s_waitcnt lgkmcnt(2)
v_mfma_f32_16x16x32_bf16 v[36:39], v[160:163], v[248:251], v[36:39]
ds_read_b128 v[244:247], v14 offset:9216
v_rcp_f32 v227, v227
v_mfma_f32_16x16x32_bf16 v[60:63], v[168:171], v[248:251], v[60:63]
v_mul_f32 v226, v200, v226
v_mul_f32 v227, v201, v227
v_mfma_f32_16x16x32_bf16 v[84:87], v[176:179], v[248:251], v[84:87]
v_fmaak_f32 v224, v208, v208, 0x409d30fc
v_lshlrev_b32_sdwa v210, v6, v210 dst_sel:DWORD dst_unused:UNUSED_PAD src0_sel:DWORD src1_sel:WORD_1
v_mfma_f32_16x16x32_bf16 v[108:111], v[184:187], v[248:251], v[108:111]
s_setprio 2
ds_read_u16_d16 v210, v210
v_fmaak_f32 v225, v209, v209, 0x409d30fc
v_lshlrev_b32_sdwa v211, v6, v211 dst_sel:DWORD dst_unused:UNUSED_PAD src0_sel:DWORD src1_sel:WORD_1
v_mfma_f32_16x16x32_bf16 v[160:163], v[240:243], v[112:115], 0
ds_read_b128 v[248:251], v14 offset:10240
ds_read_u16_d16_hi v211, v211
v_cvt_pk_bf16_f32 v200, v226, v227
v_mul_f32 v224, v208, v224
v_mfma_f32_16x16x32_bf16 v[168:171], v[240:243], v[124:127], 0
v_lshlrev_b32_sdwa v212, v6, v212 dst_sel:DWORD dst_unused:UNUSED_PAD src0_sel:DWORD src1_sel:WORD_1
v_mul_f32 v225, v209, v225
v_mfma_f32_16x16x32_bf16 v[176:179], v[240:243], v[136:139], 0
ds_read_u16_d16 v212, v212
v_lshlrev_b32_sdwa v213, v6, v213 dst_sel:DWORD dst_unused:UNUSED_PAD src0_sel:DWORD src1_sel:WORD_1
v_or_b32 v201, v202, v203
v_mfma_f32_16x16x32_bf16 v[184:187], v[240:243], v[148:151], 0
ds_read_u16_d16_hi v213, v213
v_or_b32 v202, v204, v205
s_waitcnt lgkmcnt(2)
v_or_b32 v203, v206, v207
v_mfma_f32_16x16x32_bf16 v[160:163], v[244:247], v[116:119], v[160:163]
ds_read_b128 v[240:243], v2 offset:32768
v_exp_f32 v224, v224
v_lshlrev_b32_sdwa v214, v6, v214 dst_sel:DWORD dst_unused:UNUSED_PAD src0_sel:DWORD src1_sel:WORD_1
v_mfma_f32_16x16x32_bf16 v[168:171], v[244:247], v[128:131], v[168:171]
ds_read_u16_d16 v214, v214
v_exp_f32 v225, v225
v_mfma_f32_16x16x32_bf16 v[176:179], v[244:247], v[140:143], v[176:179]
v_lshlrev_b32_sdwa v215, v6, v215 dst_sel:DWORD dst_unused:UNUSED_PAD src0_sel:DWORD src1_sel:WORD_1
v_add_f32 v224, 1.0, v224
v_mfma_f32_16x16x32_bf16 v[184:187], v[244:247], v[152:155], v[184:187]
ds_read_u16_d16_hi v215, v215
v_add_f32 v225, 1.0, v225
v_rcp_f32 v224, v224
v_mfma_f32_16x16x32_bf16 v[160:163], v[248:251], v[120:123], v[160:163]
ds_read_b128 v[244:247], v2 offset:33792
v_rcp_f32 v225, v225
v_mfma_f32_16x16x32_bf16 v[168:171], v[248:251], v[132:135], v[168:171]
v_mul_f32 v224, v208, v224
v_mul_f32 v225, v209, v225
v_mfma_f32_16x16x32_bf16 v[176:179], v[248:251], v[144:147], v[176:179]
v_fmaak_f32 v226, v216, v216, 0x409d30fc
v_lshlrev_b32_sdwa v218, v6, v218 dst_sel:DWORD dst_unused:UNUSED_PAD src0_sel:DWORD src1_sel:WORD_1
v_mfma_f32_16x16x32_bf16 v[184:187], v[248:251], v[156:159], v[184:187]
s_setprio 1
ds_read_u16_d16 v218, v218
v_fmaak_f32 v227, v217, v217, 0x409d30fc
v_lshlrev_b32_sdwa v219, v6, v219 dst_sel:DWORD dst_unused:UNUSED_PAD src0_sel:DWORD src1_sel:WORD_1
s_waitcnt lgkmcnt(1)
v_mfma_f32_16x16x32_bf16 v[164:167], v[240:243], v[112:115], 0
ds_read_b128 v[248:251], v2 offset:34816
ds_read_u16_d16_hi v219, v219
v_cvt_pk_bf16_f32 v208, v224, v225
v_mul_f32 v226, v216, v226
v_mfma_f32_16x16x32_bf16 v[172:175], v[240:243], v[124:127], 0
v_lshlrev_b32_sdwa v220, v6, v220 dst_sel:DWORD dst_unused:UNUSED_PAD src0_sel:DWORD src1_sel:WORD_1
v_mul_f32 v227, v217, v227
v_mfma_f32_16x16x32_bf16 v[180:183], v[240:243], v[136:139], 0
ds_read_u16_d16 v220, v220
v_lshlrev_b32_sdwa v221, v6, v221 dst_sel:DWORD dst_unused:UNUSED_PAD src0_sel:DWORD src1_sel:WORD_1
v_or_b32 v209, v210, v211
v_or_b32 v210, v212, v213
v_mfma_f32_16x16x32_bf16 v[188:191], v[240:243], v[148:151], 0
ds_read_u16_d16_hi v221, v221
v_or_b32 v211, v214, v215
v_mfma_f32_16x16x32_bf16 v[164:167], v[244:247], v[116:119], v[164:167]
ds_read_b128 v[240:243], v4 offset:2048
v_exp_f32 v226, v226
v_lshlrev_b32_sdwa v222, v6, v222 dst_sel:DWORD dst_unused:UNUSED_PAD src0_sel:DWORD src1_sel:WORD_1
v_mfma_f32_16x16x32_bf16 v[172:175], v[244:247], v[128:131], v[172:175]
ds_read_u16_d16 v222, v222
v_exp_f32 v227, v227
v_mfma_f32_16x16x32_bf16 v[180:183], v[244:247], v[140:143], v[180:183]
v_lshlrev_b32_sdwa v223, v6, v223 dst_sel:DWORD dst_unused:UNUSED_PAD src0_sel:DWORD src1_sel:WORD_1
v_add_f32 v226, 1.0, v226
v_mfma_f32_16x16x32_bf16 v[188:191], v[244:247], v[152:155], v[188:191]
ds_read_u16_d16_hi v223, v223
v_add_f32 v227, 1.0, v227
v_rcp_f32 v226, v226
s_waitcnt lgkmcnt(2)
v_mfma_f32_16x16x32_bf16 v[164:167], v[248:251], v[120:123], v[164:167]
ds_read_b128 v[244:247], v4 offset:3072
v_rcp_f32 v227, v227
s_add_u32 s49, s38, 0
buffer_load_dword v239, v7, s[8:11], s49 offen
v_mfma_f32_16x16x32_bf16 v[172:175], v[248:251], v[132:135], v[172:175]
v_mul_f32 v226, v216, v226
v_mul_f32 v227, v217, v227
v_mfma_f32_16x16x32_bf16 v[180:183], v[248:251], v[144:147], v[180:183]
v_cvt_pk_bf16_f32 v216, v226, v227
v_or_b32 v217, v218, v219
v_mfma_f32_16x16x32_bf16 v[188:191], v[248:251], v[156:159], v[188:191]
s_setprio 0
v_or_b32 v218, v220, v221
s_waitcnt lgkmcnt(0)
v_or_b32 v219, v222, v223
v_mfma_f32_16x16x32_bf16 v[16:19], v[192:195], v[240:243], v[16:19]
ds_read_b128 v[248:251], v4 offset:4096
v_fmaak_f32 v224, v162, v162, 0x409d30fc
v_lshlrev_b32_sdwa v160, v6, v160 dst_sel:DWORD dst_unused:UNUSED_PAD src0_sel:DWORD src1_sel:WORD_1
v_mfma_f32_16x16x32_bf16 v[40:43], v[200:203], v[240:243], v[40:43]
ds_read_u16_d16 v160, v160
v_fmaak_f32 v225, v163, v163, 0x409d30fc
v_lshlrev_b32_sdwa v161, v6, v161 dst_sel:DWORD dst_unused:UNUSED_PAD src0_sel:DWORD src1_sel:WORD_1
v_mul_f32 v224, v162, v224
v_mfma_f32_16x16x32_bf16 v[64:67], v[208:211], v[240:243], v[64:67]
ds_read_u16_d16_hi v161, v161
s_waitcnt vmcnt(4)
v_perm_b32 v212, v236, v232, s58
s_waitcnt vmcnt(2)
v_perm_b32 v213, v0, v252, s58
v_mfma_f32_16x16x32_bf16 v[88:91], v[216:219], v[240:243], v[88:91]
v_lshlrev_b32_sdwa v164, v6, v164 dst_sel:DWORD dst_unused:UNUSED_PAD src0_sel:DWORD src1_sel:WORD_1
v_mov_b32 v214, v8
v_mfma_f32_16x16x32_bf16 v[20:23], v[192:195], v[244:247], v[20:23]
ds_read_b128 v[240:243], v4 offset:5120
ds_read_u16_d16 v164, v164
v_mul_f32 v225, v163, v225
v_lshlrev_b32_sdwa v165, v6, v165 dst_sel:DWORD dst_unused:UNUSED_PAD src0_sel:DWORD src1_sel:WORD_1
v_mfma_f32_16x16x32_bf16 v[64:67], v[228:231], v[212:215], v[64:67]
ds_read_u16_d16_hi v165, v165
v_exp_f32 v224, v224
v_lshlrev_b32_sdwa v166, v6, v166 dst_sel:DWORD dst_unused:UNUSED_PAD src0_sel:DWORD src1_sel:WORD_1
v_mfma_f32_16x16x32_bf16 v[44:47], v[200:203], v[244:247], v[44:47]
ds_read_u16_d16 v166, v166
v_exp_f32 v225, v225
v_mfma_f32_16x16x32_bf16 v[68:71], v[208:211], v[244:247], v[68:71]
v_perm_b32 v212, v236, v232, s59
v_perm_b32 v213, v0, v252, s59
v_mfma_f32_16x16x32_bf16 v[92:95], v[216:219], v[244:247], v[92:95]
v_lshlrev_b32_sdwa v167, v6, v167 dst_sel:DWORD dst_unused:UNUSED_PAD src0_sel:DWORD src1_sel:WORD_1
v_mov_b32 v214, v9
s_waitcnt lgkmcnt(2)
v_mfma_f32_16x16x32_bf16 v[24:27], v[192:195], v[248:251], v[24:27]
ds_read_b128 v[244:247], v4 offset:6144
ds_read_u16_d16_hi v167, v167
v_add_f32 v224, 1.0, v224
v_add_f32 v225, 1.0, v225
v_mfma_f32_16x16x32_bf16 v[68:71], v[228:231], v[212:215], v[68:71]
v_rcp_f32 v224, v224
v_mfma_f32_16x16x32_bf16 v[48:51], v[200:203], v[248:251], v[48:51]
s_setprio 3
v_rcp_f32 v225, v225
v_mul_f32 v224, v162, v224
v_mfma_f32_16x16x32_bf16 v[72:75], v[208:211], v[248:251], v[72:75]
v_perm_b32 v212, v237, v233, s58
v_perm_b32 v213, v1, v253, s58
v_mfma_f32_16x16x32_bf16 v[96:99], v[216:219], v[248:251], v[96:99]
v_mul_f32 v225, v163, v225
v_fmaak_f32 v226, v170, v170, 0x409d30fc
v_mov_b32 v214, v10
v_mfma_f32_16x16x32_bf16 v[28:31], v[192:195], v[240:243], v[28:31]
ds_read_b128 v[248:251], v4 offset:7168
v_lshlrev_b32_sdwa v168, v6, v168 dst_sel:DWORD dst_unused:UNUSED_PAD src0_sel:DWORD src1_sel:WORD_1
v_fmaak_f32 v227, v171, v171, 0x409d30fc
v_mfma_f32_16x16x32_bf16 v[72:75], v[228:231], v[212:215], v[72:75]
ds_read_u16_d16 v168, v168
v_lshlrev_b32_sdwa v169, v6, v169 dst_sel:DWORD dst_unused:UNUSED_PAD src0_sel:DWORD src1_sel:WORD_1
v_mul_f32 v226, v170, v226
v_mfma_f32_16x16x32_bf16 v[52:55], v[200:203], v[240:243], v[52:55]
ds_read_u16_d16_hi v169, v169
v_lshlrev_b32_sdwa v172, v6, v172 dst_sel:DWORD dst_unused:UNUSED_PAD src0_sel:DWORD src1_sel:WORD_1
v_mul_f32 v227, v171, v227
v_mfma_f32_16x16x32_bf16 v[76:79], v[208:211], v[240:243], v[76:79]
ds_read_u16_d16 v172, v172
v_lshlrev_b32_sdwa v173, v6, v173 dst_sel:DWORD dst_unused:UNUSED_PAD src0_sel:DWORD src1_sel:WORD_1
v_perm_b32 v212, v237, v233, s59
v_perm_b32 v213, v1, v253, s59
v_mfma_f32_16x16x32_bf16 v[100:103], v[216:219], v[240:243], v[100:103]
ds_read_u16_d16_hi v173, v173
v_or_b32 v160, v160, v161
v_mov_b32 v214, v11
s_waitcnt lgkmcnt(3)
v_mfma_f32_16x16x32_bf16 v[32:35], v[192:195], v[244:247], v[32:35]
ds_read_b128 v[240:243], v14 offset:17408
v_cvt_pk_bf16_f32 v161, v224, v225
v_or_b32 v162, v164, v165
v_mfma_f32_16x16x32_bf16 v[76:79], v[228:231], v[212:215], v[76:79]
v_or_b32 v163, v166, v167
v_exp_f32 v226, v226
v_mfma_f32_16x16x32_bf16 v[56:59], v[200:203], v[244:247], v[56:59]
v_lshlrev_b32_sdwa v174, v6, v174 dst_sel:DWORD dst_unused:UNUSED_PAD src0_sel:DWORD src1_sel:WORD_1
v_mfma_f32_16x16x32_bf16 v[80:83], v[208:211], v[244:247], v[80:83]
ds_read_u16_d16 v174, v174
v_perm_b32 v212, v238, v234, s58
s_waitcnt vmcnt(1)
v_perm_b32 v213, v235, v254, s58
v_mfma_f32_16x16x32_bf16 v[104:107], v[216:219], v[244:247], v[104:107]
s_setprio 2
v_exp_f32 v227, v227
v_mov_b32 v214, v12
v_mfma_f32_16x16x32_bf16 v[36:39], v[192:195], v[248:251], v[36:39]
ds_read_b128 v[244:247], v14 offset:18432
v_lshlrev_b32_sdwa v175, v6, v175 dst_sel:DWORD dst_unused:UNUSED_PAD src0_sel:DWORD src1_sel:WORD_1
v_add_f32 v226, 1.0, v226
v_mfma_f32_16x16x32_bf16 v[80:83], v[228:231], v[212:215], v[80:83]
ds_read_u16_d16_hi v175, v175
v_add_f32 v227, 1.0, v227
v_rcp_f32 v226, v226
v_mfma_f32_16x16x32_bf16 v[60:63], v[200:203], v[248:251], v[60:63]
v_rcp_f32 v227, v227
v_mfma_f32_16x16x32_bf16 v[84:87], v[208:211], v[248:251], v[84:87]
v_perm_b32 v212, v238, v234, s59
v_perm_b32 v213, v235, v254, s59
v_mfma_f32_16x16x32_bf16 v[108:111], v[216:219], v[248:251], v[108:111]
v_mul_f32 v226, v170, v226
v_mul_f32 v227, v171, v227
v_mov_b32 v214, v13
s_waitcnt lgkmcnt(1)
v_mfma_f32_16x16x32_bf16 v[192:195], v[240:243], v[112:115], 0
ds_read_b128 v[248:251], v14 offset:19456
v_fmaak_f32 v224, v178, v178, 0x409d30fc
v_lshlrev_b32_sdwa v176, v6, v176 dst_sel:DWORD dst_unused:UNUSED_PAD src0_sel:DWORD src1_sel:WORD_1
v_mfma_f32_16x16x32_bf16 v[84:87], v[228:231], v[212:215], v[84:87]
ds_read_u16_d16 v176, v176
v_fmaak_f32 v225, v179, v179, 0x409d30fc
v_lshlrev_b32_sdwa v177, v6, v177 dst_sel:DWORD dst_unused:UNUSED_PAD src0_sel:DWORD src1_sel:WORD_1
v_mfma_f32_16x16x32_bf16 v[200:203], v[240:243], v[124:127], 0
ds_read_u16_d16_hi v177, v177
v_mul_f32 v224, v178, v224
v_lshlrev_b32_sdwa v180, v6, v180 dst_sel:DWORD dst_unused:UNUSED_PAD src0_sel:DWORD src1_sel:WORD_1
v_mfma_f32_16x16x32_bf16 v[208:211], v[240:243], v[136:139], 0
ds_read_u16_d16 v180, v180
v_mul_f32 v225, v179, v225
v_lshlrev_b32_sdwa v181, v6, v181 dst_sel:DWORD dst_unused:UNUSED_PAD src0_sel:DWORD src1_sel:WORD_1
v_or_b32 v168, v168, v169
v_mfma_f32_16x16x32_bf16 v[216:219], v[240:243], v[148:151], 0
ds_read_u16_d16_hi v181, v181
v_cvt_pk_bf16_f32 v169, v226, v227
v_or_b32 v170, v172, v173
v_mfma_f32_16x16x32_bf16 v[192:195], v[244:247], v[116:119], v[192:195]
ds_read_b128 v[240:243], v2 offset:41984
s_waitcnt lgkmcnt(3)
v_or_b32 v171, v174, v175
v_exp_f32 v224, v224
s_add_u32 s3, s54, 98304
buffer_load_dwordx3 v[232:234], v5, s[4:7], s3 offen offset:0
v_mfma_f32_16x16x32_bf16 v[200:203], v[244:247], v[128:131], v[200:203]
s_setprio 1
v_lshlrev_b32_sdwa v182, v6, v182 dst_sel:DWORD dst_unused:UNUSED_PAD src0_sel:DWORD src1_sel:WORD_1
v_mfma_f32_16x16x32_bf16 v[208:211], v[244:247], v[140:143], v[208:211]
ds_read_u16_d16 v182, v182
v_exp_f32 v225, v225
v_lshlrev_b32_sdwa v183, v6, v183 dst_sel:DWORD dst_unused:UNUSED_PAD src0_sel:DWORD src1_sel:WORD_1
v_mfma_f32_16x16x32_bf16 v[216:219], v[244:247], v[152:155], v[216:219]
ds_read_u16_d16_hi v183, v183
v_add_f32 v224, 1.0, v224
v_add_f32 v225, 1.0, v225
v_mfma_f32_16x16x32_bf16 v[192:195], v[248:251], v[120:123], v[192:195]
ds_read_b128 v[244:247], v2 offset:43008
v_rcp_f32 v224, v224
v_mfma_f32_16x16x32_bf16 v[200:203], v[248:251], v[132:135], v[200:203]
v_rcp_f32 v225, v225
buffer_load_dwordx3 v[236:238], v5, s[4:7], s3 offen offset:768
v_mfma_f32_16x16x32_bf16 v[208:211], v[248:251], v[144:147], v[208:211]
v_mul_f32 v224, v178, v224
v_mul_f32 v225, v179, v225
v_fmaak_f32 v226, v186, v186, 0x409d30fc
v_mfma_f32_16x16x32_bf16 v[216:219], v[248:251], v[156:159], v[216:219]
v_lshlrev_b32_sdwa v184, v6, v184 dst_sel:DWORD dst_unused:UNUSED_PAD src0_sel:DWORD src1_sel:WORD_1
v_fmaak_f32 v227, v187, v187, 0x409d30fc
s_waitcnt lgkmcnt(1)
v_mfma_f32_16x16x32_bf16 v[196:199], v[240:243], v[112:115], 0
ds_read_b128 v[248:251], v2 offset:44032
ds_read_u16_d16 v184, v184
v_lshlrev_b32_sdwa v185, v6, v185 dst_sel:DWORD dst_unused:UNUSED_PAD src0_sel:DWORD src1_sel:WORD_1
v_mul_f32 v226, v186, v226
v_mfma_f32_16x16x32_bf16 v[204:207], v[240:243], v[124:127], 0
ds_read_u16_d16_hi v185, v185
v_lshlrev_b32_sdwa v188, v6, v188 dst_sel:DWORD dst_unused:UNUSED_PAD src0_sel:DWORD src1_sel:WORD_1
v_mul_f32 v227, v187, v227
v_mfma_f32_16x16x32_bf16 v[212:215], v[240:243], v[136:139], 0
ds_read_u16_d16 v188, v188
v_lshlrev_b32_sdwa v189, v6, v189 dst_sel:DWORD dst_unused:UNUSED_PAD src0_sel:DWORD src1_sel:WORD_1
v_or_b32 v176, v176, v177
v_cvt_pk_bf16_f32 v177, v224, v225
buffer_load_dwordx3 v[252:254], v5, s[4:7], s3 offen offset:1536
v_mfma_f32_16x16x32_bf16 v[220:223], v[240:243], v[148:151], 0
ds_read_u16_d16_hi v189, v189
v_or_b32 v178, v180, v181
v_or_b32 v179, v182, v183
s_waitcnt lgkmcnt(2)
v_mfma_f32_16x16x32_bf16 v[196:199], v[244:247], v[116:119], v[196:199]
ds_read_b128 v[240:243], v4 offset:8192
v_exp_f32 v226, v226
v_mfma_f32_16x16x32_bf16 v[204:207], v[244:247], v[128:131], v[204:207]
s_setprio 0
v_lshlrev_b32_sdwa v190, v6, v190 dst_sel:DWORD dst_unused:UNUSED_PAD src0_sel:DWORD src1_sel:WORD_1
v_exp_f32 v227, v227
v_mfma_f32_16x16x32_bf16 v[212:215], v[244:247], v[140:143], v[212:215]
ds_read_u16_d16 v190, v190
v_lshlrev_b32_sdwa v191, v6, v191 dst_sel:DWORD dst_unused:UNUSED_PAD src0_sel:DWORD src1_sel:WORD_1
v_add_f32 v226, 1.0, v226
v_mfma_f32_16x16x32_bf16 v[220:223], v[244:247], v[152:155], v[220:223]
ds_read_u16_d16_hi v191, v191
v_add_f32 v227, 1.0, v227
buffer_load_dwordx2 v[0:1], v5, s[4:7], s3 offen offset:2304
buffer_load_dword v235, v5, s[4:7], s3 offen offset:2312
v_mfma_f32_16x16x32_bf16 v[196:199], v[248:251], v[120:123], v[196:199]
ds_read_b128 v[244:247], v4 offset:9216
v_rcp_f32 v226, v226
v_rcp_f32 v227, v227
s_add_u32 s49, s38, 3072
s_waitcnt vmcnt(5)
buffer_load_dword v239, v7, s[8:11], s49 offen
v_mfma_f32_16x16x32_bf16 v[204:207], v[248:251], v[132:135], v[204:207]
v_mul_f32 v226, v186, v226
v_mfma_f32_16x16x32_bf16 v[212:215], v[248:251], v[144:147], v[212:215]
v_mul_f32 v227, v187, v227
v_or_b32 v184, v184, v185
v_cvt_pk_bf16_f32 v185, v226, v227
v_mfma_f32_16x16x32_bf16 v[220:223], v[248:251], v[156:159], v[220:223]
s_waitcnt lgkmcnt(1)
v_or_b32 v186, v188, v189
v_or_b32 v187, v190, v191
v_mfma_f32_16x16x32_bf16 v[16:19], v[160:163], v[240:243], v[16:19]
ds_read_b128 v[248:251], v4 offset:10240
v_fmaak_f32 v224, v194, v194, 0x409d30fc
v_lshlrev_b32_sdwa v192, v6, v192 dst_sel:DWORD dst_unused:UNUSED_PAD src0_sel:DWORD src1_sel:WORD_1
v_mfma_f32_16x16x32_bf16 v[40:43], v[168:171], v[240:243], v[40:43]
ds_read_u16_d16 v192, v192
v_fmaak_f32 v225, v195, v195, 0x409d30fc
v_lshlrev_b32_sdwa v193, v6, v193 dst_sel:DWORD dst_unused:UNUSED_PAD src0_sel:DWORD src1_sel:WORD_1
v_mfma_f32_16x16x32_bf16 v[64:67], v[176:179], v[240:243], v[64:67]
ds_read_u16_d16_hi v193, v193
v_mul_f32 v224, v194, v224
v_lshlrev_b32_sdwa v196, v6, v196 dst_sel:DWORD dst_unused:UNUSED_PAD src0_sel:DWORD src1_sel:WORD_1
v_mul_f32 v225, v195, v225
v_mfma_f32_16x16x32_bf16 v[88:91], v[184:187], v[240:243], v[88:91]
ds_read_u16_d16 v196, v196
v_lshlrev_b32_sdwa v197, v6, v197 dst_sel:DWORD dst_unused:UNUSED_PAD src0_sel:DWORD src1_sel:WORD_1
s_waitcnt lgkmcnt(3)
v_mfma_f32_16x16x32_bf16 v[20:23], v[160:163], v[244:247], v[20:23]
ds_read_b128 v[240:243], v4 offset:11264
ds_read_u16_d16_hi v197, v197
v_exp_f32 v224, v224
v_lshlrev_b32_sdwa v198, v6, v198 dst_sel:DWORD dst_unused:UNUSED_PAD src0_sel:DWORD src1_sel:WORD_1
v_mfma_f32_16x16x32_bf16 v[44:47], v[168:171], v[244:247], v[44:47]
s_setprio 3
ds_read_u16_d16 v198, v198
v_exp_f32 v225, v225
v_mfma_f32_16x16x32_bf16 v[68:71], v[176:179], v[244:247], v[68:71]
v_lshlrev_b32_sdwa v199, v6, v199 dst_sel:DWORD dst_unused:UNUSED_PAD src0_sel:DWORD src1_sel:WORD_1
v_add_f32 v224, 1.0, v224
v_mfma_f32_16x16x32_bf16 v[92:95], v[184:187], v[244:247], v[92:95]
ds_read_u16_d16_hi v199, v199
v_add_f32 v225, 1.0, v225
v_rcp_f32 v224, v224
v_mfma_f32_16x16x32_bf16 v[24:27], v[160:163], v[248:251], v[24:27]
ds_read_b128 v[244:247], v4 offset:12288
v_rcp_f32 v225, v225
v_mfma_f32_16x16x32_bf16 v[48:51], v[168:171], v[248:251], v[48:51]
v_mul_f32 v224, v194, v224
v_mul_f32 v225, v195, v225
v_mfma_f32_16x16x32_bf16 v[72:75], v[176:179], v[248:251], v[72:75]
v_fmaak_f32 v226, v202, v202, 0x409d30fc
v_lshlrev_b32_sdwa v200, v6, v200 dst_sel:DWORD dst_unused:UNUSED_PAD src0_sel:DWORD src1_sel:WORD_1
v_mfma_f32_16x16x32_bf16 v[96:99], v[184:187], v[248:251], v[96:99]
ds_read_u16_d16 v200, v200
v_fmaak_f32 v227, v203, v203, 0x409d30fc
v_lshlrev_b32_sdwa v201, v6, v201 dst_sel:DWORD dst_unused:UNUSED_PAD src0_sel:DWORD src1_sel:WORD_1
s_waitcnt lgkmcnt(2)
v_mfma_f32_16x16x32_bf16 v[28:31], v[160:163], v[240:243], v[28:31]
ds_read_b128 v[248:251], v4 offset:13312
ds_read_u16_d16_hi v201, v201
v_mul_f32 v226, v202, v226
v_lshlrev_b32_sdwa v204, v6, v204 dst_sel:DWORD dst_unused:UNUSED_PAD src0_sel:DWORD src1_sel:WORD_1
v_mfma_f32_16x16x32_bf16 v[52:55], v[168:171], v[240:243], v[52:55]
ds_read_u16_d16 v204, v204
v_mul_f32 v227, v203, v227
v_lshlrev_b32_sdwa v205, v6, v205 dst_sel:DWORD dst_unused:UNUSED_PAD src0_sel:DWORD src1_sel:WORD_1
v_mfma_f32_16x16x32_bf16 v[76:79], v[176:179], v[240:243], v[76:79]
ds_read_u16_d16_hi v205, v205
v_or_b32 v192, v192, v193
v_cvt_pk_bf16_f32 v193, v224, v225
v_or_b32 v194, v196, v197
v_mfma_f32_16x16x32_bf16 v[100:103], v[184:187], v[240:243], v[100:103]
v_or_b32 v195, v198, v199
s_waitcnt lgkmcnt(2)
v_mfma_f32_16x16x32_bf16 v[32:35], v[160:163], v[244:247], v[32:35]
ds_read_b128 v[240:243], v14 offset:45056
v_exp_f32 v226, v226
v_lshlrev_b32_sdwa v206, v6, v206 dst_sel:DWORD dst_unused:UNUSED_PAD src0_sel:DWORD src1_sel:WORD_1
v_mfma_f32_16x16x32_bf16 v[56:59], v[168:171], v[244:247], v[56:59]
s_setprio 2
ds_read_u16_d16 v206, v206
v_exp_f32 v227, v227
v_mfma_f32_16x16x32_bf16 v[80:83], v[176:179], v[244:247], v[80:83]
v_lshlrev_b32_sdwa v207, v6, v207 dst_sel:DWORD dst_unused:UNUSED_PAD src0_sel:DWORD src1_sel:WORD_1
v_add_f32 v226, 1.0, v226
v_mfma_f32_16x16x32_bf16 v[104:107], v[184:187], v[244:247], v[104:107]
ds_read_u16_d16_hi v207, v207
v_add_f32 v227, 1.0, v227
v_rcp_f32 v226, v226
v_mfma_f32_16x16x32_bf16 v[36:39], v[160:163], v[248:251], v[36:39]
ds_read_b128 v[244:247], v14 offset:46080
v_rcp_f32 v227, v227
v_mfma_f32_16x16x32_bf16 v[60:63], v[168:171], v[248:251], v[60:63]
v_mul_f32 v226, v202, v226
v_mul_f32 v227, v203, v227
v_mfma_f32_16x16x32_bf16 v[84:87], v[176:179], v[248:251], v[84:87]
v_fmaak_f32 v224, v210, v210, 0x409d30fc
v_lshlrev_b32_sdwa v208, v6, v208 dst_sel:DWORD dst_unused:UNUSED_PAD src0_sel:DWORD src1_sel:WORD_1
v_mfma_f32_16x16x32_bf16 v[108:111], v[184:187], v[248:251], v[108:111]
ds_read_u16_d16 v208, v208
v_fmaak_f32 v225, v211, v211, 0x409d30fc
v_lshlrev_b32_sdwa v209, v6, v209 dst_sel:DWORD dst_unused:UNUSED_PAD src0_sel:DWORD src1_sel:WORD_1
s_waitcnt lgkmcnt(2)
v_mfma_f32_16x16x32_bf16 v[160:163], v[240:243], v[112:115], 0
ds_read_b128 v[248:251], v14 offset:47104
ds_read_u16_d16_hi v209, v209
v_mul_f32 v224, v210, v224
v_lshlrev_b32_sdwa v212, v6, v212 dst_sel:DWORD dst_unused:UNUSED_PAD src0_sel:DWORD src1_sel:WORD_1
v_mfma_f32_16x16x32_bf16 v[168:171], v[240:243], v[124:127], 0
ds_read_u16_d16 v212, v212
v_mul_f32 v225, v211, v225
v_lshlrev_b32_sdwa v213, v6, v213 dst_sel:DWORD dst_unused:UNUSED_PAD src0_sel:DWORD src1_sel:WORD_1
v_mfma_f32_16x16x32_bf16 v[176:179], v[240:243], v[136:139], 0
ds_read_u16_d16_hi v213, v213
v_or_b32 v200, v200, v201
v_cvt_pk_bf16_f32 v201, v226, v227
v_mfma_f32_16x16x32_bf16 v[184:187], v[240:243], v[148:151], 0
v_or_b32 v202, v204, v205
v_or_b32 v203, v206, v207
s_waitcnt lgkmcnt(2)
v_mfma_f32_16x16x32_bf16 v[160:163], v[244:247], v[116:119], v[160:163]
ds_read_b128 v[240:243], v3 offset:12288
v_exp_f32 v224, v224
v_lshlrev_b32_sdwa v214, v6, v214 dst_sel:DWORD dst_unused:UNUSED_PAD src0_sel:DWORD src1_sel:WORD_1
v_mfma_f32_16x16x32_bf16 v[168:171], v[244:247], v[128:131], v[168:171]
s_setprio 1
ds_read_u16_d16 v214, v214
v_exp_f32 v225, v225
v_mfma_f32_16x16x32_bf16 v[176:179], v[244:247], v[140:143], v[176:179]
v_lshlrev_b32_sdwa v215, v6, v215 dst_sel:DWORD dst_unused:UNUSED_PAD src0_sel:DWORD src1_sel:WORD_1
v_add_f32 v224, 1.0, v224
v_mfma_f32_16x16x32_bf16 v[184:187], v[244:247], v[152:155], v[184:187]
ds_read_u16_d16_hi v215, v215
v_add_f32 v225, 1.0, v225
v_rcp_f32 v224, v224
v_mfma_f32_16x16x32_bf16 v[160:163], v[248:251], v[120:123], v[160:163]
ds_read_b128 v[244:247], v3 offset:13312
v_rcp_f32 v225, v225
v_mfma_f32_16x16x32_bf16 v[168:171], v[248:251], v[132:135], v[168:171]
v_mul_f32 v224, v210, v224
v_mul_f32 v225, v211, v225
v_mfma_f32_16x16x32_bf16 v[176:179], v[248:251], v[144:147], v[176:179]
v_fmaak_f32 v226, v218, v218, 0x409d30fc
v_lshlrev_b32_sdwa v216, v6, v216 dst_sel:DWORD dst_unused:UNUSED_PAD src0_sel:DWORD src1_sel:WORD_1
v_mfma_f32_16x16x32_bf16 v[184:187], v[248:251], v[156:159], v[184:187]
ds_read_u16_d16 v216, v216
v_fmaak_f32 v227, v219, v219, 0x409d30fc
v_lshlrev_b32_sdwa v217, v6, v217 dst_sel:DWORD dst_unused:UNUSED_PAD src0_sel:DWORD src1_sel:WORD_1
s_waitcnt lgkmcnt(2)
v_mfma_f32_16x16x32_bf16 v[164:167], v[240:243], v[112:115], 0
ds_read_b128 v[248:251], v3 offset:14336
ds_read_u16_d16_hi v217, v217
v_mul_f32 v226, v218, v226
v_lshlrev_b32_sdwa v220, v6, v220 dst_sel:DWORD dst_unused:UNUSED_PAD src0_sel:DWORD src1_sel:WORD_1
v_mfma_f32_16x16x32_bf16 v[172:175], v[240:243], v[124:127], 0
ds_read_u16_d16 v220, v220
v_mul_f32 v227, v219, v227
v_lshlrev_b32_sdwa v221, v6, v221 dst_sel:DWORD dst_unused:UNUSED_PAD src0_sel:DWORD src1_sel:WORD_1
v_mfma_f32_16x16x32_bf16 v[180:183], v[240:243], v[136:139], 0
ds_read_u16_d16_hi v221, v221
v_or_b32 v208, v208, v209
v_cvt_pk_bf16_f32 v209, v224, v225
v_or_b32 v210, v212, v213
v_mfma_f32_16x16x32_bf16 v[188:191], v[240:243], v[148:151], 0
v_or_b32 v211, v214, v215
s_waitcnt lgkmcnt(2)
v_mfma_f32_16x16x32_bf16 v[164:167], v[244:247], v[116:119], v[164:167]
ds_read_b128 v[240:243], v4 offset:14336
v_exp_f32 v226, v226
v_lshlrev_b32_sdwa v222, v6, v222 dst_sel:DWORD dst_unused:UNUSED_PAD src0_sel:DWORD src1_sel:WORD_1
v_mfma_f32_16x16x32_bf16 v[172:175], v[244:247], v[128:131], v[172:175]
s_setprio 0
ds_read_u16_d16 v222, v222
v_exp_f32 v227, v227
v_mfma_f32_16x16x32_bf16 v[180:183], v[244:247], v[140:143], v[180:183]
v_lshlrev_b32_sdwa v223, v6, v223 dst_sel:DWORD dst_unused:UNUSED_PAD src0_sel:DWORD src1_sel:WORD_1
v_add_f32 v226, 1.0, v226
v_mfma_f32_16x16x32_bf16 v[188:191], v[244:247], v[152:155], v[188:191]
ds_read_u16_d16_hi v223, v223
v_add_f32 v227, 1.0, v227
v_rcp_f32 v226, v226
v_mfma_f32_16x16x32_bf16 v[164:167], v[248:251], v[120:123], v[164:167]
ds_read_b128 v[244:247], v4 offset:15360
v_rcp_f32 v227, v227
s_add_u32 s49, s38, 49152
s_waitcnt vmcnt(0)
buffer_load_dword v239, v7, s[8:11], s49 offen
v_mfma_f32_16x16x32_bf16 v[172:175], v[248:251], v[132:135], v[172:175]
v_mul_f32 v226, v218, v226
v_mul_f32 v227, v219, v227
v_mfma_f32_16x16x32_bf16 v[180:183], v[248:251], v[144:147], v[180:183]
v_or_b32 v216, v216, v217
v_cvt_pk_bf16_f32 v217, v226, v227
v_mfma_f32_16x16x32_bf16 v[188:191], v[248:251], v[156:159], v[188:191]
s_waitcnt lgkmcnt(1)
v_or_b32 v218, v220, v221
v_or_b32 v219, v222, v223
v_mfma_f32_16x16x32_bf16 v[16:19], v[192:195], v[240:243], v[16:19]
ds_read_b128 v[248:251], v4 offset:16384
v_fmaak_f32 v224, v162, v162, 0x409d30fc
v_lshlrev_b32_sdwa v160, v6, v160 dst_sel:DWORD dst_unused:UNUSED_PAD src0_sel:DWORD src1_sel:WORD_1
v_mfma_f32_16x16x32_bf16 v[40:43], v[200:203], v[240:243], v[40:43]
ds_read_u16_d16 v160, v160
v_fmaak_f32 v225, v163, v163, 0x409d30fc
v_lshlrev_b32_sdwa v161, v6, v161 dst_sel:DWORD dst_unused:UNUSED_PAD src0_sel:DWORD src1_sel:WORD_1
v_mfma_f32_16x16x32_bf16 v[64:67], v[208:211], v[240:243], v[64:67]
ds_read_u16_d16_hi v161, v161
v_mul_f32 v224, v162, v224
v_lshlrev_b32_sdwa v164, v6, v164 dst_sel:DWORD dst_unused:UNUSED_PAD src0_sel:DWORD src1_sel:WORD_1
v_mul_f32 v225, v163, v225
v_mfma_f32_16x16x32_bf16 v[88:91], v[216:219], v[240:243], v[88:91]
ds_read_u16_d16 v164, v164
v_lshlrev_b32_sdwa v165, v6, v165 dst_sel:DWORD dst_unused:UNUSED_PAD src0_sel:DWORD src1_sel:WORD_1
s_waitcnt lgkmcnt(3)
v_mfma_f32_16x16x32_bf16 v[20:23], v[192:195], v[244:247], v[20:23]
ds_read_b128 v[240:243], v4 offset:17408
ds_read_u16_d16_hi v165, v165
v_exp_f32 v224, v224
v_lshlrev_b32_sdwa v166, v6, v166 dst_sel:DWORD dst_unused:UNUSED_PAD src0_sel:DWORD src1_sel:WORD_1
v_mfma_f32_16x16x32_bf16 v[44:47], v[200:203], v[244:247], v[44:47]
s_setprio 3
ds_read_u16_d16 v166, v166
v_exp_f32 v225, v225
v_mfma_f32_16x16x32_bf16 v[68:71], v[208:211], v[244:247], v[68:71]
v_lshlrev_b32_sdwa v167, v6, v167 dst_sel:DWORD dst_unused:UNUSED_PAD src0_sel:DWORD src1_sel:WORD_1
v_add_f32 v224, 1.0, v224
v_mfma_f32_16x16x32_bf16 v[92:95], v[216:219], v[244:247], v[92:95]
ds_read_u16_d16_hi v167, v167
v_add_f32 v225, 1.0, v225
v_rcp_f32 v224, v224
v_mfma_f32_16x16x32_bf16 v[24:27], v[192:195], v[248:251], v[24:27]
ds_read_b128 v[244:247], v4 offset:18432
v_rcp_f32 v225, v225
v_mfma_f32_16x16x32_bf16 v[48:51], v[200:203], v[248:251], v[48:51]
v_mul_f32 v224, v162, v224
v_mul_f32 v225, v163, v225
v_mfma_f32_16x16x32_bf16 v[72:75], v[208:211], v[248:251], v[72:75]
v_fmaak_f32 v226, v170, v170, 0x409d30fc
v_lshlrev_b32_sdwa v168, v6, v168 dst_sel:DWORD dst_unused:UNUSED_PAD src0_sel:DWORD src1_sel:WORD_1
v_mfma_f32_16x16x32_bf16 v[96:99], v[216:219], v[248:251], v[96:99]
ds_read_u16_d16 v168, v168
v_fmaak_f32 v227, v171, v171, 0x409d30fc
v_lshlrev_b32_sdwa v169, v6, v169 dst_sel:DWORD dst_unused:UNUSED_PAD src0_sel:DWORD src1_sel:WORD_1
s_waitcnt lgkmcnt(2)
v_mfma_f32_16x16x32_bf16 v[28:31], v[192:195], v[240:243], v[28:31]
ds_read_b128 v[248:251], v4 offset:19456
ds_read_u16_d16_hi v169, v169
v_mul_f32 v226, v170, v226
v_lshlrev_b32_sdwa v172, v6, v172 dst_sel:DWORD dst_unused:UNUSED_PAD src0_sel:DWORD src1_sel:WORD_1
v_mfma_f32_16x16x32_bf16 v[52:55], v[200:203], v[240:243], v[52:55]
ds_read_u16_d16 v172, v172
v_mul_f32 v227, v171, v227
v_lshlrev_b32_sdwa v173, v6, v173 dst_sel:DWORD dst_unused:UNUSED_PAD src0_sel:DWORD src1_sel:WORD_1
v_mfma_f32_16x16x32_bf16 v[76:79], v[208:211], v[240:243], v[76:79]
ds_read_u16_d16_hi v173, v173
v_or_b32 v160, v160, v161
v_cvt_pk_bf16_f32 v161, v224, v225
v_or_b32 v162, v164, v165
v_mfma_f32_16x16x32_bf16 v[100:103], v[216:219], v[240:243], v[100:103]
v_or_b32 v163, v166, v167
s_waitcnt lgkmcnt(2)
v_mfma_f32_16x16x32_bf16 v[32:35], v[192:195], v[244:247], v[32:35]
ds_read_b128 v[240:243], v14 offset:54272
v_exp_f32 v226, v226
v_lshlrev_b32_sdwa v174, v6, v174 dst_sel:DWORD dst_unused:UNUSED_PAD src0_sel:DWORD src1_sel:WORD_1
v_mfma_f32_16x16x32_bf16 v[56:59], v[200:203], v[244:247], v[56:59]
s_setprio 2
ds_read_u16_d16 v174, v174
v_exp_f32 v227, v227
v_mfma_f32_16x16x32_bf16 v[80:83], v[208:211], v[244:247], v[80:83]
v_lshlrev_b32_sdwa v175, v6, v175 dst_sel:DWORD dst_unused:UNUSED_PAD src0_sel:DWORD src1_sel:WORD_1
v_add_f32 v226, 1.0, v226
v_mfma_f32_16x16x32_bf16 v[104:107], v[216:219], v[244:247], v[104:107]
ds_read_u16_d16_hi v175, v175
v_add_f32 v227, 1.0, v227
v_rcp_f32 v226, v226
v_mfma_f32_16x16x32_bf16 v[36:39], v[192:195], v[248:251], v[36:39]
ds_read_b128 v[244:247], v14 offset:55296
v_rcp_f32 v227, v227
v_mfma_f32_16x16x32_bf16 v[60:63], v[200:203], v[248:251], v[60:63]
v_mul_f32 v226, v170, v226
v_mul_f32 v227, v171, v227
v_mfma_f32_16x16x32_bf16 v[84:87], v[208:211], v[248:251], v[84:87]
v_fmaak_f32 v224, v178, v178, 0x409d30fc
v_lshlrev_b32_sdwa v176, v6, v176 dst_sel:DWORD dst_unused:UNUSED_PAD src0_sel:DWORD src1_sel:WORD_1
v_mfma_f32_16x16x32_bf16 v[108:111], v[216:219], v[248:251], v[108:111]
ds_read_u16_d16 v176, v176
v_fmaak_f32 v225, v179, v179, 0x409d30fc
v_lshlrev_b32_sdwa v177, v6, v177 dst_sel:DWORD dst_unused:UNUSED_PAD src0_sel:DWORD src1_sel:WORD_1
s_waitcnt lgkmcnt(2)
v_mfma_f32_16x16x32_bf16 v[192:195], v[240:243], v[112:115], 0
ds_read_b128 v[248:251], v14 offset:56320
ds_read_u16_d16_hi v177, v177
v_mul_f32 v224, v178, v224
v_lshlrev_b32_sdwa v180, v6, v180 dst_sel:DWORD dst_unused:UNUSED_PAD src0_sel:DWORD src1_sel:WORD_1
v_mfma_f32_16x16x32_bf16 v[200:203], v[240:243], v[124:127], 0
ds_read_u16_d16 v180, v180
v_mul_f32 v225, v179, v225
v_lshlrev_b32_sdwa v181, v6, v181 dst_sel:DWORD dst_unused:UNUSED_PAD src0_sel:DWORD src1_sel:WORD_1
v_mfma_f32_16x16x32_bf16 v[208:211], v[240:243], v[136:139], 0
ds_read_u16_d16_hi v181, v181
v_or_b32 v168, v168, v169
v_cvt_pk_bf16_f32 v169, v226, v227
v_mfma_f32_16x16x32_bf16 v[216:219], v[240:243], v[148:151], 0
v_or_b32 v170, v172, v173
v_or_b32 v171, v174, v175
s_waitcnt lgkmcnt(2)
v_mfma_f32_16x16x32_bf16 v[192:195], v[244:247], v[116:119], v[192:195]
ds_read_b128 v[240:243], v3 offset:21504
v_exp_f32 v224, v224
v_lshlrev_b32_sdwa v182, v6, v182 dst_sel:DWORD dst_unused:UNUSED_PAD src0_sel:DWORD src1_sel:WORD_1
v_mfma_f32_16x16x32_bf16 v[200:203], v[244:247], v[128:131], v[200:203]
s_setprio 1
ds_read_u16_d16 v182, v182
v_exp_f32 v225, v225
v_mfma_f32_16x16x32_bf16 v[208:211], v[244:247], v[140:143], v[208:211]
v_lshlrev_b32_sdwa v183, v6, v183 dst_sel:DWORD dst_unused:UNUSED_PAD src0_sel:DWORD src1_sel:WORD_1
v_add_f32 v224, 1.0, v224
v_mfma_f32_16x16x32_bf16 v[216:219], v[244:247], v[152:155], v[216:219]
ds_read_u16_d16_hi v183, v183
v_add_f32 v225, 1.0, v225
v_rcp_f32 v224, v224
v_mfma_f32_16x16x32_bf16 v[192:195], v[248:251], v[120:123], v[192:195]
ds_read_b128 v[244:247], v3 offset:22528
v_rcp_f32 v225, v225
v_mfma_f32_16x16x32_bf16 v[200:203], v[248:251], v[132:135], v[200:203]
v_mul_f32 v224, v178, v224
v_mul_f32 v225, v179, v225
v_mfma_f32_16x16x32_bf16 v[208:211], v[248:251], v[144:147], v[208:211]
v_fmaak_f32 v226, v186, v186, 0x409d30fc
v_lshlrev_b32_sdwa v184, v6, v184 dst_sel:DWORD dst_unused:UNUSED_PAD src0_sel:DWORD src1_sel:WORD_1
v_mfma_f32_16x16x32_bf16 v[216:219], v[248:251], v[156:159], v[216:219]
ds_read_u16_d16 v184, v184
v_fmaak_f32 v227, v187, v187, 0x409d30fc
v_lshlrev_b32_sdwa v185, v6, v185 dst_sel:DWORD dst_unused:UNUSED_PAD src0_sel:DWORD src1_sel:WORD_1
s_waitcnt lgkmcnt(2)
v_mfma_f32_16x16x32_bf16 v[196:199], v[240:243], v[112:115], 0
ds_read_b128 v[248:251], v3 offset:23552
ds_read_u16_d16_hi v185, v185
v_mul_f32 v226, v186, v226
v_lshlrev_b32_sdwa v188, v6, v188 dst_sel:DWORD dst_unused:UNUSED_PAD src0_sel:DWORD src1_sel:WORD_1
v_mfma_f32_16x16x32_bf16 v[204:207], v[240:243], v[124:127], 0
ds_read_u16_d16 v188, v188
v_mul_f32 v227, v187, v227
v_lshlrev_b32_sdwa v189, v6, v189 dst_sel:DWORD dst_unused:UNUSED_PAD src0_sel:DWORD src1_sel:WORD_1
v_mfma_f32_16x16x32_bf16 v[212:215], v[240:243], v[136:139], 0
ds_read_u16_d16_hi v189, v189
v_or_b32 v176, v176, v177
v_cvt_pk_bf16_f32 v177, v224, v225
v_or_b32 v178, v180, v181
v_mfma_f32_16x16x32_bf16 v[220:223], v[240:243], v[148:151], 0
v_or_b32 v179, v182, v183
s_waitcnt lgkmcnt(2)
v_mfma_f32_16x16x32_bf16 v[196:199], v[244:247], v[116:119], v[196:199]
ds_read_b128 v[240:243], v4 offset:20480
v_exp_f32 v226, v226
v_lshlrev_b32_sdwa v190, v6, v190 dst_sel:DWORD dst_unused:UNUSED_PAD src0_sel:DWORD src1_sel:WORD_1
v_mfma_f32_16x16x32_bf16 v[204:207], v[244:247], v[128:131], v[204:207]
s_setprio 0
ds_read_u16_d16 v190, v190
v_exp_f32 v227, v227
v_mfma_f32_16x16x32_bf16 v[212:215], v[244:247], v[140:143], v[212:215]
v_lshlrev_b32_sdwa v191, v6, v191 dst_sel:DWORD dst_unused:UNUSED_PAD src0_sel:DWORD src1_sel:WORD_1
v_add_f32 v226, 1.0, v226
v_mfma_f32_16x16x32_bf16 v[220:223], v[244:247], v[152:155], v[220:223]
ds_read_u16_d16_hi v191, v191
v_add_f32 v227, 1.0, v227
v_rcp_f32 v226, v226
v_mfma_f32_16x16x32_bf16 v[196:199], v[248:251], v[120:123], v[196:199]
ds_read_b128 v[244:247], v4 offset:21504
v_rcp_f32 v227, v227
s_add_u32 s49, s38, 52224
s_waitcnt vmcnt(0)
buffer_load_dword v239, v7, s[8:11], s49 offen
v_mfma_f32_16x16x32_bf16 v[204:207], v[248:251], v[132:135], v[204:207]
v_mul_f32 v226, v186, v226
v_mul_f32 v227, v187, v227
v_mfma_f32_16x16x32_bf16 v[212:215], v[248:251], v[144:147], v[212:215]
v_or_b32 v184, v184, v185
v_cvt_pk_bf16_f32 v185, v226, v227
v_mfma_f32_16x16x32_bf16 v[220:223], v[248:251], v[156:159], v[220:223]
s_waitcnt lgkmcnt(1)
v_or_b32 v186, v188, v189
v_or_b32 v187, v190, v191
v_mfma_f32_16x16x32_bf16 v[16:19], v[160:163], v[240:243], v[16:19]
ds_read_b128 v[248:251], v4 offset:22528
v_fmaak_f32 v224, v194, v194, 0x409d30fc
s_add_u32 s62, s38, 0
buffer_load_dwordx4 v[112:115], v2, s[8:11], s62 offen offset:0
v_lshlrev_b32_sdwa v192, v6, v192 dst_sel:DWORD dst_unused:UNUSED_PAD src0_sel:DWORD src1_sel:WORD_1
v_fmaak_f32 v225, v195, v195, 0x409d30fc
v_mfma_f32_16x16x32_bf16 v[40:43], v[168:171], v[240:243], v[40:43]
ds_read_u16_d16 v192, v192
v_lshlrev_b32_sdwa v193, v6, v193 dst_sel:DWORD dst_unused:UNUSED_PAD src0_sel:DWORD src1_sel:WORD_1
v_mul_f32 v224, v194, v224
v_mfma_f32_16x16x32_bf16 v[64:67], v[176:179], v[240:243], v[64:67]
buffer_load_dwordx4 v[116:119], v2, s[8:11], s62 offen offset:1024
ds_read_u16_d16_hi v193, v193
v_lshlrev_b32_sdwa v196, v6, v196 dst_sel:DWORD dst_unused:UNUSED_PAD src0_sel:DWORD src1_sel:WORD_1
v_mul_f32 v225, v195, v225
v_lshlrev_b32_sdwa v197, v6, v197 dst_sel:DWORD dst_unused:UNUSED_PAD src0_sel:DWORD src1_sel:WORD_1
v_mfma_f32_16x16x32_bf16 v[88:91], v[184:187], v[240:243], v[88:91]
ds_read_u16_d16 v196, v196
ds_read_u16_d16_hi v197, v197
v_perm_b32 v188, v236, v232, s58
v_perm_b32 v189, v0, v252, s58
buffer_load_dwordx4 v[120:123], v2, s[8:11], s62 offen offset:2048
s_waitcnt lgkmcnt(3)
v_mfma_f32_16x16x32_bf16 v[20:23], v[160:163], v[244:247], v[20:23]
ds_read_b128 v[240:243], v4 offset:23552
v_exp_f32 v224, v224
v_mov_b32 v190, v8
v_mfma_f32_16x16x32_bf16 v[44:47], v[168:171], v[244:247], v[44:47]
s_setprio 3
v_lshlrev_b32_sdwa v198, v6, v198 dst_sel:DWORD dst_unused:UNUSED_PAD src0_sel:DWORD src1_sel:WORD_1
v_exp_f32 v225, v225
v_mfma_f32_16x16x32_bf16 v[88:91], v[228:231], v[188:191], v[88:91]
ds_read_u16_d16 v198, v198
v_lshlrev_b32_sdwa v199, v6, v199 dst_sel:DWORD dst_unused:UNUSED_PAD src0_sel:DWORD src1_sel:WORD_1
v_add_f32 v224, 1.0, v224
v_mfma_f32_16x16x32_bf16 v[68:71], v[176:179], v[244:247], v[68:71]
ds_read_u16_d16_hi v199, v199
v_add_f32 v225, 1.0, v225
v_rcp_f32 v224, v224
v_mfma_f32_16x16x32_bf16 v[92:95], v[184:187], v[244:247], v[92:95]
v_perm_b32 v188, v236, v232, s59
v_perm_b32 v189, v0, v252, s59
v_mfma_f32_16x16x32_bf16 v[24:27], v[160:163], v[248:251], v[24:27]
ds_read_b128 v[244:247], v4 offset:24576
v_rcp_f32 v225, v225
v_mov_b32 v190, v9
v_mfma_f32_16x16x32_bf16 v[48:51], v[168:171], v[248:251], v[48:51]
v_mul_f32 v224, v194, v224
v_mul_f32 v225, v195, v225
v_mfma_f32_16x16x32_bf16 v[92:95], v[228:231], v[188:191], v[92:95]
v_fmaak_f32 v226, v202, v202, 0x409d30fc
v_lshlrev_b32_sdwa v200, v6, v200 dst_sel:DWORD dst_unused:UNUSED_PAD src0_sel:DWORD src1_sel:WORD_1
v_fmaak_f32 v227, v203, v203, 0x409d30fc
v_mfma_f32_16x16x32_bf16 v[72:75], v[176:179], v[248:251], v[72:75]
ds_read_u16_d16 v200, v200
v_lshlrev_b32_sdwa v201, v6, v201 dst_sel:DWORD dst_unused:UNUSED_PAD src0_sel:DWORD src1_sel:WORD_1
v_mul_f32 v226, v202, v226
v_mfma_f32_16x16x32_bf16 v[96:99], v[184:187], v[248:251], v[96:99]
ds_read_u16_d16_hi v201, v201
v_lshlrev_b32_sdwa v204, v6, v204 dst_sel:DWORD dst_unused:UNUSED_PAD src0_sel:DWORD src1_sel:WORD_1
v_perm_b32 v188, v237, v233, s58
v_perm_b32 v189, v1, v253, s58
s_waitcnt lgkmcnt(2)
v_mfma_f32_16x16x32_bf16 v[28:31], v[160:163], v[240:243], v[28:31]
ds_read_b128 v[248:251], v4 offset:25600
ds_read_u16_d16 v204, v204
v_mul_f32 v227, v203, v227
v_mov_b32 v190, v10
v_mfma_f32_16x16x32_bf16 v[52:55], v[168:171], v[240:243], v[52:55]
v_lshlrev_b32_sdwa v205, v6, v205 dst_sel:DWORD dst_unused:UNUSED_PAD src0_sel:DWORD src1_sel:WORD_1
v_or_b32 v192, v192, v193
v_cvt_pk_bf16_f32 v193, v224, v225
v_mfma_f32_16x16x32_bf16 v[96:99], v[228:231], v[188:191], v[96:99]
ds_read_u16_d16_hi v205, v205
v_or_b32 v194, v196, v197
v_or_b32 v195, v198, v199
v_mfma_f32_16x16x32_bf16 v[76:79], v[176:179], v[240:243], v[76:79]
s_setprio 2
v_exp_f32 v226, v226
v_lshlrev_b32_sdwa v206, v6, v206 dst_sel:DWORD dst_unused:UNUSED_PAD src0_sel:DWORD src1_sel:WORD_1
v_mfma_f32_16x16x32_bf16 v[100:103], v[184:187], v[240:243], v[100:103]
ds_read_u16_d16 v206, v206
v_perm_b32 v188, v237, v233, s59
v_perm_b32 v189, v1, v253, s59
v_mfma_f32_16x16x32_bf16 v[32:35], v[160:163], v[244:247], v[32:35]
ds_read_b128 v[240:243], v15 offset:8192
v_exp_f32 v227, v227
v_mov_b32 v190, v11
v_mfma_f32_16x16x32_bf16 v[56:59], v[168:171], v[244:247], v[56:59]
v_lshlrev_b32_sdwa v207, v6, v207 dst_sel:DWORD dst_unused:UNUSED_PAD src0_sel:DWORD src1_sel:WORD_1
v_add_f32 v226, 1.0, v226
v_mfma_f32_16x16x32_bf16 v[100:103], v[228:231], v[188:191], v[100:103]
ds_read_u16_d16_hi v207, v207
v_add_f32 v227, 1.0, v227
v_rcp_f32 v226, v226
v_mfma_f32_16x16x32_bf16 v[80:83], v[176:179], v[244:247], v[80:83]
v_rcp_f32 v227, v227
v_mfma_f32_16x16x32_bf16 v[104:107], v[184:187], v[244:247], v[104:107]
v_mul_f32 v226, v202, v226
v_perm_b32 v188, v238, v234, s58
v_perm_b32 v189, v235, v254, s58
s_waitcnt lgkmcnt(1)
v_mfma_f32_16x16x32_bf16 v[36:39], v[160:163], v[248:251], v[36:39]
ds_read_b128 v[244:247], v15 offset:9216
v_mul_f32 v227, v203, v227
v_fmaak_f32 v224, v210, v210, 0x409d30fc
v_mov_b32 v190, v12
v_mfma_f32_16x16x32_bf16 v[60:63], v[168:171], v[248:251], v[60:63]
v_lshlrev_b32_sdwa v208, v6, v208 dst_sel:DWORD dst_unused:UNUSED_PAD src0_sel:DWORD src1_sel:WORD_1
v_fmaak_f32 v225, v211, v211, 0x409d30fc
v_mfma_f32_16x16x32_bf16 v[104:107], v[228:231], v[188:191], v[104:107]
ds_read_u16_d16 v208, v208
v_lshlrev_b32_sdwa v209, v6, v209 dst_sel:DWORD dst_unused:UNUSED_PAD src0_sel:DWORD src1_sel:WORD_1
v_mul_f32 v224, v210, v224
v_lshlrev_b32_sdwa v212, v6, v212 dst_sel:DWORD dst_unused:UNUSED_PAD src0_sel:DWORD src1_sel:WORD_1
v_mfma_f32_16x16x32_bf16 v[84:87], v[176:179], v[248:251], v[84:87]
ds_read_u16_d16_hi v209, v209
ds_read_u16_d16 v212, v212
v_mul_f32 v225, v211, v225
v_lshlrev_b32_sdwa v213, v6, v213 dst_sel:DWORD dst_unused:UNUSED_PAD src0_sel:DWORD src1_sel:WORD_1
v_mfma_f32_16x16x32_bf16 v[108:111], v[184:187], v[248:251], v[108:111]
ds_read_u16_d16_hi v213, v213
v_perm_b32 v188, v238, v234, s59
v_perm_b32 v189, v235, v254, s59
v_mov_b32 v190, v13
v_mfma_f32_16x16x32_bf16 v[168:171], v[240:243], v[124:127], 0
s_setprio 1
ds_read_b128 v[248:251], v15 offset:10240
v_or_b32 v200, v200, v201
v_cvt_pk_bf16_f32 v201, v226, v227
v_mfma_f32_16x16x32_bf16 v[108:111], v[228:231], v[188:191], v[108:111]
v_or_b32 v202, v204, v205
s_waitcnt lgkmcnt(2)
v_or_b32 v203, v206, v207
v_mfma_f32_16x16x32_bf16 v[176:179], v[240:243], v[136:139], 0
v_exp_f32 v224, v224
v_lshlrev_b32_sdwa v214, v6, v214 dst_sel:DWORD dst_unused:UNUSED_PAD src0_sel:DWORD src1_sel:WORD_1
v_mfma_f32_16x16x32_bf16 v[184:187], v[240:243], v[148:151], 0
ds_read_u16_d16 v214, v214
v_exp_f32 v225, v225
v_lshlrev_b32_sdwa v215, v6, v215 dst_sel:DWORD dst_unused:UNUSED_PAD src0_sel:DWORD src1_sel:WORD_1
s_add_u32 s3, s52, 0
buffer_load_dwordx3 v[232:234], v5, s[4:7], s3 offen offset:0
v_mfma_f32_16x16x32_bf16 v[168:171], v[244:247], v[128:131], v[168:171]
ds_read_b128 v[240:243], v2 offset:51200
ds_read_u16_d16_hi v215, v215
v_add_f32 v224, 1.0, v224
v_add_f32 v225, 1.0, v225
v_mfma_f32_16x16x32_bf16 v[176:179], v[244:247], v[140:143], v[176:179]
v_rcp_f32 v224, v224
v_mfma_f32_16x16x32_bf16 v[184:187], v[244:247], v[152:155], v[184:187]
v_rcp_f32 v225, v225
v_mul_f32 v224, v210, v224
s_waitcnt lgkmcnt(2)
v_mfma_f32_16x16x32_bf16 v[168:171], v[248:251], v[132:135], v[168:171]
ds_read_b128 v[244:247], v2 offset:52224
v_mul_f32 v225, v211, v225
v_fmaak_f32 v226, v218, v218, 0x409d30fc
v_lshlrev_b32_sdwa v216, v6, v216 dst_sel:DWORD dst_unused:UNUSED_PAD src0_sel:DWORD src1_sel:WORD_1
buffer_load_dwordx3 v[236:238], v5, s[4:7], s3 offen offset:768
v_mfma_f32_16x16x32_bf16 v[176:179], v[248:251], v[144:147], v[176:179]
ds_read_u16_d16 v216, v216
v_fmaak_f32 v227, v219, v219, 0x409d30fc
v_lshlrev_b32_sdwa v217, v6, v217 dst_sel:DWORD dst_unused:UNUSED_PAD src0_sel:DWORD src1_sel:WORD_1
v_mul_f32 v226, v218, v226
v_mfma_f32_16x16x32_bf16 v[184:187], v[248:251], v[156:159], v[184:187]
ds_read_u16_d16_hi v217, v217
v_lshlrev_b32_sdwa v220, v6, v220 dst_sel:DWORD dst_unused:UNUSED_PAD src0_sel:DWORD src1_sel:WORD_1
v_mul_f32 v227, v219, v227
s_waitcnt lgkmcnt(2)
v_mfma_f32_16x16x32_bf16 v[172:175], v[240:243], v[124:127], 0
ds_read_b128 v[248:251], v2 offset:53248
ds_read_u16_d16 v220, v220
v_lshlrev_b32_sdwa v221, v6, v221 dst_sel:DWORD dst_unused:UNUSED_PAD src0_sel:DWORD src1_sel:WORD_1
v_or_b32 v208, v208, v209
v_cvt_pk_bf16_f32 v209, v224, v225
v_mfma_f32_16x16x32_bf16 v[180:183], v[240:243], v[136:139], 0
ds_read_u16_d16_hi v221, v221
v_or_b32 v210, v212, v213
v_or_b32 v211, v214, v215
buffer_load_dwordx3 v[252:254], v5, s[4:7], s3 offen offset:1536
v_mfma_f32_16x16x32_bf16 v[188:191], v[240:243], v[148:151], 0
s_setprio 0
v_exp_f32 v226, v226
v_lshlrev_b32_sdwa v222, v6, v222 dst_sel:DWORD dst_unused:UNUSED_PAD src0_sel:DWORD src1_sel:WORD_1
v_mfma_f32_16x16x32_bf16 v[172:175], v[244:247], v[128:131], v[172:175]
ds_read_b128 v[240:243], v4 offset:26624
ds_read_u16_d16 v222, v222
v_exp_f32 v227, v227
v_mfma_f32_16x16x32_bf16 v[180:183], v[244:247], v[140:143], v[180:183]
v_lshlrev_b32_sdwa v223, v6, v223 dst_sel:DWORD dst_unused:UNUSED_PAD src0_sel:DWORD src1_sel:WORD_1
v_add_f32 v226, 1.0, v226
v_add_f32 v227, 1.0, v227
v_mfma_f32_16x16x32_bf16 v[188:191], v[244:247], v[152:155], v[188:191]
ds_read_u16_d16_hi v223, v223
v_rcp_f32 v226, v226
buffer_load_dwordx2 v[0:1], v5, s[4:7], s3 offen offset:2304
buffer_load_dword v235, v5, s[4:7], s3 offen offset:2312
s_waitcnt lgkmcnt(3)
v_mfma_f32_16x16x32_bf16 v[172:175], v[248:251], v[132:135], v[172:175]
ds_read_b128 v[244:247], v4 offset:27648
v_rcp_f32 v227, v227
v_mul_f32 v226, v218, v226
v_mfma_f32_16x16x32_bf16 v[180:183], v[248:251], v[144:147], v[180:183]
v_mul_f32 v227, v219, v227
v_or_b32 v216, v216, v217
v_mfma_f32_16x16x32_bf16 v[188:191], v[248:251], v[156:159], v[188:191]
v_cvt_pk_bf16_f32 v217, v226, v227
v_or_b32 v218, v220, v221
s_waitcnt lgkmcnt(1)
v_or_b32 v219, v222, v223
v_mfma_f32_16x16x32_bf16 v[16:19], v[192:195], v[240:243], v[16:19]
ds_read_b128 v[248:251], v4 offset:28672
v_fmaak_f32 v224, v168, v168, 0x409d30fc
s_add_u32 s62, s38, 3072
buffer_load_dwordx4 v[124:127], v2, s[8:11], s62 offen offset:0
v_lshlrev_b32_sdwa v170, v6, v170 dst_sel:DWORD dst_unused:UNUSED_PAD src0_sel:DWORD src1_sel:WORD_1
v_mfma_f32_16x16x32_bf16 v[40:43], v[200:203], v[240:243], v[40:43]
ds_read_u16_d16 v170, v170
v_fmaak_f32 v225, v169, v169, 0x409d30fc
v_lshlrev_b32_sdwa v171, v6, v171 dst_sel:DWORD dst_unused:UNUSED_PAD src0_sel:DWORD src1_sel:WORD_1
v_mfma_f32_16x16x32_bf16 v[64:67], v[208:211], v[240:243], v[64:67]
buffer_load_dwordx4 v[128:131], v2, s[8:11], s62 offen offset:1024
ds_read_u16_d16_hi v171, v171
v_mul_f32 v224, v168, v224
v_lshlrev_b32_sdwa v172, v6, v172 dst_sel:DWORD dst_unused:UNUSED_PAD src0_sel:DWORD src1_sel:WORD_1
v_mfma_f32_16x16x32_bf16 v[88:91], v[216:219], v[240:243], v[88:91]
ds_read_u16_d16 v172, v172
v_mul_f32 v225, v169, v225
v_lshlrev_b32_sdwa v173, v6, v173 dst_sel:DWORD dst_unused:UNUSED_PAD src0_sel:DWORD src1_sel:WORD_1
buffer_load_dwordx4 v[132:135], v2, s[8:11], s62 offen offset:2048
s_waitcnt lgkmcnt(2)
v_mfma_f32_16x16x32_bf16 v[20:23], v[192:195], v[244:247], v[20:23]
ds_read_b128 v[240:243], v4 offset:29696
ds_read_u16_d16_hi v173, v173
v_exp_f32 v224, v224
v_mfma_f32_16x16x32_bf16 v[44:47], v[200:203], v[244:247], v[44:47]
s_setprio 3
v_lshlrev_b32_sdwa v174, v6, v174 dst_sel:DWORD dst_unused:UNUSED_PAD src0_sel:DWORD src1_sel:WORD_1
v_exp_f32 v225, v225
v_mfma_f32_16x16x32_bf16 v[68:71], v[208:211], v[244:247], v[68:71]
ds_read_u16_d16 v174, v174
v_lshlrev_b32_sdwa v175, v6, v175 dst_sel:DWORD dst_unused:UNUSED_PAD src0_sel:DWORD src1_sel:WORD_1
v_add_f32 v224, 1.0, v224
v_mfma_f32_16x16x32_bf16 v[92:95], v[216:219], v[244:247], v[92:95]
ds_read_u16_d16_hi v175, v175
v_add_f32 v225, 1.0, v225
v_mfma_f32_16x16x32_bf16 v[24:27], v[192:195], v[248:251], v[24:27]
ds_read_b128 v[244:247], v4 offset:30720
v_rcp_f32 v224, v224
v_mfma_f32_16x16x32_bf16 v[48:51], v[200:203], v[248:251], v[48:51]
v_rcp_f32 v225, v225
v_mul_f32 v224, v168, v224
v_mfma_f32_16x16x32_bf16 v[72:75], v[208:211], v[248:251], v[72:75]
v_mul_f32 v225, v169, v225
v_fmaak_f32 v226, v176, v176, 0x409d30fc
v_mfma_f32_16x16x32_bf16 v[96:99], v[216:219], v[248:251], v[96:99]
v_lshlrev_b32_sdwa v178, v6, v178 dst_sel:DWORD dst_unused:UNUSED_PAD src0_sel:DWORD src1_sel:WORD_1
v_fmaak_f32 v227, v177, v177, 0x409d30fc
s_waitcnt lgkmcnt(1)
v_mfma_f32_16x16x32_bf16 v[28:31], v[192:195], v[240:243], v[28:31]
ds_read_b128 v[248:251], v4 offset:31744
ds_read_u16_d16 v178, v178
v_lshlrev_b32_sdwa v179, v6, v179 dst_sel:DWORD dst_unused:UNUSED_PAD src0_sel:DWORD src1_sel:WORD_1
v_cvt_pk_bf16_f32 v168, v224, v225
v_mfma_f32_16x16x32_bf16 v[52:55], v[200:203], v[240:243], v[52:55]
ds_read_u16_d16_hi v179, v179
v_mul_f32 v226, v176, v226
v_lshlrev_b32_sdwa v180, v6, v180 dst_sel:DWORD dst_unused:UNUSED_PAD src0_sel:DWORD src1_sel:WORD_1
v_mfma_f32_16x16x32_bf16 v[76:79], v[208:211], v[240:243], v[76:79]
ds_read_u16_d16 v180, v180
v_mul_f32 v227, v177, v227
v_lshlrev_b32_sdwa v181, v6, v181 dst_sel:DWORD dst_unused:UNUSED_PAD src0_sel:DWORD src1_sel:WORD_1
v_mfma_f32_16x16x32_bf16 v[100:103], v[216:219], v[240:243], v[100:103]
ds_read_u16_d16_hi v181, v181
v_or_b32 v169, v170, v171
v_or_b32 v170, v172, v173
s_waitcnt lgkmcnt(3)
v_mfma_f32_16x16x32_bf16 v[32:35], v[192:195], v[244:247], v[32:35]
ds_read_b128 v[240:243], v15 offset:17408
v_or_b32 v171, v174, v175
v_exp_f32 v226, v226
v_mfma_f32_16x16x32_bf16 v[56:59], v[200:203], v[244:247], v[56:59]
s_setprio 2
v_lshlrev_b32_sdwa v182, v6, v182 dst_sel:DWORD dst_unused:UNUSED_PAD src0_sel:DWORD src1_sel:WORD_1
v_mfma_f32_16x16x32_bf16 v[80:83], v[208:211], v[244:247], v[80:83]
ds_read_u16_d16 v182, v182
v_exp_f32 v227, v227
v_mfma_f32_16x16x32_bf16 v[104:107], v[216:219], v[244:247], v[104:107]
v_lshlrev_b32_sdwa v183, v6, v183 dst_sel:DWORD dst_unused:UNUSED_PAD src0_sel:DWORD src1_sel:WORD_1
v_add_f32 v226, 1.0, v226
v_mfma_f32_16x16x32_bf16 v[36:39], v[192:195], v[248:251], v[36:39]
ds_read_b128 v[244:247], v15 offset:18432
ds_read_u16_d16_hi v183, v183
v_add_f32 v227, 1.0, v227
v_rcp_f32 v226, v226
v_mfma_f32_16x16x32_bf16 v[60:63], v[200:203], v[248:251], v[60:63]
v_rcp_f32 v227, v227
v_mfma_f32_16x16x32_bf16 v[84:87], v[208:211], v[248:251], v[84:87]
v_mul_f32 v226, v176, v226
v_mul_f32 v227, v177, v227
v_mfma_f32_16x16x32_bf16 v[108:111], v[216:219], v[248:251], v[108:111]
v_fmaak_f32 v224, v184, v184, 0x409d30fc
v_lshlrev_b32_sdwa v186, v6, v186 dst_sel:DWORD dst_unused:UNUSED_PAD src0_sel:DWORD src1_sel:WORD_1
s_waitcnt vmcnt(10) lgkmcnt(2)
v_mfma_f32_16x16x32_bf16 v[192:195], v[240:243], v[112:115], 0
ds_read_b128 v[248:251], v15 offset:19456
ds_read_u16_d16 v186, v186
v_cvt_pk_bf16_f32 v160, v16, v20
v_cvt_pk_bf16_f32 v161, v24, v28
v_cvt_pk_bf16_f32 v162, v32, v36
s_add_u32 s44, s55, 0
buffer_store_dwordx3 v[160:162], v5, s[12:15], s44 offen offset:0 nt
v_mfma_f32_16x16x32_bf16 v[208:211], v[240:243], v[136:139], 0
v_fmaak_f32 v225, v185, v185, 0x409d30fc
v_mfma_f32_16x16x32_bf16 v[216:219], v[240:243], v[148:151], 0
v_lshlrev_b32_sdwa v187, v6, v187 dst_sel:DWORD dst_unused:UNUSED_PAD src0_sel:DWORD src1_sel:WORD_1
v_cvt_pk_bf16_f32 v176, v226, v227
s_waitcnt vmcnt(10) lgkmcnt(2)
v_mfma_f32_16x16x32_bf16 v[192:195], v[244:247], v[116:119], v[192:195]
ds_read_b128 v[240:243], v2 offset:60416
ds_read_u16_d16_hi v187, v187
v_mul_f32 v224, v184, v224
v_lshlrev_b32_sdwa v188, v6, v188 dst_sel:DWORD dst_unused:UNUSED_PAD src0_sel:DWORD src1_sel:WORD_1
v_mfma_f32_16x16x32_bf16 v[208:211], v[244:247], v[140:143], v[208:211]
ds_read_u16_d16 v188, v188
v_mul_f32 v225, v185, v225
v_lshlrev_b32_sdwa v189, v6, v189 dst_sel:DWORD dst_unused:UNUSED_PAD src0_sel:DWORD src1_sel:WORD_1
v_mfma_f32_16x16x32_bf16 v[216:219], v[244:247], v[152:155], v[216:219]
s_setprio 1
ds_read_u16_d16_hi v189, v189
v_or_b32 v177, v178, v179
v_or_b32 v178, v180, v181
s_waitcnt vmcnt(9) lgkmcnt(3)
v_mfma_f32_16x16x32_bf16 v[192:195], v[248:251], v[120:123], v[192:195]
ds_read_b128 v[244:247], v2 offset:61440
v_or_b32 v179, v182, v183
v_exp_f32 v224, v224
v_mfma_f32_16x16x32_bf16 v[208:211], v[248:251], v[144:147], v[208:211]
v_lshlrev_b32_sdwa v190, v6, v190 dst_sel:DWORD dst_unused:UNUSED_PAD src0_sel:DWORD src1_sel:WORD_1
v_mfma_f32_16x16x32_bf16 v[216:219], v[248:251], v[156:159], v[216:219]
ds_read_u16_d16 v190, v190
v_exp_f32 v225, v225
v_mfma_f32_16x16x32_bf16 v[196:199], v[240:243], v[112:115], 0
ds_read_b128 v[248:251], v2 offset:62464
v_cvt_pk_bf16_f32 v164, v17, v21
v_cvt_pk_bf16_f32 v165, v25, v29
v_cvt_pk_bf16_f32 v166, v33, v37
buffer_store_dwordx3 v[164:166], v5, s[12:15], s44 offen offset:768 nt
v_mfma_f32_16x16x32_bf16 v[212:215], v[240:243], v[136:139], 0
v_lshlrev_b32_sdwa v191, v6, v191 dst_sel:DWORD dst_unused:UNUSED_PAD src0_sel:DWORD src1_sel:WORD_1
v_mfma_f32_16x16x32_bf16 v[220:223], v[240:243], v[148:151], 0
ds_read_u16_d16_hi v191, v191
v_add_f32 v224, 1.0, v224
v_add_f32 v225, 1.0, v225
s_waitcnt lgkmcnt(2)
v_mfma_f32_16x16x32_bf16 v[196:199], v[244:247], v[116:119], v[196:199]
ds_read_b128 v[240:243], v3 offset:24576
v_rcp_f32 v224, v224
v_mfma_f32_16x16x32_bf16 v[212:215], v[244:247], v[140:143], v[212:215]
v_rcp_f32 v225, v225
v_mul_f32 v224, v184, v224
v_mfma_f32_16x16x32_bf16 v[220:223], v[244:247], v[152:155], v[220:223]
v_mul_f32 v225, v185, v225
v_cvt_pk_bf16_f32 v184, v224, v225
s_waitcnt lgkmcnt(2)
v_mfma_f32_16x16x32_bf16 v[196:199], v[248:251], v[120:123], v[196:199]
ds_read_b128 v[244:247], v3 offset:25600
v_or_b32 v185, v186, v187
v_or_b32 v186, v188, v189
v_mfma_f32_16x16x32_bf16 v[212:215], v[248:251], v[144:147], v[212:215]
s_waitcnt lgkmcnt(1)
v_or_b32 v187, v190, v191
v_mfma_f32_16x16x32_bf16 v[220:223], v[248:251], v[156:159], v[220:223]
s_setprio 0
v_cvt_pk_bf16_f32 v160, v18, v22
v_cvt_pk_bf16_f32 v161, v26, v30
v_cvt_pk_bf16_f32 v162, v34, v38
buffer_store_dwordx3 v[160:162], v5, s[12:15], s44 offen offset:1536 nt
s_add_u32 s62, s38, 49152
buffer_load_dwordx4 v[136:139], v2, s[8:11], s62 offen offset:0
v_mfma_f32_16x16x32_bf16 v[40:43], v[168:171], v[240:243], v[40:43]
ds_read_b128 v[248:251], v3 offset:26624
v_fmaak_f32 v226, v192, v192, 0x409d30fc
v_lshlrev_b32_sdwa v194, v6, v194 dst_sel:DWORD dst_unused:UNUSED_PAD src0_sel:DWORD src1_sel:WORD_1
v_fmaak_f32 v227, v193, v193, 0x409d30fc
v_mfma_f32_16x16x32_bf16 v[64:67], v[176:179], v[240:243], v[64:67]
buffer_load_dwordx4 v[140:143], v2, s[8:11], s62 offen offset:1024
ds_read_u16_d16 v194, v194
v_lshlrev_b32_sdwa v195, v6, v195 dst_sel:DWORD dst_unused:UNUSED_PAD src0_sel:DWORD src1_sel:WORD_1
v_mul_f32 v226, v192, v226
v_mfma_f32_16x16x32_bf16 v[88:91], v[184:187], v[240:243], v[88:91]
ds_read_u16_d16_hi v195, v195
v_lshlrev_b32_sdwa v196, v6, v196 dst_sel:DWORD dst_unused:UNUSED_PAD src0_sel:DWORD src1_sel:WORD_1
v_mul_f32 v227, v193, v227
v_lshlrev_b32_sdwa v197, v6, v197 dst_sel:DWORD dst_unused:UNUSED_PAD src0_sel:DWORD src1_sel:WORD_1
buffer_load_dwordx4 v[144:147], v2, s[8:11], s62 offen offset:2048
s_waitcnt lgkmcnt(2)
v_mfma_f32_16x16x32_bf16 v[44:47], v[168:171], v[244:247], v[44:47]
ds_read_b128 v[240:243], v3 offset:27648
ds_read_u16_d16 v196, v196
ds_read_u16_d16_hi v197, v197
v_exp_f32 v226, v226
v_mfma_f32_16x16x32_bf16 v[68:71], v[176:179], v[244:247], v[68:71]
v_lshlrev_b32_sdwa v198, v6, v198 dst_sel:DWORD dst_unused:UNUSED_PAD src0_sel:DWORD src1_sel:WORD_1
v_exp_f32 v227, v227
v_mfma_f32_16x16x32_bf16 v[92:95], v[184:187], v[244:247], v[92:95]
ds_read_u16_d16 v198, v198
v_lshlrev_b32_sdwa v199, v6, v199 dst_sel:DWORD dst_unused:UNUSED_PAD src0_sel:DWORD src1_sel:WORD_1
v_add_f32 v226, 1.0, v226
v_mfma_f32_16x16x32_bf16 v[48:51], v[168:171], v[248:251], v[48:51]
ds_read_b128 v[244:247], v3 offset:28672
ds_read_u16_d16_hi v199, v199
v_add_f32 v227, 1.0, v227
v_rcp_f32 v226, v226
v_mfma_f32_16x16x32_bf16 v[72:75], v[176:179], v[248:251], v[72:75]
v_cvt_pk_bf16_f32 v164, v19, v23
v_cvt_pk_bf16_f32 v165, v27, v31
v_cvt_pk_bf16_f32 v166, v35, v39
buffer_store_dwordx3 v[164:166], v5, s[12:15], s44 offen offset:2304 nt
v_mfma_f32_16x16x32_bf16 v[96:99], v[184:187], v[248:251], v[96:99]
v_rcp_f32 v227, v227
s_waitcnt lgkmcnt(2)
v_mfma_f32_16x16x32_bf16 v[52:55], v[168:171], v[240:243], v[52:55]
ds_read_b128 v[248:251], v3 offset:29696
v_mul_f32 v226, v192, v226
v_mul_f32 v227, v193, v227
v_mfma_f32_16x16x32_bf16 v[76:79], v[176:179], v[240:243], v[76:79]
v_cvt_pk_bf16_f32 v192, v226, v227
v_or_b32 v193, v194, v195
v_or_b32 v194, v196, v197
v_mfma_f32_16x16x32_bf16 v[100:103], v[184:187], v[240:243], v[100:103]
s_setprio 3
s_waitcnt lgkmcnt(1)
v_or_b32 v195, v198, v199
v_fmaak_f32 v224, v208, v208, 0x409d30fc
v_mfma_f32_16x16x32_bf16 v[56:59], v[168:171], v[244:247], v[56:59]
ds_read_b128 v[240:243], v15 offset:26624
v_lshlrev_b32_sdwa v210, v6, v210 dst_sel:DWORD dst_unused:UNUSED_PAD src0_sel:DWORD src1_sel:WORD_1
v_fmaak_f32 v225, v209, v209, 0x409d30fc
v_lshlrev_b32_sdwa v211, v6, v211 dst_sel:DWORD dst_unused:UNUSED_PAD src0_sel:DWORD src1_sel:WORD_1
v_mfma_f32_16x16x32_bf16 v[80:83], v[176:179], v[244:247], v[80:83]
ds_read_u16_d16 v210, v210
ds_read_u16_d16_hi v211, v211
v_mul_f32 v224, v208, v224
v_lshlrev_b32_sdwa v212, v6, v212 dst_sel:DWORD dst_unused:UNUSED_PAD src0_sel:DWORD src1_sel:WORD_1
v_mfma_f32_16x16x32_bf16 v[104:107], v[184:187], v[244:247], v[104:107]
ds_read_u16_d16 v212, v212
v_mul_f32 v225, v209, v225
v_lshlrev_b32_sdwa v213, v6, v213 dst_sel:DWORD dst_unused:UNUSED_PAD src0_sel:DWORD src1_sel:WORD_1
s_waitcnt lgkmcnt(3)
v_mfma_f32_16x16x32_bf16 v[60:63], v[168:171], v[248:251], v[60:63]
ds_read_b128 v[244:247], v15 offset:27648
ds_read_u16_d16_hi v213, v213
v_exp_f32 v224, v224
v_lshlrev_b32_sdwa v214, v6, v214 dst_sel:DWORD dst_unused:UNUSED_PAD src0_sel:DWORD src1_sel:WORD_1
v_mfma_f32_16x16x32_bf16 v[84:87], v[176:179], v[248:251], v[84:87]
ds_read_u16_d16 v214, v214
v_exp_f32 v225, v225
v_lshlrev_b32_sdwa v215, v6, v215 dst_sel:DWORD dst_unused:UNUSED_PAD src0_sel:DWORD src1_sel:WORD_1
v_mfma_f32_16x16x32_bf16 v[108:111], v[184:187], v[248:251], v[108:111]
ds_read_u16_d16_hi v215, v215
v_add_f32 v224, 1.0, v224
v_add_f32 v225, 1.0, v225
v_mfma_f32_16x16x32_bf16 v[160:163], v[240:243], v[112:115], 0
ds_read_b128 v[248:251], v15 offset:28672
v_cvt_pk_bf16_f32 v200, v40, v44
v_cvt_pk_bf16_f32 v201, v48, v52
v_cvt_pk_bf16_f32 v202, v56, v60
s_add_u32 s45, s55, 98304
buffer_store_dwordx3 v[200:202], v5, s[12:15], s45 offen offset:0 nt
s_waitcnt vmcnt(10)
v_mfma_f32_16x16x32_bf16 v[168:171], v[240:243], v[124:127], 0
v_rcp_f32 v224, v224
v_mfma_f32_16x16x32_bf16 v[184:187], v[240:243], v[148:151], 0
v_rcp_f32 v225, v225
v_mul_f32 v224, v208, v224
s_waitcnt lgkmcnt(1)
v_mfma_f32_16x16x32_bf16 v[160:163], v[244:247], v[116:119], v[160:163]
ds_read_b128 v[240:243], v2 offset:63488
v_mul_f32 v225, v209, v225
v_fmaak_f32 v226, v216, v216, 0x409d30fc
s_waitcnt vmcnt(9)
v_mfma_f32_16x16x32_bf16 v[168:171], v[244:247], v[128:131], v[168:171]
v_lshlrev_b32_sdwa v218, v6, v218 dst_sel:DWORD dst_unused:UNUSED_PAD src0_sel:DWORD src1_sel:WORD_1
v_fmaak_f32 v227, v217, v217, 0x409d30fc
v_lshlrev_b32_sdwa v219, v6, v219 dst_sel:DWORD dst_unused:UNUSED_PAD src0_sel:DWORD src1_sel:WORD_1
v_mfma_f32_16x16x32_bf16 v[184:187], v[244:247], v[152:155], v[184:187]
s_setprio 2
ds_read_u16_d16 v218, v218
ds_read_u16_d16_hi v219, v219
v_cvt_pk_bf16_f32 v208, v224, v225
v_mul_f32 v226, v216, v226
s_waitcnt lgkmcnt(2)
v_mfma_f32_16x16x32_bf16 v[160:163], v[248:251], v[120:123], v[160:163]
ds_read_b128 v[244:247], v2 offset:64512
v_lshlrev_b32_sdwa v220, v6, v220 dst_sel:DWORD dst_unused:UNUSED_PAD src0_sel:DWORD src1_sel:WORD_1
v_mul_f32 v227, v217, v227
v_lshlrev_b32_sdwa v221, v6, v221 dst_sel:DWORD dst_unused:UNUSED_PAD src0_sel:DWORD src1_sel:WORD_1
s_waitcnt vmcnt(8)
v_mfma_f32_16x16x32_bf16 v[168:171], v[248:251], v[132:135], v[168:171]
ds_read_u16_d16 v220, v220
ds_read_u16_d16_hi v221, v221
v_or_b32 v209, v210, v211
v_or_b32 v210, v212, v213
v_mfma_f32_16x16x32_bf16 v[184:187], v[248:251], v[156:159], v[184:187]
v_or_b32 v211, v214, v215
v_exp_f32 v226, v226
v_mfma_f32_16x16x32_bf16 v[164:167], v[240:243], v[112:115], 0
ds_read_b128 v[248:251], v3 offset:8192
v_cvt_pk_bf16_f32 v204, v41, v45
v_cvt_pk_bf16_f32 v205, v49, v53
v_cvt_pk_bf16_f32 v206, v57, v61
buffer_store_dwordx3 v[204:206], v5, s[12:15], s45 offen offset:768 nt
v_mfma_f32_16x16x32_bf16 v[172:175], v[240:243], v[124:127], 0
v_lshlrev_b32_sdwa v222, v6, v222 dst_sel:DWORD dst_unused:UNUSED_PAD src0_sel:DWORD src1_sel:WORD_1
v_mfma_f32_16x16x32_bf16 v[188:191], v[240:243], v[148:151], 0
ds_read_u16_d16 v222, v222
v_exp_f32 v227, v227
v_lshlrev_b32_sdwa v223, v6, v223 dst_sel:DWORD dst_unused:UNUSED_PAD src0_sel:DWORD src1_sel:WORD_1
s_waitcnt lgkmcnt(2)
v_mfma_f32_16x16x32_bf16 v[164:167], v[244:247], v[116:119], v[164:167]
ds_read_b128 v[240:243], v3 offset:30720
ds_read_u16_d16_hi v223, v223
v_add_f32 v226, 1.0, v226
v_add_f32 v227, 1.0, v227
v_mfma_f32_16x16x32_bf16 v[172:175], v[244:247], v[128:131], v[172:175]
v_rcp_f32 v226, v226
v_rcp_f32 v227, v227
v_mfma_f32_16x16x32_bf16 v[188:191], v[244:247], v[152:155], v[188:191]
v_mul_f32 v226, v216, v226
v_mul_f32 v227, v217, v227
s_waitcnt lgkmcnt(2)
v_mfma_f32_16x16x32_bf16 v[164:167], v[248:251], v[120:123], v[164:167]
ds_read_b128 v[244:247], v3 offset:31744
v_cvt_pk_bf16_f32 v216, v226, v227
v_or_b32 v217, v218, v219
v_mfma_f32_16x16x32_bf16 v[172:175], v[248:251], v[132:135], v[172:175]
v_or_b32 v218, v220, v221
s_waitcnt lgkmcnt(1)
v_or_b32 v219, v222, v223
v_mfma_f32_16x16x32_bf16 v[188:191], v[248:251], v[156:159], v[188:191]
s_setprio 1
v_cvt_pk_bf16_f32 v200, v42, v46
v_cvt_pk_bf16_f32 v201, v50, v54
v_cvt_pk_bf16_f32 v202, v58, v62
buffer_store_dwordx3 v[200:202], v5, s[12:15], s45 offen offset:1536 nt
v_mfma_f32_16x16x32_bf16 v[16:19], v[192:195], v[240:243], 0
ds_read_b128 v[248:251], v3 offset:32768
v_fmaak_f32 v224, v160, v160, 0x409d30fc
s_add_u32 s62, s38, 52224
buffer_load_dwordx4 v[148:151], v2, s[8:11], s62 offen offset:0
v_lshlrev_b32_sdwa v162, v6, v162 dst_sel:DWORD dst_unused:UNUSED_PAD src0_sel:DWORD src1_sel:WORD_1
v_fmaak_f32 v225, v161, v161, 0x409d30fc
v_mfma_f32_16x16x32_bf16 v[64:67], v[208:211], v[240:243], v[64:67]
buffer_load_dwordx4 v[152:155], v2, s[8:11], s62 offen offset:1024
ds_read_u16_d16 v162, v162
v_lshlrev_b32_sdwa v163, v6, v163 dst_sel:DWORD dst_unused:UNUSED_PAD src0_sel:DWORD src1_sel:WORD_1
v_mul_f32 v224, v160, v224
v_lshlrev_b32_sdwa v164, v6, v164 dst_sel:DWORD dst_unused:UNUSED_PAD src0_sel:DWORD src1_sel:WORD_1
v_mfma_f32_16x16x32_bf16 v[88:91], v[216:219], v[240:243], v[88:91]
ds_read_u16_d16_hi v163, v163
ds_read_u16_d16 v164, v164
v_mul_f32 v225, v161, v225
v_lshlrev_b32_sdwa v165, v6, v165 dst_sel:DWORD dst_unused:UNUSED_PAD src0_sel:DWORD src1_sel:WORD_1
v_exp_f32 v224, v224
buffer_load_dwordx4 v[156:159], v2, s[8:11], s62 offen offset:2048
s_waitcnt lgkmcnt(3)
v_mfma_f32_16x16x32_bf16 v[20:23], v[192:195], v[244:247], 0
ds_read_b128 v[240:243], v3 offset:33792
ds_read_u16_d16_hi v165, v165
v_lshlrev_b32_sdwa v166, v6, v166 dst_sel:DWORD dst_unused:UNUSED_PAD src0_sel:DWORD src1_sel:WORD_1
v_exp_f32 v225, v225
v_mfma_f32_16x16x32_bf16 v[68:71], v[208:211], v[244:247], v[68:71]
ds_read_u16_d16 v166, v166
v_lshlrev_b32_sdwa v167, v6, v167 dst_sel:DWORD dst_unused:UNUSED_PAD src0_sel:DWORD src1_sel:WORD_1
v_add_f32 v224, 1.0, v224
v_mfma_f32_16x16x32_bf16 v[92:95], v[216:219], v[244:247], v[92:95]
ds_read_u16_d16_hi v167, v167
v_add_f32 v225, 1.0, v225
v_rcp_f32 v224, v224
v_mfma_f32_16x16x32_bf16 v[24:27], v[192:195], v[248:251], 0
ds_read_b128 v[244:247], v3 offset:34816
v_rcp_f32 v225, v225
v_mul_f32 v224, v160, v224
v_mfma_f32_16x16x32_bf16 v[72:75], v[208:211], v[248:251], v[72:75]
v_cvt_pk_bf16_f32 v204, v43, v47
v_cvt_pk_bf16_f32 v205, v51, v55
v_cvt_pk_bf16_f32 v206, v59, v63
buffer_store_dwordx3 v[204:206], v5, s[12:15], s45 offen offset:2304 nt
v_mfma_f32_16x16x32_bf16 v[96:99], v[216:219], v[248:251], v[96:99]
v_mul_f32 v225, v161, v225
v_fmaak_f32 v226, v168, v168, 0x409d30fc
v_lshlrev_b32_sdwa v170, v6, v170 dst_sel:DWORD dst_unused:UNUSED_PAD src0_sel:DWORD src1_sel:WORD_1
s_waitcnt lgkmcnt(1)
v_mfma_f32_16x16x32_bf16 v[28:31], v[192:195], v[240:243], 0
ds_read_b128 v[248:251], v3 offset:35840
ds_read_u16_d16 v170, v170
v_fmaak_f32 v227, v169, v169, 0x409d30fc
v_lshlrev_b32_sdwa v171, v6, v171 dst_sel:DWORD dst_unused:UNUSED_PAD src0_sel:DWORD src1_sel:WORD_1
v_cvt_pk_bf16_f32 v160, v224, v225
v_mfma_f32_16x16x32_bf16 v[76:79], v[208:211], v[240:243], v[76:79]
ds_read_u16_d16_hi v171, v171
v_mul_f32 v226, v168, v226
v_lshlrev_b32_sdwa v172, v6, v172 dst_sel:DWORD dst_unused:UNUSED_PAD src0_sel:DWORD src1_sel:WORD_1
v_mul_f32 v227, v169, v227
v_mfma_f32_16x16x32_bf16 v[100:103], v[216:219], v[240:243], v[100:103]
s_setprio 0
ds_read_u16_d16 v172, v172
v_lshlrev_b32_sdwa v173, v6, v173 dst_sel:DWORD dst_unused:UNUSED_PAD src0_sel:DWORD src1_sel:WORD_1
v_or_b32 v161, v162, v163
v_or_b32 v162, v164, v165
s_waitcnt lgkmcnt(2)
v_mfma_f32_16x16x32_bf16 v[32:35], v[192:195], v[244:247], 0
ds_read_b128 v[240:243], v15 offset:35840
ds_read_u16_d16_hi v173, v173
v_or_b32 v163, v166, v167
v_exp_f32 v226, v226
v_mfma_f32_16x16x32_bf16 v[80:83], v[208:211], v[244:247], v[80:83]
v_lshlrev_b32_sdwa v174, v6, v174 dst_sel:DWORD dst_unused:UNUSED_PAD src0_sel:DWORD src1_sel:WORD_1
v_exp_f32 v227, v227
v_mfma_f32_16x16x32_bf16 v[104:107], v[216:219], v[244:247], v[104:107]
ds_read_u16_d16 v174, v174
v_lshlrev_b32_sdwa v175, v6, v175 dst_sel:DWORD dst_unused:UNUSED_PAD src0_sel:DWORD src1_sel:WORD_1
v_add_f32 v226, 1.0, v226
v_add_f32 v227, 1.0, v227
v_mfma_f32_16x16x32_bf16 v[36:39], v[192:195], v[248:251], 0
ds_read_b128 v[244:247], v15 offset:36864
ds_read_u16_d16_hi v175, v175
v_rcp_f32 v226, v226
v_rcp_f32 v227, v227
v_mfma_f32_16x16x32_bf16 v[84:87], v[208:211], v[248:251], v[84:87]
v_mul_f32 v226, v168, v226
v_mul_f32 v227, v169, v227
v_mfma_f32_16x16x32_bf16 v[108:111], v[216:219], v[248:251], v[108:111]
v_cvt_pk_bf16_f32 v168, v226, v227
s_waitcnt lgkmcnt(2)
v_or_b32 v169, v170, v171
v_or_b32 v170, v172, v173
v_mfma_f32_16x16x32_bf16 v[192:195], v[240:243], v[112:115], 0
ds_read_b128 v[248:251], v15 offset:37888
v_cvt_pk_bf16_f32 v208, v64, v68
v_cvt_pk_bf16_f32 v209, v72, v76
v_cvt_pk_bf16_f32 v210, v80, v84
s_add_u32 s46, s54, 0
buffer_store_dwordx3 v[208:210], v5, s[12:15], s46 offen offset:0 nt
v_mfma_f32_16x16x32_bf16 v[200:203], v[240:243], v[124:127], 0
s_waitcnt lgkmcnt(1)
v_or_b32 v171, v174, v175
v_fmaak_f32 v224, v184, v184, 0x409d30fc
v_lshlrev_b32_sdwa v186, v6, v186 dst_sel:DWORD dst_unused:UNUSED_PAD src0_sel:DWORD src1_sel:WORD_1
v_mfma_f32_16x16x32_bf16 v[192:195], v[244:247], v[116:119], v[192:195]
ds_read_b128 v[240:243], v3 offset:15360
ds_read_u16_d16 v186, v186
v_fmaak_f32 v225, v185, v185, 0x409d30fc
v_lshlrev_b32_sdwa v187, v6, v187 dst_sel:DWORD dst_unused:UNUSED_PAD src0_sel:DWORD src1_sel:WORD_1
v_mul_f32 v224, v184, v224
v_mfma_f32_16x16x32_bf16 v[200:203], v[244:247], v[128:131], v[200:203]
ds_read_u16_d16_hi v187, v187
v_lshlrev_b32_sdwa v188, v6, v188 dst_sel:DWORD dst_unused:UNUSED_PAD src0_sel:DWORD src1_sel:WORD_1
v_mul_f32 v225, v185, v225
v_lshlrev_b32_sdwa v189, v6, v189 dst_sel:DWORD dst_unused:UNUSED_PAD src0_sel:DWORD src1_sel:WORD_1
s_waitcnt lgkmcnt(3)
v_mfma_f32_16x16x32_bf16 v[192:195], v[248:251], v[120:123], v[192:195]
ds_read_b128 v[244:247], v3 offset:16384
ds_read_u16_d16 v188, v188
ds_read_u16_d16_hi v189, v189
v_exp_f32 v224, v224
v_lshlrev_b32_sdwa v190, v6, v190 dst_sel:DWORD dst_unused:UNUSED_PAD src0_sel:DWORD src1_sel:WORD_1
v_mfma_f32_16x16x32_bf16 v[200:203], v[248:251], v[132:135], v[200:203]
s_setprio 3
ds_read_u16_d16 v190, v190
v_exp_f32 v225, v225
v_lshlrev_b32_sdwa v191, v6, v191 dst_sel:DWORD dst_unused:UNUSED_PAD src0_sel:DWORD src1_sel:WORD_1
s_waitcnt lgkmcnt(4)
v_mfma_f32_16x16x32_bf16 v[196:199], v[240:243], v[112:115], 0
ds_read_b128 v[248:251], v3 offset:17408
ds_read_u16_d16_hi v191, v191
v_cvt_pk_bf16_f32 v212, v65, v69
v_cvt_pk_bf16_f32 v213, v73, v77
v_cvt_pk_bf16_f32 v214, v81, v85
buffer_store_dwordx3 v[212:214], v5, s[12:15], s46 offen offset:768 nt
v_mfma_f32_16x16x32_bf16 v[204:207], v[240:243], v[124:127], 0
v_add_f32 v224, 1.0, v224
v_add_f32 v225, 1.0, v225
v_rcp_f32 v224, v224
s_waitcnt lgkmcnt(2)
v_mfma_f32_16x16x32_bf16 v[196:199], v[244:247], v[116:119], v[196:199]
ds_read_b128 v[240:243], v3 offset:36864
v_rcp_f32 v225, v225
v_mfma_f32_16x16x32_bf16 v[204:207], v[244:247], v[128:131], v[204:207]
v_mul_f32 v224, v184, v224
v_mul_f32 v225, v185, v225
v_cvt_pk_bf16_f32 v184, v224, v225
s_waitcnt lgkmcnt(1)
v_mfma_f32_16x16x32_bf16 v[196:199], v[248:251], v[120:123], v[196:199]
ds_read_b128 v[244:247], v3 offset:37888
v_or_b32 v185, v186, v187
v_or_b32 v186, v188, v189
v_or_b32 v187, v190, v191
v_mfma_f32_16x16x32_bf16 v[204:207], v[248:251], v[132:135], v[204:207]
v_cvt_pk_bf16_f32 v208, v66, v70
v_cvt_pk_bf16_f32 v209, v74, v78
v_cvt_pk_bf16_f32 v210, v82, v86
buffer_store_dwordx3 v[208:210], v5, s[12:15], s46 offen offset:1536 nt
s_waitcnt lgkmcnt(1)
v_mfma_f32_16x16x32_bf16 v[16:19], v[160:163], v[240:243], v[16:19]
ds_read_b128 v[248:251], v3 offset:38912
v_perm_b32 v164, v236, v232, s58
v_perm_b32 v165, v0, v252, s58
v_mfma_f32_16x16x32_bf16 v[40:43], v[168:171], v[240:243], 0
v_fmaak_f32 v226, v192, v192, 0x409d30fc
v_mov_b32 v166, v8
s_nop 1
v_mfma_f32_16x16x32_bf16 v[16:19], v[228:231], v[164:167], v[16:19]
v_lshlrev_b32_sdwa v194, v6, v194 dst_sel:DWORD dst_unused:UNUSED_PAD src0_sel:DWORD src1_sel:WORD_1
v_fmaak_f32 v227, v193, v193, 0x409d30fc
v_mfma_f32_16x16x32_bf16 v[88:91], v[184:187], v[240:243], v[88:91]
ds_read_u16_d16 v194, v194
v_lshlrev_b32_sdwa v195, v6, v195 dst_sel:DWORD dst_unused:UNUSED_PAD src0_sel:DWORD src1_sel:WORD_1
v_mul_f32 v226, v192, v226
s_waitcnt lgkmcnt(1)
v_mfma_f32_16x16x32_bf16 v[20:23], v[160:163], v[244:247], v[20:23]
ds_read_b128 v[240:243], v3 offset:39936
ds_read_u16_d16_hi v195, v195
v_perm_b32 v164, v236, v232, s59
v_perm_b32 v165, v0, v252, s59
v_mfma_f32_16x16x32_bf16 v[44:47], v[168:171], v[244:247], 0
s_setprio 2
v_lshlrev_b32_sdwa v196, v6, v196 dst_sel:DWORD dst_unused:UNUSED_PAD src0_sel:DWORD src1_sel:WORD_1
v_mov_b32 v166, v9
s_nop 1
v_mfma_f32_16x16x32_bf16 v[20:23], v[228:231], v[164:167], v[20:23]
ds_read_u16_d16 v196, v196
v_mul_f32 v227, v193, v227
v_lshlrev_b32_sdwa v197, v6, v197 dst_sel:DWORD dst_unused:UNUSED_PAD src0_sel:DWORD src1_sel:WORD_1
v_mfma_f32_16x16x32_bf16 v[92:95], v[184:187], v[244:247], v[92:95]
ds_read_u16_d16_hi v197, v197
v_exp_f32 v226, v226
v_mfma_f32_16x16x32_bf16 v[24:27], v[160:163], v[248:251], v[24:27]
ds_read_b128 v[244:247], v3 offset:40960
v_perm_b32 v164, v237, v233, s58
v_perm_b32 v165, v1, v253, s58
v_mfma_f32_16x16x32_bf16 v[48:51], v[168:171], v[248:251], 0
v_mov_b32 v166, v10
v_cvt_pk_bf16_f32 v212, v67, v71
v_cvt_pk_bf16_f32 v213, v75, v79
v_cvt_pk_bf16_f32 v214, v83, v87
buffer_store_dwordx3 v[212:214], v5, s[12:15], s46 offen offset:2304 nt
v_mfma_f32_16x16x32_bf16 v[24:27], v[228:231], v[164:167], v[24:27]
v_mfma_f32_16x16x32_bf16 v[96:99], v[184:187], v[248:251], v[96:99]
v_lshlrev_b32_sdwa v198, v6, v198 dst_sel:DWORD dst_unused:UNUSED_PAD src0_sel:DWORD src1_sel:WORD_1
s_waitcnt lgkmcnt(1)
v_mfma_f32_16x16x32_bf16 v[28:31], v[160:163], v[240:243], v[28:31]
ds_read_b128 v[248:251], v3 offset:41984
ds_read_u16_d16 v198, v198
v_perm_b32 v164, v237, v233, s59
v_perm_b32 v165, v1, v253, s59
v_mfma_f32_16x16x32_bf16 v[52:55], v[168:171], v[240:243], 0
v_exp_f32 v227, v227
v_mov_b32 v166, v11
s_nop 1
v_mfma_f32_16x16x32_bf16 v[28:31], v[228:231], v[164:167], v[28:31]
v_lshlrev_b32_sdwa v199, v6, v199 dst_sel:DWORD dst_unused:UNUSED_PAD src0_sel:DWORD src1_sel:WORD_1
v_mfma_f32_16x16x32_bf16 v[100:103], v[184:187], v[240:243], v[100:103]
ds_read_u16_d16_hi v199, v199
v_add_f32 v226, 1.0, v226
v_add_f32 v227, 1.0, v227
s_waitcnt lgkmcnt(2)
v_mfma_f32_16x16x32_bf16 v[32:35], v[160:163], v[244:247], v[32:35]
ds_read_b128 v[240:243], v14 offset:26624
v_perm_b32 v164, v238, v234, s58
v_perm_b32 v165, v235, v254, s58
v_mfma_f32_16x16x32_bf16 v[56:59], v[168:171], v[244:247], 0
s_setprio 1
v_rcp_f32 v226, v226
v_mov_b32 v166, v12
s_nop 1
v_mfma_f32_16x16x32_bf16 v[32:35], v[228:231], v[164:167], v[32:35]
v_rcp_f32 v227, v227
v_mfma_f32_16x16x32_bf16 v[104:107], v[184:187], v[244:247], v[104:107]
v_mul_f32 v226, v192, v226
v_mfma_f32_16x16x32_bf16 v[36:39], v[160:163], v[248:251], v[36:39]
ds_read_b128 v[244:247], v14 offset:27648
v_perm_b32 v164, v238, v234, s59
v_perm_b32 v165, v235, v254, s59
v_mfma_f32_16x16x32_bf16 v[60:63], v[168:171], v[248:251], 0
v_mul_f32 v227, v193, v227
v_mov_b32 v166, v13
s_nop 1
v_mfma_f32_16x16x32_bf16 v[36:39], v[228:231], v[164:167], v[36:39]
v_fmaak_f32 v224, v200, v200, 0x409d30fc
v_lshlrev_b32_sdwa v202, v6, v202 dst_sel:DWORD dst_unused:UNUSED_PAD src0_sel:DWORD src1_sel:WORD_1
v_mfma_f32_16x16x32_bf16 v[108:111], v[184:187], v[248:251], v[108:111]
ds_read_u16_d16 v202, v202
v_fmaak_f32 v225, v201, v201, 0x409d30fc
v_lshlrev_b32_sdwa v203, v6, v203 dst_sel:DWORD dst_unused:UNUSED_PAD src0_sel:DWORD src1_sel:WORD_1
s_waitcnt lgkmcnt(1)
v_mfma_f32_16x16x32_bf16 v[160:163], v[240:243], v[112:115], 0
ds_read_b128 v[248:251], v14 offset:28672
ds_read_u16_d16_hi v203, v203
v_cvt_pk_bf16_f32 v216, v88, v92
v_cvt_pk_bf16_f32 v217, v96, v100
v_cvt_pk_bf16_f32 v218, v104, v108
s_add_u32 s47, s54, 98304
buffer_store_dwordx3 v[216:218], v5, s[12:15], s47 offen offset:0 nt
v_mfma_f32_16x16x32_bf16 v[168:171], v[240:243], v[124:127], 0
v_cvt_pk_bf16_f32 v192, v226, v227
s_waitcnt vmcnt(15)
v_mfma_f32_16x16x32_bf16 v[176:179], v[240:243], v[136:139], 0
v_mul_f32 v224, v200, v224
v_lshlrev_b32_sdwa v204, v6, v204 dst_sel:DWORD dst_unused:UNUSED_PAD src0_sel:DWORD src1_sel:WORD_1
v_mfma_f32_16x16x32_bf16 v[160:163], v[244:247], v[116:119], v[160:163]
ds_read_b128 v[240:243], v2 offset:14336
ds_read_u16_d16 v204, v204
v_mul_f32 v225, v201, v225
v_lshlrev_b32_sdwa v205, v6, v205 dst_sel:DWORD dst_unused:UNUSED_PAD src0_sel:DWORD src1_sel:WORD_1
s_add_u32 s3, s52, 98304
buffer_load_dwordx3 v[232:234], v5, s[4:7], s3 offen offset:0
v_mfma_f32_16x16x32_bf16 v[168:171], v[244:247], v[128:131], v[168:171]
ds_read_u16_d16_hi v205, v205
v_or_b32 v193, v194, v195
v_or_b32 v194, v196, v197
s_waitcnt vmcnt(15)
v_mfma_f32_16x16x32_bf16 v[176:179], v[244:247], v[140:143], v[176:179]
s_setprio 0
v_or_b32 v195, v198, v199
s_waitcnt lgkmcnt(2)
v_mfma_f32_16x16x32_bf16 v[160:163], v[248:251], v[120:123], v[160:163]
ds_read_b128 v[244:247], v2 offset:15360
v_exp_f32 v224, v224
v_lshlrev_b32_sdwa v206, v6, v206 dst_sel:DWORD dst_unused:UNUSED_PAD src0_sel:DWORD src1_sel:WORD_1
v_mfma_f32_16x16x32_bf16 v[168:171], v[248:251], v[132:135], v[168:171]
ds_read_u16_d16 v206, v206
v_exp_f32 v225, v225
buffer_load_dwordx3 v[236:238], v5, s[4:7], s3 offen offset:768
s_waitcnt vmcnt(15)
v_mfma_f32_16x16x32_bf16 v[176:179], v[248:251], v[144:147], v[176:179]
v_lshlrev_b32_sdwa v207, v6, v207 dst_sel:DWORD dst_unused:UNUSED_PAD src0_sel:DWORD src1_sel:WORD_1
v_mfma_f32_16x16x32_bf16 v[164:167], v[240:243], v[112:115], 0
ds_read_b128 v[248:251], v2 offset:16384
ds_read_u16_d16_hi v207, v207
v_cvt_pk_bf16_f32 v220, v89, v93
v_cvt_pk_bf16_f32 v221, v97, v101
v_cvt_pk_bf16_f32 v222, v105, v109
buffer_store_dwordx3 v[220:222], v5, s[12:15], s47 offen offset:768 nt
v_mfma_f32_16x16x32_bf16 v[172:175], v[240:243], v[124:127], 0
v_add_f32 v224, 1.0, v224
v_mfma_f32_16x16x32_bf16 v[180:183], v[240:243], v[136:139], 0
v_add_f32 v225, 1.0, v225
v_rcp_f32 v224, v224
buffer_load_dwordx3 v[252:254], v5, s[4:7], s3 offen offset:1536
s_waitcnt lgkmcnt(2)
v_mfma_f32_16x16x32_bf16 v[164:167], v[244:247], v[116:119], v[164:167]
ds_read_b128 v[240:243], v3 offset:43008
v_rcp_f32 v225, v225
v_mfma_f32_16x16x32_bf16 v[172:175], v[244:247], v[128:131], v[172:175]
v_mul_f32 v224, v200, v224
v_mfma_f32_16x16x32_bf16 v[180:183], v[244:247], v[140:143], v[180:183]
v_mul_f32 v225, v201, v225
v_cvt_pk_bf16_f32 v200, v224, v225
buffer_load_dwordx2 v[0:1], v5, s[4:7], s3 offen offset:2304
buffer_load_dword v235, v5, s[4:7], s3 offen offset:2312
s_waitcnt lgkmcnt(1)
v_mfma_f32_16x16x32_bf16 v[164:167], v[248:251], v[120:123], v[164:167]
ds_read_b128 v[244:247], v3 offset:44032
v_or_b32 v201, v202, v203
v_or_b32 v202, v204, v205
v_mfma_f32_16x16x32_bf16 v[172:175], v[248:251], v[132:135], v[172:175]
v_or_b32 v203, v206, v207
v_mfma_f32_16x16x32_bf16 v[180:183], v[248:251], v[144:147], v[180:183]
s_setprio 3
v_cvt_pk_bf16_f32 v216, v90, v94
v_cvt_pk_bf16_f32 v217, v98, v102
v_cvt_pk_bf16_f32 v218, v106, v110
buffer_store_dwordx3 v[216:218], v5, s[12:15], s47 offen offset:1536 nt
s_waitcnt lgkmcnt(1)
v_mfma_f32_16x16x32_bf16 v[16:19], v[192:195], v[240:243], v[16:19]
ds_read_b128 v[248:251], v3 offset:45056
v_fmaak_f32 v226, v162, v162, 0x409d30fc
v_lshlrev_b32_sdwa v160, v6, v160 dst_sel:DWORD dst_unused:UNUSED_PAD src0_sel:DWORD src1_sel:WORD_1
v_fmaak_f32 v227, v163, v163, 0x409d30fc
v_mfma_f32_16x16x32_bf16 v[40:43], v[200:203], v[240:243], v[40:43]
ds_read_u16_d16 v160, v160
v_lshlrev_b32_sdwa v161, v6, v161 dst_sel:DWORD dst_unused:UNUSED_PAD src0_sel:DWORD src1_sel:WORD_1
v_mul_f32 v226, v162, v226
s_waitcnt lgkmcnt(2)
v_mfma_f32_16x16x32_bf16 v[20:23], v[192:195], v[244:247], v[20:23]
ds_read_b128 v[240:243], v3 offset:46080
ds_read_u16_d16_hi v161, v161
v_lshlrev_b32_sdwa v164, v6, v164 dst_sel:DWORD dst_unused:UNUSED_PAD src0_sel:DWORD src1_sel:WORD_1
v_mul_f32 v227, v163, v227
v_lshlrev_b32_sdwa v165, v6, v165 dst_sel:DWORD dst_unused:UNUSED_PAD src0_sel:DWORD src1_sel:WORD_1
v_mfma_f32_16x16x32_bf16 v[44:47], v[200:203], v[244:247], v[44:47]
ds_read_u16_d16 v164, v164
ds_read_u16_d16_hi v165, v165
v_exp_f32 v226, v226
v_lshlrev_b32_sdwa v166, v6, v166 dst_sel:DWORD dst_unused:UNUSED_PAD src0_sel:DWORD src1_sel:WORD_1
s_waitcnt lgkmcnt(4)
v_mfma_f32_16x16x32_bf16 v[24:27], v[192:195], v[248:251], v[24:27]
ds_read_b128 v[244:247], v3 offset:47104
ds_read_u16_d16 v166, v166
v_exp_f32 v227, v227
v_lshlrev_b32_sdwa v167, v6, v167 dst_sel:DWORD dst_unused:UNUSED_PAD src0_sel:DWORD src1_sel:WORD_1
v_mfma_f32_16x16x32_bf16 v[48:51], v[200:203], v[248:251], v[48:51]
ds_read_u16_d16_hi v167, v167
v_cvt_pk_bf16_f32 v220, v91, v95
v_cvt_pk_bf16_f32 v221, v99, v103
v_cvt_pk_bf16_f32 v222, v107, v111
buffer_store_dwordx3 v[220:222], v5, s[12:15], s47 offen offset:2304 nt
s_waitcnt lgkmcnt(3)
v_mfma_f32_16x16x32_bf16 v[28:31], v[192:195], v[240:243], v[28:31]
ds_read_b128 v[248:251], v3 offset:48128
v_add_f32 v226, 1.0, v226
v_add_f32 v227, 1.0, v227
v_mfma_f32_16x16x32_bf16 v[52:55], v[200:203], v[240:243], v[52:55]
v_rcp_f32 v226, v226
s_waitcnt lgkmcnt(2)
v_mfma_f32_16x16x32_bf16 v[32:35], v[192:195], v[244:247], v[32:35]
ds_read_b128 v[240:243], v14 offset:35840
v_rcp_f32 v227, v227
v_mul_f32 v226, v162, v226
v_mfma_f32_16x16x32_bf16 v[56:59], v[200:203], v[244:247], v[56:59]
v_mul_f32 v227, v163, v227
v_fmaak_f32 v224, v170, v170, 0x409d30fc
v_lshlrev_b32_sdwa v168, v6, v168 dst_sel:DWORD dst_unused:UNUSED_PAD src0_sel:DWORD src1_sel:WORD_1
s_waitcnt lgkmcnt(1)
v_mfma_f32_16x16x32_bf16 v[36:39], v[192:195], v[248:251], v[36:39]
ds_read_b128 v[244:247], v14 offset:36864
ds_read_u16_d16 v168, v168
v_fmaak_f32 v225, v171, v171, 0x409d30fc
v_lshlrev_b32_sdwa v169, v6, v169 dst_sel:DWORD dst_unused:UNUSED_PAD src0_sel:DWORD src1_sel:WORD_1
v_mul_f32 v224, v170, v224
v_mfma_f32_16x16x32_bf16 v[60:63], v[200:203], v[248:251], v[60:63]
s_setprio 2
ds_read_u16_d16_hi v169, v169
v_lshlrev_b32_sdwa v172, v6, v172 dst_sel:DWORD dst_unused:UNUSED_PAD src0_sel:DWORD src1_sel:WORD_1
v_mul_f32 v225, v171, v225
s_waitcnt lgkmcnt(3)
v_mfma_f32_16x16x32_bf16 v[192:195], v[240:243], v[112:115], 0
ds_read_b128 v[248:251], v14 offset:37888
ds_read_u16_d16 v172, v172
v_lshlrev_b32_sdwa v173, v6, v173 dst_sel:DWORD dst_unused:UNUSED_PAD src0_sel:DWORD src1_sel:WORD_1
v_or_b32 v160, v160, v161
v_cvt_pk_bf16_f32 v161, v226, v227
v_mfma_f32_16x16x32_bf16 v[200:203], v[240:243], v[124:127], 0
ds_read_u16_d16_hi v173, v173
v_or_b32 v162, v164, v165
v_or_b32 v163, v166, v167
v_mfma_f32_16x16x32_bf16 v[208:211], v[240:243], v[136:139], 0
v_exp_f32 v224, v224
v_lshlrev_b32_sdwa v174, v6, v174 dst_sel:DWORD dst_unused:UNUSED_PAD src0_sel:DWORD src1_sel:WORD_1
s_waitcnt lgkmcnt(3)
v_mfma_f32_16x16x32_bf16 v[192:195], v[244:247], v[116:119], v[192:195]
ds_read_b128 v[240:243], v2 offset:23552
ds_read_u16_d16 v174, v174
v_exp_f32 v225, v225
v_lshlrev_b32_sdwa v175, v6, v175 dst_sel:DWORD dst_unused:UNUSED_PAD src0_sel:DWORD src1_sel:WORD_1
v_mfma_f32_16x16x32_bf16 v[200:203], v[244:247], v[128:131], v[200:203]
ds_read_u16_d16_hi v175, v175
v_add_f32 v224, 1.0, v224
v_add_f32 v225, 1.0, v225
v_mfma_f32_16x16x32_bf16 v[208:211], v[244:247], v[140:143], v[208:211]
v_rcp_f32 v224, v224
v_rcp_f32 v225, v225
s_waitcnt lgkmcnt(3)
v_mfma_f32_16x16x32_bf16 v[192:195], v[248:251], v[120:123], v[192:195]
ds_read_b128 v[244:247], v2 offset:24576
v_mul_f32 v224, v170, v224
v_mul_f32 v225, v171, v225
v_mfma_f32_16x16x32_bf16 v[200:203], v[248:251], v[132:135], v[200:203]
v_fmaak_f32 v226, v178, v178, 0x409d30fc
v_lshlrev_b32_sdwa v176, v6, v176 dst_sel:DWORD dst_unused:UNUSED_PAD src0_sel:DWORD src1_sel:WORD_1
v_fmaak_f32 v227, v179, v179, 0x409d30fc
v_mfma_f32_16x16x32_bf16 v[208:211], v[248:251], v[144:147], v[208:211]
ds_read_u16_d16 v176, v176
v_lshlrev_b32_sdwa v177, v6, v177 dst_sel:DWORD dst_unused:UNUSED_PAD src0_sel:DWORD src1_sel:WORD_1
v_mul_f32 v226, v178, v226
v_lshlrev_b32_sdwa v180, v6, v180 dst_sel:DWORD dst_unused:UNUSED_PAD src0_sel:DWORD src1_sel:WORD_1
s_waitcnt lgkmcnt(2)
v_mfma_f32_16x16x32_bf16 v[196:199], v[240:243], v[112:115], 0
ds_read_b128 v[248:251], v2 offset:25600
ds_read_u16_d16_hi v177, v177
ds_read_u16_d16 v180, v180
v_mul_f32 v227, v179, v227
v_lshlrev_b32_sdwa v181, v6, v181 dst_sel:DWORD dst_unused:UNUSED_PAD src0_sel:DWORD src1_sel:WORD_1
v_mfma_f32_16x16x32_bf16 v[204:207], v[240:243], v[124:127], 0
ds_read_u16_d16_hi v181, v181
v_or_b32 v168, v168, v169
v_cvt_pk_bf16_f32 v169, v224, v225
v_or_b32 v170, v172, v173
v_mfma_f32_16x16x32_bf16 v[212:215], v[240:243], v[136:139], 0
s_setprio 1
v_or_b32 v171, v174, v175
v_exp_f32 v226, v226
s_waitcnt lgkmcnt(2)
v_mfma_f32_16x16x32_bf16 v[196:199], v[244:247], v[116:119], v[196:199]
ds_read_b128 v[240:243], v3 offset:49152
v_lshlrev_b32_sdwa v182, v6, v182 dst_sel:DWORD dst_unused:UNUSED_PAD src0_sel:DWORD src1_sel:WORD_1
v_exp_f32 v227, v227
v_mfma_f32_16x16x32_bf16 v[204:207], v[244:247], v[128:131], v[204:207]
ds_read_u16_d16 v182, v182
v_lshlrev_b32_sdwa v183, v6, v183 dst_sel:DWORD dst_unused:UNUSED_PAD src0_sel:DWORD src1_sel:WORD_1
v_add_f32 v226, 1.0, v226
v_mfma_f32_16x16x32_bf16 v[212:215], v[244:247], v[140:143], v[212:215]
ds_read_u16_d16_hi v183, v183
v_add_f32 v227, 1.0, v227
v_rcp_f32 v226, v226
v_mfma_f32_16x16x32_bf16 v[196:199], v[248:251], v[120:123], v[196:199]
ds_read_b128 v[244:247], v3 offset:50176
v_rcp_f32 v227, v227
v_mul_f32 v226, v178, v226
v_mfma_f32_16x16x32_bf16 v[204:207], v[248:251], v[132:135], v[204:207]
v_mul_f32 v227, v179, v227
v_or_b32 v176, v176, v177
v_mfma_f32_16x16x32_bf16 v[212:215], v[248:251], v[144:147], v[212:215]
v_cvt_pk_bf16_f32 v177, v226, v227
s_waitcnt lgkmcnt(2)
v_or_b32 v178, v180, v181
s_waitcnt lgkmcnt(1)
v_or_b32 v179, v182, v183
v_mfma_f32_16x16x32_bf16 v[16:19], v[160:163], v[240:243], v[16:19]
ds_read_b128 v[248:251], v3 offset:51200
v_fmaak_f32 v224, v194, v194, 0x409d30fc
v_lshlrev_b32_sdwa v192, v6, v192 dst_sel:DWORD dst_unused:UNUSED_PAD src0_sel:DWORD src1_sel:WORD_1
v_mfma_f32_16x16x32_bf16 v[40:43], v[168:171], v[240:243], v[40:43]
ds_read_u16_d16 v192, v192
v_fmaak_f32 v225, v195, v195, 0x409d30fc
v_lshlrev_b32_sdwa v193, v6, v193 dst_sel:DWORD dst_unused:UNUSED_PAD src0_sel:DWORD src1_sel:WORD_1
v_mfma_f32_16x16x32_bf16 v[64:67], v[176:179], v[240:243], 0
ds_read_u16_d16_hi v193, v193
v_mul_f32 v224, v194, v224
v_lshlrev_b32_sdwa v196, v6, v196 dst_sel:DWORD dst_unused:UNUSED_PAD src0_sel:DWORD src1_sel:WORD_1
s_waitcnt lgkmcnt(3)
v_mfma_f32_16x16x32_bf16 v[20:23], v[160:163], v[244:247], v[20:23]
ds_read_b128 v[240:243], v3 offset:52224
ds_read_u16_d16 v196, v196
v_mul_f32 v225, v195, v225
v_mfma_f32_16x16x32_bf16 v[44:47], v[168:171], v[244:247], v[44:47]
v_lshlrev_b32_sdwa v197, v6, v197 dst_sel:DWORD dst_unused:UNUSED_PAD src0_sel:DWORD src1_sel:WORD_1
v_exp_f32 v224, v224
v_mfma_f32_16x16x32_bf16 v[68:71], v[176:179], v[244:247], 0
s_setprio 0
ds_read_u16_d16_hi v197, v197
v_lshlrev_b32_sdwa v198, v6, v198 dst_sel:DWORD dst_unused:UNUSED_PAD src0_sel:DWORD src1_sel:WORD_1
s_waitcnt lgkmcnt(3)
v_mfma_f32_16x16x32_bf16 v[24:27], v[160:163], v[248:251], v[24:27]
ds_read_b128 v[244:247], v3 offset:53248
ds_read_u16_d16 v198, v198
v_exp_f32 v225, v225
v_mfma_f32_16x16x32_bf16 v[48:51], v[168:171], v[248:251], v[48:51]
v_lshlrev_b32_sdwa v199, v6, v199 dst_sel:DWORD dst_unused:UNUSED_PAD src0_sel:DWORD src1_sel:WORD_1
v_add_f32 v224, 1.0, v224
v_mfma_f32_16x16x32_bf16 v[72:75], v[176:179], v[248:251], 0
ds_read_u16_d16_hi v199, v199
v_add_f32 v225, 1.0, v225
s_waitcnt lgkmcnt(4)
v_mfma_f32_16x16x32_bf16 v[28:31], v[160:163], v[240:243], v[28:31]
ds_read_b128 v[248:251], v3 offset:54272
v_rcp_f32 v224, v224
v_mfma_f32_16x16x32_bf16 v[52:55], v[168:171], v[240:243], v[52:55]
v_rcp_f32 v225, v225
v_mfma_f32_16x16x32_bf16 v[76:79], v[176:179], v[240:243], 0
v_mul_f32 v224, v194, v224
v_mul_f32 v225, v195, v225
s_waitcnt lgkmcnt(2)
v_mfma_f32_16x16x32_bf16 v[32:35], v[160:163], v[244:247], v[32:35]
ds_read_b128 v[240:243], v15 offset:45056
v_fmaak_f32 v226, v202, v202, 0x409d30fc
v_lshlrev_b32_sdwa v200, v6, v200 dst_sel:DWORD dst_unused:UNUSED_PAD src0_sel:DWORD src1_sel:WORD_1
v_mfma_f32_16x16x32_bf16 v[56:59], v[168:171], v[244:247], v[56:59]
ds_read_u16_d16 v200, v200
v_fmaak_f32 v227, v203, v203, 0x409d30fc
v_lshlrev_b32_sdwa v201, v6, v201 dst_sel:DWORD dst_unused:UNUSED_PAD src0_sel:DWORD src1_sel:WORD_1
v_mfma_f32_16x16x32_bf16 v[80:83], v[176:179], v[244:247], 0
ds_read_u16_d16_hi v201, v201
v_mul_f32 v226, v202, v226
v_lshlrev_b32_sdwa v204, v6, v204 dst_sel:DWORD dst_unused:UNUSED_PAD src0_sel:DWORD src1_sel:WORD_1
s_waitcnt lgkmcnt(3)
v_mfma_f32_16x16x32_bf16 v[36:39], v[160:163], v[248:251], v[36:39]
ds_read_b128 v[244:247], v15 offset:46080
ds_read_u16_d16 v204, v204
v_mul_f32 v227, v203, v227
v_lshlrev_b32_sdwa v205, v6, v205 dst_sel:DWORD dst_unused:UNUSED_PAD src0_sel:DWORD src1_sel:WORD_1
v_mfma_f32_16x16x32_bf16 v[60:63], v[168:171], v[248:251], v[60:63]
ds_read_u16_d16_hi v205, v205
v_or_b32 v192, v192, v193
v_cvt_pk_bf16_f32 v193, v224, v225
v_mfma_f32_16x16x32_bf16 v[84:87], v[176:179], v[248:251], 0
s_setprio 3
v_or_b32 v194, v196, v197
s_waitcnt lgkmcnt(3)
v_mfma_f32_16x16x32_bf16 v[160:163], v[240:243], v[112:115], 0
ds_read_b128 v[248:251], v15 offset:47104
v_or_b32 v195, v198, v199
v_exp_f32 v226, v226
v_mfma_f32_16x16x32_bf16 v[168:171], v[240:243], v[124:127], 0
v_lshlrev_b32_sdwa v206, v6, v206 dst_sel:DWORD dst_unused:UNUSED_PAD src0_sel:DWORD src1_sel:WORD_1
v_mfma_f32_16x16x32_bf16 v[176:179], v[240:243], v[136:139], 0
ds_read_u16_d16 v206, v206
v_exp_f32 v227, v227
s_waitcnt vmcnt(16)
v_mfma_f32_16x16x32_bf16 v[184:187], v[240:243], v[148:151], 0
v_lshlrev_b32_sdwa v207, v6, v207 dst_sel:DWORD dst_unused:UNUSED_PAD src0_sel:DWORD src1_sel:WORD_1
v_add_f32 v226, 1.0, v226
s_waitcnt lgkmcnt(2)
v_mfma_f32_16x16x32_bf16 v[160:163], v[244:247], v[116:119], v[160:163]
ds_read_b128 v[240:243], v3 offset:9216
ds_read_u16_d16_hi v207, v207
v_add_f32 v227, 1.0, v227
v_mfma_f32_16x16x32_bf16 v[168:171], v[244:247], v[128:131], v[168:171]
v_rcp_f32 v226, v226
v_mfma_f32_16x16x32_bf16 v[176:179], v[244:247], v[140:143], v[176:179]
v_rcp_f32 v227, v227
s_waitcnt vmcnt(15)
v_mfma_f32_16x16x32_bf16 v[184:187], v[244:247], v[152:155], v[184:187]
v_mul_f32 v226, v202, v226
v_mul_f32 v227, v203, v227
s_waitcnt lgkmcnt(2)
v_mfma_f32_16x16x32_bf16 v[160:163], v[248:251], v[120:123], v[160:163]
ds_read_b128 v[244:247], v3 offset:10240
v_fmaak_f32 v224, v210, v210, 0x409d30fc
v_lshlrev_b32_sdwa v208, v6, v208 dst_sel:DWORD dst_unused:UNUSED_PAD src0_sel:DWORD src1_sel:WORD_1
v_mfma_f32_16x16x32_bf16 v[168:171], v[248:251], v[132:135], v[168:171]
ds_read_u16_d16 v208, v208
v_fmaak_f32 v225, v211, v211, 0x409d30fc
v_lshlrev_b32_sdwa v209, v6, v209 dst_sel:DWORD dst_unused:UNUSED_PAD src0_sel:DWORD src1_sel:WORD_1
v_mfma_f32_16x16x32_bf16 v[176:179], v[248:251], v[144:147], v[176:179]
ds_read_u16_d16_hi v209, v209
v_mul_f32 v224, v210, v224
v_lshlrev_b32_sdwa v212, v6, v212 dst_sel:DWORD dst_unused:UNUSED_PAD src0_sel:DWORD src1_sel:WORD_1
s_waitcnt vmcnt(14)
v_mfma_f32_16x16x32_bf16 v[184:187], v[248:251], v[156:159], v[184:187]
s_setprio 2
ds_read_u16_d16 v212, v212
v_mul_f32 v225, v211, v225
v_lshlrev_b32_sdwa v213, v6, v213 dst_sel:DWORD dst_unused:UNUSED_PAD src0_sel:DWORD src1_sel:WORD_1
s_waitcnt lgkmcnt(3)
v_mfma_f32_16x16x32_bf16 v[164:167], v[240:243], v[112:115], 0
ds_read_b128 v[248:251], v3 offset:11264
ds_read_u16_d16_hi v213, v213
v_or_b32 v200, v200, v201
v_cvt_pk_bf16_f32 v201, v226, v227
v_mfma_f32_16x16x32_bf16 v[172:175], v[240:243], v[124:127], 0
v_or_b32 v202, v204, v205
v_mfma_f32_16x16x32_bf16 v[180:183], v[240:243], v[136:139], 0
v_or_b32 v203, v206, v207
v_exp_f32 v224, v224
v_mfma_f32_16x16x32_bf16 v[188:191], v[240:243], v[148:151], 0
v_lshlrev_b32_sdwa v214, v6, v214 dst_sel:DWORD dst_unused:UNUSED_PAD src0_sel:DWORD src1_sel:WORD_1
v_mfma_f32_16x16x32_bf16 v[164:167], v[244:247], v[116:119], v[164:167]
ds_read_b128 v[240:243], v3 offset:55296
ds_read_u16_d16 v214, v214
v_exp_f32 v225, v225
v_mfma_f32_16x16x32_bf16 v[172:175], v[244:247], v[128:131], v[172:175]
v_lshlrev_b32_sdwa v215, v6, v215 dst_sel:DWORD dst_unused:UNUSED_PAD src0_sel:DWORD src1_sel:WORD_1
v_add_f32 v224, 1.0, v224
v_mfma_f32_16x16x32_bf16 v[180:183], v[244:247], v[140:143], v[180:183]
ds_read_u16_d16_hi v215, v215
v_add_f32 v225, 1.0, v225
v_mfma_f32_16x16x32_bf16 v[188:191], v[244:247], v[152:155], v[188:191]
v_rcp_f32 v224, v224
s_waitcnt lgkmcnt(3)
v_mfma_f32_16x16x32_bf16 v[164:167], v[248:251], v[120:123], v[164:167]
ds_read_b128 v[244:247], v3 offset:56320
v_rcp_f32 v225, v225
v_mfma_f32_16x16x32_bf16 v[172:175], v[248:251], v[132:135], v[172:175]
v_mul_f32 v224, v210, v224
v_mul_f32 v225, v211, v225
v_mfma_f32_16x16x32_bf16 v[180:183], v[248:251], v[144:147], v[180:183]
v_or_b32 v208, v208, v209
v_cvt_pk_bf16_f32 v209, v224, v225
v_mfma_f32_16x16x32_bf16 v[188:191], v[248:251], v[156:159], v[188:191]
s_setprio 1
v_or_b32 v210, v212, v213
s_waitcnt lgkmcnt(1)
v_or_b32 v211, v214, v215
v_mfma_f32_16x16x32_bf16 v[16:19], v[192:195], v[240:243], v[16:19]
ds_read_b128 v[248:251], v3 offset:57344
v_fmaak_f32 v226, v160, v160, 0x409d30fc
v_lshlrev_b32_sdwa v162, v6, v162 dst_sel:DWORD dst_unused:UNUSED_PAD src0_sel:DWORD src1_sel:WORD_1
v_fmaak_f32 v227, v161, v161, 0x409d30fc
v_mfma_f32_16x16x32_bf16 v[40:43], v[200:203], v[240:243], v[40:43]
ds_read_u16_d16 v162, v162
s_waitcnt vmcnt(6)
v_perm_b32 v204, v236, v232, s58
s_waitcnt vmcnt(3)
v_perm_b32 v205, v0, v252, s58
v_mfma_f32_16x16x32_bf16 v[64:67], v[208:211], v[240:243], v[64:67]
v_lshlrev_b32_sdwa v163, v6, v163 dst_sel:DWORD dst_unused:UNUSED_PAD src0_sel:DWORD src1_sel:WORD_1
v_mul_f32 v226, v160, v226
v_mov_b32 v206, v8
s_nop 1
v_mfma_f32_16x16x32_bf16 v[40:43], v[228:231], v[204:207], v[40:43]
ds_read_u16_d16_hi v163, v163
v_lshlrev_b32_sdwa v164, v6, v164 dst_sel:DWORD dst_unused:UNUSED_PAD src0_sel:DWORD src1_sel:WORD_1
v_mul_f32 v227, v161, v227
s_waitcnt lgkmcnt(2)
v_mfma_f32_16x16x32_bf16 v[20:23], v[192:195], v[244:247], v[20:23]
ds_read_b128 v[240:243], v3 offset:58368
ds_read_u16_d16 v164, v164
v_lshlrev_b32_sdwa v165, v6, v165 dst_sel:DWORD dst_unused:UNUSED_PAD src0_sel:DWORD src1_sel:WORD_1
v_exp_f32 v226, v226
v_mfma_f32_16x16x32_bf16 v[44:47], v[200:203], v[244:247], v[44:47]
ds_read_u16_d16_hi v165, v165
v_perm_b32 v204, v236, v232, s59
v_perm_b32 v205, v0, v252, s59
v_mfma_f32_16x16x32_bf16 v[68:71], v[208:211], v[244:247], v[68:71]
v_lshlrev_b32_sdwa v166, v6, v166 dst_sel:DWORD dst_unused:UNUSED_PAD src0_sel:DWORD src1_sel:WORD_1
v_mov_b32 v206, v9
s_nop 1
v_mfma_f32_16x16x32_bf16 v[44:47], v[228:231], v[204:207], v[44:47]
ds_read_u16_d16 v166, v166
v_exp_f32 v227, v227
v_lshlrev_b32_sdwa v167, v6, v167 dst_sel:DWORD dst_unused:UNUSED_PAD src0_sel:DWORD src1_sel:WORD_1
v_mfma_f32_16x16x32_bf16 v[24:27], v[192:195], v[248:251], v[24:27]
ds_read_b128 v[244:247], v3 offset:59392
ds_read_u16_d16_hi v167, v167
v_add_f32 v226, 1.0, v226
v_add_f32 v227, 1.0, v227
v_mfma_f32_16x16x32_bf16 v[48:51], v[200:203], v[248:251], v[48:51]
v_rcp_f32 v226, v226
v_perm_b32 v204, v237, v233, s58
v_perm_b32 v205, v1, v253, s58
v_mfma_f32_16x16x32_bf16 v[72:75], v[208:211], v[248:251], v[72:75]
v_mov_b32 v206, v10
s_nop 1
v_mfma_f32_16x16x32_bf16 v[48:51], v[228:231], v[204:207], v[48:51]
s_setprio 0
v_rcp_f32 v227, v227
v_mul_f32 v226, v160, v226
v_mul_f32 v227, v161, v227
s_waitcnt lgkmcnt(0)
v_mfma_f32_16x16x32_bf16 v[28:31], v[192:195], v[240:243], v[28:31]
ds_read_b128 v[248:251], v3 offset:60416
v_fmaak_f32 v224, v168, v168, 0x409d30fc
v_lshlrev_b32_sdwa v170, v6, v170 dst_sel:DWORD dst_unused:UNUSED_PAD src0_sel:DWORD src1_sel:WORD_1
v_mfma_f32_16x16x32_bf16 v[52:55], v[200:203], v[240:243], v[52:55]
ds_read_u16_d16 v170, v170
v_fmaak_f32 v225, v169, v169, 0x409d30fc
v_perm_b32 v204, v237, v233, s59
v_perm_b32 v205, v1, v253, s59
v_mfma_f32_16x16x32_bf16 v[76:79], v[208:211], v[240:243], v[76:79]
v_lshlrev_b32_sdwa v171, v6, v171 dst_sel:DWORD dst_unused:UNUSED_PAD src0_sel:DWORD src1_sel:WORD_1
v_mov_b32 v206, v11
s_nop 1
v_mfma_f32_16x16x32_bf16 v[52:55], v[228:231], v[204:207], v[52:55]
ds_read_u16_d16_hi v171, v171
v_cvt_pk_bf16_f32 v160, v226, v227
v_mul_f32 v224, v168, v224
v_lshlrev_b32_sdwa v172, v6, v172 dst_sel:DWORD dst_unused:UNUSED_PAD src0_sel:DWORD src1_sel:WORD_1
v_mfma_f32_16x16x32_bf16 v[32:35], v[192:195], v[244:247], v[32:35]
ds_read_b128 v[240:243], v15 offset:54272
ds_read_u16_d16 v172, v172
v_mul_f32 v225, v169, v225
v_lshlrev_b32_sdwa v173, v6, v173 dst_sel:DWORD dst_unused:UNUSED_PAD src0_sel:DWORD src1_sel:WORD_1
v_mfma_f32_16x16x32_bf16 v[56:59], v[200:203], v[244:247], v[56:59]
ds_read_u16_d16_hi v173, v173
v_or_b32 v161, v162, v163
v_perm_b32 v204, v238, v234, s58
s_waitcnt vmcnt(2)
v_perm_b32 v205, v235, v254, s58
v_mfma_f32_16x16x32_bf16 v[80:83], v[208:211], v[244:247], v[80:83]
v_or_b32 v162, v164, v165
v_mov_b32 v206, v12
s_nop 1
v_mfma_f32_16x16x32_bf16 v[56:59], v[228:231], v[204:207], v[56:59]
v_or_b32 v163, v166, v167
v_exp_f32 v224, v224
s_waitcnt lgkmcnt(1)
v_mfma_f32_16x16x32_bf16 v[36:39], v[192:195], v[248:251], v[36:39]
ds_read_b128 v[244:247], v15 offset:55296
v_lshlrev_b32_sdwa v174, v6, v174 dst_sel:DWORD dst_unused:UNUSED_PAD src0_sel:DWORD src1_sel:WORD_1
v_exp_f32 v225, v225
v_mfma_f32_16x16x32_bf16 v[60:63], v[200:203], v[248:251], v[60:63]
ds_read_u16_d16 v174, v174
v_perm_b32 v204, v238, v234, s59
v_perm_b32 v205, v235, v254, s59
v_mfma_f32_16x16x32_bf16 v[84:87], v[208:211], v[248:251], v[84:87]
v_lshlrev_b32_sdwa v175, v6, v175 dst_sel:DWORD dst_unused:UNUSED_PAD src0_sel:DWORD src1_sel:WORD_1
v_mov_b32 v206, v13
s_nop 1
v_mfma_f32_16x16x32_bf16 v[60:63], v[228:231], v[204:207], v[60:63]
s_setprio 3
ds_read_u16_d16_hi v175, v175
v_add_f32 v224, 1.0, v224
v_add_f32 v225, 1.0, v225
v_mfma_f32_16x16x32_bf16 v[192:195], v[240:243], v[112:115], 0
ds_read_b128 v[248:251], v15 offset:56320
v_rcp_f32 v224, v224
v_rcp_f32 v225, v225
v_mfma_f32_16x16x32_bf16 v[200:203], v[240:243], v[124:127], 0
v_mul_f32 v224, v168, v224
v_mul_f32 v225, v169, v225
v_mfma_f32_16x16x32_bf16 v[208:211], v[240:243], v[136:139], 0
v_fmaak_f32 v226, v176, v176, 0x409d30fc
v_lshlrev_b32_sdwa v178, v6, v178 dst_sel:DWORD dst_unused:UNUSED_PAD src0_sel:DWORD src1_sel:WORD_1
v_fmaak_f32 v227, v177, v177, 0x409d30fc
v_mfma_f32_16x16x32_bf16 v[216:219], v[240:243], v[148:151], 0
ds_read_u16_d16 v178, v178
v_lshlrev_b32_sdwa v179, v6, v179 dst_sel:DWORD dst_unused:UNUSED_PAD src0_sel:DWORD src1_sel:WORD_1
v_cvt_pk_bf16_f32 v168, v224, v225
s_waitcnt lgkmcnt(1)
v_mfma_f32_16x16x32_bf16 v[192:195], v[244:247], v[116:119], v[192:195]
ds_read_b128 v[240:243], v3 offset:18432
ds_read_u16_d16_hi v179, v179
v_mul_f32 v226, v176, v226
v_lshlrev_b32_sdwa v180, v6, v180 dst_sel:DWORD dst_unused:UNUSED_PAD src0_sel:DWORD src1_sel:WORD_1
v_mul_f32 v227, v177, v227
s_add_u32 s3, s53, 0
buffer_load_dwordx3 v[232:234], v5, s[4:7], s3 offen offset:0
v_mfma_f32_16x16x32_bf16 v[200:203], v[244:247], v[128:131], v[200:203]
ds_read_u16_d16 v180, v180
v_lshlrev_b32_sdwa v181, v6, v181 dst_sel:DWORD dst_unused:UNUSED_PAD src0_sel:DWORD src1_sel:WORD_1
v_or_b32 v169, v170, v171
v_mfma_f32_16x16x32_bf16 v[208:211], v[244:247], v[140:143], v[208:211]
ds_read_u16_d16_hi v181, v181
v_or_b32 v170, v172, v173
v_or_b32 v171, v174, v175
v_mfma_f32_16x16x32_bf16 v[216:219], v[244:247], v[152:155], v[216:219]
v_exp_f32 v226, v226
v_lshlrev_b32_sdwa v182, v6, v182 dst_sel:DWORD dst_unused:UNUSED_PAD src0_sel:DWORD src1_sel:WORD_1
v_mfma_f32_16x16x32_bf16 v[192:195], v[248:251], v[120:123], v[192:195]
ds_read_b128 v[244:247], v3 offset:19456
ds_read_u16_d16 v182, v182
v_exp_f32 v227, v227
v_lshlrev_b32_sdwa v183, v6, v183 dst_sel:DWORD dst_unused:UNUSED_PAD src0_sel:DWORD src1_sel:WORD_1
v_mfma_f32_16x16x32_bf16 v[200:203], v[248:251], v[132:135], v[200:203]
ds_read_u16_d16_hi v183, v183
v_add_f32 v226, 1.0, v226
v_add_f32 v227, 1.0, v227
buffer_load_dwordx3 v[236:238], v5, s[4:7], s3 offen offset:768
v_mfma_f32_16x16x32_bf16 v[208:211], v[248:251], v[144:147], v[208:211]
v_rcp_f32 v226, v226
v_mfma_f32_16x16x32_bf16 v[216:219], v[248:251], v[156:159], v[216:219]
s_setprio 2
v_rcp_f32 v227, v227
v_mul_f32 v226, v176, v226
s_waitcnt lgkmcnt(1)
v_mfma_f32_16x16x32_bf16 v[196:199], v[240:243], v[112:115], 0
ds_read_b128 v[248:251], v3 offset:20480
v_mul_f32 v227, v177, v227
v_fmaak_f32 v224, v184, v184, 0x409d30fc
v_lshlrev_b32_sdwa v186, v6, v186 dst_sel:DWORD dst_unused:UNUSED_PAD src0_sel:DWORD src1_sel:WORD_1
v_mfma_f32_16x16x32_bf16 v[204:207], v[240:243], v[124:127], 0
ds_read_u16_d16 v186, v186
v_fmaak_f32 v225, v185, v185, 0x409d30fc
v_lshlrev_b32_sdwa v187, v6, v187 dst_sel:DWORD dst_unused:UNUSED_PAD src0_sel:DWORD src1_sel:WORD_1
v_cvt_pk_bf16_f32 v176, v226, v227
v_mfma_f32_16x16x32_bf16 v[212:215], v[240:243], v[136:139], 0
ds_read_u16_d16_hi v187, v187
v_mul_f32 v224, v184, v224
v_lshlrev_b32_sdwa v188, v6, v188 dst_sel:DWORD dst_unused:UNUSED_PAD src0_sel:DWORD src1_sel:WORD_1
buffer_load_dwordx3 v[252:254], v5, s[4:7], s3 offen offset:1536
v_mfma_f32_16x16x32_bf16 v[220:223], v[240:243], v[148:151], 0
ds_read_u16_d16 v188, v188
v_mul_f32 v225, v185, v225
v_lshlrev_b32_sdwa v189, v6, v189 dst_sel:DWORD dst_unused:UNUSED_PAD src0_sel:DWORD src1_sel:WORD_1
v_or_b32 v177, v178, v179
v_mfma_f32_16x16x32_bf16 v[196:199], v[244:247], v[116:119], v[196:199]
ds_read_b128 v[240:243], v3 offset:61440
ds_read_u16_d16_hi v189, v189
v_or_b32 v178, v180, v181
s_waitcnt lgkmcnt(3)
v_or_b32 v179, v182, v183
v_mfma_f32_16x16x32_bf16 v[204:207], v[244:247], v[128:131], v[204:207]
v_exp_f32 v224, v224
v_lshlrev_b32_sdwa v190, v6, v190 dst_sel:DWORD dst_unused:UNUSED_PAD src0_sel:DWORD src1_sel:WORD_1
v_mfma_f32_16x16x32_bf16 v[212:215], v[244:247], v[140:143], v[212:215]
ds_read_u16_d16 v190, v190
v_exp_f32 v225, v225
v_mfma_f32_16x16x32_bf16 v[220:223], v[244:247], v[152:155], v[220:223]
v_lshlrev_b32_sdwa v191, v6, v191 dst_sel:DWORD dst_unused:UNUSED_PAD src0_sel:DWORD src1_sel:WORD_1
v_add_f32 v224, 1.0, v224
v_add_f32 v225, 1.0, v225
buffer_load_dwordx2 v[0:1], v5, s[4:7], s3 offen offset:2304
buffer_load_dword v235, v5, s[4:7], s3 offen offset:2312
v_mfma_f32_16x16x32_bf16 v[196:199], v[248:251], v[120:123], v[196:199]
ds_read_b128 v[244:247], v3 offset:62464
ds_read_u16_d16_hi v191, v191
v_rcp_f32 v224, v224
v_mfma_f32_16x16x32_bf16 v[204:207], v[248:251], v[132:135], v[204:207]
v_rcp_f32 v225, v225
v_mul_f32 v224, v184, v224
v_mfma_f32_16x16x32_bf16 v[212:215], v[248:251], v[144:147], v[212:215]
v_mul_f32 v225, v185, v225
v_cvt_pk_bf16_f32 v184, v224, v225
v_mfma_f32_16x16x32_bf16 v[220:223], v[248:251], v[156:159], v[220:223]
s_setprio 1
v_or_b32 v185, v186, v187
s_waitcnt lgkmcnt(2)
v_or_b32 v186, v188, v189
s_waitcnt lgkmcnt(0)
v_or_b32 v187, v190, v191
v_mfma_f32_16x16x32_bf16 v[16:19], v[160:163], v[240:243], v[16:19]
ds_read_b128 v[248:251], v3 offset:63488
v_fmaak_f32 v226, v192, v192, 0x409d30fc
v_lshlrev_b32_sdwa v194, v6, v194 dst_sel:DWORD dst_unused:UNUSED_PAD src0_sel:DWORD src1_sel:WORD_1
v_mfma_f32_16x16x32_bf16 v[40:43], v[168:171], v[240:243], v[40:43]
ds_read_u16_d16 v194, v194
v_fmaak_f32 v227, v193, v193, 0x409d30fc
v_lshlrev_b32_sdwa v195, v6, v195 dst_sel:DWORD dst_unused:UNUSED_PAD src0_sel:DWORD src1_sel:WORD_1
v_mfma_f32_16x16x32_bf16 v[64:67], v[176:179], v[240:243], v[64:67]
ds_read_u16_d16_hi v195, v195
v_mul_f32 v226, v192, v226
v_lshlrev_b32_sdwa v196, v6, v196 dst_sel:DWORD dst_unused:UNUSED_PAD src0_sel:DWORD src1_sel:WORD_1
v_mul_f32 v227, v193, v227
v_mfma_f32_16x16x32_bf16 v[88:91], v[184:187], v[240:243], 0
ds_read_u16_d16 v196, v196
v_lshlrev_b32_sdwa v197, v6, v197 dst_sel:DWORD dst_unused:UNUSED_PAD src0_sel:DWORD src1_sel:WORD_1
v_mfma_f32_16x16x32_bf16 v[20:23], v[160:163], v[244:247], v[20:23]
ds_read_b128 v[240:243], v3 offset:64512
ds_read_u16_d16_hi v197, v197
v_exp_f32 v226, v226
v_lshlrev_b32_sdwa v198, v6, v198 dst_sel:DWORD dst_unused:UNUSED_PAD src0_sel:DWORD src1_sel:WORD_1
v_mfma_f32_16x16x32_bf16 v[44:47], v[168:171], v[244:247], v[44:47]
ds_read_u16_d16 v198, v198
v_exp_f32 v227, v227
v_mfma_f32_16x16x32_bf16 v[68:71], v[176:179], v[244:247], v[68:71]
v_lshlrev_b32_sdwa v199, v6, v199 dst_sel:DWORD dst_unused:UNUSED_PAD src0_sel:DWORD src1_sel:WORD_1
v_add_f32 v226, 1.0, v226
v_mfma_f32_16x16x32_bf16 v[92:95], v[184:187], v[244:247], 0
ds_read_u16_d16_hi v199, v199
v_add_f32 v227, 1.0, v227
v_rcp_f32 v226, v226
s_waitcnt lgkmcnt(2)
v_mfma_f32_16x16x32_bf16 v[24:27], v[160:163], v[248:251], v[24:27]
ds_read_b128 v[244:247], v4 offset:0
v_rcp_f32 v227, v227
v_mfma_f32_16x16x32_bf16 v[48:51], v[168:171], v[248:251], v[48:51]
v_mul_f32 v226, v192, v226
v_mul_f32 v227, v193, v227
v_mfma_f32_16x16x32_bf16 v[72:75], v[176:179], v[248:251], v[72:75]
v_fmaak_f32 v224, v200, v200, 0x409d30fc
v_lshlrev_b32_sdwa v202, v6, v202 dst_sel:DWORD dst_unused:UNUSED_PAD src0_sel:DWORD src1_sel:WORD_1
v_mfma_f32_16x16x32_bf16 v[96:99], v[184:187], v[248:251], 0
s_setprio 0
ds_read_u16_d16 v202, v202
v_fmaak_f32 v225, v201, v201, 0x409d30fc
v_lshlrev_b32_sdwa v203, v6, v203 dst_sel:DWORD dst_unused:UNUSED_PAD src0_sel:DWORD src1_sel:WORD_1
v_mfma_f32_16x16x32_bf16 v[28:31], v[160:163], v[240:243], v[28:31]
ds_read_b128 v[248:251], v4 offset:1024
ds_read_u16_d16_hi v203, v203
v_cvt_pk_bf16_f32 v192, v226, v227
v_mul_f32 v224, v200, v224
v_mfma_f32_16x16x32_bf16 v[52:55], v[168:171], v[240:243], v[52:55]
v_lshlrev_b32_sdwa v204, v6, v204 dst_sel:DWORD dst_unused:UNUSED_PAD src0_sel:DWORD src1_sel:WORD_1
v_mul_f32 v225, v201, v225
v_mfma_f32_16x16x32_bf16 v[76:79], v[176:179], v[240:243], v[76:79]
ds_read_u16_d16 v204, v204
v_lshlrev_b32_sdwa v205, v6, v205 dst_sel:DWORD dst_unused:UNUSED_PAD src0_sel:DWORD src1_sel:WORD_1
v_or_b32 v193, v194, v195
v_or_b32 v194, v196, v197
v_mfma_f32_16x16x32_bf16 v[100:103], v[184:187], v[240:243], 0
ds_read_u16_d16_hi v205, v205
s_waitcnt lgkmcnt(2)
v_or_b32 v195, v198, v199
v_mfma_f32_16x16x32_bf16 v[32:35], v[160:163], v[244:247], v[32:35]
ds_read_b128 v[240:243], v14 offset:8192
v_exp_f32 v224, v224
v_lshlrev_b32_sdwa v206, v6, v206 dst_sel:DWORD dst_unused:UNUSED_PAD src0_sel:DWORD src1_sel:WORD_1
v_mfma_f32_16x16x32_bf16 v[56:59], v[168:171], v[244:247], v[56:59]
ds_read_u16_d16 v206, v206
v_exp_f32 v225, v225
v_mfma_f32_16x16x32_bf16 v[80:83], v[176:179], v[244:247], v[80:83]
v_lshlrev_b32_sdwa v207, v6, v207 dst_sel:DWORD dst_unused:UNUSED_PAD src0_sel:DWORD src1_sel:WORD_1
v_add_f32 v224, 1.0, v224
v_mfma_f32_16x16x32_bf16 v[104:107], v[184:187], v[244:247], 0
ds_read_u16_d16_hi v207, v207
v_add_f32 v225, 1.0, v225
v_rcp_f32 v224, v224
v_mfma_f32_16x16x32_bf16 v[36:39], v[160:163], v[248:251], v[36:39]
ds_read_b128 v[244:247], v14 offset:9216
v_rcp_f32 v225, v225
v_mfma_f32_16x16x32_bf16 v[60:63], v[168:171], v[248:251], v[60:63]
v_mul_f32 v224, v200, v224
v_mul_f32 v225, v201, v225
v_mfma_f32_16x16x32_bf16 v[84:87], v[176:179], v[248:251], v[84:87]
v_fmaak_f32 v226, v208, v208, 0x409d30fc
v_lshlrev_b32_sdwa v210, v6, v210 dst_sel:DWORD dst_unused:UNUSED_PAD src0_sel:DWORD src1_sel:WORD_1
v_mfma_f32_16x16x32_bf16 v[108:111], v[184:187], v[248:251], 0
s_setprio 3
ds_read_u16_d16 v210, v210
v_fmaak_f32 v227, v209, v209, 0x409d30fc
v_lshlrev_b32_sdwa v211, v6, v211 dst_sel:DWORD dst_unused:UNUSED_PAD src0_sel:DWORD src1_sel:WORD_1
s_waitcnt lgkmcnt(1)
v_mfma_f32_16x16x32_bf16 v[160:163], v[240:243], v[112:115], 0
ds_read_b128 v[248:251], v14 offset:10240
ds_read_u16_d16_hi v211, v211
v_cvt_pk_bf16_f32 v200, v224, v225
v_mul_f32 v226, v208, v226
v_mfma_f32_16x16x32_bf16 v[168:171], v[240:243], v[124:127], 0
v_lshlrev_b32_sdwa v212, v6, v212 dst_sel:DWORD dst_unused:UNUSED_PAD src0_sel:DWORD src1_sel:WORD_1
v_mul_f32 v227, v209, v227
v_mfma_f32_16x16x32_bf16 v[176:179], v[240:243], v[136:139], 0
ds_read_u16_d16 v212, v212
v_lshlrev_b32_sdwa v213, v6, v213 dst_sel:DWORD dst_unused:UNUSED_PAD src0_sel:DWORD src1_sel:WORD_1
v_or_b32 v201, v202, v203
v_mfma_f32_16x16x32_bf16 v[184:187], v[240:243], v[148:151], 0
ds_read_u16_d16_hi v213, v213
v_or_b32 v202, v204, v205
v_or_b32 v203, v206, v207
v_mfma_f32_16x16x32_bf16 v[160:163], v[244:247], v[116:119], v[160:163]
ds_read_b128 v[240:243], v2 offset:32768
v_exp_f32 v226, v226
v_lshlrev_b32_sdwa v214, v6, v214 dst_sel:DWORD dst_unused:UNUSED_PAD src0_sel:DWORD src1_sel:WORD_1
v_mfma_f32_16x16x32_bf16 v[168:171], v[244:247], v[128:131], v[168:171]
ds_read_u16_d16 v214, v214
v_exp_f32 v227, v227
v_mfma_f32_16x16x32_bf16 v[176:179], v[244:247], v[140:143], v[176:179]
v_lshlrev_b32_sdwa v215, v6, v215 dst_sel:DWORD dst_unused:UNUSED_PAD src0_sel:DWORD src1_sel:WORD_1
v_add_f32 v226, 1.0, v226
v_mfma_f32_16x16x32_bf16 v[184:187], v[244:247], v[152:155], v[184:187]
ds_read_u16_d16_hi v215, v215
v_add_f32 v227, 1.0, v227
v_rcp_f32 v226, v226
s_waitcnt lgkmcnt(2)
v_mfma_f32_16x16x32_bf16 v[160:163], v[248:251], v[120:123], v[160:163]
ds_read_b128 v[244:247], v2 offset:33792
v_rcp_f32 v227, v227
v_mfma_f32_16x16x32_bf16 v[168:171], v[248:251], v[132:135], v[168:171]
v_mul_f32 v226, v208, v226
v_mul_f32 v227, v209, v227
v_mfma_f32_16x16x32_bf16 v[176:179], v[248:251], v[144:147], v[176:179]
v_fmaak_f32 v224, v216, v216, 0x409d30fc
v_lshlrev_b32_sdwa v218, v6, v218 dst_sel:DWORD dst_unused:UNUSED_PAD src0_sel:DWORD src1_sel:WORD_1
v_mfma_f32_16x16x32_bf16 v[184:187], v[248:251], v[156:159], v[184:187]
s_setprio 2
ds_read_u16_d16 v218, v218
v_fmaak_f32 v225, v217, v217, 0x409d30fc
v_lshlrev_b32_sdwa v219, v6, v219 dst_sel:DWORD dst_unused:UNUSED_PAD src0_sel:DWORD src1_sel:WORD_1
v_mfma_f32_16x16x32_bf16 v[164:167], v[240:243], v[112:115], 0
ds_read_b128 v[248:251], v2 offset:34816
ds_read_u16_d16_hi v219, v219
v_cvt_pk_bf16_f32 v208, v226, v227
v_mul_f32 v224, v216, v224
v_mfma_f32_16x16x32_bf16 v[172:175], v[240:243], v[124:127], 0
v_lshlrev_b32_sdwa v220, v6, v220 dst_sel:DWORD dst_unused:UNUSED_PAD src0_sel:DWORD src1_sel:WORD_1
v_mul_f32 v225, v217, v225
v_mfma_f32_16x16x32_bf16 v[180:183], v[240:243], v[136:139], 0
ds_read_u16_d16 v220, v220
v_lshlrev_b32_sdwa v221, v6, v221 dst_sel:DWORD dst_unused:UNUSED_PAD src0_sel:DWORD src1_sel:WORD_1
v_or_b32 v209, v210, v211
v_or_b32 v210, v212, v213
v_mfma_f32_16x16x32_bf16 v[188:191], v[240:243], v[148:151], 0
ds_read_u16_d16_hi v221, v221
s_waitcnt lgkmcnt(2)
v_or_b32 v211, v214, v215
v_mfma_f32_16x16x32_bf16 v[164:167], v[244:247], v[116:119], v[164:167]
ds_read_b128 v[240:243], v4 offset:2048
v_exp_f32 v224, v224
v_lshlrev_b32_sdwa v222, v6, v222 dst_sel:DWORD dst_unused:UNUSED_PAD src0_sel:DWORD src1_sel:WORD_1
v_mfma_f32_16x16x32_bf16 v[172:175], v[244:247], v[128:131], v[172:175]
ds_read_u16_d16 v222, v222
v_exp_f32 v225, v225
v_mfma_f32_16x16x32_bf16 v[180:183], v[244:247], v[140:143], v[180:183]
v_lshlrev_b32_sdwa v223, v6, v223 dst_sel:DWORD dst_unused:UNUSED_PAD src0_sel:DWORD src1_sel:WORD_1
v_add_f32 v224, 1.0, v224
v_mfma_f32_16x16x32_bf16 v[188:191], v[244:247], v[152:155], v[188:191]
ds_read_u16_d16_hi v223, v223
v_add_f32 v225, 1.0, v225
v_rcp_f32 v224, v224
v_mfma_f32_16x16x32_bf16 v[164:167], v[248:251], v[120:123], v[164:167]
ds_read_b128 v[244:247], v4 offset:3072
v_rcp_f32 v225, v225
v_mfma_f32_16x16x32_bf16 v[172:175], v[248:251], v[132:135], v[172:175]
v_mul_f32 v224, v216, v224
v_mul_f32 v225, v217, v225
v_mfma_f32_16x16x32_bf16 v[180:183], v[248:251], v[144:147], v[180:183]
v_cvt_pk_bf16_f32 v216, v224, v225
v_or_b32 v217, v218, v219
v_mfma_f32_16x16x32_bf16 v[188:191], v[248:251], v[156:159], v[188:191]
s_setprio 1
s_waitcnt lgkmcnt(1)
v_or_b32 v218, v220, v221
v_or_b32 v219, v222, v223
v_mfma_f32_16x16x32_bf16 v[16:19], v[192:195], v[240:243], v[16:19]
ds_read_b128 v[248:251], v4 offset:4096
v_fmaak_f32 v226, v162, v162, 0x409d30fc
v_lshlrev_b32_sdwa v160, v6, v160 dst_sel:DWORD dst_unused:UNUSED_PAD src0_sel:DWORD src1_sel:WORD_1
v_mfma_f32_16x16x32_bf16 v[40:43], v[200:203], v[240:243], v[40:43]
ds_read_u16_d16 v160, v160
v_fmaak_f32 v227, v163, v163, 0x409d30fc
v_lshlrev_b32_sdwa v161, v6, v161 dst_sel:DWORD dst_unused:UNUSED_PAD src0_sel:DWORD src1_sel:WORD_1
v_mfma_f32_16x16x32_bf16 v[64:67], v[208:211], v[240:243], v[64:67]
ds_read_u16_d16_hi v161, v161
v_mul_f32 v226, v162, v226
v_lshlrev_b32_sdwa v164, v6, v164 dst_sel:DWORD dst_unused:UNUSED_PAD src0_sel:DWORD src1_sel:WORD_1
v_mul_f32 v227, v163, v227
v_mfma_f32_16x16x32_bf16 v[88:91], v[216:219], v[240:243], v[88:91]
ds_read_u16_d16 v164, v164
v_lshlrev_b32_sdwa v165, v6, v165 dst_sel:DWORD dst_unused:UNUSED_PAD src0_sel:DWORD src1_sel:WORD_1
s_waitcnt lgkmcnt(3)
v_mfma_f32_16x16x32_bf16 v[20:23], v[192:195], v[244:247], v[20:23]
ds_read_b128 v[240:243], v4 offset:5120
ds_read_u16_d16_hi v165, v165
v_exp_f32 v226, v226
v_lshlrev_b32_sdwa v166, v6, v166 dst_sel:DWORD dst_unused:UNUSED_PAD src0_sel:DWORD src1_sel:WORD_1
v_mfma_f32_16x16x32_bf16 v[44:47], v[200:203], v[244:247], v[44:47]
ds_read_u16_d16 v166, v166
v_exp_f32 v227, v227
v_mfma_f32_16x16x32_bf16 v[68:71], v[208:211], v[244:247], v[68:71]
v_lshlrev_b32_sdwa v167, v6, v167 dst_sel:DWORD dst_unused:UNUSED_PAD src0_sel:DWORD src1_sel:WORD_1
v_add_f32 v226, 1.0, v226
v_mfma_f32_16x16x32_bf16 v[92:95], v[216:219], v[244:247], v[92:95]
ds_read_u16_d16_hi v167, v167
v_add_f32 v227, 1.0, v227
v_rcp_f32 v226, v226
v_mfma_f32_16x16x32_bf16 v[24:27], v[192:195], v[248:251], v[24:27]
ds_read_b128 v[244:247], v4 offset:6144
v_rcp_f32 v227, v227
v_mfma_f32_16x16x32_bf16 v[48:51], v[200:203], v[248:251], v[48:51]
v_mul_f32 v226, v162, v226
v_mul_f32 v227, v163, v227
v_mfma_f32_16x16x32_bf16 v[72:75], v[208:211], v[248:251], v[72:75]
v_fmaak_f32 v224, v170, v170, 0x409d30fc
v_lshlrev_b32_sdwa v168, v6, v168 dst_sel:DWORD dst_unused:UNUSED_PAD src0_sel:DWORD src1_sel:WORD_1
v_mfma_f32_16x16x32_bf16 v[96:99], v[216:219], v[248:251], v[96:99]
s_setprio 0
ds_read_u16_d16 v168, v168
v_fmaak_f32 v225, v171, v171, 0x409d30fc
v_lshlrev_b32_sdwa v169, v6, v169 dst_sel:DWORD dst_unused:UNUSED_PAD src0_sel:DWORD src1_sel:WORD_1
s_waitcnt lgkmcnt(1)
v_mfma_f32_16x16x32_bf16 v[28:31], v[192:195], v[240:243], v[28:31]
ds_read_b128 v[248:251], v4 offset:7168
ds_read_u16_d16_hi v169, v169
v_mul_f32 v224, v170, v224
v_lshlrev_b32_sdwa v172, v6, v172 dst_sel:DWORD dst_unused:UNUSED_PAD src0_sel:DWORD src1_sel:WORD_1
v_mfma_f32_16x16x32_bf16 v[52:55], v[200:203], v[240:243], v[52:55]
ds_read_u16_d16 v172, v172
v_mul_f32 v225, v171, v225
v_lshlrev_b32_sdwa v173, v6, v173 dst_sel:DWORD dst_unused:UNUSED_PAD src0_sel:DWORD src1_sel:WORD_1
v_mfma_f32_16x16x32_bf16 v[76:79], v[208:211], v[240:243], v[76:79]
ds_read_u16_d16_hi v173, v173
v_or_b32 v160, v160, v161
v_cvt_pk_bf16_f32 v161, v226, v227
v_or_b32 v162, v164, v165
v_mfma_f32_16x16x32_bf16 v[100:103], v[216:219], v[240:243], v[100:103]
v_or_b32 v163, v166, v167
v_mfma_f32_16x16x32_bf16 v[32:35], v[192:195], v[244:247], v[32:35]
ds_read_b128 v[240:243], v14 offset:17408
v_exp_f32 v224, v224
v_lshlrev_b32_sdwa v174, v6, v174 dst_sel:DWORD dst_unused:UNUSED_PAD src0_sel:DWORD src1_sel:WORD_1
v_mfma_f32_16x16x32_bf16 v[56:59], v[200:203], v[244:247], v[56:59]
ds_read_u16_d16 v174, v174
v_exp_f32 v225, v225
v_mfma_f32_16x16x32_bf16 v[80:83], v[208:211], v[244:247], v[80:83]
v_lshlrev_b32_sdwa v175, v6, v175 dst_sel:DWORD dst_unused:UNUSED_PAD src0_sel:DWORD src1_sel:WORD_1
v_add_f32 v224, 1.0, v224
v_mfma_f32_16x16x32_bf16 v[104:107], v[216:219], v[244:247], v[104:107]
ds_read_u16_d16_hi v175, v175
v_add_f32 v225, 1.0, v225
v_rcp_f32 v224, v224
s_waitcnt lgkmcnt(2)
v_mfma_f32_16x16x32_bf16 v[36:39], v[192:195], v[248:251], v[36:39]
ds_read_b128 v[244:247], v14 offset:18432
v_rcp_f32 v225, v225
v_mfma_f32_16x16x32_bf16 v[60:63], v[200:203], v[248:251], v[60:63]
v_mul_f32 v224, v170, v224
v_mul_f32 v225, v171, v225
v_mfma_f32_16x16x32_bf16 v[84:87], v[208:211], v[248:251], v[84:87]
v_fmaak_f32 v226, v178, v178, 0x409d30fc
v_lshlrev_b32_sdwa v176, v6, v176 dst_sel:DWORD dst_unused:UNUSED_PAD src0_sel:DWORD src1_sel:WORD_1
v_mfma_f32_16x16x32_bf16 v[108:111], v[216:219], v[248:251], v[108:111]
s_setprio 3
ds_read_u16_d16 v176, v176
v_fmaak_f32 v227, v179, v179, 0x409d30fc
v_lshlrev_b32_sdwa v177, v6, v177 dst_sel:DWORD dst_unused:UNUSED_PAD src0_sel:DWORD src1_sel:WORD_1
v_mfma_f32_16x16x32_bf16 v[192:195], v[240:243], v[112:115], 0
ds_read_b128 v[248:251], v14 offset:19456
ds_read_u16_d16_hi v177, v177
v_mul_f32 v226, v178, v226
v_lshlrev_b32_sdwa v180, v6, v180 dst_sel:DWORD dst_unused:UNUSED_PAD src0_sel:DWORD src1_sel:WORD_1
v_mfma_f32_16x16x32_bf16 v[200:203], v[240:243], v[124:127], 0
ds_read_u16_d16 v180, v180
v_mul_f32 v227, v179, v227
v_lshlrev_b32_sdwa v181, v6, v181 dst_sel:DWORD dst_unused:UNUSED_PAD src0_sel:DWORD src1_sel:WORD_1
v_mfma_f32_16x16x32_bf16 v[208:211], v[240:243], v[136:139], 0
ds_read_u16_d16_hi v181, v181
v_or_b32 v168, v168, v169
v_cvt_pk_bf16_f32 v169, v224, v225
v_mfma_f32_16x16x32_bf16 v[216:219], v[240:243], v[148:151], 0
v_or_b32 v170, v172, v173
s_waitcnt lgkmcnt(2)
v_or_b32 v171, v174, v175
v_mfma_f32_16x16x32_bf16 v[192:195], v[244:247], v[116:119], v[192:195]
ds_read_b128 v[240:243], v2 offset:41984
v_exp_f32 v226, v226
v_lshlrev_b32_sdwa v182, v6, v182 dst_sel:DWORD dst_unused:UNUSED_PAD src0_sel:DWORD src1_sel:WORD_1
v_mfma_f32_16x16x32_bf16 v[200:203], v[244:247], v[128:131], v[200:203]
ds_read_u16_d16 v182, v182
v_exp_f32 v227, v227
v_mfma_f32_16x16x32_bf16 v[208:211], v[244:247], v[140:143], v[208:211]
v_lshlrev_b32_sdwa v183, v6, v183 dst_sel:DWORD dst_unused:UNUSED_PAD src0_sel:DWORD src1_sel:WORD_1
v_add_f32 v226, 1.0, v226
v_mfma_f32_16x16x32_bf16 v[216:219], v[244:247], v[152:155], v[216:219]
ds_read_u16_d16_hi v183, v183
v_add_f32 v227, 1.0, v227
v_rcp_f32 v226, v226
v_mfma_f32_16x16x32_bf16 v[192:195], v[248:251], v[120:123], v[192:195]
ds_read_b128 v[244:247], v2 offset:43008
v_rcp_f32 v227, v227
v_mfma_f32_16x16x32_bf16 v[200:203], v[248:251], v[132:135], v[200:203]
v_mul_f32 v226, v178, v226
v_mul_f32 v227, v179, v227
v_mfma_f32_16x16x32_bf16 v[208:211], v[248:251], v[144:147], v[208:211]
v_fmaak_f32 v224, v186, v186, 0x409d30fc
v_lshlrev_b32_sdwa v184, v6, v184 dst_sel:DWORD dst_unused:UNUSED_PAD src0_sel:DWORD src1_sel:WORD_1
v_mfma_f32_16x16x32_bf16 v[216:219], v[248:251], v[156:159], v[216:219]
s_setprio 2
ds_read_u16_d16 v184, v184
v_fmaak_f32 v225, v187, v187, 0x409d30fc
v_lshlrev_b32_sdwa v185, v6, v185 dst_sel:DWORD dst_unused:UNUSED_PAD src0_sel:DWORD src1_sel:WORD_1
s_waitcnt lgkmcnt(1)
v_mfma_f32_16x16x32_bf16 v[196:199], v[240:243], v[112:115], 0
ds_read_b128 v[248:251], v2 offset:44032
ds_read_u16_d16_hi v185, v185
v_mul_f32 v224, v186, v224
v_lshlrev_b32_sdwa v188, v6, v188 dst_sel:DWORD dst_unused:UNUSED_PAD src0_sel:DWORD src1_sel:WORD_1
v_mfma_f32_16x16x32_bf16 v[204:207], v[240:243], v[124:127], 0
ds_read_u16_d16 v188, v188
v_mul_f32 v225, v187, v225
v_lshlrev_b32_sdwa v189, v6, v189 dst_sel:DWORD dst_unused:UNUSED_PAD src0_sel:DWORD src1_sel:WORD_1
v_mfma_f32_16x16x32_bf16 v[212:215], v[240:243], v[136:139], 0
ds_read_u16_d16_hi v189, v189
v_or_b32 v176, v176, v177
v_cvt_pk_bf16_f32 v177, v226, v227
v_or_b32 v178, v180, v181
v_mfma_f32_16x16x32_bf16 v[220:223], v[240:243], v[148:151], 0
v_or_b32 v179, v182, v183
v_mfma_f32_16x16x32_bf16 v[196:199], v[244:247], v[116:119], v[196:199]
ds_read_b128 v[240:243], v4 offset:8192
v_exp_f32 v224, v224
v_lshlrev_b32_sdwa v190, v6, v190 dst_sel:DWORD dst_unused:UNUSED_PAD src0_sel:DWORD src1_sel:WORD_1
v_mfma_f32_16x16x32_bf16 v[204:207], v[244:247], v[128:131], v[204:207]
ds_read_u16_d16 v190, v190
v_exp_f32 v225, v225
v_mfma_f32_16x16x32_bf16 v[212:215], v[244:247], v[140:143], v[212:215]
v_lshlrev_b32_sdwa v191, v6, v191 dst_sel:DWORD dst_unused:UNUSED_PAD src0_sel:DWORD src1_sel:WORD_1
v_add_f32 v224, 1.0, v224
v_mfma_f32_16x16x32_bf16 v[220:223], v[244:247], v[152:155], v[220:223]
ds_read_u16_d16_hi v191, v191
v_add_f32 v225, 1.0, v225
v_rcp_f32 v224, v224
s_waitcnt lgkmcnt(2)
v_mfma_f32_16x16x32_bf16 v[196:199], v[248:251], v[120:123], v[196:199]
ds_read_b128 v[244:247], v4 offset:9216
v_rcp_f32 v225, v225
v_mfma_f32_16x16x32_bf16 v[204:207], v[248:251], v[132:135], v[204:207]
v_mul_f32 v224, v186, v224
v_mul_f32 v225, v187, v225
v_mfma_f32_16x16x32_bf16 v[212:215], v[248:251], v[144:147], v[212:215]
v_or_b32 v184, v184, v185
v_cvt_pk_bf16_f32 v185, v224, v225
v_mfma_f32_16x16x32_bf16 v[220:223], v[248:251], v[156:159], v[220:223]
s_setprio 1
v_or_b32 v186, v188, v189
s_waitcnt lgkmcnt(1)
v_or_b32 v187, v190, v191
v_mfma_f32_16x16x32_bf16 v[16:19], v[160:163], v[240:243], v[16:19]
ds_read_b128 v[248:251], v4 offset:10240
v_fmaak_f32 v226, v194, v194, 0x409d30fc
v_lshlrev_b32_sdwa v192, v6, v192 dst_sel:DWORD dst_unused:UNUSED_PAD src0_sel:DWORD src1_sel:WORD_1
v_mfma_f32_16x16x32_bf16 v[40:43], v[168:171], v[240:243], v[40:43]
ds_read_u16_d16 v192, v192
v_fmaak_f32 v227, v195, v195, 0x409d30fc
v_lshlrev_b32_sdwa v193, v6, v193 dst_sel:DWORD dst_unused:UNUSED_PAD src0_sel:DWORD src1_sel:WORD_1
v_mul_f32 v226, v194, v226
v_mfma_f32_16x16x32_bf16 v[64:67], v[176:179], v[240:243], v[64:67]
ds_read_u16_d16_hi v193, v193
s_waitcnt vmcnt(3)
v_perm_b32 v180, v236, v232, s58
s_waitcnt vmcnt(1)
v_perm_b32 v181, v0, v252, s58
v_mfma_f32_16x16x32_bf16 v[88:91], v[184:187], v[240:243], v[88:91]
v_lshlrev_b32_sdwa v196, v6, v196 dst_sel:DWORD dst_unused:UNUSED_PAD src0_sel:DWORD src1_sel:WORD_1
v_mov_b32 v182, v8
s_waitcnt lgkmcnt(2)
v_mfma_f32_16x16x32_bf16 v[20:23], v[160:163], v[244:247], v[20:23]
ds_read_b128 v[240:243], v4 offset:11264
ds_read_u16_d16 v196, v196
v_mul_f32 v227, v195, v227
v_lshlrev_b32_sdwa v197, v6, v197 dst_sel:DWORD dst_unused:UNUSED_PAD src0_sel:DWORD src1_sel:WORD_1
v_mfma_f32_16x16x32_bf16 v[64:67], v[228:231], v[180:183], v[64:67]
ds_read_u16_d16_hi v197, v197
v_exp_f32 v226, v226
v_lshlrev_b32_sdwa v198, v6, v198 dst_sel:DWORD dst_unused:UNUSED_PAD src0_sel:DWORD src1_sel:WORD_1
v_mfma_f32_16x16x32_bf16 v[44:47], v[168:171], v[244:247], v[44:47]
ds_read_u16_d16 v198, v198
v_exp_f32 v227, v227
v_mfma_f32_16x16x32_bf16 v[68:71], v[176:179], v[244:247], v[68:71]
v_perm_b32 v180, v236, v232, s59
v_perm_b32 v181, v0, v252, s59
v_mfma_f32_16x16x32_bf16 v[92:95], v[184:187], v[244:247], v[92:95]
v_lshlrev_b32_sdwa v199, v6, v199 dst_sel:DWORD dst_unused:UNUSED_PAD src0_sel:DWORD src1_sel:WORD_1
v_mov_b32 v182, v9
v_mfma_f32_16x16x32_bf16 v[24:27], v[160:163], v[248:251], v[24:27]
ds_read_b128 v[244:247], v4 offset:12288
ds_read_u16_d16_hi v199, v199
v_add_f32 v226, 1.0, v226
v_add_f32 v227, 1.0, v227
v_mfma_f32_16x16x32_bf16 v[68:71], v[228:231], v[180:183], v[68:71]
v_rcp_f32 v226, v226
v_mfma_f32_16x16x32_bf16 v[48:51], v[168:171], v[248:251], v[48:51]
s_setprio 0
v_rcp_f32 v227, v227
v_mul_f32 v226, v194, v226
v_mfma_f32_16x16x32_bf16 v[72:75], v[176:179], v[248:251], v[72:75]
v_perm_b32 v180, v237, v233, s58
v_perm_b32 v181, v1, v253, s58
v_mfma_f32_16x16x32_bf16 v[96:99], v[184:187], v[248:251], v[96:99]
v_mul_f32 v227, v195, v227
v_fmaak_f32 v224, v202, v202, 0x409d30fc
v_mov_b32 v182, v10
s_waitcnt lgkmcnt(0)
v_mfma_f32_16x16x32_bf16 v[28:31], v[160:163], v[240:243], v[28:31]
ds_read_b128 v[248:251], v4 offset:13312
v_lshlrev_b32_sdwa v200, v6, v200 dst_sel:DWORD dst_unused:UNUSED_PAD src0_sel:DWORD src1_sel:WORD_1
v_fmaak_f32 v225, v203, v203, 0x409d30fc
v_mfma_f32_16x16x32_bf16 v[72:75], v[228:231], v[180:183], v[72:75]
ds_read_u16_d16 v200, v200
v_lshlrev_b32_sdwa v201, v6, v201 dst_sel:DWORD dst_unused:UNUSED_PAD src0_sel:DWORD src1_sel:WORD_1
v_mul_f32 v224, v202, v224
v_mfma_f32_16x16x32_bf16 v[52:55], v[168:171], v[240:243], v[52:55]
ds_read_u16_d16_hi v201, v201
v_lshlrev_b32_sdwa v204, v6, v204 dst_sel:DWORD dst_unused:UNUSED_PAD src0_sel:DWORD src1_sel:WORD_1
v_mul_f32 v225, v203, v225
v_mfma_f32_16x16x32_bf16 v[76:79], v[176:179], v[240:243], v[76:79]
ds_read_u16_d16 v204, v204
v_lshlrev_b32_sdwa v205, v6, v205 dst_sel:DWORD dst_unused:UNUSED_PAD src0_sel:DWORD src1_sel:WORD_1
v_perm_b32 v180, v237, v233, s59
v_perm_b32 v181, v1, v253, s59
v_mfma_f32_16x16x32_bf16 v[100:103], v[184:187], v[240:243], v[100:103]
ds_read_u16_d16_hi v205, v205
v_or_b32 v192, v192, v193
v_mov_b32 v182, v11
v_mfma_f32_16x16x32_bf16 v[32:35], v[160:163], v[244:247], v[32:35]
ds_read_b128 v[240:243], v14 offset:45056
v_cvt_pk_bf16_f32 v193, v226, v227
v_or_b32 v194, v196, v197
v_mfma_f32_16x16x32_bf16 v[76:79], v[228:231], v[180:183], v[76:79]
v_or_b32 v195, v198, v199
v_exp_f32 v224, v224
v_mfma_f32_16x16x32_bf16 v[56:59], v[168:171], v[244:247], v[56:59]
v_lshlrev_b32_sdwa v206, v6, v206 dst_sel:DWORD dst_unused:UNUSED_PAD src0_sel:DWORD src1_sel:WORD_1
v_mfma_f32_16x16x32_bf16 v[80:83], v[176:179], v[244:247], v[80:83]
ds_read_u16_d16 v206, v206
v_perm_b32 v180, v238, v234, s58
s_waitcnt vmcnt(0)
v_perm_b32 v181, v235, v254, s58
v_mfma_f32_16x16x32_bf16 v[104:107], v[184:187], v[244:247], v[104:107]
s_setprio 3
v_exp_f32 v225, v225
v_mov_b32 v182, v12
s_waitcnt lgkmcnt(1)
v_mfma_f32_16x16x32_bf16 v[36:39], v[160:163], v[248:251], v[36:39]
ds_read_b128 v[244:247], v14 offset:46080
v_lshlrev_b32_sdwa v207, v6, v207 dst_sel:DWORD dst_unused:UNUSED_PAD src0_sel:DWORD src1_sel:WORD_1
v_add_f32 v224, 1.0, v224
v_mfma_f32_16x16x32_bf16 v[80:83], v[228:231], v[180:183], v[80:83]
ds_read_u16_d16_hi v207, v207
v_add_f32 v225, 1.0, v225
v_rcp_f32 v224, v224
v_mfma_f32_16x16x32_bf16 v[60:63], v[168:171], v[248:251], v[60:63]
v_rcp_f32 v225, v225
v_mfma_f32_16x16x32_bf16 v[84:87], v[176:179], v[248:251], v[84:87]
v_perm_b32 v180, v238, v234, s59
v_perm_b32 v181, v235, v254, s59
v_mfma_f32_16x16x32_bf16 v[108:111], v[184:187], v[248:251], v[108:111]
v_mul_f32 v224, v202, v224
v_mul_f32 v225, v203, v225
v_mov_b32 v182, v13
v_mfma_f32_16x16x32_bf16 v[160:163], v[240:243], v[112:115], 0
ds_read_b128 v[248:251], v14 offset:47104
v_fmaak_f32 v226, v210, v210, 0x409d30fc
v_lshlrev_b32_sdwa v208, v6, v208 dst_sel:DWORD dst_unused:UNUSED_PAD src0_sel:DWORD src1_sel:WORD_1
v_mfma_f32_16x16x32_bf16 v[84:87], v[228:231], v[180:183], v[84:87]
ds_read_u16_d16 v208, v208
v_fmaak_f32 v227, v211, v211, 0x409d30fc
v_lshlrev_b32_sdwa v209, v6, v209 dst_sel:DWORD dst_unused:UNUSED_PAD src0_sel:DWORD src1_sel:WORD_1
v_mfma_f32_16x16x32_bf16 v[168:171], v[240:243], v[124:127], 0
ds_read_u16_d16_hi v209, v209
v_mul_f32 v226, v210, v226
v_lshlrev_b32_sdwa v212, v6, v212 dst_sel:DWORD dst_unused:UNUSED_PAD src0_sel:DWORD src1_sel:WORD_1
v_mfma_f32_16x16x32_bf16 v[176:179], v[240:243], v[136:139], 0
ds_read_u16_d16 v212, v212
v_mul_f32 v227, v211, v227
v_lshlrev_b32_sdwa v213, v6, v213 dst_sel:DWORD dst_unused:UNUSED_PAD src0_sel:DWORD src1_sel:WORD_1
v_or_b32 v200, v200, v201
v_mfma_f32_16x16x32_bf16 v[184:187], v[240:243], v[148:151], 0
ds_read_u16_d16_hi v213, v213
v_cvt_pk_bf16_f32 v201, v224, v225
v_or_b32 v202, v204, v205
s_waitcnt lgkmcnt(3)
v_mfma_f32_16x16x32_bf16 v[160:163], v[244:247], v[116:119], v[160:163]
ds_read_b128 v[240:243], v3 offset:12288
v_or_b32 v203, v206, v207
v_exp_f32 v226, v226
s_add_u32 s3, s53, 98304
buffer_load_dwordx3 v[232:234], v5, s[4:7], s3 offen offset:0
v_mfma_f32_16x16x32_bf16 v[168:171], v[244:247], v[128:131], v[168:171]
s_setprio 2
v_lshlrev_b32_sdwa v214, v6, v214 dst_sel:DWORD dst_unused:UNUSED_PAD src0_sel:DWORD src1_sel:WORD_1
v_mfma_f32_16x16x32_bf16 v[176:179], v[244:247], v[140:143], v[176:179]
ds_read_u16_d16 v214, v214
v_exp_f32 v227, v227
v_lshlrev_b32_sdwa v215, v6, v215 dst_sel:DWORD dst_unused:UNUSED_PAD src0_sel:DWORD src1_sel:WORD_1
v_mfma_f32_16x16x32_bf16 v[184:187], v[244:247], v[152:155], v[184:187]
ds_read_u16_d16_hi v215, v215
v_add_f32 v226, 1.0, v226
v_add_f32 v227, 1.0, v227
v_mfma_f32_16x16x32_bf16 v[160:163], v[248:251], v[120:123], v[160:163]
ds_read_b128 v[244:247], v3 offset:13312
v_rcp_f32 v226, v226
v_mfma_f32_16x16x32_bf16 v[168:171], v[248:251], v[132:135], v[168:171]
v_rcp_f32 v227, v227
buffer_load_dwordx3 v[236:238], v5, s[4:7], s3 offen offset:768
v_mfma_f32_16x16x32_bf16 v[176:179], v[248:251], v[144:147], v[176:179]
v_mul_f32 v226, v210, v226
v_mul_f32 v227, v211, v227
v_fmaak_f32 v224, v218, v218, 0x409d30fc
v_mfma_f32_16x16x32_bf16 v[184:187], v[248:251], v[156:159], v[184:187]
v_lshlrev_b32_sdwa v216, v6, v216 dst_sel:DWORD dst_unused:UNUSED_PAD src0_sel:DWORD src1_sel:WORD_1
v_fmaak_f32 v225, v219, v219, 0x409d30fc
s_waitcnt lgkmcnt(1)
v_mfma_f32_16x16x32_bf16 v[164:167], v[240:243], v[112:115], 0
ds_read_b128 v[248:251], v3 offset:14336
ds_read_u16_d16 v216, v216
v_lshlrev_b32_sdwa v217, v6, v217 dst_sel:DWORD dst_unused:UNUSED_PAD src0_sel:DWORD src1_sel:WORD_1
v_mul_f32 v224, v218, v224
v_mfma_f32_16x16x32_bf16 v[172:175], v[240:243], v[124:127], 0
ds_read_u16_d16_hi v217, v217
v_lshlrev_b32_sdwa v220, v6, v220 dst_sel:DWORD dst_unused:UNUSED_PAD src0_sel:DWORD src1_sel:WORD_1
v_mul_f32 v225, v219, v225
v_mfma_f32_16x16x32_bf16 v[180:183], v[240:243], v[136:139], 0
ds_read_u16_d16 v220, v220
v_lshlrev_b32_sdwa v221, v6, v221 dst_sel:DWORD dst_unused:UNUSED_PAD src0_sel:DWORD src1_sel:WORD_1
v_or_b32 v208, v208, v209
v_cvt_pk_bf16_f32 v209, v226, v227
buffer_load_dwordx3 v[252:254], v5, s[4:7], s3 offen offset:1536
v_mfma_f32_16x16x32_bf16 v[188:191], v[240:243], v[148:151], 0
ds_read_u16_d16_hi v221, v221
v_or_b32 v210, v212, v213
v_or_b32 v211, v214, v215
s_waitcnt lgkmcnt(2)
v_mfma_f32_16x16x32_bf16 v[164:167], v[244:247], v[116:119], v[164:167]
ds_read_b128 v[240:243], v4 offset:14336
v_exp_f32 v224, v224
v_mfma_f32_16x16x32_bf16 v[172:175], v[244:247], v[128:131], v[172:175]
s_setprio 1
v_lshlrev_b32_sdwa v222, v6, v222 dst_sel:DWORD dst_unused:UNUSED_PAD src0_sel:DWORD src1_sel:WORD_1
v_exp_f32 v225, v225
v_mfma_f32_16x16x32_bf16 v[180:183], v[244:247], v[140:143], v[180:183]
ds_read_u16_d16 v222, v222
v_lshlrev_b32_sdwa v223, v6, v223 dst_sel:DWORD dst_unused:UNUSED_PAD src0_sel:DWORD src1_sel:WORD_1
v_add_f32 v224, 1.0, v224
v_mfma_f32_16x16x32_bf16 v[188:191], v[244:247], v[152:155], v[188:191]
ds_read_u16_d16_hi v223, v223
v_add_f32 v225, 1.0, v225
buffer_load_dwordx2 v[0:1], v5, s[4:7], s3 offen offset:2304
buffer_load_dword v235, v5, s[4:7], s3 offen offset:2312
v_mfma_f32_16x16x32_bf16 v[164:167], v[248:251], v[120:123], v[164:167]
ds_read_b128 v[244:247], v4 offset:15360
v_rcp_f32 v224, v224
v_rcp_f32 v225, v225
v_mfma_f32_16x16x32_bf16 v[172:175], v[248:251], v[132:135], v[172:175]
v_mul_f32 v224, v218, v224
v_mfma_f32_16x16x32_bf16 v[180:183], v[248:251], v[144:147], v[180:183]
v_mul_f32 v225, v219, v225
v_or_b32 v216, v216, v217
v_cvt_pk_bf16_f32 v217, v224, v225
v_mfma_f32_16x16x32_bf16 v[188:191], v[248:251], v[156:159], v[188:191]
s_waitcnt lgkmcnt(1)
v_or_b32 v218, v220, v221
v_or_b32 v219, v222, v223
v_mfma_f32_16x16x32_bf16 v[16:19], v[192:195], v[240:243], v[16:19]
ds_read_b128 v[248:251], v4 offset:16384
v_fmaak_f32 v226, v162, v162, 0x409d30fc
v_lshlrev_b32_sdwa v160, v6, v160 dst_sel:DWORD dst_unused:UNUSED_PAD src0_sel:DWORD src1_sel:WORD_1
v_mfma_f32_16x16x32_bf16 v[40:43], v[200:203], v[240:243], v[40:43]
ds_read_u16_d16 v160, v160
v_fmaak_f32 v227, v163, v163, 0x409d30fc
v_lshlrev_b32_sdwa v161, v6, v161 dst_sel:DWORD dst_unused:UNUSED_PAD src0_sel:DWORD src1_sel:WORD_1
v_mfma_f32_16x16x32_bf16 v[64:67], v[208:211], v[240:243], v[64:67]
ds_read_u16_d16_hi v161, v161
v_mul_f32 v226, v162, v226
v_lshlrev_b32_sdwa v164, v6, v164 dst_sel:DWORD dst_unused:UNUSED_PAD src0_sel:DWORD src1_sel:WORD_1
v_mul_f32 v227, v163, v227
v_mfma_f32_16x16x32_bf16 v[88:91], v[216:219], v[240:243], v[88:91]
ds_read_u16_d16 v164, v164
v_lshlrev_b32_sdwa v165, v6, v165 dst_sel:DWORD dst_unused:UNUSED_PAD src0_sel:DWORD src1_sel:WORD_1
s_waitcnt lgkmcnt(3)
v_mfma_f32_16x16x32_bf16 v[20:23], v[192:195], v[244:247], v[20:23]
ds_read_b128 v[240:243], v4 offset:17408
ds_read_u16_d16_hi v165, v165
v_exp_f32 v226, v226
v_lshlrev_b32_sdwa v166, v6, v166 dst_sel:DWORD dst_unused:UNUSED_PAD src0_sel:DWORD src1_sel:WORD_1
v_mfma_f32_16x16x32_bf16 v[44:47], v[200:203], v[244:247], v[44:47]
s_setprio 0
ds_read_u16_d16 v166, v166
v_exp_f32 v227, v227
v_mfma_f32_16x16x32_bf16 v[68:71], v[208:211], v[244:247], v[68:71]
v_lshlrev_b32_sdwa v167, v6, v167 dst_sel:DWORD dst_unused:UNUSED_PAD src0_sel:DWORD src1_sel:WORD_1
v_add_f32 v226, 1.0, v226
v_mfma_f32_16x16x32_bf16 v[92:95], v[216:219], v[244:247], v[92:95]
ds_read_u16_d16_hi v167, v167
v_add_f32 v227, 1.0, v227
v_rcp_f32 v226, v226
v_mfma_f32_16x16x32_bf16 v[24:27], v[192:195], v[248:251], v[24:27]
ds_read_b128 v[244:247], v4 offset:18432
v_rcp_f32 v227, v227
v_mfma_f32_16x16x32_bf16 v[48:51], v[200:203], v[248:251], v[48:51]
v_mul_f32 v226, v162, v226
v_mul_f32 v227, v163, v227
v_mfma_f32_16x16x32_bf16 v[72:75], v[208:211], v[248:251], v[72:75]
v_fmaak_f32 v224, v170, v170, 0x409d30fc
v_lshlrev_b32_sdwa v168, v6, v168 dst_sel:DWORD dst_unused:UNUSED_PAD src0_sel:DWORD src1_sel:WORD_1
v_mfma_f32_16x16x32_bf16 v[96:99], v[216:219], v[248:251], v[96:99]
ds_read_u16_d16 v168, v168
v_fmaak_f32 v225, v171, v171, 0x409d30fc
v_lshlrev_b32_sdwa v169, v6, v169 dst_sel:DWORD dst_unused:UNUSED_PAD src0_sel:DWORD src1_sel:WORD_1
s_waitcnt lgkmcnt(2)
v_mfma_f32_16x16x32_bf16 v[28:31], v[192:195], v[240:243], v[28:31]
ds_read_b128 v[248:251], v4 offset:19456
ds_read_u16_d16_hi v169, v169
v_mul_f32 v224, v170, v224
v_lshlrev_b32_sdwa v172, v6, v172 dst_sel:DWORD dst_unused:UNUSED_PAD src0_sel:DWORD src1_sel:WORD_1
v_mfma_f32_16x16x32_bf16 v[52:55], v[200:203], v[240:243], v[52:55]
ds_read_u16_d16 v172, v172
v_mul_f32 v225, v171, v225
v_lshlrev_b32_sdwa v173, v6, v173 dst_sel:DWORD dst_unused:UNUSED_PAD src0_sel:DWORD src1_sel:WORD_1
v_mfma_f32_16x16x32_bf16 v[76:79], v[208:211], v[240:243], v[76:79]
ds_read_u16_d16_hi v173, v173
v_or_b32 v160, v160, v161
v_cvt_pk_bf16_f32 v161, v226, v227
v_or_b32 v162, v164, v165
v_mfma_f32_16x16x32_bf16 v[100:103], v[216:219], v[240:243], v[100:103]
v_or_b32 v163, v166, v167
s_waitcnt lgkmcnt(2)
v_mfma_f32_16x16x32_bf16 v[32:35], v[192:195], v[244:247], v[32:35]
ds_read_b128 v[240:243], v14 offset:54272
v_exp_f32 v224, v224
v_lshlrev_b32_sdwa v174, v6, v174 dst_sel:DWORD dst_unused:UNUSED_PAD src0_sel:DWORD src1_sel:WORD_1
v_mfma_f32_16x16x32_bf16 v[56:59], v[200:203], v[244:247], v[56:59]
s_setprio 3
ds_read_u16_d16 v174, v174
v_exp_f32 v225, v225
v_mfma_f32_16x16x32_bf16 v[80:83], v[208:211], v[244:247], v[80:83]
v_lshlrev_b32_sdwa v175, v6, v175 dst_sel:DWORD dst_unused:UNUSED_PAD src0_sel:DWORD src1_sel:WORD_1
v_add_f32 v224, 1.0, v224
v_mfma_f32_16x16x32_bf16 v[104:107], v[216:219], v[244:247], v[104:107]
ds_read_u16_d16_hi v175, v175
v_add_f32 v225, 1.0, v225
v_rcp_f32 v224, v224
v_mfma_f32_16x16x32_bf16 v[36:39], v[192:195], v[248:251], v[36:39]
ds_read_b128 v[244:247], v14 offset:55296
v_rcp_f32 v225, v225
v_mfma_f32_16x16x32_bf16 v[60:63], v[200:203], v[248:251], v[60:63]
v_mul_f32 v224, v170, v224
v_mul_f32 v225, v171, v225
v_mfma_f32_16x16x32_bf16 v[84:87], v[208:211], v[248:251], v[84:87]
v_fmaak_f32 v226, v178, v178, 0x409d30fc
v_lshlrev_b32_sdwa v176, v6, v176 dst_sel:DWORD dst_unused:UNUSED_PAD src0_sel:DWORD src1_sel:WORD_1
v_mfma_f32_16x16x32_bf16 v[108:111], v[216:219], v[248:251], v[108:111]
ds_read_u16_d16 v176, v176
v_fmaak_f32 v227, v179, v179, 0x409d30fc
v_lshlrev_b32_sdwa v177, v6, v177 dst_sel:DWORD dst_unused:UNUSED_PAD src0_sel:DWORD src1_sel:WORD_1
s_waitcnt lgkmcnt(2)
v_mfma_f32_16x16x32_bf16 v[192:195], v[240:243], v[112:115], 0
ds_read_b128 v[248:251], v14 offset:56320
ds_read_u16_d16_hi v177, v177
v_mul_f32 v226, v178, v226
v_lshlrev_b32_sdwa v180, v6, v180 dst_sel:DWORD dst_unused:UNUSED_PAD src0_sel:DWORD src1_sel:WORD_1
v_mfma_f32_16x16x32_bf16 v[200:203], v[240:243], v[124:127], 0
ds_read_u16_d16 v180, v180
v_mul_f32 v227, v179, v227
v_lshlrev_b32_sdwa v181, v6, v181 dst_sel:DWORD dst_unused:UNUSED_PAD src0_sel:DWORD src1_sel:WORD_1
v_mfma_f32_16x16x32_bf16 v[208:211], v[240:243], v[136:139], 0
ds_read_u16_d16_hi v181, v181
v_or_b32 v168, v168, v169
v_cvt_pk_bf16_f32 v169, v224, v225
v_mfma_f32_16x16x32_bf16 v[216:219], v[240:243], v[148:151], 0
v_or_b32 v170, v172, v173
v_or_b32 v171, v174, v175
s_waitcnt lgkmcnt(2)
v_mfma_f32_16x16x32_bf16 v[192:195], v[244:247], v[116:119], v[192:195]
ds_read_b128 v[240:243], v3 offset:21504
v_exp_f32 v226, v226
v_lshlrev_b32_sdwa v182, v6, v182 dst_sel:DWORD dst_unused:UNUSED_PAD src0_sel:DWORD src1_sel:WORD_1
v_mfma_f32_16x16x32_bf16 v[200:203], v[244:247], v[128:131], v[200:203]
s_setprio 2
ds_read_u16_d16 v182, v182
v_exp_f32 v227, v227
v_mfma_f32_16x16x32_bf16 v[208:211], v[244:247], v[140:143], v[208:211]
v_lshlrev_b32_sdwa v183, v6, v183 dst_sel:DWORD dst_unused:UNUSED_PAD src0_sel:DWORD src1_sel:WORD_1
v_add_f32 v226, 1.0, v226
v_mfma_f32_16x16x32_bf16 v[216:219], v[244:247], v[152:155], v[216:219]
ds_read_u16_d16_hi v183, v183
v_add_f32 v227, 1.0, v227
v_rcp_f32 v226, v226
v_mfma_f32_16x16x32_bf16 v[192:195], v[248:251], v[120:123], v[192:195]
ds_read_b128 v[244:247], v3 offset:22528
v_rcp_f32 v227, v227
v_mfma_f32_16x16x32_bf16 v[200:203], v[248:251], v[132:135], v[200:203]
v_mul_f32 v226, v178, v226
v_mul_f32 v227, v179, v227
v_mfma_f32_16x16x32_bf16 v[208:211], v[248:251], v[144:147], v[208:211]
v_fmaak_f32 v224, v186, v186, 0x409d30fc
v_lshlrev_b32_sdwa v184, v6, v184 dst_sel:DWORD dst_unused:UNUSED_PAD src0_sel:DWORD src1_sel:WORD_1
v_mfma_f32_16x16x32_bf16 v[216:219], v[248:251], v[156:159], v[216:219]
ds_read_u16_d16 v184, v184
v_fmaak_f32 v225, v187, v187, 0x409d30fc
v_lshlrev_b32_sdwa v185, v6, v185 dst_sel:DWORD dst_unused:UNUSED_PAD src0_sel:DWORD src1_sel:WORD_1
s_waitcnt lgkmcnt(2)
v_mfma_f32_16x16x32_bf16 v[196:199], v[240:243], v[112:115], 0
ds_read_b128 v[248:251], v3 offset:23552
ds_read_u16_d16_hi v185, v185
v_mul_f32 v224, v186, v224
v_lshlrev_b32_sdwa v188, v6, v188 dst_sel:DWORD dst_unused:UNUSED_PAD src0_sel:DWORD src1_sel:WORD_1
v_mfma_f32_16x16x32_bf16 v[204:207], v[240:243], v[124:127], 0
ds_read_u16_d16 v188, v188
v_mul_f32 v225, v187, v225
v_lshlrev_b32_sdwa v189, v6, v189 dst_sel:DWORD dst_unused:UNUSED_PAD src0_sel:DWORD src1_sel:WORD_1
v_mfma_f32_16x16x32_bf16 v[212:215], v[240:243], v[136:139], 0
ds_read_u16_d16_hi v189, v189
v_or_b32 v176, v176, v177
v_cvt_pk_bf16_f32 v177, v226, v227
v_or_b32 v178, v180, v181
v_mfma_f32_16x16x32_bf16 v[220:223], v[240:243], v[148:151], 0
v_or_b32 v179, v182, v183
s_waitcnt lgkmcnt(2)
v_mfma_f32_16x16x32_bf16 v[196:199], v[244:247], v[116:119], v[196:199]
ds_read_b128 v[240:243], v4 offset:20480
v_exp_f32 v224, v224
v_lshlrev_b32_sdwa v190, v6, v190 dst_sel:DWORD dst_unused:UNUSED_PAD src0_sel:DWORD src1_sel:WORD_1
v_mfma_f32_16x16x32_bf16 v[204:207], v[244:247], v[128:131], v[204:207]
s_setprio 1
ds_read_u16_d16 v190, v190
v_exp_f32 v225, v225
v_mfma_f32_16x16x32_bf16 v[212:215], v[244:247], v[140:143], v[212:215]
v_lshlrev_b32_sdwa v191, v6, v191 dst_sel:DWORD dst_unused:UNUSED_PAD src0_sel:DWORD src1_sel:WORD_1
v_add_f32 v224, 1.0, v224
v_mfma_f32_16x16x32_bf16 v[220:223], v[244:247], v[152:155], v[220:223]
ds_read_u16_d16_hi v191, v191
v_add_f32 v225, 1.0, v225
v_rcp_f32 v224, v224
v_mfma_f32_16x16x32_bf16 v[196:199], v[248:251], v[120:123], v[196:199]
ds_read_b128 v[244:247], v4 offset:21504
v_rcp_f32 v225, v225
v_mfma_f32_16x16x32_bf16 v[204:207], v[248:251], v[132:135], v[204:207]
v_mul_f32 v224, v186, v224
v_mul_f32 v225, v187, v225
v_mfma_f32_16x16x32_bf16 v[212:215], v[248:251], v[144:147], v[212:215]
v_or_b32 v184, v184, v185
v_cvt_pk_bf16_f32 v185, v224, v225
v_mfma_f32_16x16x32_bf16 v[220:223], v[248:251], v[156:159], v[220:223]
s_waitcnt lgkmcnt(1)
v_or_b32 v186, v188, v189
v_or_b32 v187, v190, v191
v_mfma_f32_16x16x32_bf16 v[16:19], v[160:163], v[240:243], v[16:19]
ds_read_b128 v[248:251], v4 offset:22528
v_fmaak_f32 v226, v194, v194, 0x409d30fc
v_lshlrev_b32_sdwa v192, v6, v192 dst_sel:DWORD dst_unused:UNUSED_PAD src0_sel:DWORD src1_sel:WORD_1
v_mfma_f32_16x16x32_bf16 v[40:43], v[168:171], v[240:243], v[40:43]
ds_read_u16_d16 v192, v192
v_fmaak_f32 v227, v195, v195, 0x409d30fc
v_lshlrev_b32_sdwa v193, v6, v193 dst_sel:DWORD dst_unused:UNUSED_PAD src0_sel:DWORD src1_sel:WORD_1
v_mfma_f32_16x16x32_bf16 v[64:67], v[176:179], v[240:243], v[64:67]
ds_read_u16_d16_hi v193, v193
v_mul_f32 v226, v194, v226
v_lshlrev_b32_sdwa v196, v6, v196 dst_sel:DWORD dst_unused:UNUSED_PAD src0_sel:DWORD src1_sel:WORD_1
v_mul_f32 v227, v195, v227
v_mfma_f32_16x16x32_bf16 v[88:91], v[184:187], v[240:243], v[88:91]
ds_read_u16_d16 v196, v196
v_lshlrev_b32_sdwa v197, v6, v197 dst_sel:DWORD dst_unused:UNUSED_PAD src0_sel:DWORD src1_sel:WORD_1
s_waitcnt lgkmcnt(3)
v_mfma_f32_16x16x32_bf16 v[20:23], v[160:163], v[244:247], v[20:23]
ds_read_b128 v[240:243], v4 offset:23552
ds_read_u16_d16_hi v197, v197
v_exp_f32 v226, v226
v_lshlrev_b32_sdwa v198, v6, v198 dst_sel:DWORD dst_unused:UNUSED_PAD src0_sel:DWORD src1_sel:WORD_1
v_mfma_f32_16x16x32_bf16 v[44:47], v[168:171], v[244:247], v[44:47]
s_setprio 0
ds_read_u16_d16 v198, v198
v_exp_f32 v227, v227
v_mfma_f32_16x16x32_bf16 v[68:71], v[176:179], v[244:247], v[68:71]
v_lshlrev_b32_sdwa v199, v6, v199 dst_sel:DWORD dst_unused:UNUSED_PAD src0_sel:DWORD src1_sel:WORD_1
v_add_f32 v226, 1.0, v226
v_mfma_f32_16x16x32_bf16 v[92:95], v[184:187], v[244:247], v[92:95]
ds_read_u16_d16_hi v199, v199
v_add_f32 v227, 1.0, v227
v_rcp_f32 v226, v226
v_mfma_f32_16x16x32_bf16 v[24:27], v[160:163], v[248:251], v[24:27]
ds_read_b128 v[244:247], v4 offset:24576
v_rcp_f32 v227, v227
v_mfma_f32_16x16x32_bf16 v[48:51], v[168:171], v[248:251], v[48:51]
v_mul_f32 v226, v194, v226
v_mul_f32 v227, v195, v227
v_mfma_f32_16x16x32_bf16 v[72:75], v[176:179], v[248:251], v[72:75]
v_fmaak_f32 v224, v202, v202, 0x409d30fc
v_lshlrev_b32_sdwa v200, v6, v200 dst_sel:DWORD dst_unused:UNUSED_PAD src0_sel:DWORD src1_sel:WORD_1
v_mfma_f32_16x16x32_bf16 v[96:99], v[184:187], v[248:251], v[96:99]
ds_read_u16_d16 v200, v200
v_fmaak_f32 v225, v203, v203, 0x409d30fc
v_lshlrev_b32_sdwa v201, v6, v201 dst_sel:DWORD dst_unused:UNUSED_PAD src0_sel:DWORD src1_sel:WORD_1
s_waitcnt lgkmcnt(2)
v_mfma_f32_16x16x32_bf16 v[28:31], v[160:163], v[240:243], v[28:31]
ds_read_b128 v[248:251], v4 offset:25600
ds_read_u16_d16_hi v201, v201
v_mul_f32 v224, v202, v224
v_lshlrev_b32_sdwa v204, v6, v204 dst_sel:DWORD dst_unused:UNUSED_PAD src0_sel:DWORD src1_sel:WORD_1
v_mfma_f32_16x16x32_bf16 v[52:55], v[168:171], v[240:243], v[52:55]
ds_read_u16_d16 v204, v204
v_mul_f32 v225, v203, v225
v_lshlrev_b32_sdwa v205, v6, v205 dst_sel:DWORD dst_unused:UNUSED_PAD src0_sel:DWORD src1_sel:WORD_1
v_mfma_f32_16x16x32_bf16 v[76:79], v[176:179], v[240:243], v[76:79]
ds_read_u16_d16_hi v205, v205
v_or_b32 v192, v192, v193
v_cvt_pk_bf16_f32 v193, v226, v227
v_or_b32 v194, v196, v197
v_mfma_f32_16x16x32_bf16 v[100:103], v[184:187], v[240:243], v[100:103]
v_or_b32 v195, v198, v199
s_waitcnt lgkmcnt(2)
v_mfma_f32_16x16x32_bf16 v[32:35], v[160:163], v[244:247], v[32:35]
ds_read_b128 v[240:243], v15 offset:8192
v_exp_f32 v224, v224
v_lshlrev_b32_sdwa v206, v6, v206 dst_sel:DWORD dst_unused:UNUSED_PAD src0_sel:DWORD src1_sel:WORD_1
v_mfma_f32_16x16x32_bf16 v[56:59], v[168:171], v[244:247], v[56:59]
s_setprio 3
ds_read_u16_d16 v206, v206
v_exp_f32 v225, v225
v_mfma_f32_16x16x32_bf16 v[80:83], v[176:179], v[244:247], v[80:83]
v_lshlrev_b32_sdwa v207, v6, v207 dst_sel:DWORD dst_unused:UNUSED_PAD src0_sel:DWORD src1_sel:WORD_1
v_add_f32 v224, 1.0, v224
v_mfma_f32_16x16x32_bf16 v[104:107], v[184:187], v[244:247], v[104:107]
ds_read_u16_d16_hi v207, v207
v_add_f32 v225, 1.0, v225
v_rcp_f32 v224, v224
v_mfma_f32_16x16x32_bf16 v[36:39], v[160:163], v[248:251], v[36:39]
ds_read_b128 v[244:247], v15 offset:9216
v_rcp_f32 v225, v225
v_mfma_f32_16x16x32_bf16 v[60:63], v[168:171], v[248:251], v[60:63]
v_mul_f32 v224, v202, v224
v_mul_f32 v225, v203, v225
v_mfma_f32_16x16x32_bf16 v[84:87], v[176:179], v[248:251], v[84:87]
v_fmaak_f32 v226, v210, v210, 0x409d30fc
v_lshlrev_b32_sdwa v208, v6, v208 dst_sel:DWORD dst_unused:UNUSED_PAD src0_sel:DWORD src1_sel:WORD_1
v_mfma_f32_16x16x32_bf16 v[108:111], v[184:187], v[248:251], v[108:111]
ds_read_u16_d16 v208, v208
v_fmaak_f32 v227, v211, v211, 0x409d30fc
v_lshlrev_b32_sdwa v209, v6, v209 dst_sel:DWORD dst_unused:UNUSED_PAD src0_sel:DWORD src1_sel:WORD_1
s_waitcnt lgkmcnt(2)
v_mfma_f32_16x16x32_bf16 v[160:163], v[240:243], v[112:115], 0
ds_read_b128 v[248:251], v15 offset:10240
ds_read_u16_d16_hi v209, v209
v_mul_f32 v226, v210, v226
v_lshlrev_b32_sdwa v212, v6, v212 dst_sel:DWORD dst_unused:UNUSED_PAD src0_sel:DWORD src1_sel:WORD_1
v_mfma_f32_16x16x32_bf16 v[168:171], v[240:243], v[124:127], 0
ds_read_u16_d16 v212, v212
v_mul_f32 v227, v211, v227
v_lshlrev_b32_sdwa v213, v6, v213 dst_sel:DWORD dst_unused:UNUSED_PAD src0_sel:DWORD src1_sel:WORD_1
v_mfma_f32_16x16x32_bf16 v[176:179], v[240:243], v[136:139], 0
ds_read_u16_d16_hi v213, v213
v_or_b32 v200, v200, v201
v_cvt_pk_bf16_f32 v201, v224, v225
v_mfma_f32_16x16x32_bf16 v[184:187], v[240:243], v[148:151], 0
v_or_b32 v202, v204, v205
v_or_b32 v203, v206, v207
s_waitcnt lgkmcnt(2)
v_mfma_f32_16x16x32_bf16 v[160:163], v[244:247], v[116:119], v[160:163]
ds_read_b128 v[240:243], v2 offset:51200
v_exp_f32 v226, v226
v_lshlrev_b32_sdwa v214, v6, v214 dst_sel:DWORD dst_unused:UNUSED_PAD src0_sel:DWORD src1_sel:WORD_1
v_mfma_f32_16x16x32_bf16 v[168:171], v[244:247], v[128:131], v[168:171]
s_setprio 2
ds_read_u16_d16 v214, v214
v_exp_f32 v227, v227
v_mfma_f32_16x16x32_bf16 v[176:179], v[244:247], v[140:143], v[176:179]
v_lshlrev_b32_sdwa v215, v6, v215 dst_sel:DWORD dst_unused:UNUSED_PAD src0_sel:DWORD src1_sel:WORD_1
v_add_f32 v226, 1.0, v226
v_mfma_f32_16x16x32_bf16 v[184:187], v[244:247], v[152:155], v[184:187]
ds_read_u16_d16_hi v215, v215
v_add_f32 v227, 1.0, v227
v_rcp_f32 v226, v226
v_mfma_f32_16x16x32_bf16 v[160:163], v[248:251], v[120:123], v[160:163]
ds_read_b128 v[244:247], v2 offset:52224
v_rcp_f32 v227, v227
v_mfma_f32_16x16x32_bf16 v[168:171], v[248:251], v[132:135], v[168:171]
v_mul_f32 v226, v210, v226
v_mul_f32 v227, v211, v227
v_mfma_f32_16x16x32_bf16 v[176:179], v[248:251], v[144:147], v[176:179]
v_fmaak_f32 v224, v218, v218, 0x409d30fc
v_lshlrev_b32_sdwa v216, v6, v216 dst_sel:DWORD dst_unused:UNUSED_PAD src0_sel:DWORD src1_sel:WORD_1
v_mfma_f32_16x16x32_bf16 v[184:187], v[248:251], v[156:159], v[184:187]
ds_read_u16_d16 v216, v216
v_fmaak_f32 v225, v219, v219, 0x409d30fc
v_lshlrev_b32_sdwa v217, v6, v217 dst_sel:DWORD dst_unused:UNUSED_PAD src0_sel:DWORD src1_sel:WORD_1
s_waitcnt lgkmcnt(2)
v_mfma_f32_16x16x32_bf16 v[164:167], v[240:243], v[112:115], 0
ds_read_b128 v[248:251], v2 offset:53248
ds_read_u16_d16_hi v217, v217
v_mul_f32 v224, v218, v224
v_lshlrev_b32_sdwa v220, v6, v220 dst_sel:DWORD dst_unused:UNUSED_PAD src0_sel:DWORD src1_sel:WORD_1
v_mfma_f32_16x16x32_bf16 v[172:175], v[240:243], v[124:127], 0
ds_read_u16_d16 v220, v220
v_mul_f32 v225, v219, v225
v_lshlrev_b32_sdwa v221, v6, v221 dst_sel:DWORD dst_unused:UNUSED_PAD src0_sel:DWORD src1_sel:WORD_1
v_mfma_f32_16x16x32_bf16 v[180:183], v[240:243], v[136:139], 0
ds_read_u16_d16_hi v221, v221
v_or_b32 v208, v208, v209
v_cvt_pk_bf16_f32 v209, v226, v227
v_or_b32 v210, v212, v213
v_mfma_f32_16x16x32_bf16 v[188:191], v[240:243], v[148:151], 0
v_or_b32 v211, v214, v215
s_waitcnt lgkmcnt(2)
v_mfma_f32_16x16x32_bf16 v[164:167], v[244:247], v[116:119], v[164:167]
ds_read_b128 v[240:243], v4 offset:26624
v_exp_f32 v224, v224
v_lshlrev_b32_sdwa v222, v6, v222 dst_sel:DWORD dst_unused:UNUSED_PAD src0_sel:DWORD src1_sel:WORD_1
v_mfma_f32_16x16x32_bf16 v[172:175], v[244:247], v[128:131], v[172:175]
s_setprio 1
ds_read_u16_d16 v222, v222
v_exp_f32 v225, v225
v_mfma_f32_16x16x32_bf16 v[180:183], v[244:247], v[140:143], v[180:183]
v_lshlrev_b32_sdwa v223, v6, v223 dst_sel:DWORD dst_unused:UNUSED_PAD src0_sel:DWORD src1_sel:WORD_1
v_add_f32 v224, 1.0, v224
v_mfma_f32_16x16x32_bf16 v[188:191], v[244:247], v[152:155], v[188:191]
ds_read_u16_d16_hi v223, v223
v_add_f32 v225, 1.0, v225
v_rcp_f32 v224, v224
v_mfma_f32_16x16x32_bf16 v[164:167], v[248:251], v[120:123], v[164:167]
ds_read_b128 v[244:247], v4 offset:27648
v_rcp_f32 v225, v225
v_mfma_f32_16x16x32_bf16 v[172:175], v[248:251], v[132:135], v[172:175]
v_mul_f32 v224, v218, v224
v_mul_f32 v225, v219, v225
v_mfma_f32_16x16x32_bf16 v[180:183], v[248:251], v[144:147], v[180:183]
v_or_b32 v216, v216, v217
v_cvt_pk_bf16_f32 v217, v224, v225
v_mfma_f32_16x16x32_bf16 v[188:191], v[248:251], v[156:159], v[188:191]
s_waitcnt lgkmcnt(1)
v_or_b32 v218, v220, v221
v_or_b32 v219, v222, v223
v_mfma_f32_16x16x32_bf16 v[16:19], v[192:195], v[240:243], v[16:19]
ds_read_b128 v[248:251], v4 offset:28672
v_fmaak_f32 v226, v160, v160, 0x409d30fc
v_lshlrev_b32_sdwa v162, v6, v162 dst_sel:DWORD dst_unused:UNUSED_PAD src0_sel:DWORD src1_sel:WORD_1
v_fmaak_f32 v227, v161, v161, 0x409d30fc
v_mfma_f32_16x16x32_bf16 v[40:43], v[200:203], v[240:243], v[40:43]
ds_read_u16_d16 v162, v162
v_lshlrev_b32_sdwa v163, v6, v163 dst_sel:DWORD dst_unused:UNUSED_PAD src0_sel:DWORD src1_sel:WORD_1
v_mul_f32 v226, v160, v226
v_mfma_f32_16x16x32_bf16 v[64:67], v[208:211], v[240:243], v[64:67]
ds_read_u16_d16_hi v163, v163
v_lshlrev_b32_sdwa v164, v6, v164 dst_sel:DWORD dst_unused:UNUSED_PAD src0_sel:DWORD src1_sel:WORD_1
v_mul_f32 v227, v161, v227
v_lshlrev_b32_sdwa v165, v6, v165 dst_sel:DWORD dst_unused:UNUSED_PAD src0_sel:DWORD src1_sel:WORD_1
v_mfma_f32_16x16x32_bf16 v[88:91], v[216:219], v[240:243], v[88:91]
ds_read_u16_d16 v164, v164
ds_read_u16_d16_hi v165, v165
s_waitcnt vmcnt(3)
v_perm_b32 v220, v236, v232, s58
s_waitcnt vmcnt(1)
v_perm_b32 v221, v0, v252, s58
s_waitcnt lgkmcnt(3)
v_mfma_f32_16x16x32_bf16 v[20:23], v[192:195], v[244:247], v[20:23]
ds_read_b128 v[240:243], v4 offset:29696
v_exp_f32 v226, v226
v_mov_b32 v222, v8
v_mfma_f32_16x16x32_bf16 v[44:47], v[200:203], v[244:247], v[44:47]
s_setprio 0
v_lshlrev_b32_sdwa v166, v6, v166 dst_sel:DWORD dst_unused:UNUSED_PAD src0_sel:DWORD src1_sel:WORD_1
v_exp_f32 v227, v227
v_mfma_f32_16x16x32_bf16 v[88:91], v[228:231], v[220:223], v[88:91]
ds_read_u16_d16 v166, v166
v_lshlrev_b32_sdwa v167, v6, v167 dst_sel:DWORD dst_unused:UNUSED_PAD src0_sel:DWORD src1_sel:WORD_1
v_add_f32 v226, 1.0, v226
v_mfma_f32_16x16x32_bf16 v[68:71], v[208:211], v[244:247], v[68:71]
ds_read_u16_d16_hi v167, v167
v_add_f32 v227, 1.0, v227
v_rcp_f32 v226, v226
v_mfma_f32_16x16x32_bf16 v[92:95], v[216:219], v[244:247], v[92:95]
v_perm_b32 v220, v236, v232, s59
v_perm_b32 v221, v0, v252, s59
v_mfma_f32_16x16x32_bf16 v[24:27], v[192:195], v[248:251], v[24:27]
ds_read_b128 v[244:247], v4 offset:30720
v_rcp_f32 v227, v227
v_mov_b32 v222, v9
v_mfma_f32_16x16x32_bf16 v[48:51], v[200:203], v[248:251], v[48:51]
v_mul_f32 v226, v160, v226
v_mul_f32 v227, v161, v227
v_mfma_f32_16x16x32_bf16 v[92:95], v[228:231], v[220:223], v[92:95]
v_fmaak_f32 v224, v168, v168, 0x409d30fc
v_lshlrev_b32_sdwa v170, v6, v170 dst_sel:DWORD dst_unused:UNUSED_PAD src0_sel:DWORD src1_sel:WORD_1
v_fmaak_f32 v225, v169, v169, 0x409d30fc
v_mfma_f32_16x16x32_bf16 v[72:75], v[208:211], v[248:251], v[72:75]
ds_read_u16_d16 v170, v170
v_lshlrev_b32_sdwa v171, v6, v171 dst_sel:DWORD dst_unused:UNUSED_PAD src0_sel:DWORD src1_sel:WORD_1
v_cvt_pk_bf16_f32 v160, v226, v227
v_mfma_f32_16x16x32_bf16 v[96:99], v[216:219], v[248:251], v[96:99]
ds_read_u16_d16_hi v171, v171
v_mul_f32 v224, v168, v224
v_perm_b32 v220, v237, v233, s58
v_perm_b32 v221, v1, v253, s58
s_waitcnt lgkmcnt(2)
v_mfma_f32_16x16x32_bf16 v[28:31], v[192:195], v[240:243], v[28:31]
ds_read_b128 v[248:251], v4 offset:31744
v_lshlrev_b32_sdwa v172, v6, v172 dst_sel:DWORD dst_unused:UNUSED_PAD src0_sel:DWORD src1_sel:WORD_1
v_mov_b32 v222, v10
v_mfma_f32_16x16x32_bf16 v[52:55], v[200:203], v[240:243], v[52:55]
ds_read_u16_d16 v172, v172
v_mul_f32 v225, v169, v225
v_lshlrev_b32_sdwa v173, v6, v173 dst_sel:DWORD dst_unused:UNUSED_PAD src0_sel:DWORD src1_sel:WORD_1
v_or_b32 v161, v162, v163
v_mfma_f32_16x16x32_bf16 v[96:99], v[228:231], v[220:223], v[96:99]
ds_read_u16_d16_hi v173, v173
v_or_b32 v162, v164, v165
v_or_b32 v163, v166, v167
v_mfma_f32_16x16x32_bf16 v[76:79], v[208:211], v[240:243], v[76:79]
s_setprio 3
v_exp_f32 v224, v224
v_lshlrev_b32_sdwa v174, v6, v174 dst_sel:DWORD dst_unused:UNUSED_PAD src0_sel:DWORD src1_sel:WORD_1
v_mfma_f32_16x16x32_bf16 v[100:103], v[216:219], v[240:243], v[100:103]
ds_read_u16_d16 v174, v174
v_perm_b32 v220, v237, v233, s59
v_perm_b32 v221, v1, v253, s59
v_mfma_f32_16x16x32_bf16 v[32:35], v[192:195], v[244:247], v[32:35]
ds_read_b128 v[240:243], v15 offset:17408
v_exp_f32 v225, v225
v_mov_b32 v222, v11
v_mfma_f32_16x16x32_bf16 v[56:59], v[200:203], v[244:247], v[56:59]
v_lshlrev_b32_sdwa v175, v6, v175 dst_sel:DWORD dst_unused:UNUSED_PAD src0_sel:DWORD src1_sel:WORD_1
v_add_f32 v224, 1.0, v224
v_mfma_f32_16x16x32_bf16 v[100:103], v[228:231], v[220:223], v[100:103]
ds_read_u16_d16_hi v175, v175
v_add_f32 v225, 1.0, v225
v_rcp_f32 v224, v224
v_mfma_f32_16x16x32_bf16 v[80:83], v[208:211], v[244:247], v[80:83]
v_rcp_f32 v225, v225
v_mfma_f32_16x16x32_bf16 v[104:107], v[216:219], v[244:247], v[104:107]
v_mul_f32 v224, v168, v224
v_perm_b32 v220, v238, v234, s58
s_waitcnt vmcnt(0)
v_perm_b32 v221, v235, v254, s58
s_waitcnt lgkmcnt(1)
v_mfma_f32_16x16x32_bf16 v[36:39], v[192:195], v[248:251], v[36:39]
ds_read_b128 v[244:247], v15 offset:18432
v_mul_f32 v225, v169, v225
v_fmaak_f32 v226, v176, v176, 0x409d30fc
v_mov_b32 v222, v12
v_mfma_f32_16x16x32_bf16 v[60:63], v[200:203], v[248:251], v[60:63]
v_lshlrev_b32_sdwa v178, v6, v178 dst_sel:DWORD dst_unused:UNUSED_PAD src0_sel:DWORD src1_sel:WORD_1
v_fmaak_f32 v227, v177, v177, 0x409d30fc
v_mfma_f32_16x16x32_bf16 v[104:107], v[228:231], v[220:223], v[104:107]
ds_read_u16_d16 v178, v178
v_lshlrev_b32_sdwa v179, v6, v179 dst_sel:DWORD dst_unused:UNUSED_PAD src0_sel:DWORD src1_sel:WORD_1
v_cvt_pk_bf16_f32 v168, v224, v225
v_mul_f32 v226, v176, v226
v_mfma_f32_16x16x32_bf16 v[84:87], v[208:211], v[248:251], v[84:87]
ds_read_u16_d16_hi v179, v179
v_lshlrev_b32_sdwa v180, v6, v180 dst_sel:DWORD dst_unused:UNUSED_PAD src0_sel:DWORD src1_sel:WORD_1
v_mul_f32 v227, v177, v227
v_mfma_f32_16x16x32_bf16 v[108:111], v[216:219], v[248:251], v[108:111]
ds_read_u16_d16 v180, v180
v_perm_b32 v220, v238, v234, s59
v_perm_b32 v221, v235, v254, s59
v_mov_b32 v222, v13
v_mfma_f32_16x16x32_bf16 v[200:203], v[240:243], v[124:127], 0
s_setprio 2
ds_read_b128 v[248:251], v15 offset:19456
v_lshlrev_b32_sdwa v181, v6, v181 dst_sel:DWORD dst_unused:UNUSED_PAD src0_sel:DWORD src1_sel:WORD_1
v_or_b32 v169, v170, v171
v_mfma_f32_16x16x32_bf16 v[108:111], v[228:231], v[220:223], v[108:111]
ds_read_u16_d16_hi v181, v181
v_or_b32 v170, v172, v173
s_waitcnt lgkmcnt(3)
v_or_b32 v171, v174, v175
v_mfma_f32_16x16x32_bf16 v[208:211], v[240:243], v[136:139], 0
v_exp_f32 v226, v226
v_lshlrev_b32_sdwa v182, v6, v182 dst_sel:DWORD dst_unused:UNUSED_PAD src0_sel:DWORD src1_sel:WORD_1
v_mfma_f32_16x16x32_bf16 v[216:219], v[240:243], v[148:151], 0
ds_read_u16_d16 v182, v182
v_exp_f32 v227, v227
v_lshlrev_b32_sdwa v183, v6, v183 dst_sel:DWORD dst_unused:UNUSED_PAD src0_sel:DWORD src1_sel:WORD_1
v_mfma_f32_16x16x32_bf16 v[200:203], v[244:247], v[128:131], v[200:203]
ds_read_b128 v[240:243], v2 offset:60416
ds_read_u16_d16_hi v183, v183
v_add_f32 v226, 1.0, v226
v_add_f32 v227, 1.0, v227
v_mfma_f32_16x16x32_bf16 v[208:211], v[244:247], v[140:143], v[208:211]
v_rcp_f32 v226, v226
v_mfma_f32_16x16x32_bf16 v[216:219], v[244:247], v[152:155], v[216:219]
v_rcp_f32 v227, v227
v_mul_f32 v226, v176, v226
s_waitcnt lgkmcnt(2)
v_mfma_f32_16x16x32_bf16 v[200:203], v[248:251], v[132:135], v[200:203]
ds_read_b128 v[244:247], v2 offset:61440
v_mul_f32 v227, v177, v227
v_fmaak_f32 v224, v184, v184, 0x409d30fc
v_lshlrev_b32_sdwa v186, v6, v186 dst_sel:DWORD dst_unused:UNUSED_PAD src0_sel:DWORD src1_sel:WORD_1
v_mfma_f32_16x16x32_bf16 v[208:211], v[248:251], v[144:147], v[208:211]
ds_read_u16_d16 v186, v186
v_fmaak_f32 v225, v185, v185, 0x409d30fc
v_lshlrev_b32_sdwa v187, v6, v187 dst_sel:DWORD dst_unused:UNUSED_PAD src0_sel:DWORD src1_sel:WORD_1
v_cvt_pk_bf16_f32 v176, v226, v227
v_mfma_f32_16x16x32_bf16 v[216:219], v[248:251], v[156:159], v[216:219]
ds_read_u16_d16_hi v187, v187
v_mul_f32 v224, v184, v224
v_lshlrev_b32_sdwa v188, v6, v188 dst_sel:DWORD dst_unused:UNUSED_PAD src0_sel:DWORD src1_sel:WORD_1
s_waitcnt lgkmcnt(2)
v_mfma_f32_16x16x32_bf16 v[204:207], v[240:243], v[124:127], 0
ds_read_b128 v[248:251], v2 offset:62464
ds_read_u16_d16 v188, v188
v_mul_f32 v225, v185, v225
v_lshlrev_b32_sdwa v189, v6, v189 dst_sel:DWORD dst_unused:UNUSED_PAD src0_sel:DWORD src1_sel:WORD_1
v_or_b32 v177, v178, v179
v_mfma_f32_16x16x32_bf16 v[212:215], v[240:243], v[136:139], 0
ds_read_u16_d16_hi v189, v189
v_or_b32 v178, v180, v181
v_or_b32 v179, v182, v183
v_mfma_f32_16x16x32_bf16 v[220:223], v[240:243], v[148:151], 0
s_setprio 1
v_exp_f32 v224, v224
v_lshlrev_b32_sdwa v190, v6, v190 dst_sel:DWORD dst_unused:UNUSED_PAD src0_sel:DWORD src1_sel:WORD_1
v_mfma_f32_16x16x32_bf16 v[204:207], v[244:247], v[128:131], v[204:207]
ds_read_b128 v[240:243], v3 offset:24576
ds_read_u16_d16 v190, v190
v_exp_f32 v225, v225
v_mfma_f32_16x16x32_bf16 v[212:215], v[244:247], v[140:143], v[212:215]
v_lshlrev_b32_sdwa v191, v6, v191 dst_sel:DWORD dst_unused:UNUSED_PAD src0_sel:DWORD src1_sel:WORD_1
v_add_f32 v224, 1.0, v224
v_add_f32 v225, 1.0, v225
v_mfma_f32_16x16x32_bf16 v[220:223], v[244:247], v[152:155], v[220:223]
ds_read_u16_d16_hi v191, v191
v_rcp_f32 v224, v224
s_waitcnt lgkmcnt(3)
v_mfma_f32_16x16x32_bf16 v[204:207], v[248:251], v[132:135], v[204:207]
ds_read_b128 v[244:247], v3 offset:25600
v_rcp_f32 v225, v225
v_mul_f32 v224, v184, v224
v_mfma_f32_16x16x32_bf16 v[212:215], v[248:251], v[144:147], v[212:215]
v_mul_f32 v225, v185, v225
v_cvt_pk_bf16_f32 v184, v224, v225
v_mfma_f32_16x16x32_bf16 v[220:223], v[248:251], v[156:159], v[220:223]
v_or_b32 v185, v186, v187
v_or_b32 v186, v188, v189
s_waitcnt lgkmcnt(1)
v_or_b32 v187, v190, v191
v_mfma_f32_16x16x32_bf16 v[16:19], v[160:163], v[240:243], v[16:19]
ds_read_b128 v[248:251], v3 offset:26624
v_fmaak_f32 v226, v200, v200, 0x409d30fc
v_lshlrev_b32_sdwa v202, v6, v202 dst_sel:DWORD dst_unused:UNUSED_PAD src0_sel:DWORD src1_sel:WORD_1
v_mfma_f32_16x16x32_bf16 v[40:43], v[168:171], v[240:243], v[40:43]
ds_read_u16_d16 v202, v202
v_fmaak_f32 v227, v201, v201, 0x409d30fc
v_lshlrev_b32_sdwa v203, v6, v203 dst_sel:DWORD dst_unused:UNUSED_PAD src0_sel:DWORD src1_sel:WORD_1
v_mul_f32 v226, v200, v226
v_mfma_f32_16x16x32_bf16 v[64:67], v[176:179], v[240:243], v[64:67]
ds_read_u16_d16_hi v203, v203
v_lshlrev_b32_sdwa v204, v6, v204 dst_sel:DWORD dst_unused:UNUSED_PAD src0_sel:DWORD src1_sel:WORD_1
v_mul_f32 v227, v201, v227
v_mfma_f32_16x16x32_bf16 v[88:91], v[184:187], v[240:243], v[88:91]
ds_read_u16_d16 v204, v204
v_lshlrev_b32_sdwa v205, v6, v205 dst_sel:DWORD dst_unused:UNUSED_PAD src0_sel:DWORD src1_sel:WORD_1
v_exp_f32 v226, v226
s_waitcnt lgkmcnt(3)
v_mfma_f32_16x16x32_bf16 v[20:23], v[160:163], v[244:247], v[20:23]
ds_read_b128 v[240:243], v3 offset:27648
ds_read_u16_d16_hi v205, v205
v_lshlrev_b32_sdwa v206, v6, v206 dst_sel:DWORD dst_unused:UNUSED_PAD src0_sel:DWORD src1_sel:WORD_1
v_exp_f32 v227, v227
v_mfma_f32_16x16x32_bf16 v[44:47], v[168:171], v[244:247], v[44:47]
s_setprio 0
ds_read_u16_d16 v206, v206
v_lshlrev_b32_sdwa v207, v6, v207 dst_sel:DWORD dst_unused:UNUSED_PAD src0_sel:DWORD src1_sel:WORD_1
v_mfma_f32_16x16x32_bf16 v[68:71], v[176:179], v[244:247], v[68:71]
ds_read_u16_d16_hi v207, v207
v_add_f32 v226, 1.0, v226
v_add_f32 v227, 1.0, v227
v_mfma_f32_16x16x32_bf16 v[92:95], v[184:187], v[244:247], v[92:95]
v_rcp_f32 v226, v226
v_rcp_f32 v227, v227
v_mfma_f32_16x16x32_bf16 v[24:27], v[160:163], v[248:251], v[24:27]
ds_read_b128 v[244:247], v3 offset:28672
v_mul_f32 v226, v200, v226
v_mul_f32 v227, v201, v227
v_mfma_f32_16x16x32_bf16 v[48:51], v[168:171], v[248:251], v[48:51]
v_fmaak_f32 v224, v208, v208, 0x409d30fc
v_lshlrev_b32_sdwa v210, v6, v210 dst_sel:DWORD dst_unused:UNUSED_PAD src0_sel:DWORD src1_sel:WORD_1
v_mfma_f32_16x16x32_bf16 v[72:75], v[176:179], v[248:251], v[72:75]
ds_read_u16_d16 v210, v210
v_fmaak_f32 v225, v209, v209, 0x409d30fc
v_lshlrev_b32_sdwa v211, v6, v211 dst_sel:DWORD dst_unused:UNUSED_PAD src0_sel:DWORD src1_sel:WORD_1
v_cvt_pk_bf16_f32 v200, v226, v227
v_mfma_f32_16x16x32_bf16 v[96:99], v[184:187], v[248:251], v[96:99]
ds_read_u16_d16_hi v211, v211
v_mul_f32 v224, v208, v224
v_lshlrev_b32_sdwa v212, v6, v212 dst_sel:DWORD dst_unused:UNUSED_PAD src0_sel:DWORD src1_sel:WORD_1
s_waitcnt lgkmcnt(2)
v_mfma_f32_16x16x32_bf16 v[28:31], v[160:163], v[240:243], v[28:31]
ds_read_b128 v[248:251], v3 offset:29696
ds_read_u16_d16 v212, v212
v_mul_f32 v225, v209, v225
v_lshlrev_b32_sdwa v213, v6, v213 dst_sel:DWORD dst_unused:UNUSED_PAD src0_sel:DWORD src1_sel:WORD_1
v_mfma_f32_16x16x32_bf16 v[52:55], v[168:171], v[240:243], v[52:55]
ds_read_u16_d16_hi v213, v213
v_or_b32 v201, v202, v203
v_or_b32 v202, v204, v205
v_or_b32 v203, v206, v207
v_mfma_f32_16x16x32_bf16 v[76:79], v[176:179], v[240:243], v[76:79]
v_exp_f32 v224, v224
v_mfma_f32_16x16x32_bf16 v[100:103], v[184:187], v[240:243], v[100:103]
v_lshlrev_b32_sdwa v214, v6, v214 dst_sel:DWORD dst_unused:UNUSED_PAD src0_sel:DWORD src1_sel:WORD_1
v_exp_f32 v225, v225
v_mfma_f32_16x16x32_bf16 v[32:35], v[160:163], v[244:247], v[32:35]
ds_read_b128 v[240:243], v15 offset:26624
ds_read_u16_d16 v214, v214
v_lshlrev_b32_sdwa v215, v6, v215 dst_sel:DWORD dst_unused:UNUSED_PAD src0_sel:DWORD src1_sel:WORD_1
v_add_f32 v224, 1.0, v224
v_mfma_f32_16x16x32_bf16 v[56:59], v[168:171], v[244:247], v[56:59]
s_setprio 3
ds_read_u16_d16_hi v215, v215
v_add_f32 v225, 1.0, v225
v_rcp_f32 v224, v224
v_mfma_f32_16x16x32_bf16 v[80:83], v[176:179], v[244:247], v[80:83]
v_rcp_f32 v225, v225
v_mfma_f32_16x16x32_bf16 v[104:107], v[184:187], v[244:247], v[104:107]
v_mul_f32 v224, v208, v224
v_mul_f32 v225, v209, v225
s_waitcnt lgkmcnt(1)
v_mfma_f32_16x16x32_bf16 v[36:39], v[160:163], v[248:251], v[36:39]
ds_read_b128 v[244:247], v15 offset:27648
v_fmaak_f32 v226, v216, v216, 0x409d30fc
v_lshlrev_b32_sdwa v218, v6, v218 dst_sel:DWORD dst_unused:UNUSED_PAD src0_sel:DWORD src1_sel:WORD_1
v_fmaak_f32 v227, v217, v217, 0x409d30fc
v_mfma_f32_16x16x32_bf16 v[60:63], v[168:171], v[248:251], v[60:63]
ds_read_u16_d16 v218, v218
v_lshlrev_b32_sdwa v219, v6, v219 dst_sel:DWORD dst_unused:UNUSED_PAD src0_sel:DWORD src1_sel:WORD_1
v_cvt_pk_bf16_f32 v208, v224, v225
v_mfma_f32_16x16x32_bf16 v[84:87], v[176:179], v[248:251], v[84:87]
ds_read_u16_d16_hi v219, v219
v_mul_f32 v226, v216, v226
v_lshlrev_b32_sdwa v220, v6, v220 dst_sel:DWORD dst_unused:UNUSED_PAD src0_sel:DWORD src1_sel:WORD_1
v_mul_f32 v227, v217, v227
v_mfma_f32_16x16x32_bf16 v[108:111], v[184:187], v[248:251], v[108:111]
ds_read_u16_d16 v220, v220
v_cvt_pk_bf16_f32 v192, v16, v20
v_cvt_pk_bf16_f32 v193, v24, v28
v_cvt_pk_bf16_f32 v194, v32, v36
s_add_u32 s44, s52, 0
buffer_store_dwordx3 v[192:194], v5, s[12:15], s44 offen offset:0 nt
v_mfma_f32_16x16x32_bf16 v[176:179], v[240:243], v[136:139], 0
ds_read_b128 v[248:251], v15 offset:28672
v_lshlrev_b32_sdwa v221, v6, v221 dst_sel:DWORD dst_unused:UNUSED_PAD src0_sel:DWORD src1_sel:WORD_1
v_mfma_f32_16x16x32_bf16 v[184:187], v[240:243], v[148:151], 0
ds_read_u16_d16_hi v221, v221
v_or_b32 v209, v210, v211
v_or_b32 v210, v212, v213
s_waitcnt lgkmcnt(2)
v_or_b32 v211, v214, v215
v_mfma_f32_16x16x32_bf16 v[176:179], v[244:247], v[140:143], v[176:179]
ds_read_b128 v[240:243], v2 offset:63488
v_exp_f32 v226, v226
v_mfma_f32_16x16x32_bf16 v[184:187], v[244:247], v[152:155], v[184:187]
v_lshlrev_b32_sdwa v222, v6, v222 dst_sel:DWORD dst_unused:UNUSED_PAD src0_sel:DWORD src1_sel:WORD_1
v_exp_f32 v227, v227
s_waitcnt lgkmcnt(2)
v_mfma_f32_16x16x32_bf16 v[176:179], v[248:251], v[144:147], v[176:179]
ds_read_b128 v[244:247], v2 offset:64512
ds_read_u16_d16 v222, v222
v_lshlrev_b32_sdwa v223, v6, v223 dst_sel:DWORD dst_unused:UNUSED_PAD src0_sel:DWORD src1_sel:WORD_1
v_add_f32 v226, 1.0, v226
v_mfma_f32_16x16x32_bf16 v[184:187], v[248:251], v[156:159], v[184:187]
s_setprio 2
ds_read_u16_d16_hi v223, v223
v_cvt_pk_bf16_f32 v196, v17, v21
v_cvt_pk_bf16_f32 v197, v25, v29
v_cvt_pk_bf16_f32 v198, v33, v37
buffer_store_dwordx3 v[196:198], v5, s[12:15], s44 offen offset:768 nt
s_waitcnt lgkmcnt(3)
v_mfma_f32_16x16x32_bf16 v[180:183], v[240:243], v[136:139], 0
ds_read_b128 v[248:251], v3 offset:8192
v_add_f32 v227, 1.0, v227
v_mfma_f32_16x16x32_bf16 v[188:191], v[240:243], v[148:151], 0
v_rcp_f32 v226, v226
v_rcp_f32 v227, v227
s_waitcnt lgkmcnt(2)
v_mfma_f32_16x16x32_bf16 v[180:183], v[244:247], v[140:143], v[180:183]
ds_read_b128 v[240:243], v3 offset:30720
v_mul_f32 v226, v216, v226
v_mul_f32 v227, v217, v227
v_mfma_f32_16x16x32_bf16 v[188:191], v[244:247], v[152:155], v[188:191]
v_cvt_pk_bf16_f32 v216, v226, v227
v_or_b32 v217, v218, v219
s_waitcnt lgkmcnt(1)
v_mfma_f32_16x16x32_bf16 v[180:183], v[248:251], v[144:147], v[180:183]
ds_read_b128 v[244:247], v3 offset:31744
v_or_b32 v218, v220, v221
v_or_b32 v219, v222, v223
v_mfma_f32_16x16x32_bf16 v[188:191], v[248:251], v[156:159], v[188:191]
v_cvt_pk_bf16_f32 v192, v18, v22
v_cvt_pk_bf16_f32 v193, v26, v30
v_cvt_pk_bf16_f32 v194, v34, v38
buffer_store_dwordx3 v[192:194], v5, s[12:15], s44 offen offset:1536 nt
s_waitcnt lgkmcnt(1)
v_mfma_f32_16x16x32_bf16 v[40:43], v[200:203], v[240:243], v[40:43]
ds_read_b128 v[248:251], v3 offset:32768
v_fmaak_f32 v224, v176, v176, 0x409d30fc
v_lshlrev_b32_sdwa v178, v6, v178 dst_sel:DWORD dst_unused:UNUSED_PAD src0_sel:DWORD src1_sel:WORD_1
v_mfma_f32_16x16x32_bf16 v[64:67], v[208:211], v[240:243], v[64:67]
ds_read_u16_d16 v178, v178
v_fmaak_f32 v225, v177, v177, 0x409d30fc
v_lshlrev_b32_sdwa v179, v6, v179 dst_sel:DWORD dst_unused:UNUSED_PAD src0_sel:DWORD src1_sel:WORD_1
v_mfma_f32_16x16x32_bf16 v[88:91], v[216:219], v[240:243], v[88:91]
ds_read_u16_d16_hi v179, v179
v_mul_f32 v224, v176, v224
v_lshlrev_b32_sdwa v180, v6, v180 dst_sel:DWORD dst_unused:UNUSED_PAD src0_sel:DWORD src1_sel:WORD_1
s_waitcnt lgkmcnt(3)
v_mfma_f32_16x16x32_bf16 v[44:47], v[200:203], v[244:247], v[44:47]
ds_read_b128 v[240:243], v3 offset:33792
ds_read_u16_d16 v180, v180
v_mul_f32 v225, v177, v225
v_lshlrev_b32_sdwa v181, v6, v181 dst_sel:DWORD dst_unused:UNUSED_PAD src0_sel:DWORD src1_sel:WORD_1
v_mfma_f32_16x16x32_bf16 v[68:71], v[208:211], v[244:247], v[68:71]
ds_read_u16_d16_hi v181, v181
v_exp_f32 v224, v224
v_lshlrev_b32_sdwa v182, v6, v182 dst_sel:DWORD dst_unused:UNUSED_PAD src0_sel:DWORD src1_sel:WORD_1
v_mfma_f32_16x16x32_bf16 v[92:95], v[216:219], v[244:247], v[92:95]
s_setprio 1
ds_read_u16_d16 v182, v182
v_exp_f32 v225, v225
s_waitcnt lgkmcnt(4)
v_mfma_f32_16x16x32_bf16 v[48:51], v[200:203], v[248:251], v[48:51]
ds_read_b128 v[244:247], v3 offset:34816
v_lshlrev_b32_sdwa v183, v6, v183 dst_sel:DWORD dst_unused:UNUSED_PAD src0_sel:DWORD src1_sel:WORD_1
v_add_f32 v224, 1.0, v224
v_mfma_f32_16x16x32_bf16 v[72:75], v[208:211], v[248:251], v[72:75]
ds_read_u16_d16_hi v183, v183
v_cvt_pk_bf16_f32 v196, v19, v23
v_cvt_pk_bf16_f32 v197, v27, v31
v_cvt_pk_bf16_f32 v198, v35, v39
buffer_store_dwordx3 v[196:198], v5, s[12:15], s44 offen offset:2304 nt
v_mfma_f32_16x16x32_bf16 v[96:99], v[216:219], v[248:251], v[96:99]
v_add_f32 v225, 1.0, v225
s_waitcnt lgkmcnt(2)
v_mfma_f32_16x16x32_bf16 v[52:55], v[200:203], v[240:243], v[52:55]
ds_read_b128 v[248:251], v3 offset:35840
v_rcp_f32 v224, v224
v_mfma_f32_16x16x32_bf16 v[76:79], v[208:211], v[240:243], v[76:79]
v_rcp_f32 v225, v225
v_mfma_f32_16x16x32_bf16 v[100:103], v[216:219], v[240:243], v[100:103]
v_mul_f32 v224, v176, v224
v_mul_f32 v225, v177, v225
v_fmaak_f32 v226, v184, v184, 0x409d30fc
s_waitcnt lgkmcnt(1)
v_mfma_f32_16x16x32_bf16 v[56:59], v[200:203], v[244:247], v[56:59]
ds_read_b128 v[240:243], v15 offset:35840
v_lshlrev_b32_sdwa v186, v6, v186 dst_sel:DWORD dst_unused:UNUSED_PAD src0_sel:DWORD src1_sel:WORD_1
v_fmaak_f32 v227, v185, v185, 0x409d30fc
v_mfma_f32_16x16x32_bf16 v[80:83], v[208:211], v[244:247], v[80:83]
ds_read_u16_d16 v186, v186
v_lshlrev_b32_sdwa v187, v6, v187 dst_sel:DWORD dst_unused:UNUSED_PAD src0_sel:DWORD src1_sel:WORD_1
v_cvt_pk_bf16_f32 v176, v224, v225
v_mfma_f32_16x16x32_bf16 v[104:107], v[216:219], v[244:247], v[104:107]
ds_read_u16_d16_hi v187, v187
v_mul_f32 v226, v184, v226
v_lshlrev_b32_sdwa v188, v6, v188 dst_sel:DWORD dst_unused:UNUSED_PAD src0_sel:DWORD src1_sel:WORD_1
s_waitcnt lgkmcnt(3)
v_mfma_f32_16x16x32_bf16 v[60:63], v[200:203], v[248:251], v[60:63]
ds_read_b128 v[244:247], v15 offset:36864
ds_read_u16_d16 v188, v188
v_mul_f32 v227, v185, v227
v_lshlrev_b32_sdwa v189, v6, v189 dst_sel:DWORD dst_unused:UNUSED_PAD src0_sel:DWORD src1_sel:WORD_1
v_mfma_f32_16x16x32_bf16 v[84:87], v[208:211], v[248:251], v[84:87]
ds_read_u16_d16_hi v189, v189
v_or_b32 v177, v178, v179
v_or_b32 v178, v180, v181
v_mfma_f32_16x16x32_bf16 v[108:111], v[216:219], v[248:251], v[108:111]
s_setprio 0
v_cvt_pk_bf16_f32 v168, v40, v44
v_cvt_pk_bf16_f32 v169, v48, v52
v_cvt_pk_bf16_f32 v170, v56, v60
s_add_u32 s45, s52, 98304
buffer_store_dwordx3 v[168:170], v5, s[12:15], s45 offen offset:0 nt
s_waitcnt lgkmcnt(1)
v_mfma_f32_16x16x32_bf16 v[208:211], v[240:243], v[136:139], 0
ds_read_b128 v[248:251], v15 offset:37888
v_or_b32 v179, v182, v183
v_mfma_f32_16x16x32_bf16 v[216:219], v[240:243], v[148:151], 0
v_exp_f32 v226, v226
v_lshlrev_b32_sdwa v190, v6, v190 dst_sel:DWORD dst_unused:UNUSED_PAD src0_sel:DWORD src1_sel:WORD_1
v_mfma_f32_16x16x32_bf16 v[208:211], v[244:247], v[140:143], v[208:211]
ds_read_b128 v[240:243], v3 offset:15360
ds_read_u16_d16 v190, v190
v_exp_f32 v227, v227
v_mfma_f32_16x16x32_bf16 v[216:219], v[244:247], v[152:155], v[216:219]
v_lshlrev_b32_sdwa v191, v6, v191 dst_sel:DWORD dst_unused:UNUSED_PAD src0_sel:DWORD src1_sel:WORD_1
v_add_f32 v226, 1.0, v226
s_waitcnt lgkmcnt(2)
v_mfma_f32_16x16x32_bf16 v[208:211], v[248:251], v[144:147], v[208:211]
ds_read_b128 v[244:247], v3 offset:16384
ds_read_u16_d16_hi v191, v191
v_add_f32 v227, 1.0, v227
v_rcp_f32 v226, v226
v_mfma_f32_16x16x32_bf16 v[216:219], v[248:251], v[156:159], v[216:219]
v_cvt_pk_bf16_f32 v172, v41, v45
v_cvt_pk_bf16_f32 v173, v49, v53
v_cvt_pk_bf16_f32 v174, v57, v61
buffer_store_dwordx3 v[172:174], v5, s[12:15], s45 offen offset:768 nt
s_waitcnt lgkmcnt(2)
v_mfma_f32_16x16x32_bf16 v[212:215], v[240:243], v[136:139], 0
ds_read_b128 v[248:251], v3 offset:17408
v_mfma_f32_16x16x32_bf16 v[220:223], v[240:243], v[148:151], 0
v_rcp_f32 v227, v227
s_waitcnt lgkmcnt(2)
v_mfma_f32_16x16x32_bf16 v[212:215], v[244:247], v[140:143], v[212:215]
ds_read_b128 v[240:243], v3 offset:36864
v_mul_f32 v226, v184, v226
v_mul_f32 v227, v185, v227
v_cvt_pk_bf16_f32 v184, v226, v227
v_mfma_f32_16x16x32_bf16 v[220:223], v[244:247], v[152:155], v[220:223]
v_or_b32 v185, v186, v187
v_or_b32 v186, v188, v189
s_waitcnt lgkmcnt(1)
v_mfma_f32_16x16x32_bf16 v[212:215], v[248:251], v[144:147], v[212:215]
ds_read_b128 v[244:247], v3 offset:37888
v_or_b32 v187, v190, v191
v_mfma_f32_16x16x32_bf16 v[220:223], v[248:251], v[156:159], v[220:223]
s_setprio 3
v_cvt_pk_bf16_f32 v168, v42, v46
v_cvt_pk_bf16_f32 v169, v50, v54
v_cvt_pk_bf16_f32 v170, v58, v62
buffer_store_dwordx3 v[168:170], v5, s[12:15], s45 offen offset:1536 nt
s_waitcnt lgkmcnt(1)
v_mfma_f32_16x16x32_bf16 v[64:67], v[176:179], v[240:243], v[64:67]
ds_read_b128 v[248:251], v3 offset:38912
v_fmaak_f32 v224, v208, v208, 0x409d30fc
v_lshlrev_b32_sdwa v210, v6, v210 dst_sel:DWORD dst_unused:UNUSED_PAD src0_sel:DWORD src1_sel:WORD_1
v_fmaak_f32 v225, v209, v209, 0x409d30fc
v_mfma_f32_16x16x32_bf16 v[88:91], v[184:187], v[240:243], v[88:91]
ds_read_u16_d16 v210, v210
v_lshlrev_b32_sdwa v211, v6, v211 dst_sel:DWORD dst_unused:UNUSED_PAD src0_sel:DWORD src1_sel:WORD_1
v_mul_f32 v224, v208, v224
v_lshlrev_b32_sdwa v212, v6, v212 dst_sel:DWORD dst_unused:UNUSED_PAD src0_sel:DWORD src1_sel:WORD_1
s_waitcnt lgkmcnt(2)
v_mfma_f32_16x16x32_bf16 v[68:71], v[176:179], v[244:247], v[68:71]
ds_read_b128 v[240:243], v3 offset:39936
ds_read_u16_d16_hi v211, v211
ds_read_u16_d16 v212, v212
v_mul_f32 v225, v209, v225
v_lshlrev_b32_sdwa v213, v6, v213 dst_sel:DWORD dst_unused:UNUSED_PAD src0_sel:DWORD src1_sel:WORD_1
v_exp_f32 v224, v224
v_mfma_f32_16x16x32_bf16 v[92:95], v[184:187], v[244:247], v[92:95]
ds_read_u16_d16_hi v213, v213
v_lshlrev_b32_sdwa v214, v6, v214 dst_sel:DWORD dst_unused:UNUSED_PAD src0_sel:DWORD src1_sel:WORD_1
v_exp_f32 v225, v225
s_waitcnt lgkmcnt(4)
v_mfma_f32_16x16x32_bf16 v[72:75], v[176:179], v[248:251], v[72:75]
ds_read_b128 v[244:247], v3 offset:40960
ds_read_u16_d16 v214, v214
v_cvt_pk_bf16_f32 v172, v43, v47
v_cvt_pk_bf16_f32 v173, v51, v55
v_cvt_pk_bf16_f32 v174, v59, v63
buffer_store_dwordx3 v[172:174], v5, s[12:15], s45 offen offset:2304 nt
v_mfma_f32_16x16x32_bf16 v[96:99], v[184:187], v[248:251], v[96:99]
v_lshlrev_b32_sdwa v215, v6, v215 dst_sel:DWORD dst_unused:UNUSED_PAD src0_sel:DWORD src1_sel:WORD_1
v_add_f32 v224, 1.0, v224
s_waitcnt lgkmcnt(2)
v_mfma_f32_16x16x32_bf16 v[76:79], v[176:179], v[240:243], v[76:79]
ds_read_b128 v[248:251], v3 offset:41984
ds_read_u16_d16_hi v215, v215
v_add_f32 v225, 1.0, v225
v_rcp_f32 v224, v224
v_mfma_f32_16x16x32_bf16 v[100:103], v[184:187], v[240:243], v[100:103]
v_rcp_f32 v225, v225
v_mul_f32 v224, v208, v224
s_waitcnt lgkmcnt(2)
v_mfma_f32_16x16x32_bf16 v[80:83], v[176:179], v[244:247], v[80:83]
ds_read_b128 v[240:243], v14 offset:26624
v_mul_f32 v225, v209, v225
v_fmaak_f32 v226, v216, v216, 0x409d30fc
v_lshlrev_b32_sdwa v218, v6, v218 dst_sel:DWORD dst_unused:UNUSED_PAD src0_sel:DWORD src1_sel:WORD_1
v_fmaak_f32 v227, v217, v217, 0x409d30fc
v_mfma_f32_16x16x32_bf16 v[104:107], v[184:187], v[244:247], v[104:107]
ds_read_u16_d16 v218, v218
v_lshlrev_b32_sdwa v219, v6, v219 dst_sel:DWORD dst_unused:UNUSED_PAD src0_sel:DWORD src1_sel:WORD_1
v_cvt_pk_bf16_f32 v208, v224, v225
v_mul_f32 v226, v216, v226
s_waitcnt lgkmcnt(2)
v_mfma_f32_16x16x32_bf16 v[84:87], v[176:179], v[248:251], v[84:87]
ds_read_b128 v[244:247], v14 offset:27648
ds_read_u16_d16_hi v219, v219
v_lshlrev_b32_sdwa v220, v6, v220 dst_sel:DWORD dst_unused:UNUSED_PAD src0_sel:DWORD src1_sel:WORD_1
v_mul_f32 v227, v217, v227
v_lshlrev_b32_sdwa v221, v6, v221 dst_sel:DWORD dst_unused:UNUSED_PAD src0_sel:DWORD src1_sel:WORD_1
v_mfma_f32_16x16x32_bf16 v[108:111], v[184:187], v[248:251], v[108:111]
s_setprio 2
ds_read_u16_d16 v220, v220
ds_read_u16_d16_hi v221, v221
v_or_b32 v209, v210, v211
v_or_b32 v210, v212, v213
v_or_b32 v211, v214, v215
s_waitcnt lgkmcnt(4)
v_mfma_f32_16x16x32_bf16 v[184:187], v[240:243], v[148:151], 0
ds_read_b128 v[248:251], v14 offset:28672
v_exp_f32 v226, v226
v_lshlrev_b32_sdwa v222, v6, v222 dst_sel:DWORD dst_unused:UNUSED_PAD src0_sel:DWORD src1_sel:WORD_1
s_waitcnt lgkmcnt(3)
v_mfma_f32_16x16x32_bf16 v[184:187], v[244:247], v[152:155], v[184:187]
ds_read_b128 v[240:243], v2 offset:14336
ds_read_u16_d16 v222, v222
v_exp_f32 v227, v227
v_lshlrev_b32_sdwa v223, v6, v223 dst_sel:DWORD dst_unused:UNUSED_PAD src0_sel:DWORD src1_sel:WORD_1
s_waitcnt lgkmcnt(2)
v_mfma_f32_16x16x32_bf16 v[184:187], v[248:251], v[156:159], v[184:187]
ds_read_b128 v[244:247], v2 offset:15360
ds_read_u16_d16_hi v223, v223
v_add_f32 v226, 1.0, v226
v_add_f32 v227, 1.0, v227
s_waitcnt lgkmcnt(3)
v_mfma_f32_16x16x32_bf16 v[188:191], v[240:243], v[148:151], 0
ds_read_b128 v[248:251], v2 offset:16384
v_rcp_f32 v226, v226
v_rcp_f32 v227, v227
s_waitcnt lgkmcnt(2)
v_mfma_f32_16x16x32_bf16 v[188:191], v[244:247], v[152:155], v[188:191]
ds_read_b128 v[240:243], v3 offset:43008
v_mul_f32 v226, v216, v226
v_mul_f32 v227, v217, v227
v_cvt_pk_bf16_f32 v216, v226, v227
s_waitcnt lgkmcnt(1)
v_mfma_f32_16x16x32_bf16 v[188:191], v[248:251], v[156:159], v[188:191]
ds_read_b128 v[244:247], v3 offset:44032
v_or_b32 v217, v218, v219
v_or_b32 v218, v220, v221
v_or_b32 v219, v222, v223
s_waitcnt lgkmcnt(1)
v_mfma_f32_16x16x32_bf16 v[64:67], v[208:211], v[240:243], v[64:67]
ds_read_b128 v[248:251], v3 offset:45056
v_fmaak_f32 v224, v186, v186, 0x409d30fc
v_lshlrev_b32_sdwa v184, v6, v184 dst_sel:DWORD dst_unused:UNUSED_PAD src0_sel:DWORD src1_sel:WORD_1
v_mfma_f32_16x16x32_bf16 v[88:91], v[216:219], v[240:243], v[88:91]
ds_read_u16_d16 v184, v184
v_fmaak_f32 v225, v187, v187, 0x409d30fc
v_lshlrev_b32_sdwa v185, v6, v185 dst_sel:DWORD dst_unused:UNUSED_PAD src0_sel:DWORD src1_sel:WORD_1
s_waitcnt lgkmcnt(2)
v_mfma_f32_16x16x32_bf16 v[68:71], v[208:211], v[244:247], v[68:71]
ds_read_b128 v[240:243], v3 offset:46080
ds_read_u16_d16_hi v185, v185
v_mul_f32 v224, v186, v224
v_lshlrev_b32_sdwa v188, v6, v188 dst_sel:DWORD dst_unused:UNUSED_PAD src0_sel:DWORD src1_sel:WORD_1
v_mfma_f32_16x16x32_bf16 v[92:95], v[216:219], v[244:247], v[92:95]
ds_read_u16_d16 v188, v188
v_mul_f32 v225, v187, v225
v_lshlrev_b32_sdwa v189, v6, v189 dst_sel:DWORD dst_unused:UNUSED_PAD src0_sel:DWORD src1_sel:WORD_1
s_waitcnt lgkmcnt(4)
v_mfma_f32_16x16x32_bf16 v[72:75], v[208:211], v[248:251], v[72:75]
ds_read_b128 v[244:247], v3 offset:47104
ds_read_u16_d16_hi v189, v189
v_exp_f32 v224, v224
v_mfma_f32_16x16x32_bf16 v[96:99], v[216:219], v[248:251], v[96:99]
s_setprio 1
v_lshlrev_b32_sdwa v190, v6, v190 dst_sel:DWORD dst_unused:UNUSED_PAD src0_sel:DWORD src1_sel:WORD_1
s_waitcnt lgkmcnt(3)
v_mfma_f32_16x16x32_bf16 v[76:79], v[208:211], v[240:243], v[76:79]
ds_read_b128 v[248:251], v3 offset:48128
ds_read_u16_d16 v190, v190
v_exp_f32 v225, v225
v_lshlrev_b32_sdwa v191, v6, v191 dst_sel:DWORD dst_unused:UNUSED_PAD src0_sel:DWORD src1_sel:WORD_1
v_mfma_f32_16x16x32_bf16 v[100:103], v[216:219], v[240:243], v[100:103]
ds_read_u16_d16_hi v191, v191
v_add_f32 v224, 1.0, v224
v_add_f32 v225, 1.0, v225
s_waitcnt lgkmcnt(3)
v_mfma_f32_16x16x32_bf16 v[80:83], v[208:211], v[244:247], v[80:83]
ds_read_b128 v[240:243], v14 offset:35840
v_rcp_f32 v224, v224
v_mfma_f32_16x16x32_bf16 v[104:107], v[216:219], v[244:247], v[104:107]
v_rcp_f32 v225, v225
s_waitcnt lgkmcnt(3)
v_mfma_f32_16x16x32_bf16 v[84:87], v[208:211], v[248:251], v[84:87]
ds_read_b128 v[244:247], v14 offset:36864
v_mul_f32 v224, v186, v224
v_mfma_f32_16x16x32_bf16 v[108:111], v[216:219], v[248:251], v[108:111]
v_cvt_pk_bf16_f32 v176, v64, v68
v_cvt_pk_bf16_f32 v177, v72, v76
s_nop 2
v_cvt_pk_bf16_f32 v178, v80, v84
s_add_u32 s46, s53, 0
buffer_store_dwordx3 v[176:178], v5, s[12:15], s46 offen offset:0 nt
s_waitcnt lgkmcnt(1)
v_mfma_f32_16x16x32_bf16 v[216:219], v[240:243], v[148:151], 0
ds_read_b128 v[248:251], v14 offset:37888
v_mul_f32 v225, v187, v225
s_waitcnt lgkmcnt(1)
v_mfma_f32_16x16x32_bf16 v[216:219], v[244:247], v[152:155], v[216:219]
ds_read_b128 v[240:243], v2 offset:23552
v_or_b32 v184, v184, v185
v_cvt_pk_bf16_f32 v185, v224, v225
s_waitcnt lgkmcnt(1)
v_mfma_f32_16x16x32_bf16 v[216:219], v[248:251], v[156:159], v[216:219]
ds_read_b128 v[244:247], v2 offset:24576
v_cvt_pk_bf16_f32 v180, v65, v69
v_cvt_pk_bf16_f32 v181, v73, v77
v_cvt_pk_bf16_f32 v182, v81, v85
buffer_store_dwordx3 v[180:182], v5, s[12:15], s46 offen offset:768 nt
s_waitcnt lgkmcnt(1)
v_mfma_f32_16x16x32_bf16 v[220:223], v[240:243], v[148:151], 0
ds_read_b128 v[248:251], v2 offset:25600
v_or_b32 v186, v188, v189
s_waitcnt lgkmcnt(1)
v_mfma_f32_16x16x32_bf16 v[220:223], v[244:247], v[152:155], v[220:223]
ds_read_b128 v[240:243], v3 offset:49152
v_or_b32 v187, v190, v191
s_waitcnt lgkmcnt(1)
v_mfma_f32_16x16x32_bf16 v[220:223], v[248:251], v[156:159], v[220:223]
s_setprio 0
ds_read_b128 v[244:247], v3 offset:50176
v_cvt_pk_bf16_f32 v176, v66, v70
v_cvt_pk_bf16_f32 v177, v74, v78
v_cvt_pk_bf16_f32 v178, v82, v86
buffer_store_dwordx3 v[176:178], v5, s[12:15], s46 offen offset:1536 nt
s_waitcnt lgkmcnt(1)
v_mfma_f32_16x16x32_bf16 v[88:91], v[184:187], v[240:243], v[88:91]
ds_read_b128 v[248:251], v3 offset:51200
v_fmaak_f32 v226, v218, v218, 0x409d30fc
v_lshlrev_b32_sdwa v216, v6, v216 dst_sel:DWORD dst_unused:UNUSED_PAD src0_sel:DWORD src1_sel:WORD_1
v_fmaak_f32 v227, v219, v219, 0x409d30fc
v_lshlrev_b32_sdwa v217, v6, v217 dst_sel:DWORD dst_unused:UNUSED_PAD src0_sel:DWORD src1_sel:WORD_1
v_mul_f32 v226, v218, v226
s_waitcnt lgkmcnt(1)
v_mfma_f32_16x16x32_bf16 v[92:95], v[184:187], v[244:247], v[92:95]
ds_read_b128 v[240:243], v3 offset:52224
ds_read_u16_d16 v216, v216
ds_read_u16_d16_hi v217, v217
v_lshlrev_b32_sdwa v220, v6, v220 dst_sel:DWORD dst_unused:UNUSED_PAD src0_sel:DWORD src1_sel:WORD_1
v_mul_f32 v227, v219, v227
v_cvt_pk_bf16_f32 v180, v67, v71
v_cvt_pk_bf16_f32 v181, v75, v79
v_cvt_pk_bf16_f32 v182, v83, v87
buffer_store_dwordx3 v[180:182], v5, s[12:15], s46 offen offset:2304 nt
s_waitcnt lgkmcnt(3)
v_mfma_f32_16x16x32_bf16 v[96:99], v[184:187], v[248:251], v[96:99]
ds_read_b128 v[244:247], v3 offset:53248
ds_read_u16_d16 v220, v220
v_lshlrev_b32_sdwa v221, v6, v221 dst_sel:DWORD dst_unused:UNUSED_PAD src0_sel:DWORD src1_sel:WORD_1
v_exp_f32 v226, v226
v_lshlrev_b32_sdwa v222, v6, v222 dst_sel:DWORD dst_unused:UNUSED_PAD src0_sel:DWORD src1_sel:WORD_1
s_waitcnt lgkmcnt(2)
v_mfma_f32_16x16x32_bf16 v[100:103], v[184:187], v[240:243], v[100:103]
ds_read_b128 v[248:251], v3 offset:54272
ds_read_u16_d16_hi v221, v221
ds_read_u16_d16 v222, v222
v_exp_f32 v227, v227
v_lshlrev_b32_sdwa v223, v6, v223 dst_sel:DWORD dst_unused:UNUSED_PAD src0_sel:DWORD src1_sel:WORD_1
v_add_f32 v226, 1.0, v226
v_add_f32 v227, 1.0, v227
s_waitcnt lgkmcnt(4)
v_mfma_f32_16x16x32_bf16 v[104:107], v[184:187], v[244:247], v[104:107]
ds_read_u16_d16_hi v223, v223
v_rcp_f32 v226, v226
v_rcp_f32 v227, v227
v_mul_f32 v226, v218, v226
s_waitcnt lgkmcnt(3)
v_mfma_f32_16x16x32_bf16 v[108:111], v[184:187], v[248:251], v[108:111]
v_mul_f32 v227, v219, v227
v_or_b32 v216, v216, v217
v_cvt_pk_bf16_f32 v217, v226, v227
s_waitcnt lgkmcnt(1)
v_or_b32 v218, v220, v221
s_waitcnt lgkmcnt(0)
v_or_b32 v219, v222, v223
ds_read_b128 v[240:243], v3 offset:55296
s_waitcnt lgkmcnt(0)
v_mfma_f32_16x16x32_bf16 v[88:91], v[216:219], v[240:243], v[88:91]
ds_read_b128 v[244:247], v3 offset:56320
ds_read_b128 v[248:251], v3 offset:57344
s_waitcnt lgkmcnt(1)
v_mfma_f32_16x16x32_bf16 v[92:95], v[216:219], v[244:247], v[92:95]
ds_read_b128 v[240:243], v3 offset:58368
s_waitcnt lgkmcnt(1)
v_mfma_f32_16x16x32_bf16 v[96:99], v[216:219], v[248:251], v[96:99]
ds_read_b128 v[244:247], v3 offset:59392
s_waitcnt lgkmcnt(1)
v_mfma_f32_16x16x32_bf16 v[100:103], v[216:219], v[240:243], v[100:103]
ds_read_b128 v[248:251], v3 offset:60416
s_waitcnt lgkmcnt(1)
v_mfma_f32_16x16x32_bf16 v[104:107], v[216:219], v[244:247], v[104:107]
s_waitcnt lgkmcnt(0)
v_mfma_f32_16x16x32_bf16 v[108:111], v[216:219], v[248:251], v[108:111]
s_setprio 3
v_cvt_pk_bf16_f32 v184, v88, v92
s_nop 0
v_cvt_pk_bf16_f32 v185, v96, v100
s_nop 3
v_cvt_pk_bf16_f32 v186, v104, v108
s_add_u32 s47, s53, 98304
buffer_store_dwordx3 v[184:186], v5, s[12:15], s47 offen offset:0 nt
v_cvt_pk_bf16_f32 v188, v89, v93
v_cvt_pk_bf16_f32 v189, v97, v101
v_cvt_pk_bf16_f32 v190, v105, v109
buffer_store_dwordx3 v[188:190], v5, s[12:15], s47 offen offset:768 nt
v_cvt_pk_bf16_f32 v184, v90, v94
v_cvt_pk_bf16_f32 v185, v98, v102
v_cvt_pk_bf16_f32 v186, v106, v110
buffer_store_dwordx3 v[184:186], v5, s[12:15], s47 offen offset:1536 nt
v_cvt_pk_bf16_f32 v188, v91, v95
v_cvt_pk_bf16_f32 v189, v99, v103
v_cvt_pk_bf16_f32 v190, v107, v111
buffer_store_dwordx3 v[188:190], v5, s[12:15], s47 offen offset:2304 nt
s_setprio 0
L_end:
s_endpgm
L_exact:
v_mov_b32 v232, 0
s_mov_b32 s44, 0x7fff7fff
v_and_b32 v233, s44, v16
v_pk_max_u16 v232, v232, v233
v_and_b32 v233, s44, v17
v_pk_max_u16 v232, v232, v233
v_and_b32 v233, s44, v18
v_pk_max_u16 v232, v232, v233
v_and_b32 v233, s44, v20
v_pk_max_u16 v232, v232, v233
v_and_b32 v233, s44, v21
v_pk_max_u16 v232, v232, v233
v_and_b32 v233, s44, v22
v_pk_max_u16 v232, v232, v233
v_and_b32 v233, s44, v24
v_pk_max_u16 v232, v232, v233
v_and_b32 v233, s44, v25
v_pk_max_u16 v232, v232, v233
v_and_b32 v233, s44, v26
v_pk_max_u16 v232, v232, v233
v_and_b32 v233, s44, v28
v_pk_max_u16 v232, v232, v233
v_and_b32 v233, s44, v29
v_pk_max_u16 v232, v232, v233
v_and_b32 v233, s44, v30
v_pk_max_u16 v232, v232, v233
v_and_b32 v233, s44, v32
v_pk_max_u16 v232, v232, v233
v_and_b32 v233, s44, v33
v_pk_max_u16 v232, v232, v233
v_and_b32 v233, s44, v34
v_pk_max_u16 v232, v232, v233
v_and_b32 v233, s44, v36
v_pk_max_u16 v232, v232, v233
v_and_b32 v233, s44, v37
v_pk_max_u16 v232, v232, v233
v_and_b32 v233, s44, v38
v_pk_max_u16 v232, v232, v233
v_and_b32 v233, s44, v136
v_pk_max_u16 v232, v232, v233
v_and_b32 v233, s44, v137
v_pk_max_u16 v232, v232, v233
v_and_b32 v233, s44, v138
v_pk_max_u16 v232, v232, v233
v_and_b32 v233, s44, v140
v_pk_max_u16 v232, v232, v233
v_and_b32 v233, s44, v141
v_pk_max_u16 v232, v232, v233
v_and_b32 v233, s44, v142
v_pk_max_u16 v232, v232, v233
v_and_b32 v233, s44, v144
v_pk_max_u16 v232, v232, v233
v_and_b32 v233, s44, v145
v_pk_max_u16 v232, v232, v233
v_and_b32 v233, s44, v146
v_pk_max_u16 v232, v232, v233
v_and_b32 v233, s44, v148
v_pk_max_u16 v232, v232, v233
v_and_b32 v233, s44, v149
v_pk_max_u16 v232, v232, v233
v_and_b32 v233, s44, v150
v_pk_max_u16 v232, v232, v233
v_and_b32 v233, s44, v152
v_pk_max_u16 v232, v232, v233
v_and_b32 v233, s44, v153
v_pk_max_u16 v232, v232, v233
v_and_b32 v233, s44, v154
v_pk_max_u16 v232, v232, v233
v_and_b32 v233, s44, v156
v_pk_max_u16 v232, v232, v233
v_and_b32 v233, s44, v157
v_pk_max_u16 v232, v232, v233
v_and_b32 v233, s44, v158
v_pk_max_u16 v232, v232, v233
v_lshrrev_b32 v233, 16, v232
v_and_b32 v232, 0xffff, v232
v_max_u32 v232, v232, v233
s_nop 1
v_max_u32_dpp v232, v232, v232 row_shr:1 row_mask:0xf bank_mask:0xf
s_nop 1
v_max_u32_dpp v232, v232, v232 row_shr:2 row_mask:0xf bank_mask:0xf
s_nop 1
v_max_u32_dpp v232, v232, v232 row_shr:4 row_mask:0xf bank_mask:0xf
s_nop 1
v_max_u32_dpp v232, v232, v232 row_shr:8 row_mask:0xf bank_mask:0xf
s_nop 1
v_max_u32_dpp v232, v232, v232 row_bcast:15 row_mask:0xa bank_mask:0xf
s_nop 1
v_max_u32_dpp v232, v232, v232 row_bcast:31 row_mask:0xc bank_mask:0xf
s_nop 0
v_readlane_b32 s44, v232, 63
s_lshl_b32 s45, s32, 2
s_add_u32 s45, s45, 158784
s_nop 2
v_mov_b32 v232, s44
v_mov_b32 v233, s45
ds_write_b32 v233, v232
s_waitcnt lgkmcnt(0)
s_barrier
v_mov_b32 v233, 158784
ds_read_b128 v[236:239], v233
ds_read_b128 v[240:243], v233 offset:16
s_waitcnt lgkmcnt(1)
v_max_u32 v236, v236, v237
v_max3_u32 v236, v236, v238, v239
s_waitcnt lgkmcnt(0)
v_max3_u32 v236, v236, v240, v241
v_max3_u32 v236, v236, v242, v243
s_nop 0
v_readfirstlane_b32 s44, v236
s_nop 3
s_lshr_b32 s44, s44, 7
s_max_u32 s44, s44, 23
s_sub_u32 s35, s44, 23
s_mov_b32 s43, 16384
v_lshlrev_b32 v209, 19, v0
v_or_b32 v209, 0x8000, v209
v_lshlrev_b32 v208, 4, v0
v_add_u32 v210, 0x10000, v208
v_add_u32 v212, 0x0, v209
v_add_u32 v213, 0x10000, v209
v_add_u32 v214, 0x20000, v209
v_add_u32 v215, 0x30000, v209
v_ldexp_f32 v212, v212, s35
v_ldexp_f32 v213, v213, s35
v_ldexp_f32 v214, v214, s35
v_ldexp_f32 v215, v215, s35
v_fmaak_f32 v216, v212, v212, 0x409d30fc
v_fmaak_f32 v217, v213, v213, 0x409d30fc
v_fmaak_f32 v218, v214, v214, 0x409d30fc
v_fmaak_f32 v219, v215, v215, 0x409d30fc
v_mul_f32 v216, v212, v216
v_mul_f32 v217, v213, v217
v_mul_f32 v218, v214, v218
v_mul_f32 v219, v215, v219
v_exp_f32 v216, v216
v_exp_f32 v217, v217
v_exp_f32 v218, v218
v_exp_f32 v219, v219
v_add_f32 v216, 1.0, v216
v_add_f32 v217, 1.0, v217
v_add_f32 v218, 1.0, v218
v_add_f32 v219, 1.0, v219
v_rcp_f32 v216, v216
v_rcp_f32 v217, v217
v_rcp_f32 v218, v218
v_rcp_f32 v219, v219
v_mul_f32 v216, v212, v216
v_mul_f32 v217, v213, v217
v_mul_f32 v218, v214, v218
v_mul_f32 v219, v215, v219
v_sub_f32 v212, v216, v212
v_sub_f32 v213, v217, v213
v_sub_f32 v214, v218, v214
v_sub_f32 v215, v219, v215
v_cvt_pk_bf16_f32 v228, v216, v217
v_cvt_pk_bf16_f32 v229, v218, v219
v_cvt_pk_bf16_f32 v232, v212, v213
v_cvt_pk_bf16_f32 v233, v214, v215
v_mul_f32 v212, v212, v212
v_mul_f32 v213, v213, v213
v_mul_f32 v214, v214, v214
v_mul_f32 v215, v215, v215
v_mul_f32 v216, v216, v216
v_mul_f32 v217, v217, v217
v_mul_f32 v218, v218, v218
v_mul_f32 v219, v219, v219
v_cvt_pk_bf16_f32 v220, v216, v217
v_cvt_pk_bf16_f32 v221, v218, v219
v_cvt_pk_bf16_f32 v224, v212, v213
v_cvt_pk_bf16_f32 v225, v214, v215
v_add_u32 v212, 0x40000, v209
v_add_u32 v213, 0x50000, v209
v_add_u32 v214, 0x60000, v209
v_add_u32 v215, 0x70000, v209
v_ldexp_f32 v212, v212, s35
v_ldexp_f32 v213, v213, s35
v_ldexp_f32 v214, v214, s35
v_ldexp_f32 v215, v215, s35
v_fmaak_f32 v216, v212, v212, 0x409d30fc
v_fmaak_f32 v217, v213, v213, 0x409d30fc
v_fmaak_f32 v218, v214, v214, 0x409d30fc
v_fmaak_f32 v219, v215, v215, 0x409d30fc
v_mul_f32 v216, v212, v216
v_mul_f32 v217, v213, v217
v_mul_f32 v218, v214, v218
v_mul_f32 v219, v215, v219
v_exp_f32 v216, v216
v_exp_f32 v217, v217
v_exp_f32 v218, v218
v_exp_f32 v219, v219
v_add_f32 v216, 1.0, v216
v_add_f32 v217, 1.0, v217
v_add_f32 v218, 1.0, v218
v_add_f32 v219, 1.0, v219
v_rcp_f32 v216, v216
v_rcp_f32 v217, v217
v_rcp_f32 v218, v218
v_rcp_f32 v219, v219
v_mul_f32 v216, v212, v216
v_mul_f32 v217, v213, v217
v_mul_f32 v218, v214, v218
v_mul_f32 v219, v215, v219
v_sub_f32 v212, v216, v212
v_sub_f32 v213, v217, v213
v_sub_f32 v214, v218, v214
v_sub_f32 v215, v219, v215
v_cvt_pk_bf16_f32 v230, v216, v217
v_cvt_pk_bf16_f32 v231, v218, v219
v_cvt_pk_bf16_f32 v234, v212, v213
v_cvt_pk_bf16_f32 v235, v214, v215
v_mul_f32 v212, v212, v212
v_mul_f32 v213, v213, v213
v_mul_f32 v214, v214, v214
v_mul_f32 v215, v215, v215
v_mul_f32 v216, v216, v216
v_mul_f32 v217, v217, v217
v_mul_f32 v218, v218, v218
v_mul_f32 v219, v219, v219
v_cvt_pk_bf16_f32 v222, v216, v217
v_cvt_pk_bf16_f32 v223, v218, v219
v_cvt_pk_bf16_f32 v226, v212, v213
v_cvt_pk_bf16_f32 v227, v214, v215
ds_write_b128 v208, v[220:223]
ds_write_b128 v210, v[224:227]
v_lshlrev_b32 v208, 4, v0
s_add_u32 s46, s43, 50360320
buffer_store_dwordx4 v[228:231], v208, s[8:11], s46 offen
s_add_u32 s46, s43, 50368512
buffer_store_dwordx4 v[232:235], v208, s[8:11], s46 offen
s_waitcnt vmcnt(0)
s_mul_i32 s36, s35, 0x800080
s_mov_b32 s50, 0x07060302
s_mov_b32 s51, 0x05040100
v_mov_b32 v236, 0x7fff7fff
s_mul_i32 s44, s32, 3
s_add_u32 s44, s44, 0
s_lshr_b32 s45, s44, 3
s_bfe_u32 s46, s44, 0x20001
s_mul_i32 s49, s46, 6
s_lshr_b32 s49, 0xa6db6d, s49
s_mul_i32 s47, s46, 18
s_add_u32 s45, s45, s47
s_cmp_ge_u32 s45, 56
s_cselect_b32 s47, 16, 8
s_cmp_ge_u32 s45, 53
s_cselect_b32 s48, 16, 8
s_and_b32 s44, s44, 1
s_lshl_b32 s44, s44, 3
s_add_u32 s47, s47, s45
s_lshl_b32 s47, s47, 10
s_add_u32 s47, s47, s44
v_add_u32 v238, s47, v2
s_add_u32 s48, s48, s45
s_lshl_b32 s48, s48, 10
s_add_u32 s48, s48, s44
v_add_u32 v239, s48, v2
v_perm_b32 v232, v20, v16, s51
v_perm_b32 v233, v28, v24, s51
v_and_b32 v234, v236, v232
v_and_b32 v235, v236, v233
v_pk_sub_u16 v234, v234, s36 clamp
v_pk_sub_u16 v235, v235, s36 clamp
v_bitop3_b32 v232, v234, v232, v236 bitop3:0xf4
v_bitop3_b32 v233, v235, v233, v236 bitop3:0xf4
ds_write_b64 v238, v[232:233] offset:0
v_perm_b32 v232, v20, v16, s50
v_perm_b32 v233, v28, v24, s50
ds_write_b64 v239, v[232:233] offset:3072
s_bitcmp1_b32 s49, 2
s_cselect_b32 s48, s36, 0
v_perm_b32 v232, v21, v17, s51
v_perm_b32 v233, v29, v25, s51
v_and_b32 v234, v236, v232
v_and_b32 v235, v236, v233
v_pk_sub_u16 v234, v234, s48 clamp
v_pk_sub_u16 v235, v235, s48 clamp
v_bitop3_b32 v232, v234, v232, v236 bitop3:0xf4
v_bitop3_b32 v233, v235, v233, v236 bitop3:0xf4
ds_write_b64 v239, v[232:233] offset:6144
v_perm_b32 v232, v21, v17, s50
v_perm_b32 v233, v29, v25, s50
v_and_b32 v234, v236, v232
v_and_b32 v235, v236, v233
v_pk_sub_u16 v234, v234, s36 clamp
v_pk_sub_u16 v235, v235, s36 clamp
v_bitop3_b32 v232, v234, v232, v236 bitop3:0xf4
v_bitop3_b32 v233, v235, v233, v236 bitop3:0xf4
ds_write_b64 v239, v[232:233] offset:9216
v_perm_b32 v232, v22, v18, s51
v_perm_b32 v233, v30, v26, s51
ds_write_b64 v239, v[232:233] offset:12288
v_perm_b32 v232, v22, v18, s50
v_perm_b32 v233, v30, v26, s50
v_and_b32 v234, v236, v232
v_and_b32 v235, v236, v233
v_pk_sub_u16 v234, v234, s36 clamp
v_pk_sub_u16 v235, v235, s36 clamp
v_bitop3_b32 v232, v234, v232, v236 bitop3:0xf4
v_bitop3_b32 v233, v235, v233, v236 bitop3:0xf4
ds_write_b64 v239, v[232:233] offset:15360
s_mul_i32 s44, s32, 3
s_add_u32 s44, s44, 1
s_lshr_b32 s45, s44, 3
s_bfe_u32 s46, s44, 0x20001
s_mul_i32 s49, s46, 6
s_lshr_b32 s49, 0xa6db6d, s49
s_mul_i32 s47, s46, 18
s_add_u32 s45, s45, s47
s_cmp_ge_u32 s45, 56
s_cselect_b32 s47, 16, 8
s_cmp_ge_u32 s45, 53
s_cselect_b32 s48, 16, 8
s_and_b32 s44, s44, 1
s_lshl_b32 s44, s44, 3
s_add_u32 s47, s47, s45
s_lshl_b32 s47, s47, 10
s_add_u32 s47, s47, s44
v_add_u32 v238, s47, v2
s_add_u32 s48, s48, s45
s_lshl_b32 s48, s48, 10
s_add_u32 s48, s48, s44
v_add_u32 v239, s48, v2
v_perm_b32 v232, v36, v32, s51
v_perm_b32 v233, v140, v136, s51
v_and_b32 v234, v236, v232
v_and_b32 v235, v236, v233
v_pk_sub_u16 v234, v234, s36 clamp
v_pk_sub_u16 v235, v235, s36 clamp
v_bitop3_b32 v232, v234, v232, v236 bitop3:0xf4
v_bitop3_b32 v233, v235, v233, v236 bitop3:0xf4
ds_write_b64 v238, v[232:233] offset:0
v_perm_b32 v232, v36, v32, s50
v_perm_b32 v233, v140, v136, s50
ds_write_b64 v239, v[232:233] offset:3072
s_bitcmp1_b32 s49, 2
s_cselect_b32 s48, s36, 0
v_perm_b32 v232, v37, v33, s51
v_perm_b32 v233, v141, v137, s51
v_and_b32 v234, v236, v232
v_and_b32 v235, v236, v233
v_pk_sub_u16 v234, v234, s48 clamp
v_pk_sub_u16 v235, v235, s48 clamp
v_bitop3_b32 v232, v234, v232, v236 bitop3:0xf4
v_bitop3_b32 v233, v235, v233, v236 bitop3:0xf4
ds_write_b64 v239, v[232:233] offset:6144
v_perm_b32 v232, v37, v33, s50
v_perm_b32 v233, v141, v137, s50
v_and_b32 v234, v236, v232
v_and_b32 v235, v236, v233
v_pk_sub_u16 v234, v234, s36 clamp
v_pk_sub_u16 v235, v235, s36 clamp
v_bitop3_b32 v232, v234, v232, v236 bitop3:0xf4
v_bitop3_b32 v233, v235, v233, v236 bitop3:0xf4
ds_write_b64 v239, v[232:233] offset:9216
v_perm_b32 v232, v38, v34, s51
v_perm_b32 v233, v142, v138, s51
ds_write_b64 v239, v[232:233] offset:12288
v_perm_b32 v232, v38, v34, s50
v_perm_b32 v233, v142, v138, s50
v_and_b32 v234, v236, v232
v_and_b32 v235, v236, v233
v_pk_sub_u16 v234, v234, s36 clamp
v_pk_sub_u16 v235, v235, s36 clamp
v_bitop3_b32 v232, v234, v232, v236 bitop3:0xf4
v_bitop3_b32 v233, v235, v233, v236 bitop3:0xf4
ds_write_b64 v239, v[232:233] offset:15360
s_mul_i32 s44, s32, 3
s_add_u32 s44, s44, 2
s_lshr_b32 s45, s44, 3
s_bfe_u32 s46, s44, 0x20001
s_mul_i32 s49, s46, 6
s_lshr_b32 s49, 0xa6db6d, s49
s_mul_i32 s47, s46, 18
s_add_u32 s45, s45, s47
s_cmp_ge_u32 s45, 56
s_cselect_b32 s47, 16, 8
s_cmp_ge_u32 s45, 53
s_cselect_b32 s48, 16, 8
s_and_b32 s44, s44, 1
s_lshl_b32 s44, s44, 3
s_add_u32 s47, s47, s45
s_lshl_b32 s47, s47, 10
s_add_u32 s47, s47, s44
v_add_u32 v238, s47, v2
s_add_u32 s48, s48, s45
s_lshl_b32 s48, s48, 10
s_add_u32 s48, s48, s44
v_add_u32 v239, s48, v2
v_perm_b32 v232, v148, v144, s51
v_perm_b32 v233, v156, v152, s51
v_and_b32 v234, v236, v232
v_and_b32 v235, v236, v233
v_pk_sub_u16 v234, v234, s36 clamp
v_pk_sub_u16 v235, v235, s36 clamp
v_bitop3_b32 v232, v234, v232, v236 bitop3:0xf4
v_bitop3_b32 v233, v235, v233, v236 bitop3:0xf4
ds_write_b64 v238, v[232:233] offset:0
v_perm_b32 v232, v148, v144, s50
v_perm_b32 v233, v156, v152, s50
ds_write_b64 v239, v[232:233] offset:3072
s_bitcmp1_b32 s49, 2
s_cselect_b32 s48, s36, 0
v_perm_b32 v232, v149, v145, s51
v_perm_b32 v233, v157, v153, s51
v_and_b32 v234, v236, v232
v_and_b32 v235, v236, v233
v_pk_sub_u16 v234, v234, s48 clamp
v_pk_sub_u16 v235, v235, s48 clamp
v_bitop3_b32 v232, v234, v232, v236 bitop3:0xf4
v_bitop3_b32 v233, v235, v233, v236 bitop3:0xf4
ds_write_b64 v239, v[232:233] offset:6144
v_perm_b32 v232, v149, v145, s50
v_perm_b32 v233, v157, v153, s50
v_and_b32 v234, v236, v232
v_and_b32 v235, v236, v233
v_pk_sub_u16 v234, v234, s36 clamp
v_pk_sub_u16 v235, v235, s36 clamp
v_bitop3_b32 v232, v234, v232, v236 bitop3:0xf4
v_bitop3_b32 v233, v235, v233, v236 bitop3:0xf4
ds_write_b64 v239, v[232:233] offset:9216
v_perm_b32 v232, v150, v146, s51
v_perm_b32 v233, v158, v154, s51
ds_write_b64 v239, v[232:233] offset:12288
v_perm_b32 v232, v150, v146, s50
v_perm_b32 v233, v158, v154, s50
v_and_b32 v234, v236, v232
v_and_b32 v235, v236, v233
v_pk_sub_u16 v234, v234, s36 clamp
v_pk_sub_u16 v235, v235, s36 clamp
v_bitop3_b32 v232, v234, v232, v236 bitop3:0xf4
v_bitop3_b32 v233, v235, v233, v236 bitop3:0xf4
ds_write_b64 v239, v[232:233] offset:15360
s_waitcnt lgkmcnt(0)
s_barrier
s_branch L_go
.section .rodata,"a"
.p2align 6
.amdhsa_kernel standalone__modern_conv_block_slak__vision_kernel
  .amdhsa_next_free_vgpr 256
  .amdhsa_next_free_sgpr 102
  .amdhsa_accum_offset 256
  .amdhsa_group_segment_fixed_size 0
  .amdhsa_kernarg_size 72
  .amdhsa_user_sgpr_count 2
  .amdhsa_user_sgpr_kernarg_segment_ptr 1
  .amdhsa_system_sgpr_workgroup_id_x 1
  .amdhsa_float_denorm_mode_32 3
.end_amdhsa_kernel
.text
```
